```python
import torch

def _softmax(x, axis=-1):
    return torch.softmax(x, dim=axis)
def _gelu(x):
    return torch.nn.functional.gelu(x, approximate="tanh")
def _silu(x):
    return torch.nn.functional.silu(x)
def _sigmoid(x):
    return torch.sigmoid(x)
def _layernorm(x, axis=-1, eps=1e-5):
    m = x.mean(dim=axis, keepdim=True)
    v = x.var(dim=axis, keepdim=True, unbiased=False)
    return (x - m) / torch.sqrt(v + eps)
def _scatter_add(tgt, idx, src, axis=0):
    return tgt.clone().index_add_(axis, idx, src)
def _segment_sum(src, seg, n):
    out = torch.zeros((n,) + src.shape[1:], dtype=src.dtype)
    return out.index_add_(0, seg, src)
def _pad(x, pw):
    flat = tuple(v for pair in reversed(pw) for v in pair)
    return torch.nn.functional.pad(x, flat)

kernel_name = 'standalone__gqa_block_cached__near_ridge'

def setup_inputs():

    _w = (lambda a: (lambda t: t.to(torch.bfloat16) if t.is_floating_point() else t)(torch.as_tensor(a)))
    B, Sq, D = 16, 80, 576
    Hq, Hkv, Sk, Dh = 32, 16, 512, 128
    assert Hq % Hkv == 0, (Hq, Hkv)
    return {
        "x": _w((lambda *s: torch.randn(*s, dtype=torch.bfloat16) * 0.8)(B, Sq, D)),
        "k_cache": _w((lambda *s: torch.randn(*s, dtype=torch.bfloat16) * 0.8)(B, Hkv, Sk, Dh)),
        "v_cache": _w((lambda *s: torch.randn(*s, dtype=torch.bfloat16) * 0.05)(B, Hkv, Sk, Dh)),
        "wq": _w((lambda *s: torch.randn(*s, dtype=torch.bfloat16) * 0.8)(D, Hq * Dh) * (D ** -0.5)),
        "wo": _w((lambda *s: torch.randn(*s, dtype=torch.bfloat16) * 0.05)(Hq * Dh, D) * ((Hq * Dh) ** -0.5)),
    }

def reference(x, k_cache, v_cache, wq, wo):
    B, Sq, D = x.shape
    Hq, Dh = 32, 128
    Hkv = k_cache.shape[1]
    rep = Hq // Hkv
    q = (lambda x, *d: x.permute(*d))((x @ wq).reshape(B, Sq, Hq, Dh), 0, 2, 1, 3)
    k = (lambda x, n, axis: torch.repeat_interleave(x, n, dim=axis))(k_cache, rep, axis=1)
    v = (lambda x, n, axis: torch.repeat_interleave(x, n, dim=axis))(v_cache, rep, axis=1)
    scores = torch.einsum("bhqd,bhkd->bhqk", q, k) * (Dh ** -0.5)
    p = _softmax(scores, axis=-1)
    o = torch.einsum("bhqk,bhkd->bhqd", p, v)
    return (lambda x, *d: x.permute(*d))(o, 0, 2, 1, 3).reshape(B, Sq, Hq * Dh) @ wo
```

```asm
; @launch grid=(256,1,1) block=(256,1,1) lds=163840
.amdgcn_target "amdgcn-amd-amdhsa--gfx950"
.text
.globl standalone__gqa_block_cached__near_ridge_kernel
.p2align 8
.type standalone__gqa_block_cached__near_ridge_kernel,@function
standalone__gqa_block_cached__near_ridge_kernel:
    s_load_dwordx16 s[4:19], s[0:1], 0
    s_cmp_ge_u32 s2, 256
    s_cbranch_scc1 standalone__gqa_block_cached__near_ridge_end
    v_lshrrev_b32 v1, 6, v0
    v_and_b32 v2, 63, v0
    v_readfirstlane_b32 s48, v1
    s_and_b32 s52, s2, 3
    s_bfe_u32 s51, s2, 0x20003
    s_lshr_b32 s53, s2, 5
    s_bfe_u32 s57, s2, 0x10002
    s_lshl_b32 s57, s57, 3
    s_add_u32 s53, s53, s57
    s_lshl_b32 s54, s52, 2
    s_add_u32 s54, s54, s51
    s_lshr_b32 s49, s48, 1
    s_and_b32 s50, s48, 1
    s_lshl_b32 s55, s48, 12
    s_bitcmp1_b32 s51, 0
    s_cbranch_scc1 standalone__gqa_block_cached__near_ridge_pb0
standalone__gqa_block_cached__near_ridge_pa0:
    s_mul_i32 s56, s48, 2560
    s_add_u32 s56, s56, 94208
    v_lshrrev_b32 v55, 4, v2
    v_and_b32 v56, 15, v2
    v_lshlrev_b32 v57, 1, v55
    v_xor_b32 v57, v56, v57
    v_lshlrev_b32 v57, 4, v57
    v_lshl_add_u32 v4, v55, 13, v57
    v_xor_b32 v6, 128, v4
    v_add_u32 v5, 31744, v4
    v_add_u32 v7, 95232, v6
    v_add_u32 v6, 63488, v6
    v_lshrrev_b32 v55, 3, v2
    v_and_b32 v56, 7, v2
    s_mul_i32 s57, s48, 20
    v_add_u32 v57, s57, v55
    v_bfe_u32 v58, v57, 1, 3
    v_xor_b32 v58, v56, v58
    v_mul_u32_u24 v57, 1152, v57
    v_lshl_add_u32 v8, v58, 4, v57
    v_xor_b32 v9, 64, v8
    v_add_u32 v9, 8192, v9
    v_add_u32 v10, 16384, v8
    s_waitcnt lgkmcnt(0)
    s_mul_i32 s57, s53, 92160
    s_add_u32 s20, s4, s57
    s_addc_u32 s21, s5, 0
    s_mov_b32 s22, 92160
    s_mov_b32 s23, 0x20000
    s_lshl_b32 s57, s54, 9
    s_lshl_b32 s59, s49, 8
    s_add_u32 s57, s57, s59
    s_lshl_b32 s59, s50, 17
    s_add_u32 s57, s57, s59
    s_sub_u32 s59, 4718592, s57
    s_add_u32 s32, s10, s57
    s_addc_u32 s33, s11, 0
    s_mov_b32 s34, s59
    s_mov_b32 s35, 0x20000
    s_add_u32 m0, s56, 10240
    s_mov_b32 s57, 0
    buffer_load_dwordx4 v8, s[20:23], s57 offen offset:0 lds
    buffer_load_dwordx4 v9, s[20:23], s57 offen offset:1024 lds
    s_mov_b32 exec_hi, 0
    buffer_load_dwordx4 v10, s[20:23], s57 offen offset:2048 lds
    s_mov_b32 exec_hi, -1
    s_add_u32 m0, s55, 114688
    s_mov_b32 s58, 0
    buffer_load_dwordx4 v4, s[32:35], s58 offen offset:0 lds
    buffer_load_dwordx4 v5, s[32:35], s58 offen offset:1024 lds
    buffer_load_dwordx4 v6, s[32:35], s58 offen offset:2048 lds
    buffer_load_dwordx4 v7, s[32:35], s58 offen offset:3072 lds
    s_add_u32 m0, s55, 131072
    s_mov_b32 s58, 262144
    buffer_load_dwordx4 v4, s[32:35], s58 offen offset:0 lds
    buffer_load_dwordx4 v5, s[32:35], s58 offen offset:1024 lds
    buffer_load_dwordx4 v6, s[32:35], s58 offen offset:2048 lds
    buffer_load_dwordx4 v7, s[32:35], s58 offen offset:3072 lds
    v_lshrrev_b32 v55, 4, v2
    v_and_b32 v56, 15, v2
    v_lshlrev_b32 v57, 1, v55
    v_xor_b32 v57, v56, v57
    v_lshlrev_b32 v57, 4, v57
    v_lshl_add_u32 v15, v55, 8, v57
    v_xor_b32 v16, 128, v15
    v_xor_b32 v57, v56, v55
    v_lshlrev_b32 v57, 4, v57
    v_lshl_add_u32 v11, v55, 8, v57
    v_xor_b32 v12, 64, v11
    v_xor_b32 v13, 128, v11
    v_xor_b32 v14, 192, v11
    s_lshl_b32 s58, s53, 4
    s_add_u32 s58, s58, s54
    s_lshl_b32 s58, s58, 17
    s_add_u32 s24, s6, s58
    s_addc_u32 s25, s7, 0
    s_mov_b32 s26, 131072
    s_mov_b32 s27, 0x20000
    s_add_u32 s28, s8, s58
    s_addc_u32 s29, s9, 0
    s_mov_b32 s30, 131072
    s_mov_b32 s31, 0x20000
    s_mov_b32 s40, s18
    s_mov_b32 s41, s19
    s_mov_b32 s42, 134217728
    s_mov_b32 s43, 0x20000
    s_branch standalone__gqa_block_cached__near_ridge_pa
standalone__gqa_block_cached__near_ridge_pb0:
    s_getpc_b64 s[62:63]
standalone__gqa_block_cached__near_ridge_pc:
    s_sub_u32 s62, s62, standalone__gqa_block_cached__near_ridge_pc-standalone__gqa_block_cached__near_ridge_kernel
    s_subb_u32 s63, s63, 0
    s_lshr_b32 s57, s2, 4
    v_lshl_add_u32 v1, v0, 4, s57
    v_lshlrev_b32 v1, 7, v1
    v_min_u32 v1, standalone__gqa_block_cached__near_ridge_hot-standalone__gqa_block_cached__near_ridge_kernel-4, v1
    s_cmp_lg_u32 s48, 0
    s_cbranch_scc1 standalone__gqa_block_cached__near_ridge_nc
    global_load_dword v255, v1, s[62:63]
standalone__gqa_block_cached__near_ridge_nc:
    s_cmp_eq_u32 s54, 1
    s_cselect_b32 s65, 0, 2147418112
    v_lshrrev_b32 v64, 2, v0
    v_add_u32 v64, 12, v64
    v_and_b32 v65, 3, v0
    v_lshl_add_u32 v64, v64, 3, v65
    v_lshlrev_b32 v65, 3, v0
    v_min_u32 v64, v64, v65
    v_lshrrev_b32 v69, 5, v0
    v_lshlrev_b32 v69, 27, v69
    v_lshl_add_u32 v69, v64, 8, v69
    v_or_b32 v69, s65, v69
    v_mov_b32 v64, 0
    v_mov_b32 v65, 0
    v_mov_b32 v66, 0
    v_mov_b32 v67, 0
    s_mul_i32 s59, s53, 1310720
    s_add_u32 s59, s59, 1069056
    s_movk_i32 s56, 224
    v_lshlrev_b32 v72, 7, v0
    v_cmp_gt_u32 vcc, 180, v0
    v_mov_b32 v56, 2147418112
    s_lshr_b32 s57, s51, 1
    s_mul_i32 s57, s57, 46080
    v_cndmask_b32 v72, v56, v72, vcc
    s_mul_i32 s58, s53, 92160
    s_add_u32 s57, s57, s58
    v_lshrrev_b32 v73, 2, v0
    v_and_b32 v56, 3, v0
    s_and_b32 s58, s53, 7
    v_lshl_add_u32 v73, v73, 3, s58
    v_lshlrev_b32 v73, 13, v73
    v_lshl_add_u32 v73, v56, 7, v73
    v_mul_u32_u24 v74, 21846, v0
    v_lshrrev_b32 v74, 16, v74
    v_mul_u32_u24 v74, 768, v74
    v_lshl_add_u32 v74, v0, 7, v74
    v_subrev_u32 v75, 2097152, v73
    v_cmp_gt_u32 vcc, 128, v0
    v_cmp_gt_u32 s[60:61], s56, v0
    v_mov_b32 v56, 2147418112
    v_cndmask_b32 v74, v75, v74, vcc
    s_xor_b32 s58, s54, 1
    s_lshl_b32 s58, s58, 9
    v_cndmask_b32 v74, v56, v74, s[60:61]
    s_waitcnt lgkmcnt(0)
    s_mov_b32 s40, s18
    s_mov_b32 s41, s19
    s_mov_b32 s42, 134217728
    s_mov_b32 s43, 0x20000
    buffer_store_dwordx4 v[64:67], v69, s[40:43], s59 offen offset:0 sc1
    buffer_store_dwordx4 v[64:67], v69, s[40:43], s59 offen offset:1024 sc1
    s_add_u32 s44, s4, s57
    s_addc_u32 s45, s5, 0
    s_mov_b32 s46, 46080
    s_mov_b32 s47, 0x20000
    s_mov_b32 s36, s10
    s_mov_b32 s37, s11
    s_mov_b32 s38, 4718592
    s_mov_b32 s39, 0x20000
    s_cmp_lt_u32 s48, 2
    s_cselect_b32 s20, s44, s36
    s_cselect_b32 s21, s45, s37
    s_cselect_b32 s22, s46, s38
    s_cselect_b32 s58, 0, s58
    s_cselect_b32 s57, 1, 4096
    s_mov_b32 s23, 0x20000
    s_mul_i32 s57, s57, 384
    buffer_load_dword v255, v74, s[20:23], s58 offen
    s_add_u32 s58, s58, s57
    buffer_load_dword v255, v74, s[20:23], s58 offen
    s_add_u32 s58, s58, s57
    buffer_load_dword v255, v74, s[20:23], s58 offen
    s_add_u32 s58, s58, s57
    s_xor_b32 s57, s54, 0
    s_lshl_b32 s57, s57, 9
    buffer_load_dword v255, v73, s[36:39], s57 offen
    s_add_u32 s57, s57, 4194304
    buffer_load_dword v255, v73, s[36:39], s57 offen
    v_lshrrev_b32 v55, 4, v2
    v_and_b32 v56, 15, v2
    v_lshlrev_b32 v57, 1, v55
    v_xor_b32 v57, v56, v57
    v_lshlrev_b32 v57, 4, v57
    v_lshl_add_u32 v15, v55, 8, v57
    v_xor_b32 v16, 128, v15
    v_xor_b32 v57, v56, v55
    v_lshlrev_b32 v57, 4, v57
    v_lshl_add_u32 v11, v55, 8, v57
    v_xor_b32 v12, 64, v11
    v_xor_b32 v13, 128, v11
    v_xor_b32 v14, 192, v11
    s_lshl_b32 s58, s53, 4
    s_add_u32 s58, s58, s54
    s_lshl_b32 s58, s58, 17
    s_add_u32 s24, s6, s58
    s_addc_u32 s25, s7, 0
    s_mov_b32 s26, 131072
    s_mov_b32 s27, 0x20000
    s_add_u32 s28, s8, s58
    s_addc_u32 s29, s9, 0
    s_mov_b32 s30, 131072
    s_mov_b32 s31, 0x20000
    v_mov_b32 v56, 2147418112
    s_mul_i32 s58, s53, 1310720
    v_lshlrev_b32 v68, 20, v0
    v_or_b32 v68, s65, v68
    s_mul_i32 s57, s53, 92160
    s_add_u32 s20, s4, s57
    s_addc_u32 s21, s5, 0
    s_mov_b32 s22, 92160
    s_mov_b32 s23, 0x20000
    s_lshl_b32 s57, s54, 9
    s_lshl_b32 s59, s49, 8
    s_add_u32 s57, s57, s59
    s_lshl_b32 s59, s50, 17
    s_add_u32 s57, s57, s59
    s_sub_u32 s59, 4718592, s57
    s_add_u32 s32, s10, s57
    s_addc_u32 s33, s11, 0
    s_mov_b32 s34, s59
    s_mov_b32 s35, 0x20000
    s_branch standalone__gqa_block_cached__near_ridge_pb
standalone__gqa_block_cached__near_ridge_a_rdy:
    s_mov_b32 s65, 0
standalone__gqa_block_cached__near_ridge_a_rdy_p:
    buffer_load_dword v29, v1, s[4:7], s18 offen sc1
    s_add_u32 s65, s65, 1
    s_waitcnt vmcnt(0)
    v_cmp_ne_u32 vcc, 1, v29
    s_cmp_ge_u32 s65, 200000
    s_cbranch_scc1 standalone__gqa_block_cached__near_ridge_a_rdy_r
    s_cbranch_vccnz standalone__gqa_block_cached__near_ridge_a_rdy_p
    s_branch standalone__gqa_block_cached__near_ridge_a_rdy_r
standalone__gqa_block_cached__near_ridge_a_fb:
    s_waitcnt vmcnt(0) lgkmcnt(0)
    s_mov_b32 s64, 0
    s_mov_b32 s59, 0
    s_call_b64 s[62:63], standalone__gqa_block_cached__near_ridge_safe
    s_mul_i32 s57, s48, 5120
    s_nop 1
    s_add_u32 s57, s57, 0
    s_nop 1
    v_add_u32 v55, s57, v3
    s_nop 1
    s_xor_b32 s57, s48, 1
    s_nop 1
    s_mul_i32 s57, s57, 5120
    s_nop 1
    s_add_u32 s57, s57, 0
    s_nop 1
    v_add_u32 v56, s57, v3
    s_nop 1
    s_lshl_b32 s57, s48, 2
    s_nop 1
    s_add_u32 s57, s57, 20480
    s_nop 1
    v_mov_b32 v57, s57
    s_nop 1
    v_mov_b32 v251, v254
    s_nop 1
    v_accvgpr_read_b32 v250, a200
    s_nop 1
    v_subrev_u32 v60, 729808896, v250
    s_nop 1
    ds_write_b64 v55, v[250:251] offset:4096
    s_nop 1
    ds_write_b128 v55, v[192:195] offset:0
    s_nop 1
    v_accvgpr_read_b32 v248, a192
    s_nop 1
    v_subrev_u32 v58, 729808896, v248
    s_nop 1
    ds_write_b128 v55, v[196:199] offset:1024
    s_nop 1
    ds_write_b128 v55, v[200:203] offset:2048
    s_nop 1
    ds_write_b128 v55, v[204:207] offset:3072
    s_nop 1
    v_rcp_f32 v248, v248
    s_nop 1
    v_accvgpr_read_b32 v249, a196
    s_nop 1
    v_subrev_u32 v59, 729808896, v249
    s_nop 1
    v_max3_u32 v58, v58, v59, v60
    s_nop 1
    v_cmp_lt_u32 vcc, 671088640, v58
    s_nop 1
    v_rcp_f32 v62, v249
    s_nop 1
    s_cmp_lg_u64 vcc, 0
    s_cselect_b32 s57, s64, 0
    s_nop 1
    v_mov_b32 v58, s57
    s_nop 1
    ds_write_b32 v57, v58
    s_nop 1
    s_branch standalone__gqa_block_cached__near_ridge_a_x
standalone__gqa_block_cached__near_ridge_a_aq1:
    s_mov_b32 s65, 0
standalone__gqa_block_cached__near_ridge_a_aq1_p:
    buffer_load_ushort v30, v10, s[40:43], s15 offen offset:1024 sc1
    s_add_u32 s65, s65, 1
    s_waitcnt vmcnt(0)
    v_cmp_ne_u32 vcc, 1, v30
    s_nop 0
    s_and_b32 s59, vcc_lo, 4
    s_cbranch_scc0 standalone__gqa_block_cached__near_ridge_a_aq1_q
    s_and_b32 s59, s65, 15
    s_cbranch_scc1 standalone__gqa_block_cached__near_ridge_a_aq1_p
    buffer_load_ushort v30, v10, s[40:43], s15 offen offset:0 sc1
    s_add_u32 s65, s65, 1
    s_waitcnt vmcnt(0)
    v_cmp_ne_u32 vcc, 1, v30
    s_nop 0
    s_and_b32 s59, vcc_lo, 4
    s_cbranch_scc0 standalone__gqa_block_cached__near_ridge_a_aq1_q
    s_cmp_lt_u32 s65, 800000
    s_cbranch_scc1 standalone__gqa_block_cached__near_ridge_a_aq1_p
standalone__gqa_block_cached__near_ridge_a_aq1_q:
    s_branch standalone__gqa_block_cached__near_ridge_a_aq1_r
standalone__gqa_block_cached__near_ridge_a_late:
    s_mov_b32 s65, 0
standalone__gqa_block_cached__near_ridge_a_late_p:
    buffer_load_ushort v30, v10, s[40:43], s15 offen offset:1024 sc1
    s_add_u32 s65, s65, 1
    s_waitcnt vmcnt(0)
    v_cmp_ne_u32 vcc, 1, v30
    s_nop 0
    s_and_b32 s59, vcc_lo, 128
    s_cbranch_scc0 standalone__gqa_block_cached__near_ridge_a_late_q
    s_and_b32 s59, s65, 15
    s_cbranch_scc1 standalone__gqa_block_cached__near_ridge_a_late_p
    buffer_load_ushort v30, v10, s[40:43], s15 offen offset:0 sc1
    s_add_u32 s65, s65, 1
    s_waitcnt vmcnt(0)
    v_cmp_ne_u32 vcc, 1, v30
    s_nop 0
    s_and_b32 s59, vcc_lo, 128
    s_cbranch_scc0 standalone__gqa_block_cached__near_ridge_a_late_q
    s_cmp_lt_u32 s65, 800000
    s_cbranch_scc1 standalone__gqa_block_cached__near_ridge_a_late_p
standalone__gqa_block_cached__near_ridge_a_late_q:
    buffer_load_dwordx4 a[80:83], v3, s[40:43], s68 offen offset:0 sc1
    buffer_load_dwordx4 a[96:99], v11, s[40:43], s68 offen offset:0 sc1
    buffer_load_dwordx4 a[112:115], v12, s[40:43], s68 offen offset:0 sc1
    buffer_load_dwordx4 a[88:91], v3, s[40:43], s68 offen offset:2048 sc1
    buffer_load_dwordx4 a[104:107], v11, s[40:43], s68 offen offset:2048 sc1
    s_branch standalone__gqa_block_cached__near_ridge_a_late_r
standalone__gqa_block_cached__near_ridge_a_aq2:
    s_mov_b32 s65, 0
standalone__gqa_block_cached__near_ridge_a_aq2_p:
    buffer_load_ushort v30, v10, s[40:43], s15 offen offset:1024 sc1
    s_add_u32 s65, s65, 1
    s_waitcnt vmcnt(0)
    v_cmp_ne_u32 vcc, 1, v30
    s_nop 0
    s_and_b32 s59, vcc_lo, 10
    s_cbranch_scc0 standalone__gqa_block_cached__near_ridge_a_aq2_q
    s_and_b32 s59, s65, 15
    s_cbranch_scc1 standalone__gqa_block_cached__near_ridge_a_aq2_p
    buffer_load_ushort v30, v10, s[40:43], s15 offen offset:0 sc1
    s_add_u32 s65, s65, 1
    s_waitcnt vmcnt(0)
    v_cmp_ne_u32 vcc, 1, v30
    s_nop 0
    s_and_b32 s59, vcc_lo, 10
    s_cbranch_scc0 standalone__gqa_block_cached__near_ridge_a_aq2_q
    s_cmp_lt_u32 s65, 800000
    s_cbranch_scc1 standalone__gqa_block_cached__near_ridge_a_aq2_p
standalone__gqa_block_cached__near_ridge_a_aq2_q:
    s_branch standalone__gqa_block_cached__near_ridge_a_aq2_r
standalone__gqa_block_cached__near_ridge_a_w2:
    s_mov_b32 s65, 0
standalone__gqa_block_cached__near_ridge_a_w2_p:
    buffer_load_ushort v30, v10, s[40:43], s15 offen offset:1024 sc1
    s_add_u32 s65, s65, 1
    s_waitcnt vmcnt(0)
    v_cmp_ne_u32 vcc, 1, v30
    s_nop 0
    s_and_b32 s59, vcc_lo, 32
    s_cbranch_scc0 standalone__gqa_block_cached__near_ridge_a_w2_q
    s_and_b32 s59, s65, 15
    s_cbranch_scc1 standalone__gqa_block_cached__near_ridge_a_w2_p
    buffer_load_ushort v30, v10, s[40:43], s15 offen offset:0 sc1
    s_add_u32 s65, s65, 1
    s_waitcnt vmcnt(0)
    v_cmp_ne_u32 vcc, 1, v30
    s_nop 0
    s_and_b32 s59, vcc_lo, 32
    s_cbranch_scc0 standalone__gqa_block_cached__near_ridge_a_w2_q
    s_cmp_lt_u32 s65, 800000
    s_cbranch_scc1 standalone__gqa_block_cached__near_ridge_a_w2_p
standalone__gqa_block_cached__near_ridge_a_w2_q:
    s_branch standalone__gqa_block_cached__near_ridge_a_w2_r
standalone__gqa_block_cached__near_ridge_b_rdy:
    s_mov_b32 s65, 0
standalone__gqa_block_cached__near_ridge_b_rdy_p:
    buffer_load_dword v29, v1, s[4:7], s18 offen sc1
    s_add_u32 s65, s65, 1
    s_waitcnt vmcnt(0)
    v_cmp_ne_u32 vcc, 1, v29
    s_cmp_ge_u32 s65, 200000
    s_cbranch_scc1 standalone__gqa_block_cached__near_ridge_b_rdy_r
    s_cbranch_vccnz standalone__gqa_block_cached__near_ridge_b_rdy_p
    s_branch standalone__gqa_block_cached__near_ridge_b_rdy_r
standalone__gqa_block_cached__near_ridge_b_fb:
    s_waitcnt vmcnt(0) lgkmcnt(0)
    s_mov_b32 s64, 0
    s_mov_b32 s59, 81920
    s_call_b64 s[62:63], standalone__gqa_block_cached__near_ridge_safe
    s_mul_i32 s57, s48, 5120
    s_nop 1
    s_add_u32 s57, s57, 65536
    s_nop 1
    v_add_u32 v55, s57, v3
    s_nop 1
    s_xor_b32 s57, s48, 1
    s_nop 1
    s_mul_i32 s57, s57, 5120
    s_nop 1
    s_add_u32 s57, s57, 65536
    s_nop 1
    v_add_u32 v56, s57, v3
    s_nop 1
    s_lshl_b32 s57, s48, 2
    s_nop 1
    s_add_u32 s57, s57, 86016
    s_nop 1
    v_mov_b32 v57, s57
    s_nop 1
    v_mov_b32 v251, v254
    s_nop 1
    v_accvgpr_read_b32 v250, a200
    s_nop 1
    v_subrev_u32 v60, 729808896, v250
    s_nop 1
    ds_write_b64 v55, v[250:251] offset:4096
    s_nop 1
    ds_write_b128 v55, v[192:195] offset:0
    s_nop 1
    v_accvgpr_read_b32 v248, a192
    s_nop 1
    v_subrev_u32 v58, 729808896, v248
    s_nop 1
    ds_write_b128 v55, v[196:199] offset:1024
    s_nop 1
    ds_write_b128 v55, v[200:203] offset:2048
    s_nop 1
    ds_write_b128 v55, v[204:207] offset:3072
    s_nop 1
    v_rcp_f32 v248, v248
    s_nop 1
    v_accvgpr_read_b32 v249, a196
    s_nop 1
    v_subrev_u32 v59, 729808896, v249
    s_nop 1
    v_max3_u32 v58, v58, v59, v60
    s_nop 1
    v_cmp_lt_u32 vcc, 671088640, v58
    s_nop 1
    v_rcp_f32 v62, v249
    s_nop 1
    s_cmp_lg_u64 vcc, 0
    s_cselect_b32 s57, s64, 0
    s_nop 1
    v_mov_b32 v58, s57
    s_nop 1
    ds_write_b32 v57, v58
    s_nop 1
    s_branch standalone__gqa_block_cached__near_ridge_b_x
standalone__gqa_block_cached__near_ridge_b_late:
    s_waitcnt vmcnt(0)
    s_mov_b64 exec, 17
    buffer_store_short v29, v10, s[40:43], s15 offen offset:1024
    buffer_store_short v29, v10, s[40:43], s15 offen sc1
    s_mov_b64 exec, -1
    s_mov_b32 s65, 0
standalone__gqa_block_cached__near_ridge_b_late_p:
    buffer_load_ushort v30, v10, s[40:43], s15 offen offset:1024 sc1
    s_add_u32 s65, s65, 1
    s_waitcnt vmcnt(0)
    v_cmp_ne_u32 vcc, 1, v30
    s_nop 0
    s_and_b32 s59, vcc_lo, 10
    s_cbranch_scc0 standalone__gqa_block_cached__near_ridge_b_late_q
    s_and_b32 s59, s65, 15
    s_cbranch_scc1 standalone__gqa_block_cached__near_ridge_b_late_p
    buffer_load_ushort v30, v10, s[40:43], s15 offen offset:0 sc1
    s_add_u32 s65, s65, 1
    s_waitcnt vmcnt(0)
    v_cmp_ne_u32 vcc, 1, v30
    s_nop 0
    s_and_b32 s59, vcc_lo, 10
    s_cbranch_scc0 standalone__gqa_block_cached__near_ridge_b_late_q
    s_cmp_lt_u32 s65, 800000
    s_cbranch_scc1 standalone__gqa_block_cached__near_ridge_b_late_p
standalone__gqa_block_cached__near_ridge_b_late_q:
    buffer_load_dwordx4 a[0:3], v3, s[40:43], s66 offen offset:0 sc1
    buffer_load_dwordx4 a[16:19], v11, s[40:43], s66 offen offset:0 sc1
    buffer_load_dwordx4 a[32:35], v12, s[40:43], s66 offen offset:0 sc1
    buffer_load_dwordx4 a[8:11], v3, s[40:43], s66 offen offset:2048 sc1
    buffer_load_dwordx4 a[24:27], v11, s[40:43], s66 offen offset:2048 sc1
    buffer_load_dwordx4 a[4:7], v3, s[40:43], s66 offen offset:1024 sc1
    buffer_load_dwordx4 a[20:23], v11, s[40:43], s66 offen offset:1024 sc1
    buffer_load_dwordx4 a[36:39], v12, s[40:43], s66 offen offset:1024 sc1
    buffer_load_dwordx4 a[12:15], v3, s[40:43], s66 offen offset:3072 sc1
    buffer_load_dwordx4 a[28:31], v11, s[40:43], s66 offen offset:3072 sc1
    s_branch standalone__gqa_block_cached__near_ridge_b_late_r
standalone__gqa_block_cached__near_ridge_b_aq1:
    s_mov_b32 s65, 0
standalone__gqa_block_cached__near_ridge_b_aq1_p:
    buffer_load_ushort v30, v10, s[40:43], s15 offen offset:1024 sc1
    s_add_u32 s65, s65, 1
    s_waitcnt vmcnt(0)
    v_cmp_ne_u32 vcc, 1, v30
    s_nop 0
    s_and_b32 s59, vcc_lo, 4
    s_cbranch_scc0 standalone__gqa_block_cached__near_ridge_b_aq1_q
    s_and_b32 s59, s65, 15
    s_cbranch_scc1 standalone__gqa_block_cached__near_ridge_b_aq1_p
    buffer_load_ushort v30, v10, s[40:43], s15 offen offset:0 sc1
    s_add_u32 s65, s65, 1
    s_waitcnt vmcnt(0)
    v_cmp_ne_u32 vcc, 1, v30
    s_nop 0
    s_and_b32 s59, vcc_lo, 4
    s_cbranch_scc0 standalone__gqa_block_cached__near_ridge_b_aq1_q
    s_cmp_lt_u32 s65, 800000
    s_cbranch_scc1 standalone__gqa_block_cached__near_ridge_b_aq1_p
standalone__gqa_block_cached__near_ridge_b_aq1_q:
    s_branch standalone__gqa_block_cached__near_ridge_b_aq1_r
.p2align 12
standalone__gqa_block_cached__near_ridge_pa:
    v_lshrrev_b32 v55, 4, v2
    v_and_b32 v56, 15, v2
    v_bfe_u32 v57, v2, 2, 2
    v_and_b32 v58, 3, v2
    v_and_b32 v61, 1, v55
    v_lshl_add_u32 v60, v61, 2, v57
    v_lshlrev_b32 v60, 5, v60
    v_lshl_add_u32 v60, v58, 3, v60
    s_lshl_b32 s58, s50, 7
    v_xor_b32 v60, s58, v60
    v_lshl_add_u32 v59, v55, 3, v57
    v_lshl_add_u32 v59, v59, 8, v60
    s_lshl_b32 s57, s49, 13
    s_add_u32 s57, s57, 114688
    v_add_u32 v17, s57, v59
    v_xor_b32 v18, 32, v17
    v_xor_b32 v19, 64, v17
    v_xor_b32 v20, 96, v17
    v_xor_b32 v21, 128, v17
    v_xor_b32 v22, 160, v17
    v_xor_b32 v23, 192, v17
    v_xor_b32 v24, 224, v17
    v_lshl_add_u32 v59, v55, 2, v57
    v_lshl_add_u32 v59, v59, 8, v60
    s_lshl_b32 s57, s50, 13
    s_add_u32 s59, s57, 49152
    v_add_u32 v39, s59, v59
    v_xor_b32 v40, 32, v39
    v_xor_b32 v41, 64, v39
    v_xor_b32 v42, 96, v39
    v_xor_b32 v43, 128, v39
    v_xor_b32 v44, 160, v39
    v_xor_b32 v45, 192, v39
    v_xor_b32 v46, 224, v39
    v_xor_b32 v47, 8192, v39
    v_xor_b32 v48, 8224, v39
    v_xor_b32 v49, 8256, v39
    v_xor_b32 v50, 8288, v39
    v_xor_b32 v51, 8320, v39
    v_xor_b32 v52, 8352, v39
    v_xor_b32 v53, 8384, v39
    v_xor_b32 v54, 8416, v39
    v_lshrrev_b32 v59, 1, v55
    v_lshl_add_u32 v59, v61, 1, v59
    v_xor_b32 v59, v59, v56
    v_lshlrev_b32 v59, 4, v59
    v_xor_b32 v59, s58, v59
    v_lshl_add_u32 v59, v56, 8, v59
    v_add_u32 v31, s57, v59
    v_xor_b32 v32, 64, v31
    v_xor_b32 v33, 128, v31
    v_xor_b32 v34, 192, v31
    v_xor_b32 v35, 8192, v31
    v_xor_b32 v36, 8256, v31
    v_xor_b32 v37, 8320, v31
    v_xor_b32 v38, 8384, v31
    v_lshrrev_b32 v59, 1, v56
    v_xor_b32 v59, v59, v55
    v_lshlrev_b32 v59, 4, v59
    v_lshl_add_u32 v59, v56, 7, v59
    s_lshl_b32 s57, s50, 1
    s_add_u32 s57, s57, s49
    s_lshl_b32 s57, s57, 11
    s_xor_b32 s58, s57, 2048
    s_add_u32 s57, s57, 94208
    s_add_u32 s58, s58, 94208
    v_add_u32 v25, s57, v59
    v_add_u32 v27, s58, v59
    v_add_u32 v29, 102400, v59
    v_xor_b32 v26, 64, v25
    v_xor_b32 v28, 64, v27
    v_xor_b32 v30, 64, v29
    v_lshlrev_b32 v3, 4, v2
    v_mov_b32 v1, 0
    s_mov_b32 s60, 1040356334
    s_mov_b32 s61, 1040356334
    s_mov_b32 s64, 1
    v_mov_b32 v254, 0
    v_mov_b32 v59, 0x3f803f80
    v_accvgpr_write_b32 a204, v59
    v_accvgpr_write_b32 a205, v59
    v_accvgpr_write_b32 a206, v59
    v_accvgpr_write_b32 a207, v59
    s_mul_i32 s57, s52, 1179648
    s_add_u32 s36, s12, s57
    s_addc_u32 s37, s13, 0
    s_mov_b32 s38, 1179648
    s_mov_b32 s39, 0x20000
    s_mov_b32 s44, s14
    s_mov_b32 s45, s15
    s_mov_b32 s46, 1474560
    s_mov_b32 s47, 0x20000
    s_mov_b32 s4, s16
    s_mov_b32 s5, s17
    s_mov_b32 s6, 256
    s_mov_b32 s7, 0x20000
    s_lshl_b32 s18, s53, 4
    v_lshrrev_b32 v57, 3, v0
    v_mul_u32_u24 v57, 1152, v57
    v_and_b32 v58, 7, v0
    v_lshl_add_u32 v57, v58, 7, v57
    v_lshrrev_b32 v252, 2, v58
    v_lshl_add_u32 v252, v252, 30, v57
    v_add_u32 v58, 3, v58
    v_lshrrev_b32 v58, 3, v58
    v_lshl_add_u32 v253, v58, 30, v57
    s_bfe_u32 s74, s53, 0x10002
    s_lshl_b32 s74, s74, 4
    s_and_b32 s73, s53, 3
    s_lshl_b32 s73, s73, 1
    s_add_u32 s74, s74, s73
    s_lshr_b32 s73, s51, 1
    s_add_u32 s74, s74, s73
    s_mul_i32 s73, s74, 36864
    s_add_u32 s74, s73, 294912
    s_mov_b64 exec, 0
    s_cmp_eq_u32 s48, 0
    s_cbranch_scc1 standalone__gqa_block_cached__near_ridge_a_h0_0
    s_cmp_eq_u32 s48, 1
    s_cbranch_scc1 standalone__gqa_block_cached__near_ridge_a_h0_1
    s_cmp_eq_u32 s48, 2
    s_cbranch_scc1 standalone__gqa_block_cached__near_ridge_a_h0_2
    s_branch standalone__gqa_block_cached__near_ridge_a_h0_3
standalone__gqa_block_cached__near_ridge_a_h0_r:
    s_mov_b64 exec, -1
    s_add_u32 m0, s56, 0
    s_mov_b32 s57, 128
    buffer_load_dwordx4 v8, s[20:23], s57 offen offset:0 lds
    buffer_load_dwordx4 v9, s[20:23], s57 offen offset:1024 lds
    s_mov_b32 exec_hi, 0
    buffer_load_dwordx4 v10, s[20:23], s57 offen offset:2048 lds
    s_mov_b32 exec_hi, -1
    s_add_u32 m0, s55, 147456
    s_mov_b32 s58, 524288
    buffer_load_dwordx4 v4, s[32:35], s58 offen offset:0 lds
    buffer_load_dwordx4 v5, s[32:35], s58 offen offset:1024 lds
    buffer_load_dwordx4 v6, s[32:35], s58 offen offset:2048 lds
    buffer_load_dwordx4 v7, s[32:35], s58 offen offset:3072 lds
    s_waitcnt vmcnt(11)
    s_barrier
    ds_read_b128 a[208:211], v25 offset:10240
    ds_read_b128 a[212:215], v27 offset:10240
    ds_read_b128 a[216:219], v29 offset:10240
    ds_read_b64_tr_b16 a[64:65], v17 offset:0
    ds_read_b64_tr_b16 a[66:67], v17 offset:1024
    ds_read_b64_tr_b16 a[68:69], v18 offset:0
    ds_read_b64_tr_b16 a[70:71], v18 offset:1024
    ds_read_b64_tr_b16 a[72:73], v19 offset:0
    ds_read_b64_tr_b16 a[74:75], v19 offset:1024
    ds_read_b64_tr_b16 a[76:77], v20 offset:0
    ds_read_b64_tr_b16 a[78:79], v20 offset:1024
    ds_read_b64_tr_b16 a[80:81], v21 offset:0
    ds_read_b64_tr_b16 a[82:83], v21 offset:1024
    ds_read_b64_tr_b16 a[84:85], v22 offset:0
    ds_read_b64_tr_b16 a[86:87], v22 offset:1024
    ds_read_b64_tr_b16 a[88:89], v23 offset:0
    ds_read_b64_tr_b16 a[90:91], v23 offset:1024
    ds_read_b64_tr_b16 a[92:93], v24 offset:0
    ds_read_b64_tr_b16 a[94:95], v24 offset:1024
    s_waitcnt lgkmcnt(12)
    v_mfma_f32_16x16x32_bf16 v[112:115], a[64:67], a[208:211], 0
    v_mfma_f32_16x16x32_bf16 v[144:147], a[64:67], a[212:215], 0
    v_mfma_f32_16x16x32_bf16 v[176:179], a[64:67], a[216:219], 0
    v_mfma_f32_16x16x32_bf16 v[116:119], a[68:71], a[208:211], 0
    v_mfma_f32_16x16x32_bf16 v[148:151], a[68:71], a[212:215], 0
    v_mfma_f32_16x16x32_bf16 v[180:183], a[68:71], a[216:219], 0
    s_waitcnt lgkmcnt(10)
    v_mfma_f32_16x16x32_bf16 v[120:123], a[72:75], a[208:211], 0
    v_mfma_f32_16x16x32_bf16 v[152:155], a[72:75], a[212:215], 0
    s_waitcnt vmcnt(7) lgkmcnt(0)
    v_mfma_f32_16x16x32_bf16 v[184:187], a[72:75], a[216:219], 0
    s_barrier
    ds_read_b128 a[220:223], v26 offset:10240
    v_mfma_f32_16x16x32_bf16 v[124:127], a[76:79], a[208:211], 0
    s_mov_b32 s58, 786432
    ds_read_b128 a[224:227], v28 offset:10240
    ds_read_b128 a[228:231], v30 offset:10240
    v_mfma_f32_16x16x32_bf16 v[156:159], a[76:79], a[212:215], 0
    s_add_u32 m0, s55, 114688
    ds_read_b64_tr_b16 a[96:97], v17 offset:16384
    ds_read_b64_tr_b16 a[98:99], v17 offset:17408
    v_mfma_f32_16x16x32_bf16 v[188:191], a[76:79], a[216:219], 0
    buffer_load_dwordx4 v4, s[32:35], s58 offen offset:0 lds
    v_mfma_f32_16x16x32_bf16 v[128:131], a[80:83], a[208:211], 0
    ds_read_b64_tr_b16 a[100:101], v18 offset:16384
    ds_read_b64_tr_b16 a[102:103], v18 offset:17408
    v_mfma_f32_16x16x32_bf16 v[160:163], a[80:83], a[212:215], 0
    ds_read_b64_tr_b16 a[104:105], v19 offset:16384
    ds_read_b64_tr_b16 a[106:107], v19 offset:17408
    v_mfma_f32_16x16x32_bf16 v[132:135], a[84:87], a[208:211], 0
    ds_read_b64_tr_b16 a[108:109], v20 offset:16384
    ds_read_b64_tr_b16 a[110:111], v20 offset:17408
    v_mfma_f32_16x16x32_bf16 v[164:167], a[84:87], a[212:215], 0
    ds_read_b64_tr_b16 a[112:113], v21 offset:16384
    ds_read_b64_tr_b16 a[114:115], v21 offset:17408
    v_mfma_f32_16x16x32_bf16 v[136:139], a[88:91], a[208:211], 0
    buffer_load_dwordx4 v5, s[32:35], s58 offen offset:1024 lds
    v_mfma_f32_16x16x32_bf16 v[168:171], a[88:91], a[212:215], 0
    ds_read_b64_tr_b16 a[116:117], v22 offset:16384
    ds_read_b64_tr_b16 a[118:119], v22 offset:17408
    v_mfma_f32_16x16x32_bf16 v[140:143], a[92:95], a[208:211], 0
    ds_read_b64_tr_b16 a[120:121], v23 offset:16384
    ds_read_b64_tr_b16 a[122:123], v23 offset:17408
    v_mfma_f32_16x16x32_bf16 v[172:175], a[92:95], a[212:215], 0
    s_waitcnt lgkmcnt(12)
    ds_read_b64_tr_b16 a[124:125], v24 offset:16384
    ds_read_b64_tr_b16 a[126:127], v24 offset:17408
    v_mfma_f32_16x16x32_bf16 v[112:115], a[96:99], a[220:223], v[112:115]
    v_mfma_f32_16x16x32_bf16 v[144:147], a[96:99], a[224:227], v[144:147]
    buffer_load_dwordx4 v6, s[32:35], s58 offen offset:2048 lds
    v_mfma_f32_16x16x32_bf16 v[176:179], a[96:99], a[228:231], v[176:179]
    s_waitcnt lgkmcnt(12)
    v_mfma_f32_16x16x32_bf16 v[116:119], a[100:103], a[220:223], v[116:119]
    v_mfma_f32_16x16x32_bf16 v[148:151], a[100:103], a[224:227], v[148:151]
    v_mfma_f32_16x16x32_bf16 v[180:183], a[100:103], a[228:231], v[180:183]
    s_waitcnt lgkmcnt(10)
    v_mfma_f32_16x16x32_bf16 v[120:123], a[104:107], a[220:223], v[120:123]
    buffer_load_dwordx4 v7, s[32:35], s58 offen offset:3072 lds
    v_mfma_f32_16x16x32_bf16 v[152:155], a[104:107], a[224:227], v[152:155]
    s_waitcnt vmcnt(4) lgkmcnt(0)
    v_mfma_f32_16x16x32_bf16 v[184:187], a[104:107], a[228:231], v[184:187]
    s_barrier
    ds_read_b128 a[208:211], v25 offset:0
    v_mfma_f32_16x16x32_bf16 v[124:127], a[108:111], a[220:223], v[124:127]
    s_mov_b32 s57, 256
    s_add_u32 m0, s56, 10240
    ds_read_b128 a[212:215], v27 offset:0
    v_mfma_f32_16x16x32_bf16 v[156:159], a[108:111], a[224:227], v[156:159]
    buffer_load_dwordx4 v8, s[20:23], s57 offen offset:0 lds
    v_mfma_f32_16x16x32_bf16 v[188:191], a[108:111], a[228:231], v[188:191]
    ds_read_b128 a[216:219], v29 offset:0
    ds_read_b64_tr_b16 a[64:65], v17 offset:32768
    v_mfma_f32_16x16x32_bf16 v[128:131], a[112:115], a[220:223], v[128:131]
    buffer_load_dwordx4 v9, s[20:23], s57 offen offset:1024 lds
    v_mfma_f32_16x16x32_bf16 v[160:163], a[112:115], a[224:227], v[160:163]
    ds_read_b64_tr_b16 a[66:67], v17 offset:33792
    ds_read_b64_tr_b16 a[68:69], v18 offset:32768
    v_mfma_f32_16x16x32_bf16 v[132:135], a[116:119], a[220:223], v[132:135]
    ds_read_b64_tr_b16 a[70:71], v18 offset:33792
    ds_read_b64_tr_b16 a[72:73], v19 offset:32768
    v_mfma_f32_16x16x32_bf16 v[164:167], a[116:119], a[224:227], v[164:167]
    s_mov_b32 exec_hi, 0
    buffer_load_dwordx4 v10, s[20:23], s57 offen offset:2048 lds
    s_mov_b32 exec_hi, -1
    v_mfma_f32_16x16x32_bf16 v[136:139], a[120:123], a[220:223], v[136:139]
    s_mov_b32 s58, 1048576
    ds_read_b64_tr_b16 a[74:75], v19 offset:33792
    ds_read_b64_tr_b16 a[76:77], v20 offset:32768
    v_mfma_f32_16x16x32_bf16 v[168:171], a[120:123], a[224:227], v[168:171]
    s_add_u32 m0, s55, 131072
    ds_read_b64_tr_b16 a[78:79], v20 offset:33792
    ds_read_b64_tr_b16 a[80:81], v21 offset:32768
    v_mfma_f32_16x16x32_bf16 v[140:143], a[124:127], a[220:223], v[140:143]
    buffer_load_dwordx4 v4, s[32:35], s58 offen offset:0 lds
    v_mfma_f32_16x16x32_bf16 v[172:175], a[124:127], a[224:227], v[172:175]
    s_waitcnt lgkmcnt(7)
    ds_read_b64_tr_b16 a[82:83], v21 offset:33792
    ds_read_b64_tr_b16 a[84:85], v22 offset:32768
    v_mfma_f32_16x16x32_bf16 v[112:115], a[64:67], a[208:211], v[112:115]
    ds_read_b64_tr_b16 a[86:87], v22 offset:33792
    ds_read_b64_tr_b16 a[88:89], v23 offset:32768
    v_mfma_f32_16x16x32_bf16 v[144:147], a[64:67], a[212:215], v[144:147]
    buffer_load_dwordx4 v5, s[32:35], s58 offen offset:1024 lds
    v_mfma_f32_16x16x32_bf16 v[176:179], a[64:67], a[216:219], v[176:179]
    s_waitcnt lgkmcnt(9)
    ds_read_b64_tr_b16 a[90:91], v23 offset:33792
    ds_read_b64_tr_b16 a[92:93], v24 offset:32768
    v_mfma_f32_16x16x32_bf16 v[116:119], a[68:71], a[208:211], v[116:119]
    ds_read_b64_tr_b16 a[94:95], v24 offset:33792
    v_mfma_f32_16x16x32_bf16 v[148:151], a[68:71], a[212:215], v[148:151]
    buffer_load_dwordx4 v6, s[32:35], s58 offen offset:2048 lds
    v_mfma_f32_16x16x32_bf16 v[180:183], a[68:71], a[216:219], v[180:183]
    s_waitcnt lgkmcnt(10)
    v_mfma_f32_16x16x32_bf16 v[120:123], a[72:75], a[208:211], v[120:123]
    v_mfma_f32_16x16x32_bf16 v[152:155], a[72:75], a[212:215], v[152:155]
    s_waitcnt vmcnt(6) lgkmcnt(0)
    buffer_load_dwordx4 v7, s[32:35], s58 offen offset:3072 lds
    v_mfma_f32_16x16x32_bf16 v[184:187], a[72:75], a[216:219], v[184:187]
    s_barrier
    ds_read_b128 a[220:223], v26 offset:0
    v_mfma_f32_16x16x32_bf16 v[124:127], a[76:79], a[208:211], v[124:127]
    s_mov_b32 s58, 1310720
    ds_read_b128 a[224:227], v28 offset:0
    ds_read_b128 a[228:231], v30 offset:0
    v_mfma_f32_16x16x32_bf16 v[156:159], a[76:79], a[212:215], v[156:159]
    s_add_u32 m0, s55, 147456
    ds_read_b64_tr_b16 a[96:97], v17 offset:0
    ds_read_b64_tr_b16 a[98:99], v17 offset:1024
    v_mfma_f32_16x16x32_bf16 v[188:191], a[76:79], a[216:219], v[188:191]
    buffer_load_dwordx4 v4, s[32:35], s58 offen offset:0 lds
    v_mfma_f32_16x16x32_bf16 v[128:131], a[80:83], a[208:211], v[128:131]
    ds_read_b64_tr_b16 a[100:101], v18 offset:0
    ds_read_b64_tr_b16 a[102:103], v18 offset:1024
    v_mfma_f32_16x16x32_bf16 v[160:163], a[80:83], a[212:215], v[160:163]
    ds_read_b64_tr_b16 a[104:105], v19 offset:0
    ds_read_b64_tr_b16 a[106:107], v19 offset:1024
    v_mfma_f32_16x16x32_bf16 v[132:135], a[84:87], a[208:211], v[132:135]
    ds_read_b64_tr_b16 a[108:109], v20 offset:0
    ds_read_b64_tr_b16 a[110:111], v20 offset:1024
    v_mfma_f32_16x16x32_bf16 v[164:167], a[84:87], a[212:215], v[164:167]
    ds_read_b64_tr_b16 a[112:113], v21 offset:0
    ds_read_b64_tr_b16 a[114:115], v21 offset:1024
    v_mfma_f32_16x16x32_bf16 v[136:139], a[88:91], a[208:211], v[136:139]
    buffer_load_dwordx4 v5, s[32:35], s58 offen offset:1024 lds
    v_mfma_f32_16x16x32_bf16 v[168:171], a[88:91], a[212:215], v[168:171]
    ds_read_b64_tr_b16 a[116:117], v22 offset:0
    ds_read_b64_tr_b16 a[118:119], v22 offset:1024
    v_mfma_f32_16x16x32_bf16 v[140:143], a[92:95], a[208:211], v[140:143]
    ds_read_b64_tr_b16 a[120:121], v23 offset:0
    ds_read_b64_tr_b16 a[122:123], v23 offset:1024
    v_mfma_f32_16x16x32_bf16 v[172:175], a[92:95], a[212:215], v[172:175]
    s_waitcnt lgkmcnt(12)
    ds_read_b64_tr_b16 a[124:125], v24 offset:0
    ds_read_b64_tr_b16 a[126:127], v24 offset:1024
    v_mfma_f32_16x16x32_bf16 v[112:115], a[96:99], a[220:223], v[112:115]
    v_mfma_f32_16x16x32_bf16 v[144:147], a[96:99], a[224:227], v[144:147]
    buffer_load_dwordx4 v6, s[32:35], s58 offen offset:2048 lds
    v_mfma_f32_16x16x32_bf16 v[176:179], a[96:99], a[228:231], v[176:179]
    s_waitcnt lgkmcnt(12)
    v_mfma_f32_16x16x32_bf16 v[116:119], a[100:103], a[220:223], v[116:119]
    v_mfma_f32_16x16x32_bf16 v[148:151], a[100:103], a[224:227], v[148:151]
    v_mfma_f32_16x16x32_bf16 v[180:183], a[100:103], a[228:231], v[180:183]
    s_waitcnt lgkmcnt(10)
    v_mfma_f32_16x16x32_bf16 v[120:123], a[104:107], a[220:223], v[120:123]
    buffer_load_dwordx4 v7, s[32:35], s58 offen offset:3072 lds
    v_mfma_f32_16x16x32_bf16 v[152:155], a[104:107], a[224:227], v[152:155]
    s_waitcnt vmcnt(4) lgkmcnt(0)
    v_mfma_f32_16x16x32_bf16 v[184:187], a[104:107], a[228:231], v[184:187]
    s_barrier
    ds_read_b128 a[208:211], v25 offset:10240
    v_mfma_f32_16x16x32_bf16 v[124:127], a[108:111], a[220:223], v[124:127]
    s_mov_b32 s57, 384
    s_add_u32 m0, s56, 0
    ds_read_b128 a[212:215], v27 offset:10240
    v_mfma_f32_16x16x32_bf16 v[156:159], a[108:111], a[224:227], v[156:159]
    buffer_load_dwordx4 v8, s[20:23], s57 offen offset:0 lds
    v_mfma_f32_16x16x32_bf16 v[188:191], a[108:111], a[228:231], v[188:191]
    ds_read_b128 a[216:219], v29 offset:10240
    ds_read_b64_tr_b16 a[64:65], v17 offset:16384
    v_mfma_f32_16x16x32_bf16 v[128:131], a[112:115], a[220:223], v[128:131]
    buffer_load_dwordx4 v9, s[20:23], s57 offen offset:1024 lds
    v_mfma_f32_16x16x32_bf16 v[160:163], a[112:115], a[224:227], v[160:163]
    ds_read_b64_tr_b16 a[66:67], v17 offset:17408
    ds_read_b64_tr_b16 a[68:69], v18 offset:16384
    v_mfma_f32_16x16x32_bf16 v[132:135], a[116:119], a[220:223], v[132:135]
    ds_read_b64_tr_b16 a[70:71], v18 offset:17408
    ds_read_b64_tr_b16 a[72:73], v19 offset:16384
    v_mfma_f32_16x16x32_bf16 v[164:167], a[116:119], a[224:227], v[164:167]
    s_mov_b32 exec_hi, 0
    buffer_load_dwordx4 v10, s[20:23], s57 offen offset:2048 lds
    s_mov_b32 exec_hi, -1
    v_mfma_f32_16x16x32_bf16 v[136:139], a[120:123], a[220:223], v[136:139]
    s_mov_b32 s58, 1572864
    ds_read_b64_tr_b16 a[74:75], v19 offset:17408
    ds_read_b64_tr_b16 a[76:77], v20 offset:16384
    v_mfma_f32_16x16x32_bf16 v[168:171], a[120:123], a[224:227], v[168:171]
    s_add_u32 m0, s55, 114688
    ds_read_b64_tr_b16 a[78:79], v20 offset:17408
    ds_read_b64_tr_b16 a[80:81], v21 offset:16384
    v_mfma_f32_16x16x32_bf16 v[140:143], a[124:127], a[220:223], v[140:143]
    buffer_load_dwordx4 v4, s[32:35], s58 offen offset:0 lds
    v_mfma_f32_16x16x32_bf16 v[172:175], a[124:127], a[224:227], v[172:175]
    s_waitcnt lgkmcnt(7)
    ds_read_b64_tr_b16 a[82:83], v21 offset:17408
    ds_read_b64_tr_b16 a[84:85], v22 offset:16384
    v_mfma_f32_16x16x32_bf16 v[112:115], a[64:67], a[208:211], v[112:115]
    ds_read_b64_tr_b16 a[86:87], v22 offset:17408
    ds_read_b64_tr_b16 a[88:89], v23 offset:16384
    v_mfma_f32_16x16x32_bf16 v[144:147], a[64:67], a[212:215], v[144:147]
    buffer_load_dwordx4 v5, s[32:35], s58 offen offset:1024 lds
    v_mfma_f32_16x16x32_bf16 v[176:179], a[64:67], a[216:219], v[176:179]
    s_waitcnt lgkmcnt(9)
    ds_read_b64_tr_b16 a[90:91], v23 offset:17408
    ds_read_b64_tr_b16 a[92:93], v24 offset:16384
    v_mfma_f32_16x16x32_bf16 v[116:119], a[68:71], a[208:211], v[116:119]
    ds_read_b64_tr_b16 a[94:95], v24 offset:17408
    v_mfma_f32_16x16x32_bf16 v[148:151], a[68:71], a[212:215], v[148:151]
    buffer_load_dwordx4 v6, s[32:35], s58 offen offset:2048 lds
    v_mfma_f32_16x16x32_bf16 v[180:183], a[68:71], a[216:219], v[180:183]
    s_waitcnt lgkmcnt(10)
    v_mfma_f32_16x16x32_bf16 v[120:123], a[72:75], a[208:211], v[120:123]
    v_mfma_f32_16x16x32_bf16 v[152:155], a[72:75], a[212:215], v[152:155]
    s_waitcnt vmcnt(6) lgkmcnt(0)
    buffer_load_dwordx4 v7, s[32:35], s58 offen offset:3072 lds
    v_mfma_f32_16x16x32_bf16 v[184:187], a[72:75], a[216:219], v[184:187]
    s_barrier
    ds_read_b128 a[220:223], v26 offset:10240
    v_mfma_f32_16x16x32_bf16 v[124:127], a[76:79], a[208:211], v[124:127]
    s_mov_b32 s58, 1835008
    ds_read_b128 a[224:227], v28 offset:10240
    ds_read_b128 a[228:231], v30 offset:10240
    v_mfma_f32_16x16x32_bf16 v[156:159], a[76:79], a[212:215], v[156:159]
    s_add_u32 m0, s55, 131072
    ds_read_b64_tr_b16 a[96:97], v17 offset:32768
    ds_read_b64_tr_b16 a[98:99], v17 offset:33792
    v_mfma_f32_16x16x32_bf16 v[188:191], a[76:79], a[216:219], v[188:191]
    buffer_load_dwordx4 v4, s[32:35], s58 offen offset:0 lds
    v_mfma_f32_16x16x32_bf16 v[128:131], a[80:83], a[208:211], v[128:131]
    ds_read_b64_tr_b16 a[100:101], v18 offset:32768
    ds_read_b64_tr_b16 a[102:103], v18 offset:33792
    v_mfma_f32_16x16x32_bf16 v[160:163], a[80:83], a[212:215], v[160:163]
    ds_read_b64_tr_b16 a[104:105], v19 offset:32768
    ds_read_b64_tr_b16 a[106:107], v19 offset:33792
    v_mfma_f32_16x16x32_bf16 v[132:135], a[84:87], a[208:211], v[132:135]
    ds_read_b64_tr_b16 a[108:109], v20 offset:32768
    ds_read_b64_tr_b16 a[110:111], v20 offset:33792
    v_mfma_f32_16x16x32_bf16 v[164:167], a[84:87], a[212:215], v[164:167]
    ds_read_b64_tr_b16 a[112:113], v21 offset:32768
    ds_read_b64_tr_b16 a[114:115], v21 offset:33792
    v_mfma_f32_16x16x32_bf16 v[136:139], a[88:91], a[208:211], v[136:139]
    buffer_load_dwordx4 v5, s[32:35], s58 offen offset:1024 lds
    v_mfma_f32_16x16x32_bf16 v[168:171], a[88:91], a[212:215], v[168:171]
    ds_read_b64_tr_b16 a[116:117], v22 offset:32768
    ds_read_b64_tr_b16 a[118:119], v22 offset:33792
    v_mfma_f32_16x16x32_bf16 v[140:143], a[92:95], a[208:211], v[140:143]
    ds_read_b64_tr_b16 a[120:121], v23 offset:32768
    ds_read_b64_tr_b16 a[122:123], v23 offset:33792
    v_mfma_f32_16x16x32_bf16 v[172:175], a[92:95], a[212:215], v[172:175]
    s_waitcnt lgkmcnt(12)
    ds_read_b64_tr_b16 a[124:125], v24 offset:32768
    ds_read_b64_tr_b16 a[126:127], v24 offset:33792
    v_mfma_f32_16x16x32_bf16 v[112:115], a[96:99], a[220:223], v[112:115]
    v_mfma_f32_16x16x32_bf16 v[144:147], a[96:99], a[224:227], v[144:147]
    buffer_load_dwordx4 v6, s[32:35], s58 offen offset:2048 lds
    v_mfma_f32_16x16x32_bf16 v[176:179], a[96:99], a[228:231], v[176:179]
    s_waitcnt lgkmcnt(12)
    v_mfma_f32_16x16x32_bf16 v[116:119], a[100:103], a[220:223], v[116:119]
    v_mfma_f32_16x16x32_bf16 v[148:151], a[100:103], a[224:227], v[148:151]
    v_mfma_f32_16x16x32_bf16 v[180:183], a[100:103], a[228:231], v[180:183]
    s_waitcnt lgkmcnt(10)
    v_mfma_f32_16x16x32_bf16 v[120:123], a[104:107], a[220:223], v[120:123]
    buffer_load_dwordx4 v7, s[32:35], s58 offen offset:3072 lds
    v_mfma_f32_16x16x32_bf16 v[152:155], a[104:107], a[224:227], v[152:155]
    s_waitcnt vmcnt(4) lgkmcnt(0)
    v_mfma_f32_16x16x32_bf16 v[184:187], a[104:107], a[228:231], v[184:187]
    s_barrier
    ds_read_b128 a[208:211], v25 offset:0
    v_mfma_f32_16x16x32_bf16 v[124:127], a[108:111], a[220:223], v[124:127]
    s_mov_b32 s57, 512
    s_add_u32 m0, s56, 10240
    ds_read_b128 a[212:215], v27 offset:0
    v_mfma_f32_16x16x32_bf16 v[156:159], a[108:111], a[224:227], v[156:159]
    buffer_load_dwordx4 v8, s[20:23], s57 offen offset:0 lds
    v_mfma_f32_16x16x32_bf16 v[188:191], a[108:111], a[228:231], v[188:191]
    ds_read_b128 a[216:219], v29 offset:0
    ds_read_b64_tr_b16 a[64:65], v17 offset:0
    v_mfma_f32_16x16x32_bf16 v[128:131], a[112:115], a[220:223], v[128:131]
    buffer_load_dwordx4 v9, s[20:23], s57 offen offset:1024 lds
    v_mfma_f32_16x16x32_bf16 v[160:163], a[112:115], a[224:227], v[160:163]
    ds_read_b64_tr_b16 a[66:67], v17 offset:1024
    ds_read_b64_tr_b16 a[68:69], v18 offset:0
    v_mfma_f32_16x16x32_bf16 v[132:135], a[116:119], a[220:223], v[132:135]
    ds_read_b64_tr_b16 a[70:71], v18 offset:1024
    ds_read_b64_tr_b16 a[72:73], v19 offset:0
    v_mfma_f32_16x16x32_bf16 v[164:167], a[116:119], a[224:227], v[164:167]
    s_mov_b32 exec_hi, 0
    buffer_load_dwordx4 v10, s[20:23], s57 offen offset:2048 lds
    s_mov_b32 exec_hi, -1
    v_mfma_f32_16x16x32_bf16 v[136:139], a[120:123], a[220:223], v[136:139]
    s_mov_b32 s58, 2097152
    ds_read_b64_tr_b16 a[74:75], v19 offset:1024
    ds_read_b64_tr_b16 a[76:77], v20 offset:0
    v_mfma_f32_16x16x32_bf16 v[168:171], a[120:123], a[224:227], v[168:171]
    s_add_u32 m0, s55, 147456
    ds_read_b64_tr_b16 a[78:79], v20 offset:1024
    ds_read_b64_tr_b16 a[80:81], v21 offset:0
    v_mfma_f32_16x16x32_bf16 v[140:143], a[124:127], a[220:223], v[140:143]
    buffer_load_dwordx4 v4, s[32:35], s58 offen offset:0 lds
    v_mfma_f32_16x16x32_bf16 v[172:175], a[124:127], a[224:227], v[172:175]
    s_waitcnt lgkmcnt(7)
    ds_read_b64_tr_b16 a[82:83], v21 offset:1024
    ds_read_b64_tr_b16 a[84:85], v22 offset:0
    v_mfma_f32_16x16x32_bf16 v[112:115], a[64:67], a[208:211], v[112:115]
    ds_read_b64_tr_b16 a[86:87], v22 offset:1024
    ds_read_b64_tr_b16 a[88:89], v23 offset:0
    v_mfma_f32_16x16x32_bf16 v[144:147], a[64:67], a[212:215], v[144:147]
    buffer_load_dwordx4 v5, s[32:35], s58 offen offset:1024 lds
    v_mfma_f32_16x16x32_bf16 v[176:179], a[64:67], a[216:219], v[176:179]
    s_waitcnt lgkmcnt(9)
    ds_read_b64_tr_b16 a[90:91], v23 offset:1024
    ds_read_b64_tr_b16 a[92:93], v24 offset:0
    v_mfma_f32_16x16x32_bf16 v[116:119], a[68:71], a[208:211], v[116:119]
    ds_read_b64_tr_b16 a[94:95], v24 offset:1024
    v_mfma_f32_16x16x32_bf16 v[148:151], a[68:71], a[212:215], v[148:151]
    buffer_load_dwordx4 v6, s[32:35], s58 offen offset:2048 lds
    v_mfma_f32_16x16x32_bf16 v[180:183], a[68:71], a[216:219], v[180:183]
    s_waitcnt lgkmcnt(10)
    v_mfma_f32_16x16x32_bf16 v[120:123], a[72:75], a[208:211], v[120:123]
    v_mfma_f32_16x16x32_bf16 v[152:155], a[72:75], a[212:215], v[152:155]
    s_waitcnt vmcnt(6) lgkmcnt(0)
    buffer_load_dwordx4 v7, s[32:35], s58 offen offset:3072 lds
    v_mfma_f32_16x16x32_bf16 v[184:187], a[72:75], a[216:219], v[184:187]
    s_barrier
    ds_read_b128 a[220:223], v26 offset:0
    v_mfma_f32_16x16x32_bf16 v[124:127], a[76:79], a[208:211], v[124:127]
    s_mov_b32 s58, 2359296
    ds_read_b128 a[224:227], v28 offset:0
    ds_read_b128 a[228:231], v30 offset:0
    v_mfma_f32_16x16x32_bf16 v[156:159], a[76:79], a[212:215], v[156:159]
    s_add_u32 m0, s55, 114688
    ds_read_b64_tr_b16 a[96:97], v17 offset:16384
    ds_read_b64_tr_b16 a[98:99], v17 offset:17408
    v_mfma_f32_16x16x32_bf16 v[188:191], a[76:79], a[216:219], v[188:191]
    buffer_load_dwordx4 v4, s[32:35], s58 offen offset:0 lds
    v_mfma_f32_16x16x32_bf16 v[128:131], a[80:83], a[208:211], v[128:131]
    ds_read_b64_tr_b16 a[100:101], v18 offset:16384
    ds_read_b64_tr_b16 a[102:103], v18 offset:17408
    v_mfma_f32_16x16x32_bf16 v[160:163], a[80:83], a[212:215], v[160:163]
    ds_read_b64_tr_b16 a[104:105], v19 offset:16384
    ds_read_b64_tr_b16 a[106:107], v19 offset:17408
    v_mfma_f32_16x16x32_bf16 v[132:135], a[84:87], a[208:211], v[132:135]
    ds_read_b64_tr_b16 a[108:109], v20 offset:16384
    ds_read_b64_tr_b16 a[110:111], v20 offset:17408
    v_mfma_f32_16x16x32_bf16 v[164:167], a[84:87], a[212:215], v[164:167]
    ds_read_b64_tr_b16 a[112:113], v21 offset:16384
    ds_read_b64_tr_b16 a[114:115], v21 offset:17408
    v_mfma_f32_16x16x32_bf16 v[136:139], a[88:91], a[208:211], v[136:139]
    buffer_load_dwordx4 v5, s[32:35], s58 offen offset:1024 lds
    v_mfma_f32_16x16x32_bf16 v[168:171], a[88:91], a[212:215], v[168:171]
    ds_read_b64_tr_b16 a[116:117], v22 offset:16384
    ds_read_b64_tr_b16 a[118:119], v22 offset:17408
    v_mfma_f32_16x16x32_bf16 v[140:143], a[92:95], a[208:211], v[140:143]
    ds_read_b64_tr_b16 a[120:121], v23 offset:16384
    ds_read_b64_tr_b16 a[122:123], v23 offset:17408
    v_mfma_f32_16x16x32_bf16 v[172:175], a[92:95], a[212:215], v[172:175]
    s_waitcnt lgkmcnt(12)
    ds_read_b64_tr_b16 a[124:125], v24 offset:16384
    ds_read_b64_tr_b16 a[126:127], v24 offset:17408
    v_mfma_f32_16x16x32_bf16 v[112:115], a[96:99], a[220:223], v[112:115]
    v_mfma_f32_16x16x32_bf16 v[144:147], a[96:99], a[224:227], v[144:147]
    buffer_load_dwordx4 v6, s[32:35], s58 offen offset:2048 lds
    v_mfma_f32_16x16x32_bf16 v[176:179], a[96:99], a[228:231], v[176:179]
    s_waitcnt lgkmcnt(12)
    v_mfma_f32_16x16x32_bf16 v[116:119], a[100:103], a[220:223], v[116:119]
    v_mfma_f32_16x16x32_bf16 v[148:151], a[100:103], a[224:227], v[148:151]
    v_mfma_f32_16x16x32_bf16 v[180:183], a[100:103], a[228:231], v[180:183]
    s_waitcnt lgkmcnt(10)
    v_mfma_f32_16x16x32_bf16 v[120:123], a[104:107], a[220:223], v[120:123]
    buffer_load_dwordx4 v7, s[32:35], s58 offen offset:3072 lds
    v_mfma_f32_16x16x32_bf16 v[152:155], a[104:107], a[224:227], v[152:155]
    s_waitcnt vmcnt(4) lgkmcnt(0)
    v_mfma_f32_16x16x32_bf16 v[184:187], a[104:107], a[228:231], v[184:187]
    s_barrier
    ds_read_b128 a[208:211], v25 offset:10240
    v_mfma_f32_16x16x32_bf16 v[124:127], a[108:111], a[220:223], v[124:127]
    s_mov_b32 s57, 640
    s_add_u32 m0, s56, 0
    ds_read_b128 a[212:215], v27 offset:10240
    v_mfma_f32_16x16x32_bf16 v[156:159], a[108:111], a[224:227], v[156:159]
    buffer_load_dwordx4 v8, s[20:23], s57 offen offset:0 lds
    v_mfma_f32_16x16x32_bf16 v[188:191], a[108:111], a[228:231], v[188:191]
    ds_read_b128 a[216:219], v29 offset:10240
    ds_read_b64_tr_b16 a[64:65], v17 offset:32768
    v_mfma_f32_16x16x32_bf16 v[128:131], a[112:115], a[220:223], v[128:131]
    buffer_load_dwordx4 v9, s[20:23], s57 offen offset:1024 lds
    v_mfma_f32_16x16x32_bf16 v[160:163], a[112:115], a[224:227], v[160:163]
    ds_read_b64_tr_b16 a[66:67], v17 offset:33792
    ds_read_b64_tr_b16 a[68:69], v18 offset:32768
    v_mfma_f32_16x16x32_bf16 v[132:135], a[116:119], a[220:223], v[132:135]
    ds_read_b64_tr_b16 a[70:71], v18 offset:33792
    ds_read_b64_tr_b16 a[72:73], v19 offset:32768
    v_mfma_f32_16x16x32_bf16 v[164:167], a[116:119], a[224:227], v[164:167]
    s_mov_b32 exec_hi, 0
    buffer_load_dwordx4 v10, s[20:23], s57 offen offset:2048 lds
    s_mov_b32 exec_hi, -1
    v_mfma_f32_16x16x32_bf16 v[136:139], a[120:123], a[220:223], v[136:139]
    s_mov_b32 s58, 2621440
    ds_read_b64_tr_b16 a[74:75], v19 offset:33792
    ds_read_b64_tr_b16 a[76:77], v20 offset:32768
    v_mfma_f32_16x16x32_bf16 v[168:171], a[120:123], a[224:227], v[168:171]
    s_add_u32 m0, s55, 131072
    ds_read_b64_tr_b16 a[78:79], v20 offset:33792
    ds_read_b64_tr_b16 a[80:81], v21 offset:32768
    v_mfma_f32_16x16x32_bf16 v[140:143], a[124:127], a[220:223], v[140:143]
standalone__gqa_block_cached__near_ridge_a_h0_0:
    s_cbranch_execz standalone__gqa_block_cached__near_ridge_a_h0_4
    buffer_load_dwordx4 v4, s[32:35], s58 offen offset:0 lds
    v_mfma_f32_16x16x32_bf16 v[172:175], a[124:127], a[224:227], v[172:175]
    s_waitcnt lgkmcnt(7)
    ds_read_b64_tr_b16 a[82:83], v21 offset:33792
    ds_read_b64_tr_b16 a[84:85], v22 offset:32768
    v_mfma_f32_16x16x32_bf16 v[112:115], a[64:67], a[208:211], v[112:115]
    ds_read_b64_tr_b16 a[86:87], v22 offset:33792
    ds_read_b64_tr_b16 a[88:89], v23 offset:32768
    v_mfma_f32_16x16x32_bf16 v[144:147], a[64:67], a[212:215], v[144:147]
    buffer_load_dwordx4 v5, s[32:35], s58 offen offset:1024 lds
    v_mfma_f32_16x16x32_bf16 v[176:179], a[64:67], a[216:219], v[176:179]
    s_waitcnt lgkmcnt(9)
    ds_read_b64_tr_b16 a[90:91], v23 offset:33792
    ds_read_b64_tr_b16 a[92:93], v24 offset:32768
    v_mfma_f32_16x16x32_bf16 v[116:119], a[68:71], a[208:211], v[116:119]
    ds_read_b64_tr_b16 a[94:95], v24 offset:33792
    v_mfma_f32_16x16x32_bf16 v[148:151], a[68:71], a[212:215], v[148:151]
    buffer_load_dwordx4 v6, s[32:35], s58 offen offset:2048 lds
    v_mfma_f32_16x16x32_bf16 v[180:183], a[68:71], a[216:219], v[180:183]
    s_waitcnt lgkmcnt(10)
    v_mfma_f32_16x16x32_bf16 v[120:123], a[72:75], a[208:211], v[120:123]
    v_mfma_f32_16x16x32_bf16 v[152:155], a[72:75], a[212:215], v[152:155]
    s_waitcnt vmcnt(6) lgkmcnt(0)
    buffer_load_dwordx4 v7, s[32:35], s58 offen offset:3072 lds
    v_mfma_f32_16x16x32_bf16 v[184:187], a[72:75], a[216:219], v[184:187]
    s_barrier
    ds_read_b128 a[220:223], v26 offset:10240
    v_mfma_f32_16x16x32_bf16 v[124:127], a[76:79], a[208:211], v[124:127]
    s_mov_b32 s58, 2883584
    ds_read_b128 a[224:227], v28 offset:10240
    ds_read_b128 a[228:231], v30 offset:10240
    v_mfma_f32_16x16x32_bf16 v[156:159], a[76:79], a[212:215], v[156:159]
    s_add_u32 m0, s55, 147456
    ds_read_b64_tr_b16 a[96:97], v17 offset:0
    ds_read_b64_tr_b16 a[98:99], v17 offset:1024
    v_mfma_f32_16x16x32_bf16 v[188:191], a[76:79], a[216:219], v[188:191]
    buffer_load_dwordx4 v4, s[32:35], s58 offen offset:0 lds
    v_mfma_f32_16x16x32_bf16 v[128:131], a[80:83], a[208:211], v[128:131]
    ds_read_b64_tr_b16 a[100:101], v18 offset:0
    ds_read_b64_tr_b16 a[102:103], v18 offset:1024
    v_mfma_f32_16x16x32_bf16 v[160:163], a[80:83], a[212:215], v[160:163]
    ds_read_b64_tr_b16 a[104:105], v19 offset:0
    ds_read_b64_tr_b16 a[106:107], v19 offset:1024
    v_mfma_f32_16x16x32_bf16 v[132:135], a[84:87], a[208:211], v[132:135]
    ds_read_b64_tr_b16 a[108:109], v20 offset:0
    ds_read_b64_tr_b16 a[110:111], v20 offset:1024
    v_mfma_f32_16x16x32_bf16 v[164:167], a[84:87], a[212:215], v[164:167]
    ds_read_b64_tr_b16 a[112:113], v21 offset:0
    ds_read_b64_tr_b16 a[114:115], v21 offset:1024
    v_mfma_f32_16x16x32_bf16 v[136:139], a[88:91], a[208:211], v[136:139]
    buffer_load_dwordx4 v5, s[32:35], s58 offen offset:1024 lds
    v_mfma_f32_16x16x32_bf16 v[168:171], a[88:91], a[212:215], v[168:171]
    ds_read_b64_tr_b16 a[116:117], v22 offset:0
    ds_read_b64_tr_b16 a[118:119], v22 offset:1024
    v_mfma_f32_16x16x32_bf16 v[140:143], a[92:95], a[208:211], v[140:143]
    ds_read_b64_tr_b16 a[120:121], v23 offset:0
    ds_read_b64_tr_b16 a[122:123], v23 offset:1024
    v_mfma_f32_16x16x32_bf16 v[172:175], a[92:95], a[212:215], v[172:175]
    s_waitcnt lgkmcnt(12)
    ds_read_b64_tr_b16 a[124:125], v24 offset:0
    ds_read_b64_tr_b16 a[126:127], v24 offset:1024
    v_mfma_f32_16x16x32_bf16 v[112:115], a[96:99], a[220:223], v[112:115]
    v_mfma_f32_16x16x32_bf16 v[144:147], a[96:99], a[224:227], v[144:147]
    buffer_load_dwordx4 v6, s[32:35], s58 offen offset:2048 lds
    v_mfma_f32_16x16x32_bf16 v[176:179], a[96:99], a[228:231], v[176:179]
    s_waitcnt lgkmcnt(12)
    v_mfma_f32_16x16x32_bf16 v[116:119], a[100:103], a[220:223], v[116:119]
    v_mfma_f32_16x16x32_bf16 v[148:151], a[100:103], a[224:227], v[148:151]
    v_mfma_f32_16x16x32_bf16 v[180:183], a[100:103], a[228:231], v[180:183]
    s_waitcnt lgkmcnt(10)
    v_mfma_f32_16x16x32_bf16 v[120:123], a[104:107], a[220:223], v[120:123]
    buffer_load_dwordx4 v7, s[32:35], s58 offen offset:3072 lds
    v_mfma_f32_16x16x32_bf16 v[152:155], a[104:107], a[224:227], v[152:155]
    s_waitcnt vmcnt(4) lgkmcnt(0)
    v_mfma_f32_16x16x32_bf16 v[184:187], a[104:107], a[228:231], v[184:187]
    s_barrier
    ds_read_b128 a[208:211], v25 offset:0
    v_mfma_f32_16x16x32_bf16 v[124:127], a[108:111], a[220:223], v[124:127]
    s_mov_b32 s57, 768
    s_add_u32 m0, s56, 10240
    ds_read_b128 a[212:215], v27 offset:0
    v_mfma_f32_16x16x32_bf16 v[156:159], a[108:111], a[224:227], v[156:159]
    buffer_load_dwordx4 v8, s[20:23], s57 offen offset:0 lds
    v_mfma_f32_16x16x32_bf16 v[188:191], a[108:111], a[228:231], v[188:191]
    ds_read_b128 a[216:219], v29 offset:0
    ds_read_b64_tr_b16 a[64:65], v17 offset:16384
    v_mfma_f32_16x16x32_bf16 v[128:131], a[112:115], a[220:223], v[128:131]
    buffer_load_dwordx4 v9, s[20:23], s57 offen offset:1024 lds
    v_mfma_f32_16x16x32_bf16 v[160:163], a[112:115], a[224:227], v[160:163]
    ds_read_b64_tr_b16 a[66:67], v17 offset:17408
    ds_read_b64_tr_b16 a[68:69], v18 offset:16384
    v_mfma_f32_16x16x32_bf16 v[132:135], a[116:119], a[220:223], v[132:135]
    ds_read_b64_tr_b16 a[70:71], v18 offset:17408
    ds_read_b64_tr_b16 a[72:73], v19 offset:16384
    v_mfma_f32_16x16x32_bf16 v[164:167], a[116:119], a[224:227], v[164:167]
    s_mov_b32 exec_hi, 0
    buffer_load_dwordx4 v10, s[20:23], s57 offen offset:2048 lds
    s_mov_b32 exec_hi, -1
    v_mfma_f32_16x16x32_bf16 v[136:139], a[120:123], a[220:223], v[136:139]
    s_mov_b32 s58, 3145728
    ds_read_b64_tr_b16 a[74:75], v19 offset:17408
    ds_read_b64_tr_b16 a[76:77], v20 offset:16384
    v_mfma_f32_16x16x32_bf16 v[168:171], a[120:123], a[224:227], v[168:171]
    s_add_u32 m0, s55, 114688
    ds_read_b64_tr_b16 a[78:79], v20 offset:17408
    ds_read_b64_tr_b16 a[80:81], v21 offset:16384
    v_mfma_f32_16x16x32_bf16 v[140:143], a[124:127], a[220:223], v[140:143]
    buffer_load_dwordx4 v4, s[32:35], s58 offen offset:0 lds
    v_mfma_f32_16x16x32_bf16 v[172:175], a[124:127], a[224:227], v[172:175]
    s_waitcnt lgkmcnt(7)
    ds_read_b64_tr_b16 a[82:83], v21 offset:17408
    ds_read_b64_tr_b16 a[84:85], v22 offset:16384
    v_mfma_f32_16x16x32_bf16 v[112:115], a[64:67], a[208:211], v[112:115]
    ds_read_b64_tr_b16 a[86:87], v22 offset:17408
    ds_read_b64_tr_b16 a[88:89], v23 offset:16384
    v_mfma_f32_16x16x32_bf16 v[144:147], a[64:67], a[212:215], v[144:147]
    buffer_load_dwordx4 v5, s[32:35], s58 offen offset:1024 lds
    v_mfma_f32_16x16x32_bf16 v[176:179], a[64:67], a[216:219], v[176:179]
    s_waitcnt lgkmcnt(9)
    ds_read_b64_tr_b16 a[90:91], v23 offset:17408
    ds_read_b64_tr_b16 a[92:93], v24 offset:16384
    v_mfma_f32_16x16x32_bf16 v[116:119], a[68:71], a[208:211], v[116:119]
    ds_read_b64_tr_b16 a[94:95], v24 offset:17408
    v_mfma_f32_16x16x32_bf16 v[148:151], a[68:71], a[212:215], v[148:151]
    buffer_load_dwordx4 v6, s[32:35], s58 offen offset:2048 lds
    v_mfma_f32_16x16x32_bf16 v[180:183], a[68:71], a[216:219], v[180:183]
    s_waitcnt lgkmcnt(10)
    v_mfma_f32_16x16x32_bf16 v[120:123], a[72:75], a[208:211], v[120:123]
    v_mfma_f32_16x16x32_bf16 v[152:155], a[72:75], a[212:215], v[152:155]
    s_waitcnt vmcnt(6) lgkmcnt(0)
    buffer_load_dwordx4 v7, s[32:35], s58 offen offset:3072 lds
    v_mfma_f32_16x16x32_bf16 v[184:187], a[72:75], a[216:219], v[184:187]
    s_barrier
    ds_read_b128 a[220:223], v26 offset:0
    v_mfma_f32_16x16x32_bf16 v[124:127], a[76:79], a[208:211], v[124:127]
    s_mov_b32 s58, 3407872
    ds_read_b128 a[224:227], v28 offset:0
    ds_read_b128 a[228:231], v30 offset:0
    v_mfma_f32_16x16x32_bf16 v[156:159], a[76:79], a[212:215], v[156:159]
    s_add_u32 m0, s55, 131072
    ds_read_b64_tr_b16 a[96:97], v17 offset:32768
    ds_read_b64_tr_b16 a[98:99], v17 offset:33792
    v_mfma_f32_16x16x32_bf16 v[188:191], a[76:79], a[216:219], v[188:191]
    buffer_load_dwordx4 v4, s[32:35], s58 offen offset:0 lds
    v_mfma_f32_16x16x32_bf16 v[128:131], a[80:83], a[208:211], v[128:131]
    ds_read_b64_tr_b16 a[100:101], v18 offset:32768
    ds_read_b64_tr_b16 a[102:103], v18 offset:33792
    v_mfma_f32_16x16x32_bf16 v[160:163], a[80:83], a[212:215], v[160:163]
    ds_read_b64_tr_b16 a[104:105], v19 offset:32768
    ds_read_b64_tr_b16 a[106:107], v19 offset:33792
    v_mfma_f32_16x16x32_bf16 v[132:135], a[84:87], a[208:211], v[132:135]
    ds_read_b64_tr_b16 a[108:109], v20 offset:32768
    ds_read_b64_tr_b16 a[110:111], v20 offset:33792
    v_mfma_f32_16x16x32_bf16 v[164:167], a[84:87], a[212:215], v[164:167]
    ds_read_b64_tr_b16 a[112:113], v21 offset:32768
    ds_read_b64_tr_b16 a[114:115], v21 offset:33792
    v_mfma_f32_16x16x32_bf16 v[136:139], a[88:91], a[208:211], v[136:139]
    buffer_load_dwordx4 v5, s[32:35], s58 offen offset:1024 lds
    v_mfma_f32_16x16x32_bf16 v[168:171], a[88:91], a[212:215], v[168:171]
    ds_read_b64_tr_b16 a[116:117], v22 offset:32768
    ds_read_b64_tr_b16 a[118:119], v22 offset:33792
    v_mfma_f32_16x16x32_bf16 v[140:143], a[92:95], a[208:211], v[140:143]
    ds_read_b64_tr_b16 a[120:121], v23 offset:32768
    ds_read_b64_tr_b16 a[122:123], v23 offset:33792
    v_mfma_f32_16x16x32_bf16 v[172:175], a[92:95], a[212:215], v[172:175]
    s_waitcnt lgkmcnt(12)
    ds_read_b64_tr_b16 a[124:125], v24 offset:32768
    ds_read_b64_tr_b16 a[126:127], v24 offset:33792
    v_mfma_f32_16x16x32_bf16 v[112:115], a[96:99], a[220:223], v[112:115]
    v_mfma_f32_16x16x32_bf16 v[144:147], a[96:99], a[224:227], v[144:147]
    buffer_load_dwordx4 v6, s[32:35], s58 offen offset:2048 lds
    v_mfma_f32_16x16x32_bf16 v[176:179], a[96:99], a[228:231], v[176:179]
    s_waitcnt lgkmcnt(12)
    v_mfma_f32_16x16x32_bf16 v[116:119], a[100:103], a[220:223], v[116:119]
    v_mfma_f32_16x16x32_bf16 v[148:151], a[100:103], a[224:227], v[148:151]
    v_mfma_f32_16x16x32_bf16 v[180:183], a[100:103], a[228:231], v[180:183]
    s_waitcnt lgkmcnt(10)
    v_mfma_f32_16x16x32_bf16 v[120:123], a[104:107], a[220:223], v[120:123]
    buffer_load_dwordx4 v7, s[32:35], s58 offen offset:3072 lds
    v_mfma_f32_16x16x32_bf16 v[152:155], a[104:107], a[224:227], v[152:155]
    s_waitcnt vmcnt(4) lgkmcnt(0)
    v_mfma_f32_16x16x32_bf16 v[184:187], a[104:107], a[228:231], v[184:187]
    s_barrier
    ds_read_b128 a[208:211], v25 offset:10240
    v_mfma_f32_16x16x32_bf16 v[124:127], a[108:111], a[220:223], v[124:127]
    s_mov_b32 s57, 896
    s_add_u32 m0, s56, 0
    ds_read_b128 a[212:215], v27 offset:10240
    v_mfma_f32_16x16x32_bf16 v[156:159], a[108:111], a[224:227], v[156:159]
    buffer_load_dwordx4 v8, s[20:23], s57 offen offset:0 lds
    v_mfma_f32_16x16x32_bf16 v[188:191], a[108:111], a[228:231], v[188:191]
    ds_read_b128 a[216:219], v29 offset:10240
    ds_read_b64_tr_b16 a[64:65], v17 offset:0
    v_mfma_f32_16x16x32_bf16 v[128:131], a[112:115], a[220:223], v[128:131]
    buffer_load_dwordx4 v9, s[20:23], s57 offen offset:1024 lds
    v_mfma_f32_16x16x32_bf16 v[160:163], a[112:115], a[224:227], v[160:163]
    ds_read_b64_tr_b16 a[66:67], v17 offset:1024
    ds_read_b64_tr_b16 a[68:69], v18 offset:0
    v_mfma_f32_16x16x32_bf16 v[132:135], a[116:119], a[220:223], v[132:135]
    ds_read_b64_tr_b16 a[70:71], v18 offset:1024
    ds_read_b64_tr_b16 a[72:73], v19 offset:0
    v_mfma_f32_16x16x32_bf16 v[164:167], a[116:119], a[224:227], v[164:167]
    s_mov_b32 exec_hi, 0
    buffer_load_dwordx4 v10, s[20:23], s57 offen offset:2048 lds
    s_mov_b32 exec_hi, -1
    v_mfma_f32_16x16x32_bf16 v[136:139], a[120:123], a[220:223], v[136:139]
    s_mov_b32 s58, 3670016
    ds_read_b64_tr_b16 a[74:75], v19 offset:1024
    ds_read_b64_tr_b16 a[76:77], v20 offset:0
    v_mfma_f32_16x16x32_bf16 v[168:171], a[120:123], a[224:227], v[168:171]
    s_add_u32 m0, s55, 147456
    ds_read_b64_tr_b16 a[78:79], v20 offset:1024
    ds_read_b64_tr_b16 a[80:81], v21 offset:0
    v_mfma_f32_16x16x32_bf16 v[140:143], a[124:127], a[220:223], v[140:143]
    buffer_load_dwordx4 v4, s[32:35], s58 offen offset:0 lds
    v_mfma_f32_16x16x32_bf16 v[172:175], a[124:127], a[224:227], v[172:175]
    s_waitcnt lgkmcnt(7)
    ds_read_b64_tr_b16 a[82:83], v21 offset:1024
    ds_read_b64_tr_b16 a[84:85], v22 offset:0
    v_mfma_f32_16x16x32_bf16 v[112:115], a[64:67], a[208:211], v[112:115]
    ds_read_b64_tr_b16 a[86:87], v22 offset:1024
    ds_read_b64_tr_b16 a[88:89], v23 offset:0
    v_mfma_f32_16x16x32_bf16 v[144:147], a[64:67], a[212:215], v[144:147]
    buffer_load_dwordx4 v5, s[32:35], s58 offen offset:1024 lds
    v_mfma_f32_16x16x32_bf16 v[176:179], a[64:67], a[216:219], v[176:179]
    s_waitcnt lgkmcnt(9)
    ds_read_b64_tr_b16 a[90:91], v23 offset:1024
    ds_read_b64_tr_b16 a[92:93], v24 offset:0
    v_mfma_f32_16x16x32_bf16 v[116:119], a[68:71], a[208:211], v[116:119]
    ds_read_b64_tr_b16 a[94:95], v24 offset:1024
    v_mfma_f32_16x16x32_bf16 v[148:151], a[68:71], a[212:215], v[148:151]
    buffer_load_dwordx4 v6, s[32:35], s58 offen offset:2048 lds
    v_mfma_f32_16x16x32_bf16 v[180:183], a[68:71], a[216:219], v[180:183]
    s_waitcnt lgkmcnt(10)
    v_mfma_f32_16x16x32_bf16 v[120:123], a[72:75], a[208:211], v[120:123]
    v_mfma_f32_16x16x32_bf16 v[152:155], a[72:75], a[212:215], v[152:155]
    s_waitcnt vmcnt(6) lgkmcnt(0)
    buffer_load_dwordx4 v7, s[32:35], s58 offen offset:3072 lds
    v_mfma_f32_16x16x32_bf16 v[184:187], a[72:75], a[216:219], v[184:187]
    s_barrier
    ds_read_b128 a[220:223], v26 offset:10240
    v_mfma_f32_16x16x32_bf16 v[124:127], a[76:79], a[208:211], v[124:127]
    s_mov_b32 s58, 3932160
    ds_read_b128 a[224:227], v28 offset:10240
    ds_read_b128 a[228:231], v30 offset:10240
    v_mfma_f32_16x16x32_bf16 v[156:159], a[76:79], a[212:215], v[156:159]
    s_add_u32 m0, s55, 114688
    ds_read_b64_tr_b16 a[96:97], v17 offset:16384
    ds_read_b64_tr_b16 a[98:99], v17 offset:17408
    v_mfma_f32_16x16x32_bf16 v[188:191], a[76:79], a[216:219], v[188:191]
    buffer_load_dwordx4 v4, s[32:35], s58 offen offset:0 lds
    v_mfma_f32_16x16x32_bf16 v[128:131], a[80:83], a[208:211], v[128:131]
    ds_read_b64_tr_b16 a[100:101], v18 offset:16384
    ds_read_b64_tr_b16 a[102:103], v18 offset:17408
    v_mfma_f32_16x16x32_bf16 v[160:163], a[80:83], a[212:215], v[160:163]
    ds_read_b64_tr_b16 a[104:105], v19 offset:16384
    ds_read_b64_tr_b16 a[106:107], v19 offset:17408
    v_mfma_f32_16x16x32_bf16 v[132:135], a[84:87], a[208:211], v[132:135]
    ds_read_b64_tr_b16 a[108:109], v20 offset:16384
    ds_read_b64_tr_b16 a[110:111], v20 offset:17408
    v_mfma_f32_16x16x32_bf16 v[164:167], a[84:87], a[212:215], v[164:167]
    ds_read_b64_tr_b16 a[112:113], v21 offset:16384
    ds_read_b64_tr_b16 a[114:115], v21 offset:17408
    v_mfma_f32_16x16x32_bf16 v[136:139], a[88:91], a[208:211], v[136:139]
    buffer_load_dwordx4 v5, s[32:35], s58 offen offset:1024 lds
    v_mfma_f32_16x16x32_bf16 v[168:171], a[88:91], a[212:215], v[168:171]
    ds_read_b64_tr_b16 a[116:117], v22 offset:16384
    ds_read_b64_tr_b16 a[118:119], v22 offset:17408
    v_mfma_f32_16x16x32_bf16 v[140:143], a[92:95], a[208:211], v[140:143]
    ds_read_b64_tr_b16 a[120:121], v23 offset:16384
    ds_read_b64_tr_b16 a[122:123], v23 offset:17408
    v_mfma_f32_16x16x32_bf16 v[172:175], a[92:95], a[212:215], v[172:175]
    s_waitcnt lgkmcnt(12)
    ds_read_b64_tr_b16 a[124:125], v24 offset:16384
    ds_read_b64_tr_b16 a[126:127], v24 offset:17408
    v_mfma_f32_16x16x32_bf16 v[112:115], a[96:99], a[220:223], v[112:115]
    v_mfma_f32_16x16x32_bf16 v[144:147], a[96:99], a[224:227], v[144:147]
    buffer_load_dwordx4 v6, s[32:35], s58 offen offset:2048 lds
    v_mfma_f32_16x16x32_bf16 v[176:179], a[96:99], a[228:231], v[176:179]
    s_waitcnt lgkmcnt(12)
    v_mfma_f32_16x16x32_bf16 v[116:119], a[100:103], a[220:223], v[116:119]
    v_mfma_f32_16x16x32_bf16 v[148:151], a[100:103], a[224:227], v[148:151]
    v_mfma_f32_16x16x32_bf16 v[180:183], a[100:103], a[228:231], v[180:183]
    s_waitcnt lgkmcnt(10)
    v_mfma_f32_16x16x32_bf16 v[120:123], a[104:107], a[220:223], v[120:123]
    buffer_load_dwordx4 v7, s[32:35], s58 offen offset:3072 lds
    v_mfma_f32_16x16x32_bf16 v[152:155], a[104:107], a[224:227], v[152:155]
    s_waitcnt vmcnt(4) lgkmcnt(0)
    v_mfma_f32_16x16x32_bf16 v[184:187], a[104:107], a[228:231], v[184:187]
    s_barrier
    ds_read_b128 a[208:211], v25 offset:0
    v_mfma_f32_16x16x32_bf16 v[124:127], a[108:111], a[220:223], v[124:127]
    s_mov_b32 s57, 1024
    s_add_u32 m0, s56, 10240
    ds_read_b128 a[212:215], v27 offset:0
    v_mfma_f32_16x16x32_bf16 v[156:159], a[108:111], a[224:227], v[156:159]
    buffer_load_dwordx4 v8, s[20:23], s57 offen offset:0 lds
    v_mfma_f32_16x16x32_bf16 v[188:191], a[108:111], a[228:231], v[188:191]
    ds_read_b128 a[216:219], v29 offset:0
    ds_read_b64_tr_b16 a[64:65], v17 offset:32768
    v_mfma_f32_16x16x32_bf16 v[128:131], a[112:115], a[220:223], v[128:131]
    buffer_load_dwordx4 v9, s[20:23], s57 offen offset:1024 lds
    v_mfma_f32_16x16x32_bf16 v[160:163], a[112:115], a[224:227], v[160:163]
    ds_read_b64_tr_b16 a[66:67], v17 offset:33792
    ds_read_b64_tr_b16 a[68:69], v18 offset:32768
    v_mfma_f32_16x16x32_bf16 v[132:135], a[116:119], a[220:223], v[132:135]
    ds_read_b64_tr_b16 a[70:71], v18 offset:33792
    ds_read_b64_tr_b16 a[72:73], v19 offset:32768
    v_mfma_f32_16x16x32_bf16 v[164:167], a[116:119], a[224:227], v[164:167]
    s_mov_b32 exec_hi, 0
    buffer_load_dwordx4 v10, s[20:23], s57 offen offset:2048 lds
    s_mov_b32 exec_hi, -1
    v_mfma_f32_16x16x32_bf16 v[136:139], a[120:123], a[220:223], v[136:139]
    s_mov_b32 s58, 4194304
    ds_read_b64_tr_b16 a[74:75], v19 offset:33792
    ds_read_b64_tr_b16 a[76:77], v20 offset:32768
    v_mfma_f32_16x16x32_bf16 v[168:171], a[120:123], a[224:227], v[168:171]
    s_add_u32 m0, s55, 131072
    ds_read_b64_tr_b16 a[78:79], v20 offset:33792
    ds_read_b64_tr_b16 a[80:81], v21 offset:32768
    v_mfma_f32_16x16x32_bf16 v[140:143], a[124:127], a[220:223], v[140:143]
    buffer_load_dwordx4 v4, s[32:35], s58 offen offset:0 lds
    v_mfma_f32_16x16x32_bf16 v[172:175], a[124:127], a[224:227], v[172:175]
    s_waitcnt lgkmcnt(7)
    ds_read_b64_tr_b16 a[82:83], v21 offset:33792
    ds_read_b64_tr_b16 a[84:85], v22 offset:32768
    v_mfma_f32_16x16x32_bf16 v[112:115], a[64:67], a[208:211], v[112:115]
    ds_read_b64_tr_b16 a[86:87], v22 offset:33792
    ds_read_b64_tr_b16 a[88:89], v23 offset:32768
    v_mfma_f32_16x16x32_bf16 v[144:147], a[64:67], a[212:215], v[144:147]
    buffer_load_dwordx4 v5, s[32:35], s58 offen offset:1024 lds
    v_mfma_f32_16x16x32_bf16 v[176:179], a[64:67], a[216:219], v[176:179]
    s_waitcnt lgkmcnt(9)
    ds_read_b64_tr_b16 a[90:91], v23 offset:33792
    ds_read_b64_tr_b16 a[92:93], v24 offset:32768
    v_mfma_f32_16x16x32_bf16 v[116:119], a[68:71], a[208:211], v[116:119]
    ds_read_b64_tr_b16 a[94:95], v24 offset:33792
    v_mfma_f32_16x16x32_bf16 v[148:151], a[68:71], a[212:215], v[148:151]
    buffer_load_dwordx4 v6, s[32:35], s58 offen offset:2048 lds
    v_mfma_f32_16x16x32_bf16 v[180:183], a[68:71], a[216:219], v[180:183]
    s_waitcnt lgkmcnt(10)
    v_mfma_f32_16x16x32_bf16 v[120:123], a[72:75], a[208:211], v[120:123]
    v_mfma_f32_16x16x32_bf16 v[152:155], a[72:75], a[212:215], v[152:155]
    s_waitcnt vmcnt(6) lgkmcnt(0)
    buffer_load_dwordx4 v7, s[32:35], s58 offen offset:3072 lds
    v_mfma_f32_16x16x32_bf16 v[184:187], a[72:75], a[216:219], v[184:187]
    s_barrier
    ds_read_b128 a[220:223], v26 offset:0
    v_mfma_f32_16x16x32_bf16 v[124:127], a[76:79], a[208:211], v[124:127]
    s_mov_b32 s58, 4456448
    ds_read_b128 a[224:227], v28 offset:0
    ds_read_b128 a[228:231], v30 offset:0
    v_mfma_f32_16x16x32_bf16 v[156:159], a[76:79], a[212:215], v[156:159]
    s_add_u32 m0, s55, 147456
    ds_read_b64_tr_b16 a[96:97], v17 offset:0
    ds_read_b64_tr_b16 a[98:99], v17 offset:1024
    v_mfma_f32_16x16x32_bf16 v[188:191], a[76:79], a[216:219], v[188:191]
    buffer_load_dwordx4 v4, s[32:35], s58 offen offset:0 lds
    v_mfma_f32_16x16x32_bf16 v[128:131], a[80:83], a[208:211], v[128:131]
    ds_read_b64_tr_b16 a[100:101], v18 offset:0
    ds_read_b64_tr_b16 a[102:103], v18 offset:1024
    v_mfma_f32_16x16x32_bf16 v[160:163], a[80:83], a[212:215], v[160:163]
    ds_read_b64_tr_b16 a[104:105], v19 offset:0
    ds_read_b64_tr_b16 a[106:107], v19 offset:1024
    v_mfma_f32_16x16x32_bf16 v[132:135], a[84:87], a[208:211], v[132:135]
    ds_read_b64_tr_b16 a[108:109], v20 offset:0
    ds_read_b64_tr_b16 a[110:111], v20 offset:1024
    v_mfma_f32_16x16x32_bf16 v[164:167], a[84:87], a[212:215], v[164:167]
    ds_read_b64_tr_b16 a[112:113], v21 offset:0
    ds_read_b64_tr_b16 a[114:115], v21 offset:1024
    v_mfma_f32_16x16x32_bf16 v[136:139], a[88:91], a[208:211], v[136:139]
    buffer_load_dwordx4 v5, s[32:35], s58 offen offset:1024 lds
    v_mfma_f32_16x16x32_bf16 v[168:171], a[88:91], a[212:215], v[168:171]
    ds_read_b64_tr_b16 a[116:117], v22 offset:0
    ds_read_b64_tr_b16 a[118:119], v22 offset:1024
    v_mfma_f32_16x16x32_bf16 v[140:143], a[92:95], a[208:211], v[140:143]
    ds_read_b64_tr_b16 a[120:121], v23 offset:0
    ds_read_b64_tr_b16 a[122:123], v23 offset:1024
    v_mfma_f32_16x16x32_bf16 v[172:175], a[92:95], a[212:215], v[172:175]
    s_waitcnt lgkmcnt(12)
    ds_read_b64_tr_b16 a[124:125], v24 offset:0
    ds_read_b64_tr_b16 a[126:127], v24 offset:1024
    v_mfma_f32_16x16x32_bf16 v[112:115], a[96:99], a[220:223], v[112:115]
    v_mfma_f32_16x16x32_bf16 v[144:147], a[96:99], a[224:227], v[144:147]
    buffer_load_dwordx4 v6, s[32:35], s58 offen offset:2048 lds
    v_mfma_f32_16x16x32_bf16 v[176:179], a[96:99], a[228:231], v[176:179]
    s_waitcnt lgkmcnt(12)
    v_mfma_f32_16x16x32_bf16 v[116:119], a[100:103], a[220:223], v[116:119]
    v_mfma_f32_16x16x32_bf16 v[148:151], a[100:103], a[224:227], v[148:151]
    v_mfma_f32_16x16x32_bf16 v[180:183], a[100:103], a[228:231], v[180:183]
    s_waitcnt lgkmcnt(10)
    v_mfma_f32_16x16x32_bf16 v[120:123], a[104:107], a[220:223], v[120:123]
    buffer_load_dwordx4 v7, s[32:35], s58 offen offset:3072 lds
    v_mfma_f32_16x16x32_bf16 v[152:155], a[104:107], a[224:227], v[152:155]
    s_waitcnt vmcnt(4) lgkmcnt(0)
    v_mfma_f32_16x16x32_bf16 v[184:187], a[104:107], a[228:231], v[184:187]
    s_barrier
    ds_read_b128 a[208:211], v25 offset:10240
    v_mfma_f32_16x16x32_bf16 v[124:127], a[108:111], a[220:223], v[124:127]
    s_add_u32 s58, s55, 0
    ds_read_b128 a[212:215], v27 offset:10240
    ds_read_b128 a[216:219], v29 offset:10240
    v_mfma_f32_16x16x32_bf16 v[156:159], a[108:111], a[224:227], v[156:159]
    s_add_u32 m0, s55, 0
    ds_read_b64_tr_b16 a[64:65], v17 offset:16384
    ds_read_b64_tr_b16 a[66:67], v17 offset:17408
    v_mfma_f32_16x16x32_bf16 v[188:191], a[108:111], a[228:231], v[188:191]
    buffer_load_dwordx4 v11, s[24:27], s58 offen offset:0 nt lds
    v_mfma_f32_16x16x32_bf16 v[128:131], a[112:115], a[220:223], v[128:131]
    ds_read_b64_tr_b16 a[68:69], v18 offset:16384
    ds_read_b64_tr_b16 a[70:71], v18 offset:17408
    v_mfma_f32_16x16x32_bf16 v[160:163], a[112:115], a[224:227], v[160:163]
    ds_read_b64_tr_b16 a[72:73], v19 offset:16384
    ds_read_b64_tr_b16 a[74:75], v19 offset:17408
    v_mfma_f32_16x16x32_bf16 v[132:135], a[116:119], a[220:223], v[132:135]
    ds_read_b64_tr_b16 a[76:77], v20 offset:16384
    ds_read_b64_tr_b16 a[78:79], v20 offset:17408
    v_mfma_f32_16x16x32_bf16 v[164:167], a[116:119], a[224:227], v[164:167]
    ds_read_b64_tr_b16 a[80:81], v21 offset:16384
    ds_read_b64_tr_b16 a[82:83], v21 offset:17408
    v_mfma_f32_16x16x32_bf16 v[136:139], a[120:123], a[220:223], v[136:139]
    buffer_load_dwordx4 v12, s[24:27], s58 offen offset:1024 nt lds
    v_mfma_f32_16x16x32_bf16 v[168:171], a[120:123], a[224:227], v[168:171]
    ds_read_b64_tr_b16 a[84:85], v22 offset:16384
    ds_read_b64_tr_b16 a[86:87], v22 offset:17408
    v_mfma_f32_16x16x32_bf16 v[140:143], a[124:127], a[220:223], v[140:143]
    ds_read_b64_tr_b16 a[88:89], v23 offset:16384
    ds_read_b64_tr_b16 a[90:91], v23 offset:17408
    v_mfma_f32_16x16x32_bf16 v[172:175], a[124:127], a[224:227], v[172:175]
    s_waitcnt lgkmcnt(12)
    ds_read_b64_tr_b16 a[92:93], v24 offset:16384
    ds_read_b64_tr_b16 a[94:95], v24 offset:17408
    v_mfma_f32_16x16x32_bf16 v[112:115], a[64:67], a[208:211], v[112:115]
    v_mfma_f32_16x16x32_bf16 v[144:147], a[64:67], a[212:215], v[144:147]
    buffer_load_dwordx4 v13, s[24:27], s58 offen offset:2048 nt lds
    v_mfma_f32_16x16x32_bf16 v[176:179], a[64:67], a[216:219], v[176:179]
    s_waitcnt lgkmcnt(12)
    v_mfma_f32_16x16x32_bf16 v[116:119], a[68:71], a[208:211], v[116:119]
    v_mfma_f32_16x16x32_bf16 v[148:151], a[68:71], a[212:215], v[148:151]
    v_mfma_f32_16x16x32_bf16 v[180:183], a[68:71], a[216:219], v[180:183]
    s_waitcnt lgkmcnt(10)
    v_mfma_f32_16x16x32_bf16 v[120:123], a[72:75], a[208:211], v[120:123]
    buffer_load_dwordx4 v14, s[24:27], s58 offen offset:3072 nt lds
    v_mfma_f32_16x16x32_bf16 v[152:155], a[72:75], a[212:215], v[152:155]
    s_waitcnt vmcnt(4) lgkmcnt(0)
    v_mfma_f32_16x16x32_bf16 v[184:187], a[72:75], a[216:219], v[184:187]
    s_barrier
    ds_read_b128 a[220:223], v26 offset:10240
    v_mfma_f32_16x16x32_bf16 v[124:127], a[76:79], a[208:211], v[124:127]
    s_add_u32 s58, s55, 16384
    ds_read_b128 a[224:227], v28 offset:10240
    ds_read_b128 a[228:231], v30 offset:10240
    v_mfma_f32_16x16x32_bf16 v[156:159], a[76:79], a[212:215], v[156:159]
    s_add_u32 m0, s55, 16384
    ds_read_b64_tr_b16 a[96:97], v17 offset:32768
    ds_read_b64_tr_b16 a[98:99], v17 offset:33792
    v_mfma_f32_16x16x32_bf16 v[188:191], a[76:79], a[216:219], v[188:191]
    buffer_load_dwordx4 v11, s[24:27], s58 offen offset:0 nt lds
    v_mfma_f32_16x16x32_bf16 v[128:131], a[80:83], a[208:211], v[128:131]
    ds_read_b64_tr_b16 a[100:101], v18 offset:32768
    ds_read_b64_tr_b16 a[102:103], v18 offset:33792
    v_mfma_f32_16x16x32_bf16 v[160:163], a[80:83], a[212:215], v[160:163]
    ds_read_b64_tr_b16 a[104:105], v19 offset:32768
    ds_read_b64_tr_b16 a[106:107], v19 offset:33792
    v_mfma_f32_16x16x32_bf16 v[132:135], a[84:87], a[208:211], v[132:135]
    ds_read_b64_tr_b16 a[108:109], v20 offset:32768
    ds_read_b64_tr_b16 a[110:111], v20 offset:33792
    v_mfma_f32_16x16x32_bf16 v[164:167], a[84:87], a[212:215], v[164:167]
    ds_read_b64_tr_b16 a[112:113], v21 offset:32768
    ds_read_b64_tr_b16 a[114:115], v21 offset:33792
    v_mfma_f32_16x16x32_bf16 v[136:139], a[88:91], a[208:211], v[136:139]
    buffer_load_dwordx4 v12, s[24:27], s58 offen offset:1024 nt lds
    v_mfma_f32_16x16x32_bf16 v[168:171], a[88:91], a[212:215], v[168:171]
    ds_read_b64_tr_b16 a[116:117], v22 offset:32768
    ds_read_b64_tr_b16 a[118:119], v22 offset:33792
    v_mfma_f32_16x16x32_bf16 v[140:143], a[92:95], a[208:211], v[140:143]
    ds_read_b64_tr_b16 a[120:121], v23 offset:32768
    ds_read_b64_tr_b16 a[122:123], v23 offset:33792
    v_mfma_f32_16x16x32_bf16 v[172:175], a[92:95], a[212:215], v[172:175]
    s_waitcnt lgkmcnt(12)
    ds_read_b64_tr_b16 a[124:125], v24 offset:32768
    ds_read_b64_tr_b16 a[126:127], v24 offset:33792
    v_mfma_f32_16x16x32_bf16 v[112:115], a[96:99], a[220:223], v[112:115]
    v_mfma_f32_16x16x32_bf16 v[144:147], a[96:99], a[224:227], v[144:147]
    buffer_load_dwordx4 v13, s[24:27], s58 offen offset:2048 nt lds
    v_mfma_f32_16x16x32_bf16 v[176:179], a[96:99], a[228:231], v[176:179]
    s_waitcnt lgkmcnt(12)
    v_mfma_f32_16x16x32_bf16 v[116:119], a[100:103], a[220:223], v[116:119]
    v_mfma_f32_16x16x32_bf16 v[148:151], a[100:103], a[224:227], v[148:151]
    v_mfma_f32_16x16x32_bf16 v[180:183], a[100:103], a[228:231], v[180:183]
    s_waitcnt lgkmcnt(10)
    v_mfma_f32_16x16x32_bf16 v[120:123], a[104:107], a[220:223], v[120:123]
    buffer_load_dwordx4 v14, s[24:27], s58 offen offset:3072 nt lds
    v_mfma_f32_16x16x32_bf16 v[152:155], a[104:107], a[224:227], v[152:155]
    v_mfma_f32_16x16x32_bf16 v[184:187], a[104:107], a[228:231], v[184:187]
    s_waitcnt lgkmcnt(8)
    v_mfma_f32_16x16x32_bf16 v[124:127], a[108:111], a[220:223], v[124:127]
    s_add_u32 s58, s55, 0
    v_mfma_f32_16x16x32_bf16 v[156:159], a[108:111], a[224:227], v[156:159]
    s_add_u32 m0, s55, 49152
    v_mfma_f32_16x16x32_bf16 v[188:191], a[108:111], a[228:231], v[188:191]
    s_waitcnt lgkmcnt(6)
    buffer_load_dwordx4 v15, s[28:31], s58 offen offset:0 nt lds
    v_mfma_f32_16x16x32_bf16 v[128:131], a[112:115], a[220:223], v[128:131]
    v_mfma_f32_16x16x32_bf16 v[160:163], a[112:115], a[224:227], v[160:163]
    s_waitcnt lgkmcnt(4)
    v_mfma_f32_16x16x32_bf16 v[132:135], a[116:119], a[220:223], v[132:135]
    v_mfma_f32_16x16x32_bf16 v[164:167], a[116:119], a[224:227], v[164:167]
    s_waitcnt lgkmcnt(2)
    v_mfma_f32_16x16x32_bf16 v[136:139], a[120:123], a[220:223], v[136:139]
    buffer_load_dwordx4 v16, s[28:31], s58 offen offset:1024 nt lds
    v_mfma_f32_16x16x32_bf16 v[168:171], a[120:123], a[224:227], v[168:171]
    s_waitcnt lgkmcnt(0)
    v_mfma_f32_16x16x32_bf16 v[140:143], a[124:127], a[220:223], v[140:143]
    buffer_load_dwordx4 v15, s[28:31], s58 offen offset:2048 nt lds
    v_mfma_f32_16x16x32_bf16 v[172:175], a[124:127], a[224:227], v[172:175]
    buffer_load_dwordx4 v16, s[28:31], s58 offen offset:3072 nt lds
    s_lshl_b32 s57, s48, 11
    s_add_u32 s57, s57, 114688
    v_add_u32 v55, s57, v3
    v_xor_b32 v56, 2048, v55
    v_pk_mul_f32 v[176:177], v[176:177], s[60:61]
    v_pk_mul_f32 v[178:179], v[178:179], s[60:61]
    v_pk_mul_f32 v[180:181], v[180:181], s[60:61]
    v_pk_mul_f32 v[182:183], v[182:183], s[60:61]
    v_cvt_pk_bf16_f32 v96, v176, v177
    v_cvt_pk_bf16_f32 v97, v178, v179
    v_cvt_pk_bf16_f32 v98, v180, v181
    v_cvt_pk_bf16_f32 v99, v182, v183
    v_pk_mul_f32 v[184:185], v[184:185], s[60:61]
    v_pk_mul_f32 v[186:187], v[186:187], s[60:61]
    v_pk_mul_f32 v[188:189], v[188:189], s[60:61]
    v_pk_mul_f32 v[190:191], v[190:191], s[60:61]
    v_cvt_pk_bf16_f32 v100, v184, v185
    v_cvt_pk_bf16_f32 v101, v186, v187
    v_cvt_pk_bf16_f32 v102, v188, v189
    v_cvt_pk_bf16_f32 v103, v190, v191
    v_permlane16_swap_b32 v96, v98
    v_permlane16_swap_b32 v97, v99
    ds_write_b128 v55, v[96:99] offset:0
    v_pk_mul_f32 v[112:113], v[112:113], s[60:61]
    v_pk_mul_f32 v[114:115], v[114:115], s[60:61]
    v_pk_mul_f32 v[116:117], v[116:117], s[60:61]
    v_pk_mul_f32 v[118:119], v[118:119], s[60:61]
    v_cvt_pk_bf16_f32 v64, v112, v113
    v_cvt_pk_bf16_f32 v65, v114, v115
    v_cvt_pk_bf16_f32 v66, v116, v117
    v_cvt_pk_bf16_f32 v67, v118, v119
standalone__gqa_block_cached__near_ridge_a_h0_1:
    s_cbranch_execz standalone__gqa_block_cached__near_ridge_a_h0_r
    v_permlane16_swap_b32 v100, v102
    v_permlane16_swap_b32 v101, v103
    ds_write_b128 v55, v[100:103] offset:1024
    v_pk_mul_f32 v[120:121], v[120:121], s[60:61]
    v_pk_mul_f32 v[122:123], v[122:123], s[60:61]
    v_pk_mul_f32 v[124:125], v[124:125], s[60:61]
    v_pk_mul_f32 v[126:127], v[126:127], s[60:61]
    v_cvt_pk_bf16_f32 v68, v120, v121
    v_cvt_pk_bf16_f32 v69, v122, v123
    v_cvt_pk_bf16_f32 v70, v124, v125
    v_cvt_pk_bf16_f32 v71, v126, v127
    v_permlane16_swap_b32 v64, v66
    v_permlane16_swap_b32 v65, v67
    v_pk_mul_f32 v[128:129], v[128:129], s[60:61]
    v_pk_mul_f32 v[130:131], v[130:131], s[60:61]
    v_pk_mul_f32 v[132:133], v[132:133], s[60:61]
    v_pk_mul_f32 v[134:135], v[134:135], s[60:61]
    v_cvt_pk_bf16_f32 v72, v128, v129
    v_cvt_pk_bf16_f32 v73, v130, v131
    v_cvt_pk_bf16_f32 v74, v132, v133
    v_cvt_pk_bf16_f32 v75, v134, v135
    v_permlane16_swap_b32 v68, v70
    v_permlane16_swap_b32 v69, v71
    v_pk_mul_f32 v[136:137], v[136:137], s[60:61]
    v_pk_mul_f32 v[138:139], v[138:139], s[60:61]
    v_pk_mul_f32 v[140:141], v[140:141], s[60:61]
    v_pk_mul_f32 v[142:143], v[142:143], s[60:61]
    v_cvt_pk_bf16_f32 v76, v136, v137
    v_cvt_pk_bf16_f32 v77, v138, v139
    v_cvt_pk_bf16_f32 v78, v140, v141
    v_cvt_pk_bf16_f32 v79, v142, v143
    v_permlane16_swap_b32 v72, v74
    v_permlane16_swap_b32 v73, v75
    v_pk_mul_f32 v[144:145], v[144:145], s[60:61]
    v_pk_mul_f32 v[146:147], v[146:147], s[60:61]
    v_pk_mul_f32 v[148:149], v[148:149], s[60:61]
    v_pk_mul_f32 v[150:151], v[150:151], s[60:61]
    v_cvt_pk_bf16_f32 v80, v144, v145
    v_cvt_pk_bf16_f32 v81, v146, v147
    v_cvt_pk_bf16_f32 v82, v148, v149
    v_cvt_pk_bf16_f32 v83, v150, v151
    v_permlane16_swap_b32 v76, v78
    v_permlane16_swap_b32 v77, v79
    v_pk_mul_f32 v[152:153], v[152:153], s[60:61]
    v_pk_mul_f32 v[154:155], v[154:155], s[60:61]
    v_pk_mul_f32 v[156:157], v[156:157], s[60:61]
    v_pk_mul_f32 v[158:159], v[158:159], s[60:61]
    v_cvt_pk_bf16_f32 v84, v152, v153
    v_cvt_pk_bf16_f32 v85, v154, v155
    v_cvt_pk_bf16_f32 v86, v156, v157
    v_cvt_pk_bf16_f32 v87, v158, v159
    v_permlane16_swap_b32 v80, v82
    v_permlane16_swap_b32 v81, v83
    v_pk_mul_f32 v[160:161], v[160:161], s[60:61]
    v_pk_mul_f32 v[162:163], v[162:163], s[60:61]
    v_pk_mul_f32 v[164:165], v[164:165], s[60:61]
    v_pk_mul_f32 v[166:167], v[166:167], s[60:61]
    v_cvt_pk_bf16_f32 v88, v160, v161
    v_cvt_pk_bf16_f32 v89, v162, v163
    v_cvt_pk_bf16_f32 v90, v164, v165
    v_cvt_pk_bf16_f32 v91, v166, v167
    v_permlane16_swap_b32 v84, v86
    v_permlane16_swap_b32 v85, v87
    v_pk_mul_f32 v[168:169], v[168:169], s[60:61]
    v_pk_mul_f32 v[170:171], v[170:171], s[60:61]
    v_pk_mul_f32 v[172:173], v[172:173], s[60:61]
    v_pk_mul_f32 v[174:175], v[174:175], s[60:61]
    v_cvt_pk_bf16_f32 v92, v168, v169
    v_cvt_pk_bf16_f32 v93, v170, v171
    v_cvt_pk_bf16_f32 v94, v172, v173
    v_cvt_pk_bf16_f32 v95, v174, v175
    v_permlane16_swap_b32 v88, v90
    v_permlane16_swap_b32 v89, v91
    v_permlane16_swap_b32 v92, v94
    v_permlane16_swap_b32 v93, v95
    s_waitcnt vmcnt(8) lgkmcnt(0)
    s_barrier
    ds_read_b128 a[0:3], v31 offset:0
    ds_read_b128 a[4:7], v32 offset:0
    ds_read_b128 a[8:11], v33 offset:0
    ds_read_b128 a[12:15], v34 offset:0
    ds_read_b128 a[16:19], v31 offset:4096
    ds_read_b128 a[20:23], v32 offset:4096
    ds_read_b128 a[24:27], v33 offset:4096
    ds_read_b128 a[28:31], v34 offset:4096
    ds_read_b128 a[32:35], v35 offset:0
    ds_read_b128 a[36:39], v36 offset:0
    ds_read_b128 a[40:43], v37 offset:0
    ds_read_b128 a[44:47], v38 offset:0
    ds_read_b128 a[48:51], v35 offset:4096
    ds_read_b128 a[52:55], v36 offset:4096
    ds_read_b128 a[56:59], v37 offset:4096
    ds_read_b128 a[60:63], v38 offset:4096
    ds_read_b128 v[104:107], v56 offset:0
    ds_read_b128 v[108:111], v56 offset:1024
    s_waitcnt lgkmcnt(12)
    v_mfma_f32_16x16x32_bf16 v[208:211], a[0:3], v[64:67], 0
    s_add_u32 s58, s55, 32768
    v_mfma_f32_16x16x32_bf16 v[208:211], a[4:7], v[68:71], v[208:211]
    s_add_u32 m0, s55, 32768
    v_mfma_f32_16x16x32_bf16 v[208:211], a[8:11], v[72:75], v[208:211]
    buffer_load_dwordx4 v11, s[24:27], s58 offen offset:0 nt lds
    v_mfma_f32_16x16x32_bf16 v[208:211], a[12:15], v[76:79], v[208:211]
    v_mfma_f32_16x16x32_bf16 v[212:215], a[16:19], v[64:67], 0
    v_mfma_f32_16x16x32_bf16 v[212:215], a[20:23], v[68:71], v[212:215]
    s_waitcnt lgkmcnt(11)
    v_mfma_f32_16x16x32_bf16 v[212:215], a[24:27], v[72:75], v[212:215]
    s_waitcnt lgkmcnt(10)
    buffer_load_dwordx4 v12, s[24:27], s58 offen offset:1024 nt lds
    v_mfma_f32_16x16x32_bf16 v[212:215], a[28:31], v[76:79], v[212:215]
    s_nop 0
    v_exp_f32 v208, v208
    v_mfma_f32_16x16x32_bf16 v[216:219], a[0:3], v[80:83], 0
    v_exp_f32 v209, v209
    v_mfma_f32_16x16x32_bf16 v[216:219], a[4:7], v[84:87], v[216:219]
    v_exp_f32 v210, v210
    v_mfma_f32_16x16x32_bf16 v[216:219], a[8:11], v[88:91], v[216:219]
    buffer_load_dwordx4 v13, s[24:27], s58 offen offset:2048 nt lds
    v_mfma_f32_16x16x32_bf16 v[216:219], a[12:15], v[92:95], v[216:219]
    v_exp_f32 v211, v211
    v_mfma_f32_16x16x32_bf16 v[220:223], a[16:19], v[80:83], 0
    v_cvt_pk_bf16_f32 v208, v208, v209
    v_cvt_pk_bf16_f32 v209, v210, v211
    v_mfma_f32_16x16x32_bf16 v[220:223], a[20:23], v[84:87], v[220:223]
    v_exp_f32 v212, v212
    v_mfma_f32_16x16x32_bf16 v[220:223], a[24:27], v[88:91], v[220:223]
    v_exp_f32 v213, v213
    v_mfma_f32_16x16x32_bf16 v[220:223], a[28:31], v[92:95], v[220:223]
    buffer_load_dwordx4 v14, s[24:27], s58 offen offset:3072 nt lds
    v_mfma_f32_16x16x32_bf16 v[224:227], a[0:3], v[96:99], 0
    s_waitcnt lgkmcnt(1)
    v_exp_f32 v214, v214
    v_mfma_f32_16x16x32_bf16 v[224:227], a[4:7], v[100:103], v[224:227]
    s_add_u32 s58, s55, 16384
    v_exp_f32 v216, v216
    v_mfma_f32_16x16x32_bf16 v[224:227], a[8:11], v[104:107], v[224:227]
    s_waitcnt vmcnt(4) lgkmcnt(0)
    v_exp_f32 v215, v215
    v_mfma_f32_16x16x32_bf16 v[224:227], a[12:15], v[108:111], v[224:227]
    s_add_u32 m0, s55, 65536
    s_barrier
    v_mfma_f32_16x16x32_bf16 v[228:231], a[16:19], v[96:99], 0
    buffer_load_dwordx4 v15, s[28:31], s58 offen offset:0 nt lds
    v_mfma_f32_16x16x32_bf16 v[228:231], a[20:23], v[100:103], v[228:231]
    ds_read_b64_tr_b16 a[128:129], v39 offset:0
    ds_read_b64_tr_b16 a[130:131], v39 offset:4096
    v_mfma_f32_16x16x32_bf16 v[228:231], a[24:27], v[104:107], v[228:231]
    ds_read_b128 a[64:67], v31 offset:16384
    v_cvt_pk_bf16_f32 v210, v212, v213
    v_mfma_f32_16x16x32_bf16 v[228:231], a[28:31], v[108:111], v[228:231]
    ds_read_b64_tr_b16 a[132:133], v40 offset:0
    ds_read_b64_tr_b16 a[134:135], v40 offset:4096
    buffer_load_dwordx4 v16, s[28:31], s58 offen offset:1024 nt lds
    v_mfma_f32_16x16x32_bf16 v[232:235], a[32:35], v[64:67], 0
    ds_read_b128 a[68:71], v32 offset:16384
    v_cvt_pk_bf16_f32 v211, v214, v215
    v_mfma_f32_16x16x32_bf16 v[232:235], a[36:39], v[68:71], v[232:235]
    ds_read_b64_tr_b16 a[136:137], v41 offset:0
    ds_read_b64_tr_b16 a[138:139], v41 offset:4096
    v_mfma_f32_16x16x32_bf16 v[232:235], a[40:43], v[72:75], v[232:235]
    v_exp_f32 v217, v217
    v_mfma_f32_16x16x32_bf16 v[232:235], a[44:47], v[76:79], v[232:235]
    ds_read_b64_tr_b16 a[140:141], v42 offset:0
    ds_read_b64_tr_b16 a[142:143], v42 offset:4096
    v_mfma_f32_16x16x32_bf16 v[236:239], a[48:51], v[64:67], 0
    buffer_load_dwordx4 v15, s[28:31], s58 offen offset:2048 nt lds
    v_mfma_f32_16x16x32_bf16 v[236:239], a[52:55], v[68:71], v[236:239]
    ds_read_b64_tr_b16 a[144:145], v43 offset:0
    ds_read_b64_tr_b16 a[146:147], v43 offset:4096
    v_mfma_f32_16x16x32_bf16 v[236:239], a[56:59], v[72:75], v[236:239]
    ds_read_b128 a[72:75], v33 offset:16384
    v_cvt_pk_bf16_f32 v216, v216, v217
    v_mfma_f32_16x16x32_bf16 v[236:239], a[60:63], v[76:79], v[236:239]
    ds_read_b64_tr_b16 a[148:149], v44 offset:0
    ds_read_b64_tr_b16 a[150:151], v44 offset:4096
    v_mfma_f32_16x16x32_bf16 v[240:243], a[32:35], v[80:83], 0
    buffer_load_dwordx4 v16, s[28:31], s58 offen offset:3072 nt lds
    v_mfma_f32_16x16x32_bf16 v[240:243], a[36:39], v[84:87], v[240:243]
    ds_read_b64_tr_b16 a[152:153], v45 offset:0
    ds_read_b64_tr_b16 a[154:155], v45 offset:4096
    v_mfma_f32_16x16x32_bf16 v[240:243], a[40:43], v[88:91], v[240:243]
    ds_read_b128 a[76:79], v34 offset:16384
    v_lshrrev_b32 v57, 4, v2
    v_mfma_f32_16x16x32_bf16 v[240:243], a[44:47], v[92:95], v[240:243]
    s_add_u32 s58, s55, 49152
    ds_read_b64_tr_b16 a[156:157], v46 offset:0
    ds_read_b64_tr_b16 a[158:159], v46 offset:4096
    v_mfma_f32_16x16x32_bf16 v[244:247], a[48:51], v[80:83], 0
    s_add_u32 m0, s55, 0
    ds_read_b128 a[80:83], v31 offset:20480
    v_mul_u32_u24 v57, 896, v57
    v_mfma_f32_16x16x32_bf16 v[244:247], a[52:55], v[84:87], v[244:247]
    buffer_load_dwordx4 v11, s[24:27], s58 offen offset:0 nt lds
    v_mfma_f32_16x16x32_bf16 v[244:247], a[56:59], v[88:91], v[244:247]
    v_exp_f32 v218, v218
    v_mfma_f32_16x16x32_bf16 v[244:247], a[60:63], v[92:95], v[244:247]
    s_waitcnt lgkmcnt(12)
    v_exp_f32 v219, v219
    v_mfma_f32_16x16x32_bf16 v[112:115], a[128:131], v[208:211], 0
    ds_read_b64_tr_b16 a[160:161], v47 offset:0
    ds_read_b64_tr_b16 a[162:163], v47 offset:4096
    v_mfma_f32_16x16x32_bf16 v[116:119], a[132:135], v[208:211], 0
    buffer_load_dwordx4 v12, s[24:27], s58 offen offset:1024 nt lds
    v_exp_f32 v220, v220
    v_cvt_pk_bf16_f32 v217, v218, v219
    v_mfma_f32_16x16x32_bf16 v[120:123], a[136:139], v[208:211], 0
    s_waitcnt lgkmcnt(12)
    v_exp_f32 v221, v221
    v_mfma_f32_16x16x32_bf16 v[124:127], a[140:143], v[208:211], 0
    s_waitcnt lgkmcnt(11)
    ds_read_b64_tr_b16 a[164:165], v48 offset:0
    ds_read_b64_tr_b16 a[166:167], v48 offset:4096
    v_mfma_f32_16x16x32_bf16 v[128:131], a[144:147], v[208:211], 0
    s_waitcnt lgkmcnt(10)
    v_exp_f32 v222, v222
    v_cvt_pk_bf16_f32 v218, v220, v221
    v_exp_f32 v224, v224
    v_mfma_f32_16x16x32_bf16 v[132:135], a[148:151], v[208:211], 0
    s_waitcnt lgkmcnt(8)
    buffer_load_dwordx4 v13, s[24:27], s58 offen offset:2048 nt lds
    v_exp_f32 v223, v223
    v_exp_f32 v225, v225
    v_mfma_f32_16x16x32_bf16 v[136:139], a[152:155], v[208:211], 0
    s_waitcnt lgkmcnt(5)
    ds_read_b64_tr_b16 a[168:169], v49 offset:0
    ds_read_b64_tr_b16 a[170:171], v49 offset:4096
    v_mfma_f32_16x16x32_bf16 v[140:143], a[156:159], v[208:211], 0
    v_cvt_pk_bf16_f32 v219, v222, v223
    v_exp_f32 v226, v226
    v_cvt_pk_bf16_f32 v224, v224, v225
    v_mfma_f32_16x16x32_bf16 a[192:195], a[204:207], v[208:211], 0
    v_exp_f32 v227, v227
    v_mfma_f32_16x16x32_bf16 v[144:147], a[128:131], v[216:219], 0
    ds_read_b64_tr_b16 a[172:173], v50 offset:0
    ds_read_b64_tr_b16 a[174:175], v50 offset:4096
    v_mfma_f32_16x16x32_bf16 v[148:151], a[132:135], v[216:219], 0
    buffer_load_dwordx4 v14, s[24:27], s58 offen offset:3072 nt lds
    v_exp_f32 v228, v228
    v_cvt_pk_bf16_f32 v225, v226, v227
    v_mfma_f32_16x16x32_bf16 v[152:155], a[136:139], v[216:219], 0
    v_exp_f32 v229, v229
    v_mfma_f32_16x16x32_bf16 v[156:159], a[140:143], v[216:219], 0
    s_add_u32 s58, s55, 32768
    ds_read_b64_tr_b16 a[176:177], v51 offset:0
    ds_read_b64_tr_b16 a[178:179], v51 offset:4096
    v_mfma_f32_16x16x32_bf16 v[160:163], a[144:147], v[216:219], 0
    s_add_u32 m0, s55, 81920
    v_exp_f32 v230, v230
    v_cvt_pk_bf16_f32 v226, v228, v229
    v_exp_f32 v232, v232
    v_mfma_f32_16x16x32_bf16 v[164:167], a[148:151], v[216:219], 0
    buffer_load_dwordx4 v15, s[28:31], s58 offen offset:0 nt lds
    v_exp_f32 v231, v231
    v_exp_f32 v233, v233
    v_mfma_f32_16x16x32_bf16 v[168:171], a[152:155], v[216:219], 0
    ds_read_b64_tr_b16 a[180:181], v52 offset:0
    ds_read_b64_tr_b16 a[182:183], v52 offset:4096
    v_mfma_f32_16x16x32_bf16 v[172:175], a[156:159], v[216:219], 0
    v_cvt_pk_bf16_f32 v227, v230, v231
    v_exp_f32 v234, v234
    v_cvt_pk_bf16_f32 v232, v232, v233
    v_mfma_f32_16x16x32_bf16 a[196:199], a[204:207], v[216:219], 0
    v_exp_f32 v235, v235
    v_mfma_f32_16x16x32_bf16 v[176:179], a[128:131], v[224:227], 0
    ds_read_b64_tr_b16 a[184:185], v53 offset:0
    ds_read_b64_tr_b16 a[186:187], v53 offset:4096
    buffer_load_dwordx4 v16, s[28:31], s58 offen offset:1024 nt lds
    v_mfma_f32_16x16x32_bf16 v[180:183], a[132:135], v[224:227], 0
    v_exp_f32 v236, v236
    v_cvt_pk_bf16_f32 v233, v234, v235
    v_mfma_f32_16x16x32_bf16 v[184:187], a[136:139], v[224:227], 0
    v_exp_f32 v237, v237
    v_mfma_f32_16x16x32_bf16 v[188:191], a[140:143], v[224:227], 0
    ds_read_b64_tr_b16 a[188:189], v54 offset:0
    ds_read_b64_tr_b16 a[190:191], v54 offset:4096
    v_mfma_f32_16x16x32_bf16 v[192:195], a[144:147], v[224:227], 0
    v_exp_f32 v238, v238
    v_cvt_pk_bf16_f32 v234, v236, v237
    v_exp_f32 v240, v240
    v_mfma_f32_16x16x32_bf16 v[196:199], a[148:151], v[224:227], 0
    buffer_load_dwordx4 v15, s[28:31], s58 offen offset:2048 nt lds
    v_exp_f32 v239, v239
    v_exp_f32 v241, v241
    v_mfma_f32_16x16x32_bf16 v[200:203], a[152:155], v[224:227], 0
    ds_read_b128 a[84:87], v32 offset:20480
    v_cvt_pk_bf16_f32 v235, v238, v239
    v_mfma_f32_16x16x32_bf16 v[204:207], a[156:159], v[224:227], 0
    v_exp_f32 v242, v242
    v_cvt_pk_bf16_f32 v240, v240, v241
    v_mfma_f32_16x16x32_bf16 a[200:203], a[204:207], v[224:227], 0
    s_waitcnt lgkmcnt(12)
    v_exp_f32 v243, v243
    v_mfma_f32_16x16x32_bf16 v[112:115], a[160:163], v[232:235], v[112:115]
    buffer_load_dwordx4 v16, s[28:31], s58 offen offset:3072 nt lds
    v_mfma_f32_16x16x32_bf16 v[116:119], a[164:167], v[232:235], v[116:119]
    s_waitcnt lgkmcnt(11)
    v_exp_f32 v244, v244
    v_cvt_pk_bf16_f32 v241, v242, v243
    v_mfma_f32_16x16x32_bf16 v[120:123], a[168:171], v[232:235], v[120:123]
    s_waitcnt lgkmcnt(9)
    v_exp_f32 v245, v245
    v_mfma_f32_16x16x32_bf16 v[124:127], a[172:175], v[232:235], v[124:127]
    s_waitcnt lgkmcnt(7)
    ds_read_b128 a[88:91], v33 offset:20480
    ds_read_b128 a[92:95], v34 offset:20480
    ds_read_b128 a[96:99], v35 offset:16384
    ds_read_b128 a[100:103], v36 offset:16384
    ds_read_b128 a[104:107], v37 offset:16384
    ds_read_b128 a[108:111], v38 offset:16384
    ds_read_b128 a[112:115], v35 offset:20480
    ds_read_b128 a[116:119], v36 offset:20480
    ds_read_b128 a[120:123], v37 offset:20480
    ds_read_b128 a[124:127], v38 offset:20480
    v_mfma_f32_16x16x32_bf16 v[128:131], a[176:179], v[232:235], v[128:131]
    s_waitcnt lgkmcnt(12)
    v_exp_f32 v246, v246
    v_cvt_pk_bf16_f32 v242, v244, v245
    v_mfma_f32_16x16x32_bf16 v[132:135], a[180:183], v[232:235], v[132:135]
    v_exp_f32 v247, v247
    v_mfma_f32_16x16x32_bf16 v[136:139], a[184:187], v[232:235], v[136:139]
    s_waitcnt lgkmcnt(11)
    v_cvt_pk_bf16_f32 v243, v246, v247
    v_add_u32 v4, v15, v57
    v_mfma_f32_16x16x32_bf16 v[140:143], a[188:191], v[232:235], v[140:143]
    s_waitcnt vmcnt(8) lgkmcnt(0)
    v_add_u32 v5, v16, v57
    v_mfma_f32_16x16x32_bf16 a[192:195], a[204:207], v[232:235], a[192:195]
    s_barrier
    ds_read_b64_tr_b16 a[128:129], v39 offset:16384
    v_mfma_f32_16x16x32_bf16 v[144:147], a[160:163], v[240:243], v[144:147]
    s_add_u32 s58, s55, 65536
    ds_read_b64_tr_b16 a[130:131], v39 offset:20480
    ds_read_b64_tr_b16 a[132:133], v40 offset:16384
    v_mfma_f32_16x16x32_bf16 v[148:151], a[164:167], v[240:243], v[148:151]
    s_add_u32 m0, s55, 16384
    ds_read_b64_tr_b16 a[134:135], v40 offset:20480
    ds_read_b64_tr_b16 a[136:137], v41 offset:16384
    v_mfma_f32_16x16x32_bf16 v[152:155], a[168:171], v[240:243], v[152:155]
    buffer_load_dwordx4 v11, s[24:27], s58 offen offset:0 nt lds
    v_mfma_f32_16x16x32_bf16 v[156:159], a[172:175], v[240:243], v[156:159]
    ds_read_b64_tr_b16 a[138:139], v41 offset:20480
    ds_read_b64_tr_b16 a[140:141], v42 offset:16384
    v_mfma_f32_16x16x32_bf16 v[160:163], a[176:179], v[240:243], v[160:163]
    ds_read_b64_tr_b16 a[142:143], v42 offset:20480
    ds_read_b64_tr_b16 a[144:145], v43 offset:16384
    v_mfma_f32_16x16x32_bf16 v[164:167], a[180:183], v[240:243], v[164:167]
    ds_read_b64_tr_b16 a[146:147], v43 offset:20480
    ds_read_b64_tr_b16 a[148:149], v44 offset:16384
    v_mfma_f32_16x16x32_bf16 v[168:171], a[184:187], v[240:243], v[168:171]
    buffer_load_dwordx4 v12, s[24:27], s58 offen offset:1024 nt lds
    v_mfma_f32_16x16x32_bf16 v[172:175], a[188:191], v[240:243], v[172:175]
    ds_read_b64_tr_b16 a[150:151], v44 offset:20480
    ds_read_b64_tr_b16 a[152:153], v45 offset:16384
    v_mfma_f32_16x16x32_bf16 a[196:199], a[204:207], v[240:243], a[196:199]
    ds_read_b64_tr_b16 a[154:155], v45 offset:20480
    ds_read_b64_tr_b16 a[156:157], v46 offset:16384
    v_mfma_f32_16x16x32_bf16 v[208:211], a[64:67], v[64:67], 0
    ds_read_b64_tr_b16 a[158:159], v46 offset:20480
    ds_read_b64_tr_b16 a[160:161], v47 offset:16384
    v_mfma_f32_16x16x32_bf16 v[208:211], a[68:71], v[68:71], v[208:211]
    buffer_load_dwordx4 v13, s[24:27], s58 offen offset:2048 nt lds
    v_mfma_f32_16x16x32_bf16 v[208:211], a[72:75], v[72:75], v[208:211]
    ds_read_b64_tr_b16 a[162:163], v47 offset:20480
    ds_read_b64_tr_b16 a[164:165], v48 offset:16384
    v_mfma_f32_16x16x32_bf16 v[208:211], a[76:79], v[76:79], v[208:211]
    ds_read_b64_tr_b16 a[166:167], v48 offset:20480
    ds_read_b64_tr_b16 a[168:169], v49 offset:16384
    v_mfma_f32_16x16x32_bf16 v[212:215], a[80:83], v[64:67], 0
    ds_read_b64_tr_b16 a[170:171], v49 offset:20480
    ds_read_b64_tr_b16 a[172:173], v50 offset:16384
    v_mfma_f32_16x16x32_bf16 v[212:215], a[84:87], v[68:71], v[212:215]
    buffer_load_dwordx4 v14, s[24:27], s58 offen offset:3072 nt lds
    v_mfma_f32_16x16x32_bf16 v[212:215], a[88:91], v[72:75], v[212:215]
    ds_read_b64_tr_b16 a[174:175], v50 offset:20480
    v_add_u32 v6, 7168, v4
    v_mfma_f32_16x16x32_bf16 v[212:215], a[92:95], v[76:79], v[212:215]
    v_exp_f32 v208, v208
    v_mfma_f32_16x16x32_bf16 v[216:219], a[64:67], v[80:83], 0
    v_exp_f32 v209, v209
    v_mfma_f32_16x16x32_bf16 v[216:219], a[68:71], v[84:87], v[216:219]
    ds_read_b128 a[0:3], v31 offset:32768
    v_cvt_pk_bf16_f32 v208, v208, v209
    v_mfma_f32_16x16x32_bf16 v[216:219], a[72:75], v[88:91], v[216:219]
    ds_read_b128 a[4:7], v32 offset:32768
    v_add_u32 v7, 10752, v5
    v_mfma_f32_16x16x32_bf16 v[216:219], a[76:79], v[92:95], v[216:219]
    ds_read_b128 a[8:11], v33 offset:32768
    v_add_u32 v5, 3584, v5
    v_mfma_f32_16x16x32_bf16 v[220:223], a[80:83], v[80:83], 0
    s_lshl_b32 s19, s48, 13
    v_exp_f32 v210, v210
    v_mfma_f32_16x16x32_bf16 v[220:223], a[84:87], v[84:87], v[220:223]
    s_lshr_b32 s59, s51, 1
    v_exp_f32 v211, v211
    v_mfma_f32_16x16x32_bf16 v[220:223], a[88:91], v[88:91], v[220:223]
    s_mul_i32 s59, s59, 384
    ds_read_b128 a[12:15], v34 offset:32768
    v_cvt_pk_bf16_f32 v209, v210, v211
    v_mfma_f32_16x16x32_bf16 v[220:223], a[92:95], v[92:95], v[220:223]
    s_add_u32 s75, s59, 512
    v_exp_f32 v212, v212
    v_mfma_f32_16x16x32_bf16 v[224:227], a[64:67], v[96:99], 0
    s_mul_i32 s59, s48, 73728
    v_exp_f32 v213, v213
    v_mfma_f32_16x16x32_bf16 v[224:227], a[68:71], v[100:103], v[224:227]
    s_add_u32 s58, s55, 49152
    ds_read_b128 a[16:19], v31 offset:36864
    v_cvt_pk_bf16_f32 v210, v212, v213
    v_mfma_f32_16x16x32_bf16 v[224:227], a[72:75], v[104:107], v[224:227]
    s_add_u32 m0, s55, 49152
    v_exp_f32 v214, v214
    v_mfma_f32_16x16x32_bf16 v[224:227], a[76:79], v[108:111], v[224:227]
    s_add_u32 s59, s59, s75
    buffer_load_dwordx4 v15, s[28:31], s58 offen offset:0 nt lds
    v_mfma_f32_16x16x32_bf16 v[228:231], a[80:83], v[96:99], 0
    s_xor_b32 s8, s51, 0
    v_exp_f32 v216, v216
    v_mfma_f32_16x16x32_bf16 v[228:231], a[84:87], v[100:103], v[228:231]
    s_mul_i32 s8, s8, 294912
    v_exp_f32 v215, v215
    v_mfma_f32_16x16x32_bf16 v[228:231], a[88:91], v[104:107], v[228:231]
    s_add_u32 s8, s8, s59
    ds_read_b64_tr_b16 a[176:177], v51 offset:16384
    ds_read_b64_tr_b16 a[178:179], v51 offset:20480
    v_mfma_f32_16x16x32_bf16 v[228:231], a[92:95], v[108:111], v[228:231]
    s_xor_b32 s9, s51, 2
    ds_read_b128 a[20:23], v32 offset:36864
    v_cvt_pk_bf16_f32 v211, v214, v215
    v_mfma_f32_16x16x32_bf16 v[232:235], a[96:99], v[64:67], 0
    s_mul_i32 s9, s9, 294912
    v_exp_f32 v217, v217
    v_mfma_f32_16x16x32_bf16 v[232:235], a[100:103], v[68:71], v[232:235]
    s_add_u32 s9, s9, s59
    ds_read_b128 a[24:27], v33 offset:36864
    v_cvt_pk_bf16_f32 v216, v216, v217
    v_mfma_f32_16x16x32_bf16 v[232:235], a[104:107], v[72:75], v[232:235]
    s_xor_b32 s10, s51, 1
    v_exp_f32 v218, v218
    v_mfma_f32_16x16x32_bf16 v[232:235], a[108:111], v[76:79], v[232:235]
    s_mul_i32 s10, s10, 294912
    v_exp_f32 v219, v219
    v_mfma_f32_16x16x32_bf16 v[236:239], a[112:115], v[64:67], 0
    s_add_u32 s10, s10, s59
    ds_read_b128 a[28:31], v34 offset:36864
    v_cvt_pk_bf16_f32 v217, v218, v219
    v_mfma_f32_16x16x32_bf16 v[236:239], a[116:119], v[68:71], v[236:239]
    s_xor_b32 s11, s51, 3
    v_exp_f32 v220, v220
    v_mfma_f32_16x16x32_bf16 v[236:239], a[120:123], v[72:75], v[236:239]
    s_mul_i32 s11, s11, 294912
    v_exp_f32 v221, v221
    v_mfma_f32_16x16x32_bf16 v[236:239], a[124:127], v[76:79], v[236:239]
    s_add_u32 s11, s11, s59
    buffer_load_dwordx4 v16, s[28:31], s58 offen offset:1024 nt lds
    v_mfma_f32_16x16x32_bf16 v[240:243], a[96:99], v[80:83], 0
    s_mul_i32 s59, s53, 1310720
    ds_read_b64_tr_b16 a[180:181], v52 offset:16384
    ds_read_b64_tr_b16 a[182:183], v52 offset:20480
    v_mfma_f32_16x16x32_bf16 v[240:243], a[100:103], v[84:87], v[240:243]
    s_mul_i32 s12, s48, 10240
    ds_read_b128 a[32:35], v35 offset:32768
    v_cvt_pk_bf16_f32 v218, v220, v221
    v_mfma_f32_16x16x32_bf16 v[240:243], a[104:107], v[88:91], v[240:243]
    s_add_u32 s59, s59, s12
    v_exp_f32 v222, v222
    v_mfma_f32_16x16x32_bf16 v[240:243], a[108:111], v[92:95], v[240:243]
    s_mul_i32 s12, s54, 66816
    v_exp_f32 v224, v224
    v_mfma_f32_16x16x32_bf16 v[244:247], a[112:115], v[80:83], 0
    s_add_u32 s12, s12, s59
    v_exp_f32 v223, v223
    v_mfma_f32_16x16x32_bf16 v[244:247], a[116:119], v[84:87], v[244:247]
    s_add_u32 s13, s12, 4096
    ds_read_b128 a[36:39], v36 offset:32768
    v_cvt_pk_bf16_f32 v219, v222, v223
    v_mfma_f32_16x16x32_bf16 v[244:247], a[120:123], v[88:91], v[244:247]
    s_add_u32 s14, s12, 8192
    v_exp_f32 v225, v225
    v_mfma_f32_16x16x32_bf16 v[244:247], a[124:127], v[92:95], v[244:247]
    s_xor_b32 s66, s54, 2
    ds_read_b128 a[40:43], v37 offset:32768
    v_cvt_pk_bf16_f32 v224, v224, v225
    s_waitcnt lgkmcnt(12)
    v_mfma_f32_16x16x32_bf16 v[112:115], a[128:131], v[208:211], v[112:115]
    s_mul_i32 s66, s66, 66816
    v_exp_f32 v226, v226
    v_mfma_f32_16x16x32_bf16 v[116:119], a[132:135], v[208:211], v[116:119]
    s_add_u32 s66, s66, s59
    v_exp_f32 v227, v227
    v_mfma_f32_16x16x32_bf16 v[120:123], a[136:139], v[208:211], v[120:123]
    s_xor_b32 s67, s54, 1
    ds_read_b64_tr_b16 a[184:185], v53 offset:16384
    ds_read_b64_tr_b16 a[186:187], v53 offset:20480
    v_mfma_f32_16x16x32_bf16 v[124:127], a[140:143], v[208:211], v[124:127]
    s_mul_i32 s67, s67, 66816
    buffer_load_dwordx4 v15, s[28:31], s58 offen offset:2048 nt lds
    v_mfma_f32_16x16x32_bf16 v[128:131], a[144:147], v[208:211], v[128:131]
    s_add_u32 s67, s67, s59
    ds_read_b128 a[44:47], v38 offset:32768
    v_cvt_pk_bf16_f32 v225, v226, v227
    v_mfma_f32_16x16x32_bf16 v[132:135], a[148:151], v[208:211], v[132:135]
    s_xor_b32 s68, s54, 3
    v_exp_f32 v228, v228
    v_mfma_f32_16x16x32_bf16 v[136:139], a[152:155], v[208:211], v[136:139]
    s_mul_i32 s68, s68, 66816
    v_exp_f32 v229, v229
    v_mfma_f32_16x16x32_bf16 v[140:143], a[156:159], v[208:211], v[140:143]
    s_add_u32 s68, s68, s59
    ds_read_b128 a[48:51], v35 offset:36864
    v_cvt_pk_bf16_f32 v226, v228, v229
    v_mfma_f32_16x16x32_bf16 a[192:195], a[204:207], v[208:211], a[192:195]
    s_lshl_b32 s15, s52, 2
    v_exp_f32 v230, v230
    v_mfma_f32_16x16x32_bf16 v[144:147], a[128:131], v[216:219], v[144:147]
    s_add_u32 s15, s15, s48
    v_exp_f32 v232, v232
    v_mfma_f32_16x16x32_bf16 v[148:151], a[132:135], v[216:219], v[148:151]
    s_lshl_b32 s15, s15, 11
    v_exp_f32 v231, v231
    v_mfma_f32_16x16x32_bf16 v[152:155], a[136:139], v[216:219], v[152:155]
    s_mul_i32 s59, s53, 1310720
    ds_read_b128 a[52:55], v36 offset:36864
    v_cvt_pk_bf16_f32 v227, v230, v231
    v_mfma_f32_16x16x32_bf16 v[156:159], a[140:143], v[216:219], v[156:159]
    s_add_u32 s15, s15, s59
    ds_read_b64_tr_b16 a[188:189], v54 offset:16384
    ds_read_b64_tr_b16 a[190:191], v54 offset:20480
    v_mfma_f32_16x16x32_bf16 v[160:163], a[144:147], v[216:219], v[160:163]
    s_add_u32 s15, s15, 1069056
    v_exp_f32 v233, v233
    v_mfma_f32_16x16x32_bf16 v[164:167], a[148:151], v[216:219], v[164:167]
    ds_read_b128 a[56:59], v37 offset:36864
    v_cvt_pk_bf16_f32 v232, v232, v233
    v_mfma_f32_16x16x32_bf16 v[168:171], a[152:155], v[216:219], v[168:171]
    buffer_load_dwordx4 v16, s[28:31], s58 offen offset:3072 nt lds
    v_mfma_f32_16x16x32_bf16 v[172:175], a[156:159], v[216:219], v[172:175]
    v_exp_f32 v234, v234
    v_mfma_f32_16x16x32_bf16 a[196:199], a[204:207], v[216:219], a[196:199]
    v_exp_f32 v235, v235
    v_mfma_f32_16x16x32_bf16 v[176:179], a[128:131], v[224:227], v[176:179]
    ds_read_b128 a[60:63], v38 offset:36864
    v_cvt_pk_bf16_f32 v233, v234, v235
    v_mfma_f32_16x16x32_bf16 v[180:183], a[132:135], v[224:227], v[180:183]
    v_exp_f32 v236, v236
    v_mfma_f32_16x16x32_bf16 v[184:187], a[136:139], v[224:227], v[184:187]
    v_exp_f32 v237, v237
    v_mfma_f32_16x16x32_bf16 v[188:191], a[140:143], v[224:227], v[188:191]
    v_exp_f32 v238, v238
    v_mfma_f32_16x16x32_bf16 v[192:195], a[144:147], v[224:227], v[192:195]
    v_cvt_pk_bf16_f32 v234, v236, v237
    v_exp_f32 v240, v240
    v_mfma_f32_16x16x32_bf16 v[196:199], a[148:151], v[224:227], v[196:199]
    v_exp_f32 v239, v239
    v_exp_f32 v241, v241
    v_mfma_f32_16x16x32_bf16 v[200:203], a[152:155], v[224:227], v[200:203]
    v_cvt_pk_bf16_f32 v235, v238, v239
    v_cvt_pk_bf16_f32 v240, v240, v241
    v_mfma_f32_16x16x32_bf16 v[204:207], a[156:159], v[224:227], v[204:207]
    v_exp_f32 v242, v242
    v_mfma_f32_16x16x32_bf16 a[200:203], a[204:207], v[224:227], a[200:203]
    v_exp_f32 v243, v243
    v_mfma_f32_16x16x32_bf16 v[112:115], a[160:163], v[232:235], v[112:115]
    v_exp_f32 v244, v244
    v_mfma_f32_16x16x32_bf16 v[116:119], a[164:167], v[232:235], v[116:119]
    v_cvt_pk_bf16_f32 v241, v242, v243
    v_and_b32 v10, 7, v2
    v_mfma_f32_16x16x32_bf16 v[120:123], a[168:171], v[232:235], v[120:123]
    buffer_load_dword v255, v252, s[36:39], s74 offen offset:0
    v_exp_f32 v245, v245
    v_mfma_f32_16x16x32_bf16 v[124:127], a[172:175], v[232:235], v[124:127]
    s_waitcnt lgkmcnt(12)
    v_exp_f32 v246, v246
    v_mfma_f32_16x16x32_bf16 v[128:131], a[176:179], v[232:235], v[128:131]
    v_cvt_pk_bf16_f32 v242, v244, v245
    v_xor_b32 v10, s51, v10
    v_mfma_f32_16x16x32_bf16 v[132:135], a[180:183], v[232:235], v[132:135]
    s_waitcnt lgkmcnt(7)
    v_exp_f32 v247, v247
    v_mfma_f32_16x16x32_bf16 v[136:139], a[184:187], v[232:235], v[136:139]
    s_waitcnt lgkmcnt(2)
    v_cvt_pk_bf16_f32 v243, v246, v247
    v_lshlrev_b32 v10, 1, v10
    v_mfma_f32_16x16x32_bf16 v[140:143], a[188:191], v[232:235], v[140:143]
    s_waitcnt vmcnt(9) lgkmcnt(0)
    v_mfma_f32_16x16x32_bf16 a[192:195], a[204:207], v[232:235], a[192:195]
standalone__gqa_block_cached__near_ridge_a_h0_2:
    s_cbranch_execz standalone__gqa_block_cached__near_ridge_a_h0_r
    s_barrier
    ds_read_b64_tr_b16 a[128:129], v39 offset:32768
    v_mfma_f32_16x16x32_bf16 v[144:147], a[160:163], v[240:243], v[144:147]
    s_add_u32 s58, s55, 81920
    ds_read_b64_tr_b16 a[130:131], v39 offset:36864
    ds_read_b64_tr_b16 a[132:133], v40 offset:32768
    v_mfma_f32_16x16x32_bf16 v[148:151], a[164:167], v[240:243], v[148:151]
    s_add_u32 m0, s55, 32768
    ds_read_b64_tr_b16 a[134:135], v40 offset:36864
    ds_read_b64_tr_b16 a[136:137], v41 offset:32768
    v_mfma_f32_16x16x32_bf16 v[152:155], a[168:171], v[240:243], v[152:155]
    s_lshl_b32 s59, s50, 7
    buffer_load_dwordx4 v11, s[24:27], s58 offen offset:0 nt lds
    v_mfma_f32_16x16x32_bf16 v[156:159], a[172:175], v[240:243], v[156:159]
    s_lshl_b32 s16, s48, 6
    ds_read_b64_tr_b16 a[138:139], v41 offset:36864
    ds_read_b64_tr_b16 a[140:141], v42 offset:32768
    v_mfma_f32_16x16x32_bf16 v[160:163], a[176:179], v[240:243], v[160:163]
    s_xor_b32 s59, s59, s16
    ds_read_b64_tr_b16 a[142:143], v42 offset:36864
    ds_read_b64_tr_b16 a[144:145], v43 offset:32768
    v_mfma_f32_16x16x32_bf16 v[164:167], a[180:183], v[240:243], v[164:167]
    ds_read_b64_tr_b16 a[146:147], v43 offset:36864
    ds_read_b64_tr_b16 a[148:149], v44 offset:32768
    v_mfma_f32_16x16x32_bf16 v[168:171], a[184:187], v[240:243], v[168:171]
    buffer_load_dwordx4 v12, s[24:27], s58 offen offset:1024 nt lds
    v_mfma_f32_16x16x32_bf16 v[172:175], a[188:191], v[240:243], v[172:175]
    ds_read_b64_tr_b16 a[150:151], v44 offset:36864
    ds_read_b64_tr_b16 a[152:153], v45 offset:32768
    v_mfma_f32_16x16x32_bf16 a[196:199], a[204:207], v[240:243], a[196:199]
    ds_read_b64_tr_b16 a[154:155], v45 offset:36864
    ds_read_b64_tr_b16 a[156:157], v46 offset:32768
    v_mfma_f32_16x16x32_bf16 v[208:211], a[0:3], v[64:67], 0
    ds_read_b64_tr_b16 a[158:159], v46 offset:36864
    ds_read_b64_tr_b16 a[160:161], v47 offset:32768
    v_mfma_f32_16x16x32_bf16 v[208:211], a[4:7], v[68:71], v[208:211]
    buffer_load_dwordx4 v13, s[24:27], s58 offen offset:2048 nt lds
    v_mfma_f32_16x16x32_bf16 v[208:211], a[8:11], v[72:75], v[208:211]
    ds_read_b64_tr_b16 a[162:163], v47 offset:36864
    ds_read_b64_tr_b16 a[164:165], v48 offset:32768
    v_mfma_f32_16x16x32_bf16 v[208:211], a[12:15], v[76:79], v[208:211]
    ds_read_b64_tr_b16 a[166:167], v48 offset:36864
    ds_read_b64_tr_b16 a[168:169], v49 offset:32768
    v_mfma_f32_16x16x32_bf16 v[212:215], a[16:19], v[64:67], 0
    ds_read_b64_tr_b16 a[170:171], v49 offset:36864
    ds_read_b64_tr_b16 a[172:173], v50 offset:32768
    v_mfma_f32_16x16x32_bf16 v[212:215], a[20:23], v[68:71], v[212:215]
    buffer_load_dwordx4 v14, s[24:27], s58 offen offset:3072 nt lds
    v_mfma_f32_16x16x32_bf16 v[212:215], a[24:27], v[72:75], v[212:215]
    ds_read_b64_tr_b16 a[174:175], v50 offset:36864
    v_xor_b32 v17, s59, v39
    v_mfma_f32_16x16x32_bf16 v[212:215], a[28:31], v[76:79], v[212:215]
    s_lshl_b32 s59, s49, 14
    v_exp_f32 v208, v208
    v_mfma_f32_16x16x32_bf16 v[216:219], a[0:3], v[80:83], 0
    s_add_u32 s59, s59, 49152
    v_exp_f32 v209, v209
    v_mfma_f32_16x16x32_bf16 v[216:219], a[4:7], v[84:87], v[216:219]
    ds_read_b128 a[64:67], v31 offset:0
    v_cvt_pk_bf16_f32 v208, v208, v209
    v_mfma_f32_16x16x32_bf16 v[216:219], a[8:11], v[88:91], v[216:219]
    ds_read_b128 a[68:71], v32 offset:0
    v_add_u32 v17, s59, v17
    v_mfma_f32_16x16x32_bf16 v[216:219], a[12:15], v[92:95], v[216:219]
    ds_read_b128 a[72:75], v33 offset:0
    v_xor_b32 v18, 32, v17
    v_mfma_f32_16x16x32_bf16 v[220:223], a[16:19], v[80:83], 0
    ds_read_b128 a[76:79], v34 offset:0
    v_xor_b32 v19, 64, v17
    v_mfma_f32_16x16x32_bf16 v[220:223], a[20:23], v[84:87], v[220:223]
    ds_read_b128 a[80:83], v31 offset:4096
    v_xor_b32 v20, 96, v17
    v_mfma_f32_16x16x32_bf16 v[220:223], a[24:27], v[88:91], v[220:223]
    ds_read_b128 a[84:87], v32 offset:4096
    v_xor_b32 v21, 128, v17
    v_mfma_f32_16x16x32_bf16 v[220:223], a[28:31], v[92:95], v[220:223]
    ds_read_b128 a[88:91], v33 offset:4096
    v_xor_b32 v22, 160, v17
    v_mfma_f32_16x16x32_bf16 v[224:227], a[0:3], v[96:99], 0
    ds_read_b128 a[92:95], v34 offset:4096
    v_xor_b32 v23, 192, v17
    v_mfma_f32_16x16x32_bf16 v[224:227], a[4:7], v[100:103], v[224:227]
    s_add_u32 s58, s55, 65536
    ds_read_b128 a[96:99], v35 offset:0
    v_xor_b32 v24, 224, v17
    v_mfma_f32_16x16x32_bf16 v[224:227], a[8:11], v[104:107], v[224:227]
    s_add_u32 m0, s55, 65536
    v_exp_f32 v210, v210
    v_mfma_f32_16x16x32_bf16 v[224:227], a[12:15], v[108:111], v[224:227]
    s_lshr_b32 s16, s51, 1
    buffer_load_dwordx4 v15, s[28:31], s58 offen offset:0 nt lds
    v_mfma_f32_16x16x32_bf16 v[228:231], a[16:19], v[96:99], 0
    s_mul_i32 s16, s16, -320
    v_exp_f32 v211, v211
    v_mfma_f32_16x16x32_bf16 v[228:231], a[20:23], v[100:103], v[228:231]
    s_add_u32 s16, s16, 256
    ds_read_b128 a[100:103], v36 offset:0
    v_cvt_pk_bf16_f32 v209, v210, v211
    v_mfma_f32_16x16x32_bf16 v[228:231], a[24:27], v[104:107], v[228:231]
    ds_read_b64_tr_b16 a[176:177], v51 offset:32768
    ds_read_b64_tr_b16 a[178:179], v51 offset:36864
    v_mfma_f32_16x16x32_bf16 v[228:231], a[28:31], v[108:111], v[228:231]
    ds_read_b128 a[104:107], v37 offset:0
    v_lshrrev_b32 v57, 2, v2
    v_mfma_f32_16x16x32_bf16 v[232:235], a[32:35], v[64:67], 0
    ds_read_b128 a[108:111], v38 offset:0
    v_mul_u32_u24 v57, 1152, v57
    v_mfma_f32_16x16x32_bf16 v[232:235], a[36:39], v[68:71], v[232:235]
    ds_read_b128 a[112:115], v35 offset:4096
    v_bfe_u32 v58, v2, 4, 1
    v_mfma_f32_16x16x32_bf16 v[232:235], a[40:43], v[72:75], v[232:235]
    ds_read_b128 a[116:119], v36 offset:4096
    v_lshlrev_b32 v58, 1, v58
    v_mfma_f32_16x16x32_bf16 v[232:235], a[44:47], v[76:79], v[232:235]
    ds_read_b128 a[120:123], v37 offset:4096
    v_and_b32 v59, 3, v2
    v_mfma_f32_16x16x32_bf16 v[236:239], a[48:51], v[64:67], 0
    ds_read_b128 a[124:127], v38 offset:4096
    v_xor_b32 v59, v59, v58
    v_mfma_f32_16x16x32_bf16 v[236:239], a[52:55], v[68:71], v[236:239]
    v_exp_f32 v212, v212
    v_mfma_f32_16x16x32_bf16 v[236:239], a[56:59], v[72:75], v[236:239]
    ds_read_b64_tr_b16 a[180:181], v52 offset:32768
    ds_read_b64_tr_b16 a[182:183], v52 offset:36864
    v_mfma_f32_16x16x32_bf16 v[236:239], a[60:63], v[76:79], v[236:239]
    buffer_load_dwordx4 v16, s[28:31], s58 offen offset:1024 nt lds
    v_mfma_f32_16x16x32_bf16 v[240:243], a[32:35], v[80:83], 0
    v_exp_f32 v213, v213
    v_mfma_f32_16x16x32_bf16 v[240:243], a[36:39], v[84:87], v[240:243]
    v_exp_f32 v214, v214
    v_mfma_f32_16x16x32_bf16 v[240:243], a[40:43], v[88:91], v[240:243]
    v_cvt_pk_bf16_f32 v210, v212, v213
    v_lshl_add_u32 v8, v59, 4, v57
    v_mfma_f32_16x16x32_bf16 v[240:243], a[44:47], v[92:95], v[240:243]
    v_exp_f32 v216, v216
    v_mfma_f32_16x16x32_bf16 v[244:247], a[48:51], v[80:83], 0
    v_exp_f32 v215, v215
    v_exp_f32 v217, v217
    v_mfma_f32_16x16x32_bf16 v[244:247], a[52:55], v[84:87], v[244:247]
    v_cvt_pk_bf16_f32 v211, v214, v215
    v_cvt_pk_bf16_f32 v216, v216, v217
    v_mfma_f32_16x16x32_bf16 v[244:247], a[56:59], v[88:91], v[244:247]
    v_exp_f32 v218, v218
    v_mfma_f32_16x16x32_bf16 v[244:247], a[60:63], v[92:95], v[244:247]
    s_waitcnt lgkmcnt(12)
    v_exp_f32 v219, v219
    v_mfma_f32_16x16x32_bf16 v[112:115], a[128:131], v[208:211], v[112:115]
    v_exp_f32 v220, v220
    v_mfma_f32_16x16x32_bf16 v[116:119], a[132:135], v[208:211], v[116:119]
    ds_read_b64_tr_b16 a[184:185], v53 offset:32768
    v_cvt_pk_bf16_f32 v217, v218, v219
    v_mfma_f32_16x16x32_bf16 v[120:123], a[136:139], v[208:211], v[120:123]
    ds_read_b64_tr_b16 a[186:187], v53 offset:36864
    v_exp_f32 v221, v221
    v_mfma_f32_16x16x32_bf16 v[124:127], a[140:143], v[208:211], v[124:127]
    buffer_load_dwordx4 v15, s[28:31], s58 offen offset:2048 nt lds
    v_mfma_f32_16x16x32_bf16 v[128:131], a[144:147], v[208:211], v[128:131]
    v_exp_f32 v222, v222
    v_cvt_pk_bf16_f32 v218, v220, v221
    v_exp_f32 v224, v224
    v_mfma_f32_16x16x32_bf16 v[132:135], a[148:151], v[208:211], v[132:135]
    v_exp_f32 v223, v223
    v_exp_f32 v225, v225
    v_mfma_f32_16x16x32_bf16 v[136:139], a[152:155], v[208:211], v[136:139]
    v_cvt_pk_bf16_f32 v219, v222, v223
    v_cvt_pk_bf16_f32 v224, v224, v225
    v_mfma_f32_16x16x32_bf16 v[140:143], a[156:159], v[208:211], v[140:143]
    v_exp_f32 v226, v226
    v_mfma_f32_16x16x32_bf16 a[192:195], a[204:207], v[208:211], a[192:195]
    v_exp_f32 v227, v227
    v_mfma_f32_16x16x32_bf16 v[144:147], a[128:131], v[216:219], v[144:147]
    v_exp_f32 v228, v228
    v_mfma_f32_16x16x32_bf16 v[148:151], a[132:135], v[216:219], v[148:151]
    ds_read_b64_tr_b16 a[188:189], v54 offset:32768
    v_cvt_pk_bf16_f32 v225, v226, v227
    v_mfma_f32_16x16x32_bf16 v[152:155], a[136:139], v[216:219], v[152:155]
    v_exp_f32 v229, v229
    v_mfma_f32_16x16x32_bf16 v[156:159], a[140:143], v[216:219], v[156:159]
    ds_read_b64_tr_b16 a[190:191], v54 offset:36864
    v_cvt_pk_bf16_f32 v226, v228, v229
    v_mfma_f32_16x16x32_bf16 v[160:163], a[144:147], v[216:219], v[160:163]
    v_exp_f32 v230, v230
    v_exp_f32 v232, v232
    v_mfma_f32_16x16x32_bf16 v[164:167], a[148:151], v[216:219], v[164:167]
    v_exp_f32 v231, v231
    v_exp_f32 v233, v233
    v_mfma_f32_16x16x32_bf16 v[168:171], a[152:155], v[216:219], v[168:171]
    buffer_load_dwordx4 v16, s[28:31], s58 offen offset:3072 nt lds
    v_mfma_f32_16x16x32_bf16 v[172:175], a[156:159], v[216:219], v[172:175]
    v_cvt_pk_bf16_f32 v227, v230, v231
    v_exp_f32 v234, v234
    v_cvt_pk_bf16_f32 v232, v232, v233
    v_mfma_f32_16x16x32_bf16 a[196:199], a[204:207], v[216:219], a[196:199]
    v_exp_f32 v235, v235
    v_mfma_f32_16x16x32_bf16 v[176:179], a[128:131], v[224:227], v[176:179]
    v_exp_f32 v236, v236
    v_mfma_f32_16x16x32_bf16 v[180:183], a[132:135], v[224:227], v[180:183]
    v_cvt_pk_bf16_f32 v233, v234, v235
    v_add_u32 v9, 17408, v8
    v_mfma_f32_16x16x32_bf16 v[184:187], a[136:139], v[224:227], v[184:187]
    v_exp_f32 v237, v237
    v_mfma_f32_16x16x32_bf16 v[188:191], a[140:143], v[224:227], v[188:191]
    v_exp_f32 v238, v238
    v_mfma_f32_16x16x32_bf16 v[192:195], a[144:147], v[224:227], v[192:195]
    v_cvt_pk_bf16_f32 v234, v236, v237
    v_exp_f32 v240, v240
    v_mfma_f32_16x16x32_bf16 v[196:199], a[148:151], v[224:227], v[196:199]
    v_exp_f32 v239, v239
    v_exp_f32 v241, v241
    v_mfma_f32_16x16x32_bf16 v[200:203], a[152:155], v[224:227], v[200:203]
    v_cvt_pk_bf16_f32 v235, v238, v239
    v_cvt_pk_bf16_f32 v240, v240, v241
    v_mfma_f32_16x16x32_bf16 v[204:207], a[156:159], v[224:227], v[204:207]
    v_exp_f32 v242, v242
    v_mfma_f32_16x16x32_bf16 a[200:203], a[204:207], v[224:227], a[200:203]
    v_exp_f32 v243, v243
    v_mfma_f32_16x16x32_bf16 v[112:115], a[160:163], v[232:235], v[112:115]
    v_exp_f32 v244, v244
    v_mfma_f32_16x16x32_bf16 v[116:119], a[164:167], v[232:235], v[116:119]
    v_cvt_pk_bf16_f32 v241, v242, v243
    v_lshrrev_b32 v57, 2, v2
    v_mfma_f32_16x16x32_bf16 v[120:123], a[168:171], v[232:235], v[120:123]
    v_exp_f32 v245, v245
    v_mfma_f32_16x16x32_bf16 v[124:127], a[172:175], v[232:235], v[124:127]
    s_waitcnt lgkmcnt(12)
    v_exp_f32 v246, v246
    v_mfma_f32_16x16x32_bf16 v[128:131], a[176:179], v[232:235], v[128:131]
    s_waitcnt lgkmcnt(4)
    v_cvt_pk_bf16_f32 v242, v244, v245
    v_lshlrev_b32 v57, 6, v57
    v_mfma_f32_16x16x32_bf16 v[132:135], a[180:183], v[232:235], v[132:135]
    s_waitcnt lgkmcnt(2)
    v_exp_f32 v247, v247
    v_mfma_f32_16x16x32_bf16 v[136:139], a[184:187], v[232:235], v[136:139]
    s_waitcnt lgkmcnt(0)
    v_cvt_pk_bf16_f32 v243, v246, v247
    v_lshl_add_u32 v57, v58, 4, v57
    v_mfma_f32_16x16x32_bf16 v[140:143], a[188:191], v[232:235], v[140:143]
    s_waitcnt vmcnt(9) lgkmcnt(0)
    v_and_b32 v59, 3, v2
    v_mfma_f32_16x16x32_bf16 a[192:195], a[204:207], v[232:235], a[192:195]
    s_barrier
    ds_read_b64_tr_b16 a[128:129], v39 offset:0
    v_mfma_f32_16x16x32_bf16 v[144:147], a[160:163], v[240:243], v[144:147]
    s_add_u32 s58, s55, 98304
    ds_read_b64_tr_b16 a[130:131], v39 offset:4096
    ds_read_b64_tr_b16 a[132:133], v40 offset:0
    v_mfma_f32_16x16x32_bf16 v[148:151], a[164:167], v[240:243], v[148:151]
    s_add_u32 m0, s55, 0
    ds_read_b64_tr_b16 a[134:135], v40 offset:4096
    ds_read_b64_tr_b16 a[136:137], v41 offset:0
    v_mfma_f32_16x16x32_bf16 v[152:155], a[168:171], v[240:243], v[152:155]
    buffer_load_dwordx4 v11, s[24:27], s58 offen offset:0 nt lds
    v_mfma_f32_16x16x32_bf16 v[156:159], a[172:175], v[240:243], v[156:159]
    ds_read_b64_tr_b16 a[138:139], v41 offset:4096
    ds_read_b64_tr_b16 a[140:141], v42 offset:0
    v_mfma_f32_16x16x32_bf16 v[160:163], a[176:179], v[240:243], v[160:163]
    ds_read_b64_tr_b16 a[142:143], v42 offset:4096
    ds_read_b64_tr_b16 a[144:145], v43 offset:0
    v_mfma_f32_16x16x32_bf16 v[164:167], a[180:183], v[240:243], v[164:167]
    ds_read_b64_tr_b16 a[146:147], v43 offset:4096
    ds_read_b64_tr_b16 a[148:149], v44 offset:0
    v_mfma_f32_16x16x32_bf16 v[168:171], a[184:187], v[240:243], v[168:171]
    buffer_load_dwordx4 v12, s[24:27], s58 offen offset:1024 nt lds
    v_mfma_f32_16x16x32_bf16 v[172:175], a[188:191], v[240:243], v[172:175]
    ds_read_b64_tr_b16 a[150:151], v44 offset:4096
    ds_read_b64_tr_b16 a[152:153], v45 offset:0
    v_mfma_f32_16x16x32_bf16 a[196:199], a[204:207], v[240:243], a[196:199]
    ds_read_b64_tr_b16 a[154:155], v45 offset:4096
    ds_read_b64_tr_b16 a[156:157], v46 offset:0
    v_mfma_f32_16x16x32_bf16 v[208:211], a[64:67], v[64:67], 0
    ds_read_b64_tr_b16 a[158:159], v46 offset:4096
    ds_read_b64_tr_b16 a[160:161], v47 offset:0
    v_mfma_f32_16x16x32_bf16 v[208:211], a[68:71], v[68:71], v[208:211]
    buffer_load_dwordx4 v13, s[24:27], s58 offen offset:2048 nt lds
    v_mfma_f32_16x16x32_bf16 v[208:211], a[72:75], v[72:75], v[208:211]
    ds_read_b64_tr_b16 a[162:163], v47 offset:4096
    ds_read_b64_tr_b16 a[164:165], v48 offset:0
    v_mfma_f32_16x16x32_bf16 v[208:211], a[76:79], v[76:79], v[208:211]
    ds_read_b64_tr_b16 a[166:167], v48 offset:4096
    ds_read_b64_tr_b16 a[168:169], v49 offset:0
    v_mfma_f32_16x16x32_bf16 v[212:215], a[80:83], v[64:67], 0
    ds_read_b64_tr_b16 a[170:171], v49 offset:4096
    ds_read_b64_tr_b16 a[172:173], v50 offset:0
    v_mfma_f32_16x16x32_bf16 v[212:215], a[84:87], v[68:71], v[212:215]
    buffer_load_dwordx4 v14, s[24:27], s58 offen offset:3072 nt lds
    v_mfma_f32_16x16x32_bf16 v[212:215], a[88:91], v[72:75], v[212:215]
    ds_read_b64_tr_b16 a[174:175], v50 offset:4096
    v_lshl_add_u32 v57, v59, 3, v57
    v_mfma_f32_16x16x32_bf16 v[212:215], a[92:95], v[76:79], v[212:215]
    s_lshl_b32 s59, s48, 11
    v_exp_f32 v208, v208
    v_mfma_f32_16x16x32_bf16 v[216:219], a[64:67], v[80:83], 0
    s_add_u32 s59, s59, 65536
    v_exp_f32 v209, v209
    v_mfma_f32_16x16x32_bf16 v[216:219], a[68:71], v[84:87], v[216:219]
    ds_read_b128 a[0:3], v31 offset:16384
    v_cvt_pk_bf16_f32 v208, v208, v209
    v_mfma_f32_16x16x32_bf16 v[216:219], a[72:75], v[88:91], v[216:219]
    ds_read_b128 a[4:7], v32 offset:16384
    v_add_u32 v25, s59, v57
    v_mfma_f32_16x16x32_bf16 v[216:219], a[76:79], v[92:95], v[216:219]
    ds_read_b128 a[8:11], v33 offset:16384
    v_xor_b32 v26, 32, v25
    v_mfma_f32_16x16x32_bf16 v[220:223], a[80:83], v[80:83], 0
    ds_read_b128 a[12:15], v34 offset:16384
    v_xor_b32 v27, 2048, v25
    v_mfma_f32_16x16x32_bf16 v[220:223], a[84:87], v[84:87], v[220:223]
    ds_read_b128 a[16:19], v31 offset:20480
    v_xor_b32 v28, 2080, v25
    v_mfma_f32_16x16x32_bf16 v[220:223], a[88:91], v[88:91], v[220:223]
    v_exp_f32 v210, v210
    v_mfma_f32_16x16x32_bf16 v[220:223], a[92:95], v[92:95], v[220:223]
    v_exp_f32 v211, v211
    v_mfma_f32_16x16x32_bf16 v[224:227], a[64:67], v[96:99], 0
    ds_read_b128 a[20:23], v32 offset:20480
    v_cvt_pk_bf16_f32 v209, v210, v211
    v_mfma_f32_16x16x32_bf16 v[224:227], a[68:71], v[100:103], v[224:227]
    s_add_u32 s58, s55, 81920
    v_exp_f32 v212, v212
    v_mfma_f32_16x16x32_bf16 v[224:227], a[72:75], v[104:107], v[224:227]
    s_add_u32 m0, s55, 81920
    v_exp_f32 v213, v213
    v_mfma_f32_16x16x32_bf16 v[224:227], a[76:79], v[108:111], v[224:227]
    buffer_load_dwordx4 v15, s[28:31], s58 offen offset:0 nt lds
    v_mfma_f32_16x16x32_bf16 v[228:231], a[80:83], v[96:99], 0
    ds_read_b128 a[24:27], v33 offset:20480
    v_cvt_pk_bf16_f32 v210, v212, v213
    v_mfma_f32_16x16x32_bf16 v[228:231], a[84:87], v[100:103], v[228:231]
    v_exp_f32 v214, v214
    v_mfma_f32_16x16x32_bf16 v[228:231], a[88:91], v[104:107], v[228:231]
    ds_read_b64_tr_b16 a[176:177], v51 offset:0
    ds_read_b64_tr_b16 a[178:179], v51 offset:4096
    v_mfma_f32_16x16x32_bf16 v[228:231], a[92:95], v[108:111], v[228:231]
    v_exp_f32 v216, v216
    v_mfma_f32_16x16x32_bf16 v[232:235], a[96:99], v[64:67], 0
    v_exp_f32 v215, v215
    v_mfma_f32_16x16x32_bf16 v[232:235], a[100:103], v[68:71], v[232:235]
    ds_read_b128 a[28:31], v34 offset:20480
    v_cvt_pk_bf16_f32 v211, v214, v215
    v_mfma_f32_16x16x32_bf16 v[232:235], a[104:107], v[72:75], v[232:235]
    v_exp_f32 v217, v217
    v_mfma_f32_16x16x32_bf16 v[232:235], a[108:111], v[76:79], v[232:235]
    ds_read_b128 a[32:35], v35 offset:16384
    v_cvt_pk_bf16_f32 v216, v216, v217
    v_mfma_f32_16x16x32_bf16 v[236:239], a[112:115], v[64:67], 0
    v_exp_f32 v218, v218
    v_mfma_f32_16x16x32_bf16 v[236:239], a[116:119], v[68:71], v[236:239]
    v_exp_f32 v219, v219
    v_mfma_f32_16x16x32_bf16 v[236:239], a[120:123], v[72:75], v[236:239]
    ds_read_b128 a[36:39], v36 offset:16384
    v_cvt_pk_bf16_f32 v217, v218, v219
    v_mfma_f32_16x16x32_bf16 v[236:239], a[124:127], v[76:79], v[236:239]
    buffer_load_dwordx4 v16, s[28:31], s58 offen offset:1024 nt lds
    v_mfma_f32_16x16x32_bf16 v[240:243], a[96:99], v[80:83], 0
    ds_read_b64_tr_b16 a[180:181], v52 offset:0
    ds_read_b64_tr_b16 a[182:183], v52 offset:4096
    v_mfma_f32_16x16x32_bf16 v[240:243], a[100:103], v[84:87], v[240:243]
    v_exp_f32 v220, v220
    v_mfma_f32_16x16x32_bf16 v[240:243], a[104:107], v[88:91], v[240:243]
    v_exp_f32 v221, v221
    v_mfma_f32_16x16x32_bf16 v[240:243], a[108:111], v[92:95], v[240:243]
    ds_read_b128 a[40:43], v37 offset:16384
    v_cvt_pk_bf16_f32 v218, v220, v221
    v_mfma_f32_16x16x32_bf16 v[244:247], a[112:115], v[80:83], 0
    v_exp_f32 v222, v222
    v_mfma_f32_16x16x32_bf16 v[244:247], a[116:119], v[84:87], v[244:247]
    v_exp_f32 v224, v224
    v_mfma_f32_16x16x32_bf16 v[244:247], a[120:123], v[88:91], v[244:247]
    v_exp_f32 v223, v223
    v_mfma_f32_16x16x32_bf16 v[244:247], a[124:127], v[92:95], v[244:247]
    s_waitcnt lgkmcnt(12)
    ds_read_b128 a[44:47], v38 offset:16384
    v_cvt_pk_bf16_f32 v219, v222, v223
    v_mfma_f32_16x16x32_bf16 v[112:115], a[128:131], v[208:211], v[112:115]
    v_exp_f32 v225, v225
    v_mfma_f32_16x16x32_bf16 v[116:119], a[132:135], v[208:211], v[116:119]
    ds_read_b128 a[48:51], v35 offset:20480
    v_cvt_pk_bf16_f32 v224, v224, v225
    v_mfma_f32_16x16x32_bf16 v[120:123], a[136:139], v[208:211], v[120:123]
    ds_read_b64_tr_b16 a[184:185], v53 offset:0
    ds_read_b64_tr_b16 a[186:187], v53 offset:4096
    v_mfma_f32_16x16x32_bf16 v[124:127], a[140:143], v[208:211], v[124:127]
    buffer_load_dwordx4 v15, s[28:31], s58 offen offset:2048 nt lds
    v_mfma_f32_16x16x32_bf16 v[128:131], a[144:147], v[208:211], v[128:131]
    v_exp_f32 v226, v226
    v_mfma_f32_16x16x32_bf16 v[132:135], a[148:151], v[208:211], v[132:135]
    v_exp_f32 v227, v227
    v_mfma_f32_16x16x32_bf16 v[136:139], a[152:155], v[208:211], v[136:139]
    ds_read_b128 a[52:55], v36 offset:20480
    v_cvt_pk_bf16_f32 v225, v226, v227
    v_mfma_f32_16x16x32_bf16 v[140:143], a[156:159], v[208:211], v[140:143]
    v_exp_f32 v228, v228
    v_mfma_f32_16x16x32_bf16 a[192:195], a[204:207], v[208:211], a[192:195]
    v_exp_f32 v229, v229
    v_mfma_f32_16x16x32_bf16 v[144:147], a[128:131], v[216:219], v[144:147]
    ds_read_b128 a[56:59], v37 offset:20480
    v_cvt_pk_bf16_f32 v226, v228, v229
    v_mfma_f32_16x16x32_bf16 v[148:151], a[132:135], v[216:219], v[148:151]
    v_exp_f32 v230, v230
    v_mfma_f32_16x16x32_bf16 v[152:155], a[136:139], v[216:219], v[152:155]
    v_exp_f32 v232, v232
    v_mfma_f32_16x16x32_bf16 v[156:159], a[140:143], v[216:219], v[156:159]
    ds_read_b64_tr_b16 a[188:189], v54 offset:0
    ds_read_b64_tr_b16 a[190:191], v54 offset:4096
    v_mfma_f32_16x16x32_bf16 v[160:163], a[144:147], v[216:219], v[160:163]
    v_exp_f32 v231, v231
    v_mfma_f32_16x16x32_bf16 v[164:167], a[148:151], v[216:219], v[164:167]
    v_exp_f32 v233, v233
    v_mfma_f32_16x16x32_bf16 v[168:171], a[152:155], v[216:219], v[168:171]
    buffer_load_dwordx4 v16, s[28:31], s58 offen offset:3072 nt lds
    v_mfma_f32_16x16x32_bf16 v[172:175], a[156:159], v[216:219], v[172:175]
    v_cvt_pk_bf16_f32 v227, v230, v231
    v_exp_f32 v234, v234
    v_cvt_pk_bf16_f32 v232, v232, v233
    v_mfma_f32_16x16x32_bf16 a[196:199], a[204:207], v[216:219], a[196:199]
    v_exp_f32 v235, v235
    v_mfma_f32_16x16x32_bf16 v[176:179], a[128:131], v[224:227], v[176:179]
    ds_read_b128 a[60:63], v38 offset:20480
    v_cvt_pk_bf16_f32 v233, v234, v235
    v_mfma_f32_16x16x32_bf16 v[180:183], a[132:135], v[224:227], v[180:183]
    v_exp_f32 v236, v236
    v_mfma_f32_16x16x32_bf16 v[184:187], a[136:139], v[224:227], v[184:187]
    v_exp_f32 v237, v237
    v_mfma_f32_16x16x32_bf16 v[188:191], a[140:143], v[224:227], v[188:191]
    v_exp_f32 v238, v238
    v_mfma_f32_16x16x32_bf16 v[192:195], a[144:147], v[224:227], v[192:195]
    v_cvt_pk_bf16_f32 v234, v236, v237
    v_exp_f32 v240, v240
    v_mfma_f32_16x16x32_bf16 v[196:199], a[148:151], v[224:227], v[196:199]
    v_exp_f32 v239, v239
    v_exp_f32 v241, v241
    v_mfma_f32_16x16x32_bf16 v[200:203], a[152:155], v[224:227], v[200:203]
    v_cvt_pk_bf16_f32 v235, v238, v239
    v_cvt_pk_bf16_f32 v240, v240, v241
    v_mfma_f32_16x16x32_bf16 v[204:207], a[156:159], v[224:227], v[204:207]
    v_exp_f32 v242, v242
    v_mfma_f32_16x16x32_bf16 a[200:203], a[204:207], v[224:227], a[200:203]
    v_exp_f32 v243, v243
    v_mfma_f32_16x16x32_bf16 v[112:115], a[160:163], v[232:235], v[112:115]
    v_exp_f32 v244, v244
    v_mfma_f32_16x16x32_bf16 v[116:119], a[164:167], v[232:235], v[116:119]
    v_cvt_pk_bf16_f32 v241, v242, v243
    v_mfma_f32_16x16x32_bf16 v[120:123], a[168:171], v[232:235], v[120:123]
    v_exp_f32 v245, v245
    v_mfma_f32_16x16x32_bf16 v[124:127], a[172:175], v[232:235], v[124:127]
    s_waitcnt lgkmcnt(12)
    v_exp_f32 v246, v246
    v_mfma_f32_16x16x32_bf16 v[128:131], a[176:179], v[232:235], v[128:131]
    s_waitcnt lgkmcnt(10)
    buffer_load_dword v29, v1, s[4:7], s18 offen sc1
    v_cvt_pk_bf16_f32 v242, v244, v245
    v_mfma_f32_16x16x32_bf16 v[132:135], a[180:183], v[232:235], v[132:135]
    s_waitcnt lgkmcnt(5)
    v_exp_f32 v247, v247
    v_mfma_f32_16x16x32_bf16 v[136:139], a[184:187], v[232:235], v[136:139]
    s_waitcnt lgkmcnt(1)
    v_cvt_pk_bf16_f32 v243, v246, v247
    v_mfma_f32_16x16x32_bf16 v[140:143], a[188:191], v[232:235], v[140:143]
    s_waitcnt vmcnt(9) lgkmcnt(0)
    v_mfma_f32_16x16x32_bf16 a[192:195], a[204:207], v[232:235], a[192:195]
    s_barrier
    ds_read_b64_tr_b16 a[128:129], v39 offset:16384
    v_mfma_f32_16x16x32_bf16 v[144:147], a[160:163], v[240:243], v[144:147]
    s_add_u32 s58, s55, 114688
    ds_read_b64_tr_b16 a[130:131], v39 offset:20480
    ds_read_b64_tr_b16 a[132:133], v40 offset:16384
    v_mfma_f32_16x16x32_bf16 v[148:151], a[164:167], v[240:243], v[148:151]
    s_add_u32 m0, s55, 16384
    ds_read_b64_tr_b16 a[134:135], v40 offset:20480
    ds_read_b64_tr_b16 a[136:137], v41 offset:16384
    v_mfma_f32_16x16x32_bf16 v[152:155], a[168:171], v[240:243], v[152:155]
    buffer_load_dwordx4 v11, s[24:27], s58 offen offset:0 nt lds
    v_mfma_f32_16x16x32_bf16 v[156:159], a[172:175], v[240:243], v[156:159]
    ds_read_b64_tr_b16 a[138:139], v41 offset:20480
    ds_read_b64_tr_b16 a[140:141], v42 offset:16384
    v_mfma_f32_16x16x32_bf16 v[160:163], a[176:179], v[240:243], v[160:163]
    ds_read_b64_tr_b16 a[142:143], v42 offset:20480
    ds_read_b64_tr_b16 a[144:145], v43 offset:16384
    v_mfma_f32_16x16x32_bf16 v[164:167], a[180:183], v[240:243], v[164:167]
    ds_read_b64_tr_b16 a[146:147], v43 offset:20480
    ds_read_b64_tr_b16 a[148:149], v44 offset:16384
    v_mfma_f32_16x16x32_bf16 v[168:171], a[184:187], v[240:243], v[168:171]
    buffer_load_dwordx4 v12, s[24:27], s58 offen offset:1024 nt lds
    v_mfma_f32_16x16x32_bf16 v[172:175], a[188:191], v[240:243], v[172:175]
    ds_read_b64_tr_b16 a[150:151], v44 offset:20480
    ds_read_b64_tr_b16 a[152:153], v45 offset:16384
    v_mfma_f32_16x16x32_bf16 a[196:199], a[204:207], v[240:243], a[196:199]
    ds_read_b64_tr_b16 a[154:155], v45 offset:20480
    ds_read_b64_tr_b16 a[156:157], v46 offset:16384
    v_mfma_f32_16x16x32_bf16 v[208:211], a[0:3], v[64:67], 0
    ds_read_b64_tr_b16 a[158:159], v46 offset:20480
    ds_read_b64_tr_b16 a[160:161], v47 offset:16384
    v_mfma_f32_16x16x32_bf16 v[208:211], a[4:7], v[68:71], v[208:211]
    buffer_load_dwordx4 v13, s[24:27], s58 offen offset:2048 nt lds
    v_mfma_f32_16x16x32_bf16 v[208:211], a[8:11], v[72:75], v[208:211]
    ds_read_b64_tr_b16 a[162:163], v47 offset:20480
    ds_read_b64_tr_b16 a[164:165], v48 offset:16384
    v_mfma_f32_16x16x32_bf16 v[208:211], a[12:15], v[76:79], v[208:211]
    ds_read_b64_tr_b16 a[166:167], v48 offset:20480
    ds_read_b64_tr_b16 a[168:169], v49 offset:16384
    v_mfma_f32_16x16x32_bf16 v[212:215], a[16:19], v[64:67], 0
    ds_read_b64_tr_b16 a[170:171], v49 offset:20480
    ds_read_b64_tr_b16 a[172:173], v50 offset:16384
    v_mfma_f32_16x16x32_bf16 v[212:215], a[20:23], v[68:71], v[212:215]
    buffer_load_dwordx4 v14, s[24:27], s58 offen offset:3072 nt lds
    v_mfma_f32_16x16x32_bf16 v[212:215], a[24:27], v[72:75], v[212:215]
    ds_read_b64_tr_b16 a[174:175], v50 offset:20480
    v_mfma_f32_16x16x32_bf16 v[212:215], a[28:31], v[76:79], v[212:215]
    v_exp_f32 v208, v208
    v_mfma_f32_16x16x32_bf16 v[216:219], a[0:3], v[80:83], 0
    v_exp_f32 v209, v209
    v_mfma_f32_16x16x32_bf16 v[216:219], a[4:7], v[84:87], v[216:219]
    ds_read_b128 a[64:67], v31 offset:32768
    v_cvt_pk_bf16_f32 v208, v208, v209
    v_mfma_f32_16x16x32_bf16 v[216:219], a[8:11], v[88:91], v[216:219]
    v_exp_f32 v210, v210
    v_mfma_f32_16x16x32_bf16 v[216:219], a[12:15], v[92:95], v[216:219]
    v_exp_f32 v211, v211
    v_mfma_f32_16x16x32_bf16 v[220:223], a[16:19], v[80:83], 0
    ds_read_b128 a[68:71], v32 offset:32768
    v_cvt_pk_bf16_f32 v209, v210, v211
    v_mfma_f32_16x16x32_bf16 v[220:223], a[20:23], v[84:87], v[220:223]
    v_exp_f32 v212, v212
    v_mfma_f32_16x16x32_bf16 v[220:223], a[24:27], v[88:91], v[220:223]
    v_exp_f32 v213, v213
    v_mfma_f32_16x16x32_bf16 v[220:223], a[28:31], v[92:95], v[220:223]
    ds_read_b128 a[72:75], v33 offset:32768
    v_cvt_pk_bf16_f32 v210, v212, v213
    v_mfma_f32_16x16x32_bf16 v[224:227], a[0:3], v[96:99], 0
    v_exp_f32 v214, v214
    v_mfma_f32_16x16x32_bf16 v[224:227], a[4:7], v[100:103], v[224:227]
    s_add_u32 s58, s55, 98304
    v_exp_f32 v216, v216
    v_mfma_f32_16x16x32_bf16 v[224:227], a[8:11], v[104:107], v[224:227]
    s_add_u32 m0, s55, 49152
    v_exp_f32 v215, v215
    v_mfma_f32_16x16x32_bf16 v[224:227], a[12:15], v[108:111], v[224:227]
    buffer_load_dwordx4 v15, s[28:31], s58 offen offset:0 nt lds
    v_mfma_f32_16x16x32_bf16 v[228:231], a[16:19], v[96:99], 0
    ds_read_b128 a[76:79], v34 offset:32768
    v_cvt_pk_bf16_f32 v211, v214, v215
    v_mfma_f32_16x16x32_bf16 v[228:231], a[20:23], v[100:103], v[228:231]
    v_exp_f32 v217, v217
    v_mfma_f32_16x16x32_bf16 v[228:231], a[24:27], v[104:107], v[228:231]
    ds_read_b64_tr_b16 a[176:177], v51 offset:16384
    ds_read_b64_tr_b16 a[178:179], v51 offset:20480
    v_mfma_f32_16x16x32_bf16 v[228:231], a[28:31], v[108:111], v[228:231]
    ds_read_b128 a[80:83], v31 offset:36864
    v_cvt_pk_bf16_f32 v216, v216, v217
    v_mfma_f32_16x16x32_bf16 v[232:235], a[32:35], v[64:67], 0
    v_exp_f32 v218, v218
    v_mfma_f32_16x16x32_bf16 v[232:235], a[36:39], v[68:71], v[232:235]
    v_exp_f32 v219, v219
    v_mfma_f32_16x16x32_bf16 v[232:235], a[40:43], v[72:75], v[232:235]
    ds_read_b128 a[84:87], v32 offset:36864
    v_cvt_pk_bf16_f32 v217, v218, v219
    v_mfma_f32_16x16x32_bf16 v[232:235], a[44:47], v[76:79], v[232:235]
    v_exp_f32 v220, v220
    v_mfma_f32_16x16x32_bf16 v[236:239], a[48:51], v[64:67], 0
    v_exp_f32 v221, v221
    v_mfma_f32_16x16x32_bf16 v[236:239], a[52:55], v[68:71], v[236:239]
    ds_read_b128 a[88:91], v33 offset:36864
    v_cvt_pk_bf16_f32 v218, v220, v221
    v_mfma_f32_16x16x32_bf16 v[236:239], a[56:59], v[72:75], v[236:239]
    v_exp_f32 v222, v222
    v_mfma_f32_16x16x32_bf16 v[236:239], a[60:63], v[76:79], v[236:239]
    buffer_load_dwordx4 v16, s[28:31], s58 offen offset:1024 nt lds
    v_mfma_f32_16x16x32_bf16 v[240:243], a[32:35], v[80:83], 0
    ds_read_b64_tr_b16 a[180:181], v52 offset:16384
    ds_read_b64_tr_b16 a[182:183], v52 offset:20480
    v_mfma_f32_16x16x32_bf16 v[240:243], a[36:39], v[84:87], v[240:243]
    v_exp_f32 v224, v224
    v_mfma_f32_16x16x32_bf16 v[240:243], a[40:43], v[88:91], v[240:243]
    v_exp_f32 v223, v223
    v_mfma_f32_16x16x32_bf16 v[240:243], a[44:47], v[92:95], v[240:243]
    ds_read_b128 a[92:95], v34 offset:36864
    v_cvt_pk_bf16_f32 v219, v222, v223
    v_mfma_f32_16x16x32_bf16 v[244:247], a[48:51], v[80:83], 0
standalone__gqa_block_cached__near_ridge_a_h0_3:
    s_cbranch_execz standalone__gqa_block_cached__near_ridge_a_h0_r
    v_exp_f32 v225, v225
    v_mfma_f32_16x16x32_bf16 v[244:247], a[52:55], v[84:87], v[244:247]
    ds_read_b128 a[96:99], v35 offset:32768
    v_cvt_pk_bf16_f32 v224, v224, v225
    v_mfma_f32_16x16x32_bf16 v[244:247], a[56:59], v[88:91], v[244:247]
    v_exp_f32 v226, v226
    v_mfma_f32_16x16x32_bf16 v[244:247], a[60:63], v[92:95], v[244:247]
    s_waitcnt lgkmcnt(12)
    v_exp_f32 v227, v227
    v_mfma_f32_16x16x32_bf16 v[112:115], a[128:131], v[208:211], v[112:115]
    ds_read_b128 a[100:103], v36 offset:32768
    v_cvt_pk_bf16_f32 v225, v226, v227
    v_mfma_f32_16x16x32_bf16 v[116:119], a[132:135], v[208:211], v[116:119]
    v_exp_f32 v228, v228
    v_mfma_f32_16x16x32_bf16 v[120:123], a[136:139], v[208:211], v[120:123]
    ds_read_b64_tr_b16 a[184:185], v53 offset:16384
    ds_read_b64_tr_b16 a[186:187], v53 offset:20480
    v_mfma_f32_16x16x32_bf16 v[124:127], a[140:143], v[208:211], v[124:127]
    buffer_load_dwordx4 v15, s[28:31], s58 offen offset:2048 nt lds
    v_mfma_f32_16x16x32_bf16 v[128:131], a[144:147], v[208:211], v[128:131]
    v_exp_f32 v229, v229
    v_mfma_f32_16x16x32_bf16 v[132:135], a[148:151], v[208:211], v[132:135]
    ds_read_b128 a[104:107], v37 offset:32768
    v_cvt_pk_bf16_f32 v226, v228, v229
    v_mfma_f32_16x16x32_bf16 v[136:139], a[152:155], v[208:211], v[136:139]
    v_exp_f32 v230, v230
    v_mfma_f32_16x16x32_bf16 v[140:143], a[156:159], v[208:211], v[140:143]
    v_exp_f32 v232, v232
    v_mfma_f32_16x16x32_bf16 a[192:195], a[204:207], v[208:211], a[192:195]
    v_exp_f32 v231, v231
    v_mfma_f32_16x16x32_bf16 v[144:147], a[128:131], v[216:219], v[144:147]
    ds_read_b128 a[108:111], v38 offset:32768
    v_cvt_pk_bf16_f32 v227, v230, v231
    v_mfma_f32_16x16x32_bf16 v[148:151], a[132:135], v[216:219], v[148:151]
    v_exp_f32 v233, v233
    v_mfma_f32_16x16x32_bf16 v[152:155], a[136:139], v[216:219], v[152:155]
    ds_read_b128 a[112:115], v35 offset:36864
    v_cvt_pk_bf16_f32 v232, v232, v233
    v_mfma_f32_16x16x32_bf16 v[156:159], a[140:143], v[216:219], v[156:159]
    ds_read_b64_tr_b16 a[188:189], v54 offset:16384
    ds_read_b64_tr_b16 a[190:191], v54 offset:20480
    v_mfma_f32_16x16x32_bf16 v[160:163], a[144:147], v[216:219], v[160:163]
    v_exp_f32 v234, v234
    v_mfma_f32_16x16x32_bf16 v[164:167], a[148:151], v[216:219], v[164:167]
    v_exp_f32 v235, v235
    v_mfma_f32_16x16x32_bf16 v[168:171], a[152:155], v[216:219], v[168:171]
    buffer_load_dwordx4 v16, s[28:31], s58 offen offset:3072 nt lds
    v_mfma_f32_16x16x32_bf16 v[172:175], a[156:159], v[216:219], v[172:175]
    ds_read_b128 a[116:119], v36 offset:36864
    v_cvt_pk_bf16_f32 v233, v234, v235
    v_mfma_f32_16x16x32_bf16 a[196:199], a[204:207], v[216:219], a[196:199]
    v_exp_f32 v236, v236
    v_mfma_f32_16x16x32_bf16 v[176:179], a[128:131], v[224:227], v[176:179]
    v_exp_f32 v237, v237
    v_mfma_f32_16x16x32_bf16 v[180:183], a[132:135], v[224:227], v[180:183]
    ds_read_b128 a[120:123], v37 offset:36864
    v_cvt_pk_bf16_f32 v234, v236, v237
    v_mfma_f32_16x16x32_bf16 v[184:187], a[136:139], v[224:227], v[184:187]
    v_exp_f32 v238, v238
    v_mfma_f32_16x16x32_bf16 v[188:191], a[140:143], v[224:227], v[188:191]
    v_exp_f32 v240, v240
    v_mfma_f32_16x16x32_bf16 v[192:195], a[144:147], v[224:227], v[192:195]
    v_exp_f32 v239, v239
    v_mfma_f32_16x16x32_bf16 v[196:199], a[148:151], v[224:227], v[196:199]
    v_exp_f32 v241, v241
    v_mfma_f32_16x16x32_bf16 v[200:203], a[152:155], v[224:227], v[200:203]
    ds_read_b128 a[124:127], v38 offset:36864
    v_cvt_pk_bf16_f32 v235, v238, v239
    v_mfma_f32_16x16x32_bf16 v[204:207], a[156:159], v[224:227], v[204:207]
    v_exp_f32 v242, v242
    v_cvt_pk_bf16_f32 v240, v240, v241
    v_mfma_f32_16x16x32_bf16 a[200:203], a[204:207], v[224:227], a[200:203]
    v_exp_f32 v243, v243
    v_mfma_f32_16x16x32_bf16 v[112:115], a[160:163], v[232:235], v[112:115]
    v_exp_f32 v244, v244
    v_mfma_f32_16x16x32_bf16 v[116:119], a[164:167], v[232:235], v[116:119]
    v_cvt_pk_bf16_f32 v241, v242, v243
    v_mfma_f32_16x16x32_bf16 v[120:123], a[168:171], v[232:235], v[120:123]
    v_exp_f32 v245, v245
    v_mfma_f32_16x16x32_bf16 v[124:127], a[172:175], v[232:235], v[124:127]
    s_waitcnt lgkmcnt(12)
    v_exp_f32 v246, v246
    v_mfma_f32_16x16x32_bf16 v[128:131], a[176:179], v[232:235], v[128:131]
    v_cvt_pk_bf16_f32 v242, v244, v245
    v_mfma_f32_16x16x32_bf16 v[132:135], a[180:183], v[232:235], v[132:135]
    s_waitcnt lgkmcnt(8)
    v_exp_f32 v247, v247
    v_mfma_f32_16x16x32_bf16 v[136:139], a[184:187], v[232:235], v[136:139]
    s_waitcnt lgkmcnt(3)
    v_cvt_pk_bf16_f32 v243, v246, v247
    v_mfma_f32_16x16x32_bf16 v[140:143], a[188:191], v[232:235], v[140:143]
    s_waitcnt vmcnt(9) lgkmcnt(0)
    v_mfma_f32_16x16x32_bf16 a[192:195], a[204:207], v[232:235], a[192:195]
    s_barrier
    ds_read_b64_tr_b16 a[128:129], v39 offset:32768
    v_mfma_f32_16x16x32_bf16 v[144:147], a[160:163], v[240:243], v[144:147]
    s_add_u32 s58, s55, 114688
    ds_read_b64_tr_b16 a[130:131], v39 offset:36864
    ds_read_b64_tr_b16 a[132:133], v40 offset:32768
    v_mfma_f32_16x16x32_bf16 v[148:151], a[164:167], v[240:243], v[148:151]
    s_add_u32 m0, s55, 65536
    ds_read_b64_tr_b16 a[134:135], v40 offset:36864
    ds_read_b64_tr_b16 a[136:137], v41 offset:32768
    v_mfma_f32_16x16x32_bf16 v[152:155], a[168:171], v[240:243], v[152:155]
    buffer_load_dwordx4 v15, s[28:31], s58 offen offset:0 nt lds
    v_mfma_f32_16x16x32_bf16 v[156:159], a[172:175], v[240:243], v[156:159]
    ds_read_b64_tr_b16 a[138:139], v41 offset:36864
    ds_read_b64_tr_b16 a[140:141], v42 offset:32768
    v_mfma_f32_16x16x32_bf16 v[160:163], a[176:179], v[240:243], v[160:163]
    ds_read_b64_tr_b16 a[142:143], v42 offset:36864
    ds_read_b64_tr_b16 a[144:145], v43 offset:32768
    v_mfma_f32_16x16x32_bf16 v[164:167], a[180:183], v[240:243], v[164:167]
    ds_read_b64_tr_b16 a[146:147], v43 offset:36864
    ds_read_b64_tr_b16 a[148:149], v44 offset:32768
    v_mfma_f32_16x16x32_bf16 v[168:171], a[184:187], v[240:243], v[168:171]
    buffer_load_dwordx4 v16, s[28:31], s58 offen offset:1024 nt lds
    v_mfma_f32_16x16x32_bf16 v[172:175], a[188:191], v[240:243], v[172:175]
    ds_read_b64_tr_b16 a[150:151], v44 offset:36864
    ds_read_b64_tr_b16 a[152:153], v45 offset:32768
    v_mfma_f32_16x16x32_bf16 a[196:199], a[204:207], v[240:243], a[196:199]
    ds_read_b64_tr_b16 a[154:155], v45 offset:36864
    ds_read_b64_tr_b16 a[156:157], v46 offset:32768
    v_mfma_f32_16x16x32_bf16 v[208:211], a[64:67], v[64:67], 0
    ds_read_b64_tr_b16 a[158:159], v46 offset:36864
    ds_read_b64_tr_b16 a[160:161], v47 offset:32768
    v_mfma_f32_16x16x32_bf16 v[208:211], a[68:71], v[68:71], v[208:211]
    buffer_load_dwordx4 v15, s[28:31], s58 offen offset:2048 nt lds
    v_mfma_f32_16x16x32_bf16 v[208:211], a[72:75], v[72:75], v[208:211]
    ds_read_b64_tr_b16 a[162:163], v47 offset:36864
    ds_read_b64_tr_b16 a[164:165], v48 offset:32768
    v_mfma_f32_16x16x32_bf16 v[208:211], a[76:79], v[76:79], v[208:211]
    ds_read_b64_tr_b16 a[166:167], v48 offset:36864
    ds_read_b64_tr_b16 a[168:169], v49 offset:32768
    v_mfma_f32_16x16x32_bf16 v[212:215], a[80:83], v[64:67], 0
    ds_read_b64_tr_b16 a[170:171], v49 offset:36864
    ds_read_b64_tr_b16 a[172:173], v50 offset:32768
    v_mfma_f32_16x16x32_bf16 v[212:215], a[84:87], v[68:71], v[212:215]
    buffer_load_dwordx4 v16, s[28:31], s58 offen offset:3072 nt lds
    v_mfma_f32_16x16x32_bf16 v[212:215], a[88:91], v[72:75], v[212:215]
    ds_read_b64_tr_b16 a[174:175], v50 offset:36864
    v_mfma_f32_16x16x32_bf16 v[212:215], a[92:95], v[76:79], v[212:215]
    v_exp_f32 v208, v208
    v_mfma_f32_16x16x32_bf16 v[216:219], a[64:67], v[80:83], 0
    buffer_load_dword v255, v253, s[36:39], s73 offen offset:512
    v_mfma_f32_16x16x32_bf16 v[216:219], a[68:71], v[84:87], v[216:219]
    v_exp_f32 v209, v209
    v_mfma_f32_16x16x32_bf16 v[216:219], a[72:75], v[88:91], v[216:219]
    s_mul_i32 s57, s48, 5120
    ds_read_b128 a[0:3], v31 offset:0
    v_cvt_pk_bf16_f32 v208, v208, v209
    v_mfma_f32_16x16x32_bf16 v[216:219], a[76:79], v[92:95], v[216:219]
    s_add_u32 s57, s57, 0
    ds_read_b128 a[4:7], v32 offset:0
    v_add_u32 v55, s57, v3
    v_mfma_f32_16x16x32_bf16 v[220:223], a[80:83], v[80:83], 0
    s_xor_b32 s57, s48, 1
    v_exp_f32 v210, v210
    v_mfma_f32_16x16x32_bf16 v[220:223], a[84:87], v[84:87], v[220:223]
    s_mul_i32 s57, s57, 5120
    v_exp_f32 v211, v211
    v_mfma_f32_16x16x32_bf16 v[220:223], a[88:91], v[88:91], v[220:223]
    s_add_u32 s57, s57, 0
    ds_read_b128 a[8:11], v33 offset:0
    v_cvt_pk_bf16_f32 v209, v210, v211
    v_mfma_f32_16x16x32_bf16 v[220:223], a[92:95], v[92:95], v[220:223]
    ds_read_b128 a[12:15], v34 offset:0
    v_add_u32 v56, s57, v3
    v_mfma_f32_16x16x32_bf16 v[224:227], a[64:67], v[96:99], 0
    s_lshl_b32 s57, s48, 2
    v_exp_f32 v212, v212
    v_mfma_f32_16x16x32_bf16 v[224:227], a[68:71], v[100:103], v[224:227]
    s_add_u32 s57, s57, 20480
    ds_read_b128 a[16:19], v31 offset:4096
    v_mov_b32 v57, s57
    v_mfma_f32_16x16x32_bf16 v[224:227], a[72:75], v[104:107], v[224:227]
    ds_read_b128 a[20:23], v32 offset:4096
    v_mov_b32 v251, v254
    v_mfma_f32_16x16x32_bf16 v[224:227], a[76:79], v[108:111], v[224:227]
    v_exp_f32 v213, v213
    v_mfma_f32_16x16x32_bf16 v[228:231], a[80:83], v[96:99], 0
    ds_read_b128 a[24:27], v33 offset:4096
    v_cvt_pk_bf16_f32 v210, v212, v213
    v_mfma_f32_16x16x32_bf16 v[228:231], a[84:87], v[100:103], v[228:231]
    v_exp_f32 v214, v214
    v_mfma_f32_16x16x32_bf16 v[228:231], a[88:91], v[104:107], v[228:231]
    ds_read_b64_tr_b16 a[176:177], v51 offset:32768
    ds_read_b64_tr_b16 a[178:179], v51 offset:36864
    v_mfma_f32_16x16x32_bf16 v[228:231], a[92:95], v[108:111], v[228:231]
    v_exp_f32 v216, v216
    v_mfma_f32_16x16x32_bf16 v[232:235], a[96:99], v[64:67], 0
    v_exp_f32 v215, v215
    v_mfma_f32_16x16x32_bf16 v[232:235], a[100:103], v[68:71], v[232:235]
    ds_read_b128 a[28:31], v34 offset:4096
    v_cvt_pk_bf16_f32 v211, v214, v215
    v_mfma_f32_16x16x32_bf16 v[232:235], a[104:107], v[72:75], v[232:235]
    v_exp_f32 v217, v217
    v_mfma_f32_16x16x32_bf16 v[232:235], a[108:111], v[76:79], v[232:235]
    ds_read_b128 a[32:35], v35 offset:0
    v_cvt_pk_bf16_f32 v216, v216, v217
    v_mfma_f32_16x16x32_bf16 v[236:239], a[112:115], v[64:67], 0
    v_exp_f32 v218, v218
    v_mfma_f32_16x16x32_bf16 v[236:239], a[116:119], v[68:71], v[236:239]
    v_exp_f32 v219, v219
    v_mfma_f32_16x16x32_bf16 v[236:239], a[120:123], v[72:75], v[236:239]
    ds_read_b128 a[36:39], v36 offset:0
    v_cvt_pk_bf16_f32 v217, v218, v219
    v_mfma_f32_16x16x32_bf16 v[236:239], a[124:127], v[76:79], v[236:239]
    v_exp_f32 v220, v220
    v_mfma_f32_16x16x32_bf16 v[240:243], a[96:99], v[80:83], 0
    ds_read_b64_tr_b16 a[180:181], v52 offset:32768
    ds_read_b64_tr_b16 a[182:183], v52 offset:36864
    v_mfma_f32_16x16x32_bf16 v[240:243], a[100:103], v[84:87], v[240:243]
    v_exp_f32 v221, v221
    v_mfma_f32_16x16x32_bf16 v[240:243], a[104:107], v[88:91], v[240:243]
    ds_read_b128 a[40:43], v37 offset:0
    v_cvt_pk_bf16_f32 v218, v220, v221
    v_mfma_f32_16x16x32_bf16 v[240:243], a[108:111], v[92:95], v[240:243]
    v_exp_f32 v222, v222
    v_mfma_f32_16x16x32_bf16 v[244:247], a[112:115], v[80:83], 0
    v_exp_f32 v224, v224
    v_mfma_f32_16x16x32_bf16 v[244:247], a[116:119], v[84:87], v[244:247]
    v_exp_f32 v223, v223
    v_mfma_f32_16x16x32_bf16 v[244:247], a[120:123], v[88:91], v[244:247]
    ds_read_b128 a[44:47], v38 offset:0
    v_cvt_pk_bf16_f32 v219, v222, v223
    v_mfma_f32_16x16x32_bf16 v[244:247], a[124:127], v[92:95], v[244:247]
    s_waitcnt lgkmcnt(12)
    v_exp_f32 v225, v225
    v_mfma_f32_16x16x32_bf16 v[112:115], a[128:131], v[208:211], v[112:115]
    ds_read_b128 a[48:51], v35 offset:4096
    v_cvt_pk_bf16_f32 v224, v224, v225
    v_mfma_f32_16x16x32_bf16 v[116:119], a[132:135], v[208:211], v[116:119]
    v_exp_f32 v226, v226
    v_mfma_f32_16x16x32_bf16 v[120:123], a[136:139], v[208:211], v[120:123]
    ds_read_b64_tr_b16 a[184:185], v53 offset:32768
    ds_read_b64_tr_b16 a[186:187], v53 offset:36864
    v_mfma_f32_16x16x32_bf16 v[124:127], a[140:143], v[208:211], v[124:127]
    v_exp_f32 v227, v227
    v_mfma_f32_16x16x32_bf16 v[128:131], a[144:147], v[208:211], v[128:131]
    ds_read_b128 a[52:55], v36 offset:4096
    v_cvt_pk_bf16_f32 v225, v226, v227
    v_mfma_f32_16x16x32_bf16 v[132:135], a[148:151], v[208:211], v[132:135]
    v_exp_f32 v228, v228
    v_mfma_f32_16x16x32_bf16 v[136:139], a[152:155], v[208:211], v[136:139]
    v_exp_f32 v229, v229
    v_mfma_f32_16x16x32_bf16 v[140:143], a[156:159], v[208:211], v[140:143]
    ds_read_b128 a[56:59], v37 offset:4096
    v_cvt_pk_bf16_f32 v226, v228, v229
    v_mfma_f32_16x16x32_bf16 a[192:195], a[204:207], v[208:211], a[192:195]
    v_exp_f32 v230, v230
    v_mfma_f32_16x16x32_bf16 v[144:147], a[128:131], v[216:219], v[144:147]
    v_exp_f32 v232, v232
    v_mfma_f32_16x16x32_bf16 v[148:151], a[132:135], v[216:219], v[148:151]
    v_exp_f32 v231, v231
    v_mfma_f32_16x16x32_bf16 v[152:155], a[136:139], v[216:219], v[152:155]
    ds_read_b128 a[60:63], v38 offset:4096
    v_cvt_pk_bf16_f32 v227, v230, v231
    v_mfma_f32_16x16x32_bf16 v[156:159], a[140:143], v[216:219], v[156:159]
    ds_read_b64_tr_b16 a[188:189], v54 offset:32768
    ds_read_b64_tr_b16 a[190:191], v54 offset:36864
    v_mfma_f32_16x16x32_bf16 v[160:163], a[144:147], v[216:219], v[160:163]
    v_exp_f32 v233, v233
    v_mfma_f32_16x16x32_bf16 v[164:167], a[148:151], v[216:219], v[164:167]
    v_exp_f32 v234, v234
    v_mfma_f32_16x16x32_bf16 v[168:171], a[152:155], v[216:219], v[168:171]
    v_exp_f32 v235, v235
    v_mfma_f32_16x16x32_bf16 v[172:175], a[156:159], v[216:219], v[172:175]
    v_cvt_pk_bf16_f32 v232, v232, v233
    v_cvt_pk_bf16_f32 v233, v234, v235
    v_mfma_f32_16x16x32_bf16 a[196:199], a[204:207], v[216:219], a[196:199]
    v_exp_f32 v236, v236
    v_mfma_f32_16x16x32_bf16 v[176:179], a[128:131], v[224:227], v[176:179]
    v_exp_f32 v237, v237
    v_mfma_f32_16x16x32_bf16 v[180:183], a[132:135], v[224:227], v[180:183]
    v_exp_f32 v238, v238
    v_mfma_f32_16x16x32_bf16 v[184:187], a[136:139], v[224:227], v[184:187]
    v_exp_f32 v240, v240
    v_mfma_f32_16x16x32_bf16 v[188:191], a[140:143], v[224:227], v[188:191]
    v_exp_f32 v239, v239
    v_mfma_f32_16x16x32_bf16 v[192:195], a[144:147], v[224:227], v[192:195]
    v_cvt_pk_bf16_f32 v234, v236, v237
    v_cvt_pk_bf16_f32 v235, v238, v239
    v_mfma_f32_16x16x32_bf16 v[196:199], a[148:151], v[224:227], v[196:199]
    v_exp_f32 v241, v241
    v_mfma_f32_16x16x32_bf16 v[200:203], a[152:155], v[224:227], v[200:203]
    v_exp_f32 v242, v242
    v_mfma_f32_16x16x32_bf16 v[204:207], a[156:159], v[224:227], v[204:207]
    v_cvt_pk_bf16_f32 v240, v240, v241
    v_mfma_f32_16x16x32_bf16 a[200:203], a[204:207], v[224:227], a[200:203]
    v_exp_f32 v243, v243
    v_mfma_f32_16x16x32_bf16 v[112:115], a[160:163], v[232:235], v[112:115]
    v_exp_f32 v244, v244
    v_mfma_f32_16x16x32_bf16 v[116:119], a[164:167], v[232:235], v[116:119]
    v_cvt_pk_bf16_f32 v241, v242, v243
    v_mfma_f32_16x16x32_bf16 v[120:123], a[168:171], v[232:235], v[120:123]
    v_exp_f32 v245, v245
    v_mfma_f32_16x16x32_bf16 v[124:127], a[172:175], v[232:235], v[124:127]
    s_waitcnt lgkmcnt(12)
    v_exp_f32 v246, v246
    v_mfma_f32_16x16x32_bf16 v[128:131], a[176:179], v[232:235], v[128:131]
    s_waitcnt lgkmcnt(10)
    v_cvt_pk_bf16_f32 v242, v244, v245
    v_mfma_f32_16x16x32_bf16 v[132:135], a[180:183], v[232:235], v[132:135]
    s_waitcnt lgkmcnt(5)
    v_exp_f32 v247, v247
    v_mfma_f32_16x16x32_bf16 v[136:139], a[184:187], v[232:235], v[136:139]
    s_waitcnt lgkmcnt(0)
    v_cvt_pk_bf16_f32 v243, v246, v247
    v_mfma_f32_16x16x32_bf16 v[140:143], a[188:191], v[232:235], v[140:143]
    s_waitcnt vmcnt(5) lgkmcnt(0)
    v_mfma_f32_16x16x32_bf16 a[192:195], a[204:207], v[232:235], a[192:195]
    s_barrier
    ds_read_b64_tr_b16 a[128:129], v39 offset:0
    v_mfma_f32_16x16x32_bf16 v[144:147], a[160:163], v[240:243], v[144:147]
    ds_read_b64_tr_b16 a[130:131], v39 offset:4096
    ds_read_b64_tr_b16 a[132:133], v40 offset:0
    v_mfma_f32_16x16x32_bf16 v[148:151], a[164:167], v[240:243], v[148:151]
    ds_read_b64_tr_b16 a[134:135], v40 offset:4096
    ds_read_b64_tr_b16 a[136:137], v41 offset:0
    v_mfma_f32_16x16x32_bf16 v[152:155], a[168:171], v[240:243], v[152:155]
    ds_read_b64_tr_b16 a[138:139], v41 offset:4096
    ds_read_b64_tr_b16 a[140:141], v42 offset:0
    v_mfma_f32_16x16x32_bf16 v[156:159], a[172:175], v[240:243], v[156:159]
    ds_read_b64_tr_b16 a[142:143], v42 offset:4096
    ds_read_b64_tr_b16 a[144:145], v43 offset:0
    v_mfma_f32_16x16x32_bf16 v[160:163], a[176:179], v[240:243], v[160:163]
    ds_read_b64_tr_b16 a[146:147], v43 offset:4096
    ds_read_b64_tr_b16 a[148:149], v44 offset:0
    v_mfma_f32_16x16x32_bf16 v[164:167], a[180:183], v[240:243], v[164:167]
    ds_read_b64_tr_b16 a[150:151], v44 offset:4096
    ds_read_b64_tr_b16 a[152:153], v45 offset:0
    v_mfma_f32_16x16x32_bf16 v[168:171], a[184:187], v[240:243], v[168:171]
    ds_read_b64_tr_b16 a[154:155], v45 offset:4096
    ds_read_b64_tr_b16 a[156:157], v46 offset:0
    v_mfma_f32_16x16x32_bf16 v[172:175], a[188:191], v[240:243], v[172:175]
    ds_read_b64_tr_b16 a[158:159], v46 offset:4096
    ds_read_b64_tr_b16 a[160:161], v47 offset:0
    v_mfma_f32_16x16x32_bf16 a[196:199], a[204:207], v[240:243], a[196:199]
    ds_read_b64_tr_b16 a[162:163], v47 offset:4096
    ds_read_b64_tr_b16 a[164:165], v48 offset:0
    v_mfma_f32_16x16x32_bf16 v[208:211], a[0:3], v[64:67], 0
    ds_read_b64_tr_b16 a[166:167], v48 offset:4096
    v_cmp_ne_u32 vcc, 1, v29
    v_mfma_f32_16x16x32_bf16 v[208:211], a[4:7], v[68:71], v[208:211]
    ds_read_b64_tr_b16 a[168:169], v49 offset:0
    ds_read_b64_tr_b16 a[170:171], v49 offset:4096
    v_mfma_f32_16x16x32_bf16 v[208:211], a[8:11], v[72:75], v[208:211]
    ds_read_b64_tr_b16 a[172:173], v50 offset:0
    ds_read_b64_tr_b16 a[174:175], v50 offset:4096
    v_mfma_f32_16x16x32_bf16 v[208:211], a[12:15], v[76:79], v[208:211]
    s_cbranch_vccnz standalone__gqa_block_cached__near_ridge_a_rdy
standalone__gqa_block_cached__near_ridge_a_rdy_r:
    v_mfma_f32_16x16x32_bf16 v[212:215], a[16:19], v[64:67], 0
    v_mfma_f32_16x16x32_bf16 v[212:215], a[20:23], v[68:71], v[212:215]
    v_mfma_f32_16x16x32_bf16 v[212:215], a[24:27], v[72:75], v[212:215]
    s_nop 0
    s_nop 0
    v_mfma_f32_16x16x32_bf16 v[212:215], a[28:31], v[76:79], v[212:215]
    s_nop 0
    v_exp_f32 v208, v208
    v_mfma_f32_16x16x32_bf16 v[216:219], a[0:3], v[80:83], 0
    v_exp_f32 v209, v209
    v_mfma_f32_16x16x32_bf16 v[216:219], a[4:7], v[84:87], v[216:219]
    ds_read_b128 a[64:67], v31 offset:16384
    v_cvt_pk_bf16_f32 v208, v208, v209
    v_mfma_f32_16x16x32_bf16 v[216:219], a[8:11], v[88:91], v[216:219]
    v_exp_f32 v210, v210
    v_mfma_f32_16x16x32_bf16 v[216:219], a[12:15], v[92:95], v[216:219]
    v_exp_f32 v211, v211
    v_mfma_f32_16x16x32_bf16 v[220:223], a[16:19], v[80:83], 0
    ds_read_b128 a[68:71], v32 offset:16384
    v_cvt_pk_bf16_f32 v209, v210, v211
    v_mfma_f32_16x16x32_bf16 v[220:223], a[20:23], v[84:87], v[220:223]
    v_exp_f32 v212, v212
    v_mfma_f32_16x16x32_bf16 v[220:223], a[24:27], v[88:91], v[220:223]
    v_exp_f32 v213, v213
    v_mfma_f32_16x16x32_bf16 v[220:223], a[28:31], v[92:95], v[220:223]
    ds_read_b128 a[72:75], v33 offset:16384
    v_cvt_pk_bf16_f32 v210, v212, v213
    v_mfma_f32_16x16x32_bf16 v[224:227], a[0:3], v[96:99], 0
    v_exp_f32 v214, v214
    v_mfma_f32_16x16x32_bf16 v[224:227], a[4:7], v[100:103], v[224:227]
    v_exp_f32 v216, v216
    v_mfma_f32_16x16x32_bf16 v[224:227], a[8:11], v[104:107], v[224:227]
    v_exp_f32 v215, v215
    v_mfma_f32_16x16x32_bf16 v[224:227], a[12:15], v[108:111], v[224:227]
    ds_read_b128 a[76:79], v34 offset:16384
    v_cvt_pk_bf16_f32 v211, v214, v215
    v_mfma_f32_16x16x32_bf16 v[228:231], a[16:19], v[96:99], 0
    v_exp_f32 v217, v217
    v_mfma_f32_16x16x32_bf16 v[228:231], a[20:23], v[100:103], v[228:231]
    ds_read_b128 a[80:83], v31 offset:20480
    v_cvt_pk_bf16_f32 v216, v216, v217
    v_mfma_f32_16x16x32_bf16 v[228:231], a[24:27], v[104:107], v[228:231]
    ds_read_b64_tr_b16 a[176:177], v51 offset:0
    ds_read_b64_tr_b16 a[178:179], v51 offset:4096
    v_mfma_f32_16x16x32_bf16 v[228:231], a[28:31], v[108:111], v[228:231]
    v_exp_f32 v218, v218
    v_mfma_f32_16x16x32_bf16 v[232:235], a[32:35], v[64:67], 0
    v_exp_f32 v219, v219
    v_mfma_f32_16x16x32_bf16 v[232:235], a[36:39], v[68:71], v[232:235]
    ds_read_b128 a[84:87], v32 offset:20480
    v_cvt_pk_bf16_f32 v217, v218, v219
    v_mfma_f32_16x16x32_bf16 v[232:235], a[40:43], v[72:75], v[232:235]
    v_exp_f32 v220, v220
    v_mfma_f32_16x16x32_bf16 v[232:235], a[44:47], v[76:79], v[232:235]
    v_exp_f32 v221, v221
    v_mfma_f32_16x16x32_bf16 v[236:239], a[48:51], v[64:67], 0
    ds_read_b128 a[88:91], v33 offset:20480
    v_cvt_pk_bf16_f32 v218, v220, v221
    v_mfma_f32_16x16x32_bf16 v[236:239], a[52:55], v[68:71], v[236:239]
    s_add_u32 s58, s8, 0
    v_exp_f32 v222, v222
    v_mfma_f32_16x16x32_bf16 v[236:239], a[56:59], v[72:75], v[236:239]
    s_add_u32 m0, s19, 98304
    v_exp_f32 v224, v224
    v_mfma_f32_16x16x32_bf16 v[236:239], a[60:63], v[76:79], v[236:239]
    buffer_load_dwordx4 v4, s[36:39], s58 offen offset:0 lds
    v_mfma_f32_16x16x32_bf16 v[240:243], a[32:35], v[80:83], 0
    ds_read_b64_tr_b16 a[180:181], v52 offset:0
    ds_read_b64_tr_b16 a[182:183], v52 offset:4096
    v_mfma_f32_16x16x32_bf16 v[240:243], a[36:39], v[84:87], v[240:243]
    v_exp_f32 v223, v223
    v_mfma_f32_16x16x32_bf16 v[240:243], a[40:43], v[88:91], v[240:243]
    buffer_load_dwordx4 v5, s[36:39], s58 offen offset:1024 lds
    v_mfma_f32_16x16x32_bf16 v[240:243], a[44:47], v[92:95], v[240:243]
    ds_read_b128 a[92:95], v34 offset:20480
    v_cvt_pk_bf16_f32 v219, v222, v223
    v_mfma_f32_16x16x32_bf16 v[244:247], a[48:51], v[80:83], 0
    v_exp_f32 v225, v225
    v_mfma_f32_16x16x32_bf16 v[244:247], a[52:55], v[84:87], v[244:247]
    ds_read_b128 a[96:99], v35 offset:16384
    v_cvt_pk_bf16_f32 v224, v224, v225
    v_mfma_f32_16x16x32_bf16 v[244:247], a[56:59], v[88:91], v[244:247]
    v_exp_f32 v226, v226
    v_mfma_f32_16x16x32_bf16 v[244:247], a[60:63], v[92:95], v[244:247]
    s_waitcnt lgkmcnt(12)
    buffer_load_dwordx4 v6, s[36:39], s58 offen offset:2048 lds
    v_mfma_f32_16x16x32_bf16 v[112:115], a[128:131], v[208:211], v[112:115]
    v_exp_f32 v227, v227
    v_mfma_f32_16x16x32_bf16 v[116:119], a[132:135], v[208:211], v[116:119]
    ds_read_b128 a[100:103], v36 offset:16384
    v_cvt_pk_bf16_f32 v225, v226, v227
    v_mfma_f32_16x16x32_bf16 v[120:123], a[136:139], v[208:211], v[120:123]
    ds_read_b64_tr_b16 a[184:185], v53 offset:0
    ds_read_b64_tr_b16 a[186:187], v53 offset:4096
    v_mfma_f32_16x16x32_bf16 v[124:127], a[140:143], v[208:211], v[124:127]
    buffer_load_dwordx4 v7, s[36:39], s58 offen offset:3072 lds
    v_mfma_f32_16x16x32_bf16 v[128:131], a[144:147], v[208:211], v[128:131]
    v_exp_f32 v228, v228
    v_mfma_f32_16x16x32_bf16 v[132:135], a[148:151], v[208:211], v[132:135]
    v_exp_f32 v229, v229
    v_mfma_f32_16x16x32_bf16 v[136:139], a[152:155], v[208:211], v[136:139]
    s_add_u32 s58, s8, 18432
    ds_read_b128 a[104:107], v37 offset:16384
    v_cvt_pk_bf16_f32 v226, v228, v229
    v_mfma_f32_16x16x32_bf16 v[140:143], a[156:159], v[208:211], v[140:143]
    s_add_u32 m0, s19, 102400
    v_exp_f32 v230, v230
    v_mfma_f32_16x16x32_bf16 a[192:195], a[204:207], v[208:211], a[192:195]
    buffer_load_dwordx4 v4, s[36:39], s58 offen offset:0 lds
    v_mfma_f32_16x16x32_bf16 v[144:147], a[128:131], v[216:219], v[144:147]
    v_exp_f32 v232, v232
    v_mfma_f32_16x16x32_bf16 v[148:151], a[132:135], v[216:219], v[148:151]
    v_exp_f32 v231, v231
    v_mfma_f32_16x16x32_bf16 v[152:155], a[136:139], v[216:219], v[152:155]
    ds_read_b128 a[108:111], v38 offset:16384
    v_cvt_pk_bf16_f32 v227, v230, v231
    v_mfma_f32_16x16x32_bf16 v[156:159], a[140:143], v[216:219], v[156:159]
    ds_read_b64_tr_b16 a[188:189], v54 offset:0
    ds_read_b64_tr_b16 a[190:191], v54 offset:4096
    buffer_load_dwordx4 v5, s[36:39], s58 offen offset:1024 lds
    v_mfma_f32_16x16x32_bf16 v[160:163], a[144:147], v[216:219], v[160:163]
    v_exp_f32 v233, v233
    v_mfma_f32_16x16x32_bf16 v[164:167], a[148:151], v[216:219], v[164:167]
    ds_read_b128 a[112:115], v35 offset:20480
    v_cvt_pk_bf16_f32 v232, v232, v233
    v_mfma_f32_16x16x32_bf16 v[168:171], a[152:155], v[216:219], v[168:171]
    v_exp_f32 v234, v234
    v_mfma_f32_16x16x32_bf16 v[172:175], a[156:159], v[216:219], v[172:175]
    v_exp_f32 v235, v235
    v_mfma_f32_16x16x32_bf16 a[196:199], a[204:207], v[216:219], a[196:199]
    buffer_load_dwordx4 v6, s[36:39], s58 offen offset:2048 lds
    v_mfma_f32_16x16x32_bf16 v[176:179], a[128:131], v[224:227], v[176:179]
    ds_read_b128 a[116:119], v36 offset:20480
    v_cvt_pk_bf16_f32 v233, v234, v235
    v_mfma_f32_16x16x32_bf16 v[180:183], a[132:135], v[224:227], v[180:183]
    v_exp_f32 v236, v236
    v_mfma_f32_16x16x32_bf16 v[184:187], a[136:139], v[224:227], v[184:187]
    v_exp_f32 v237, v237
    v_mfma_f32_16x16x32_bf16 v[188:191], a[140:143], v[224:227], v[188:191]
    buffer_load_dwordx4 v7, s[36:39], s58 offen offset:3072 lds
    v_mfma_f32_16x16x32_bf16 v[192:195], a[144:147], v[224:227], v[192:195]
    v_exp_f32 v238, v238
    v_cvt_pk_bf16_f32 v234, v236, v237
    v_exp_f32 v240, v240
    v_mfma_f32_16x16x32_bf16 v[196:199], a[148:151], v[224:227], v[196:199]
    v_exp_f32 v239, v239
    v_exp_f32 v241, v241
    v_mfma_f32_16x16x32_bf16 v[200:203], a[152:155], v[224:227], v[200:203]
    s_add_u32 s58, s8, 36864
    ds_read_b128 a[120:123], v37 offset:20480
    v_cvt_pk_bf16_f32 v235, v238, v239
    v_mfma_f32_16x16x32_bf16 v[204:207], a[156:159], v[224:227], v[204:207]
    s_add_u32 m0, s19, 131072
    v_exp_f32 v242, v242
    v_cvt_pk_bf16_f32 v240, v240, v241
    v_mfma_f32_16x16x32_bf16 a[200:203], a[204:207], v[224:227], a[200:203]
    buffer_load_dwordx4 v4, s[36:39], s58 offen offset:0 lds
    v_exp_f32 v243, v243
    v_mfma_f32_16x16x32_bf16 v[112:115], a[160:163], v[232:235], v[112:115]
    ds_read_b128 a[124:127], v38 offset:20480
    v_cvt_pk_bf16_f32 v241, v242, v243
    v_mfma_f32_16x16x32_bf16 v[116:119], a[164:167], v[232:235], v[116:119]
    v_exp_f32 v244, v244
    v_mfma_f32_16x16x32_bf16 v[120:123], a[168:171], v[232:235], v[120:123]
    v_exp_f32 v245, v245
    v_mfma_f32_16x16x32_bf16 v[124:127], a[172:175], v[232:235], v[124:127]
    s_waitcnt lgkmcnt(12)
    buffer_load_dwordx4 v5, s[36:39], s58 offen offset:1024 lds
    v_mfma_f32_16x16x32_bf16 v[128:131], a[176:179], v[232:235], v[128:131]
    v_exp_f32 v246, v246
    v_cvt_pk_bf16_f32 v242, v244, v245
    v_mfma_f32_16x16x32_bf16 v[132:135], a[180:183], v[232:235], v[132:135]
    s_waitcnt lgkmcnt(8)
    v_exp_f32 v247, v247
    v_mfma_f32_16x16x32_bf16 v[136:139], a[184:187], v[232:235], v[136:139]
    s_waitcnt lgkmcnt(4)
    v_cvt_pk_bf16_f32 v243, v246, v247
    v_mfma_f32_16x16x32_bf16 v[140:143], a[188:191], v[232:235], v[140:143]
    s_waitcnt vmcnt(11) lgkmcnt(0)
    v_mfma_f32_16x16x32_bf16 a[192:195], a[204:207], v[232:235], a[192:195]
    s_barrier
    buffer_load_dwordx4 v6, s[36:39], s58 offen offset:2048 lds
    v_mfma_f32_16x16x32_bf16 v[144:147], a[160:163], v[240:243], v[144:147]
    ds_read_b64_tr_b16 a[128:129], v39 offset:16384
    ds_read_b64_tr_b16 a[130:131], v39 offset:20480
    v_mfma_f32_16x16x32_bf16 v[148:151], a[164:167], v[240:243], v[148:151]
    ds_read_b64_tr_b16 a[132:133], v40 offset:16384
    ds_read_b64_tr_b16 a[134:135], v40 offset:20480
    v_mfma_f32_16x16x32_bf16 v[152:155], a[168:171], v[240:243], v[152:155]
    ds_read_b64_tr_b16 a[136:137], v41 offset:16384
    ds_read_b64_tr_b16 a[138:139], v41 offset:20480
    v_mfma_f32_16x16x32_bf16 v[156:159], a[172:175], v[240:243], v[156:159]
    buffer_load_dwordx4 v7, s[36:39], s58 offen offset:3072 lds
    v_mfma_f32_16x16x32_bf16 v[160:163], a[176:179], v[240:243], v[160:163]
    ds_read_b64_tr_b16 a[140:141], v42 offset:16384
    ds_read_b64_tr_b16 a[142:143], v42 offset:20480
    v_mfma_f32_16x16x32_bf16 v[164:167], a[180:183], v[240:243], v[164:167]
    ds_read_b64_tr_b16 a[144:145], v43 offset:16384
    ds_read_b64_tr_b16 a[146:147], v43 offset:20480
    v_mfma_f32_16x16x32_bf16 v[168:171], a[184:187], v[240:243], v[168:171]
    s_add_u32 s58, s8, 55296
    ds_read_b64_tr_b16 a[148:149], v44 offset:16384
    ds_read_b64_tr_b16 a[150:151], v44 offset:20480
    v_mfma_f32_16x16x32_bf16 v[172:175], a[188:191], v[240:243], v[172:175]
    s_add_u32 m0, s19, 135168
    ds_read_b64_tr_b16 a[152:153], v45 offset:16384
    ds_read_b64_tr_b16 a[154:155], v45 offset:20480
    v_mfma_f32_16x16x32_bf16 a[196:199], a[204:207], v[240:243], a[196:199]
    buffer_load_dwordx4 v4, s[36:39], s58 offen offset:0 lds
    v_mfma_f32_16x16x32_bf16 v[208:211], a[64:67], v[64:67], 0
    ds_read_b64_tr_b16 a[156:157], v46 offset:16384
    ds_read_b64_tr_b16 a[158:159], v46 offset:20480
    v_mfma_f32_16x16x32_bf16 v[208:211], a[68:71], v[68:71], v[208:211]
    ds_read_b64_tr_b16 a[160:161], v47 offset:16384
    ds_read_b64_tr_b16 a[162:163], v47 offset:20480
    v_mfma_f32_16x16x32_bf16 v[208:211], a[72:75], v[72:75], v[208:211]
    ds_read_b64_tr_b16 a[164:165], v48 offset:16384
    ds_read_b64_tr_b16 a[166:167], v48 offset:20480
    v_mfma_f32_16x16x32_bf16 v[208:211], a[76:79], v[76:79], v[208:211]
    buffer_load_dwordx4 v5, s[36:39], s58 offen offset:1024 lds
    v_mfma_f32_16x16x32_bf16 v[212:215], a[80:83], v[64:67], 0
    ds_read_b64_tr_b16 a[168:169], v49 offset:16384
    ds_read_b64_tr_b16 a[170:171], v49 offset:20480
    v_mfma_f32_16x16x32_bf16 v[212:215], a[84:87], v[68:71], v[212:215]
    ds_read_b64_tr_b16 a[172:173], v50 offset:16384
    ds_read_b64_tr_b16 a[174:175], v50 offset:20480
    v_mfma_f32_16x16x32_bf16 v[212:215], a[88:91], v[72:75], v[212:215]
standalone__gqa_block_cached__near_ridge_a_h0_4:
    s_cbranch_execz standalone__gqa_block_cached__near_ridge_a_h0_r
    v_xor_b32 v31, 8192, v17
    v_xor_b32 v32, 8192, v18
    v_mfma_f32_16x16x32_bf16 v[212:215], a[92:95], v[76:79], v[212:215]
    v_exp_f32 v208, v208
    v_mfma_f32_16x16x32_bf16 v[216:219], a[64:67], v[80:83], 0
    buffer_load_dwordx4 v6, s[36:39], s58 offen offset:2048 lds
    v_mfma_f32_16x16x32_bf16 v[216:219], a[68:71], v[84:87], v[216:219]
    v_exp_f32 v209, v209
    v_mfma_f32_16x16x32_bf16 v[216:219], a[72:75], v[88:91], v[216:219]
    v_exp_f32 v210, v210
    v_mfma_f32_16x16x32_bf16 v[216:219], a[76:79], v[92:95], v[216:219]
    v_cvt_pk_bf16_f32 v208, v208, v209
    v_xor_b32 v33, 8192, v19
    v_mfma_f32_16x16x32_bf16 v[220:223], a[80:83], v[80:83], 0
    buffer_load_dwordx4 v7, s[36:39], s58 offen offset:3072 lds
    v_mfma_f32_16x16x32_bf16 v[220:223], a[84:87], v[84:87], v[220:223]
    v_exp_f32 v211, v211
    v_mfma_f32_16x16x32_bf16 v[220:223], a[88:91], v[88:91], v[220:223]
    v_exp_f32 v212, v212
    v_mfma_f32_16x16x32_bf16 v[220:223], a[92:95], v[92:95], v[220:223]
    s_add_u32 s58, s8, 0
    s_add_u32 s58, s58, s16
    v_cvt_pk_bf16_f32 v209, v210, v211
    v_xor_b32 v34, 8192, v20
    v_mfma_f32_16x16x32_bf16 v[224:227], a[64:67], v[96:99], 0
    s_lshl_b32 m0, s48, 11
    s_add_u32 m0, m0, 81920
    v_exp_f32 v213, v213
    v_mfma_f32_16x16x32_bf16 v[224:227], a[68:71], v[100:103], v[224:227]
    buffer_load_dwordx4 v8, s[36:39], s58 offen offset:0 lds
    v_mfma_f32_16x16x32_bf16 v[224:227], a[72:75], v[104:107], v[224:227]
    v_exp_f32 v214, v214
    v_mfma_f32_16x16x32_bf16 v[224:227], a[76:79], v[108:111], v[224:227]
    v_cvt_pk_bf16_f32 v210, v212, v213
    v_xor_b32 v35, 8192, v21
    v_mfma_f32_16x16x32_bf16 v[228:231], a[80:83], v[96:99], 0
    ds_read_b64_tr_b16 a[176:177], v51 offset:16384
    ds_read_b64_tr_b16 a[178:179], v51 offset:20480
    v_mfma_f32_16x16x32_bf16 v[228:231], a[84:87], v[100:103], v[228:231]
    buffer_load_dwordx4 v9, s[36:39], s58 offen offset:1024 lds
    v_mfma_f32_16x16x32_bf16 v[228:231], a[88:91], v[104:107], v[228:231]
    v_exp_f32 v216, v216
    v_mfma_f32_16x16x32_bf16 v[228:231], a[92:95], v[108:111], v[228:231]
    v_exp_f32 v215, v215
    v_mfma_f32_16x16x32_bf16 v[232:235], a[96:99], v[64:67], 0
    s_add_u32 s58, s8, 36864
    s_add_u32 s58, s58, s16
    v_exp_f32 v217, v217
    v_mfma_f32_16x16x32_bf16 v[232:235], a[100:103], v[68:71], v[232:235]
    s_lshl_b32 m0, s48, 11
    s_add_u32 m0, m0, 90112
    v_cvt_pk_bf16_f32 v211, v214, v215
    v_cvt_pk_bf16_f32 v216, v216, v217
    v_mfma_f32_16x16x32_bf16 v[232:235], a[104:107], v[72:75], v[232:235]
    buffer_load_dwordx4 v8, s[36:39], s58 offen offset:0 lds
    v_mfma_f32_16x16x32_bf16 v[232:235], a[108:111], v[76:79], v[232:235]
    v_exp_f32 v218, v218
    v_mfma_f32_16x16x32_bf16 v[236:239], a[112:115], v[64:67], 0
    v_exp_f32 v219, v219
    v_mfma_f32_16x16x32_bf16 v[236:239], a[116:119], v[68:71], v[236:239]
    v_exp_f32 v220, v220
    v_mfma_f32_16x16x32_bf16 v[236:239], a[120:123], v[72:75], v[236:239]
    ds_read_b64_tr_b16 a[180:181], v52 offset:16384
    ds_read_b64_tr_b16 a[182:183], v52 offset:20480
    v_mfma_f32_16x16x32_bf16 v[236:239], a[124:127], v[76:79], v[236:239]
    buffer_load_dwordx4 v9, s[36:39], s58 offen offset:1024 lds
    v_mfma_f32_16x16x32_bf16 v[240:243], a[96:99], v[80:83], 0
    v_cvt_pk_bf16_f32 v217, v218, v219
    v_xor_b32 v36, 8192, v22
    v_mfma_f32_16x16x32_bf16 v[240:243], a[100:103], v[84:87], v[240:243]
    s_add_u32 s58, s9, 0
    v_exp_f32 v221, v221
    v_mfma_f32_16x16x32_bf16 v[240:243], a[104:107], v[88:91], v[240:243]
    s_add_u32 m0, s19, 32768
    v_exp_f32 v222, v222
    v_mfma_f32_16x16x32_bf16 v[240:243], a[108:111], v[92:95], v[240:243]
    buffer_load_dwordx4 v4, s[36:39], s58 offen offset:0 lds
    v_mfma_f32_16x16x32_bf16 v[244:247], a[112:115], v[80:83], 0
    v_cvt_pk_bf16_f32 v218, v220, v221
    v_xor_b32 v37, 8192, v23
    v_mfma_f32_16x16x32_bf16 v[244:247], a[116:119], v[84:87], v[244:247]
    v_exp_f32 v224, v224
    v_mfma_f32_16x16x32_bf16 v[244:247], a[120:123], v[88:91], v[244:247]
    v_exp_f32 v223, v223
    v_mfma_f32_16x16x32_bf16 v[244:247], a[124:127], v[92:95], v[244:247]
    buffer_load_dwordx4 v5, s[36:39], s58 offen offset:1024 lds
    v_mfma_f32_16x16x32_bf16 a[192:195], a[204:207], v[208:211], a[192:195]
    s_waitcnt lgkmcnt(12)
    ds_read_b64_tr_b16 a[184:185], v53 offset:16384
    ds_read_b64_tr_b16 a[186:187], v53 offset:20480
    v_mfma_f32_16x16x32_bf16 v[112:115], a[128:131], v[208:211], v[112:115]
    v_exp_f32 v225, v225
    v_mfma_f32_16x16x32_bf16 v[116:119], a[132:135], v[208:211], v[116:119]
    v_cvt_pk_bf16_f32 v219, v222, v223
    v_cvt_pk_bf16_f32 v224, v224, v225
    v_mfma_f32_16x16x32_bf16 v[120:123], a[136:139], v[208:211], v[120:123]
    buffer_load_dwordx4 v6, s[36:39], s58 offen offset:2048 lds
    v_mfma_f32_16x16x32_bf16 v[124:127], a[140:143], v[208:211], v[124:127]
    v_exp_f32 v226, v226
    v_mfma_f32_16x16x32_bf16 v[128:131], a[144:147], v[208:211], v[128:131]
    v_exp_f32 v227, v227
    v_mfma_f32_16x16x32_bf16 v[132:135], a[148:151], v[208:211], v[132:135]
    v_exp_f32 v228, v228
    v_mfma_f32_16x16x32_bf16 v[136:139], a[152:155], v[208:211], v[136:139]
    v_cvt_pk_bf16_f32 v225, v226, v227
    v_xor_b32 v38, 8192, v24
    v_mfma_f32_16x16x32_bf16 v[140:143], a[156:159], v[208:211], v[140:143]
    buffer_load_dwordx4 v7, s[36:39], s58 offen offset:3072 lds
    v_mfma_f32_16x16x32_bf16 a[196:199], a[204:207], v[216:219], a[196:199]
    v_exp_f32 v229, v229
    v_mfma_f32_16x16x32_bf16 v[144:147], a[128:131], v[216:219], v[144:147]
    ds_read_b64_tr_b16 a[188:189], v54 offset:16384
    ds_read_b64_tr_b16 a[190:191], v54 offset:20480
    v_mfma_f32_16x16x32_bf16 v[148:151], a[132:135], v[216:219], v[148:151]
    s_add_u32 s58, s9, 18432
    v_exp_f32 v230, v230
    v_mfma_f32_16x16x32_bf16 v[152:155], a[136:139], v[216:219], v[152:155]
    s_add_u32 m0, s19, 36864
    v_exp_f32 v232, v232
    v_mfma_f32_16x16x32_bf16 v[156:159], a[140:143], v[216:219], v[156:159]
    buffer_load_dwordx4 v4, s[36:39], s58 offen offset:0 lds
    v_cvt_pk_bf16_f32 v226, v228, v229
    v_mfma_f32_16x16x32_bf16 v[160:163], a[144:147], v[216:219], v[160:163]
    v_exp_f32 v231, v231
    v_exp_f32 v233, v233
    v_mfma_f32_16x16x32_bf16 v[164:167], a[148:151], v[216:219], v[164:167]
    v_cvt_pk_bf16_f32 v227, v230, v231
    v_cvt_pk_bf16_f32 v232, v232, v233
    v_mfma_f32_16x16x32_bf16 v[168:171], a[152:155], v[216:219], v[168:171]
    v_exp_f32 v234, v234
    v_mfma_f32_16x16x32_bf16 v[172:175], a[156:159], v[216:219], v[172:175]
    buffer_load_dwordx4 v5, s[36:39], s58 offen offset:1024 lds
    v_exp_f32 v235, v235
    v_mfma_f32_16x16x32_bf16 a[200:203], a[204:207], v[224:227], a[200:203]
    v_exp_f32 v236, v236
    v_mfma_f32_16x16x32_bf16 v[176:179], a[128:131], v[224:227], v[176:179]
    v_cvt_pk_bf16_f32 v233, v234, v235
    v_mfma_f32_16x16x32_bf16 v[180:183], a[132:135], v[224:227], v[180:183]
    v_exp_f32 v237, v237
    v_mfma_f32_16x16x32_bf16 v[184:187], a[136:139], v[224:227], v[184:187]
    v_exp_f32 v238, v238
    v_mfma_f32_16x16x32_bf16 v[188:191], a[140:143], v[224:227], v[188:191]
    s_waitcnt lgkmcnt(0)
    buffer_load_dwordx4 v6, s[36:39], s58 offen offset:2048 lds
    v_cvt_pk_bf16_f32 v234, v236, v237
    v_exp_f32 v240, v240
    v_mfma_f32_16x16x32_bf16 v[192:195], a[144:147], v[224:227], v[192:195]
    v_exp_f32 v239, v239
    v_exp_f32 v241, v241
    v_mfma_f32_16x16x32_bf16 v[196:199], a[148:151], v[224:227], v[196:199]
    v_cvt_pk_bf16_f32 v235, v238, v239
    v_cvt_pk_bf16_f32 v240, v240, v241
    v_mfma_f32_16x16x32_bf16 v[200:203], a[152:155], v[224:227], v[200:203]
    v_exp_f32 v242, v242
    v_accvgpr_read_b32 v250, a200
    v_subrev_u32 v60, 729808896, v250
    v_mfma_f32_16x16x32_bf16 v[204:207], a[156:159], v[224:227], v[204:207]
    buffer_load_dwordx4 v7, s[36:39], s58 offen offset:3072 lds
    v_exp_f32 v243, v243
    v_mfma_f32_16x16x32_bf16 a[192:195], a[204:207], v[232:235], a[192:195]
    v_exp_f32 v244, v244
    v_mfma_f32_16x16x32_bf16 v[112:115], a[160:163], v[232:235], v[112:115]
    s_barrier
    ds_write_b64 v55, v[250:251] offset:4096
    v_cvt_pk_bf16_f32 v241, v242, v243
    v_mfma_f32_16x16x32_bf16 v[116:119], a[164:167], v[232:235], v[116:119]
    v_exp_f32 v245, v245
    v_mfma_f32_16x16x32_bf16 v[120:123], a[168:171], v[232:235], v[120:123]
    v_exp_f32 v246, v246
    v_mfma_f32_16x16x32_bf16 v[124:127], a[172:175], v[232:235], v[124:127]
    v_cvt_pk_bf16_f32 v242, v244, v245
    v_mfma_f32_16x16x32_bf16 v[128:131], a[176:179], v[232:235], v[128:131]
    ds_write_b128 v55, v[192:195] offset:0
    v_exp_f32 v247, v247
    v_mfma_f32_16x16x32_bf16 v[132:135], a[180:183], v[232:235], v[132:135]
    v_cvt_pk_bf16_f32 v243, v246, v247
    v_accvgpr_read_b32 v248, a192
    v_mfma_f32_16x16x32_bf16 v[136:139], a[184:187], v[232:235], v[136:139]
    v_subrev_u32 v58, 729808896, v248
    v_mfma_f32_16x16x32_bf16 v[140:143], a[188:191], v[232:235], v[140:143]
    ds_write_b128 v55, v[196:199] offset:1024
    v_mfma_f32_16x16x32_bf16 a[196:199], a[204:207], v[240:243], a[196:199]
    ds_write_b128 v55, v[200:203] offset:2048
    v_mfma_f32_16x16x32_bf16 v[144:147], a[160:163], v[240:243], v[144:147]
    v_mfma_f32_16x16x32_bf16 v[148:151], a[164:167], v[240:243], v[148:151]
    ds_write_b128 v55, v[204:207] offset:3072
    v_mfma_f32_16x16x32_bf16 v[152:155], a[168:171], v[240:243], v[152:155]
    v_rcp_f32 v248, v248
    v_mfma_f32_16x16x32_bf16 v[156:159], a[172:175], v[240:243], v[156:159]
    s_nop 0
    v_accvgpr_read_b32 v249, a196
    v_subrev_u32 v59, 729808896, v249
    v_mfma_f32_16x16x32_bf16 v[160:163], a[176:179], v[240:243], v[160:163]
    v_max3_u32 v58, v58, v59, v60
    v_cmp_lt_u32 vcc, 671088640, v58
    v_mfma_f32_16x16x32_bf16 v[164:167], a[180:183], v[240:243], v[164:167]
    v_rcp_f32 v62, v249
    v_mfma_f32_16x16x32_bf16 v[168:171], a[184:187], v[240:243], v[168:171]
    s_cmp_lg_u64 vcc, 0
    s_cselect_b32 s57, s64, 0
    v_mov_b32 v58, s57
    v_mfma_f32_16x16x32_bf16 v[172:175], a[188:191], v[240:243], v[172:175]
    ds_write_b32 v57, v58
standalone__gqa_block_cached__near_ridge_a_x:
    v_pk_mul_f32 v[112:113], v[112:113], v[248:249] op_sel_hi:[1,0]
    v_pk_mul_f32 v[114:115], v[114:115], v[248:249] op_sel_hi:[1,0]
    v_pk_mul_f32 v[116:117], v[116:117], v[248:249] op_sel_hi:[1,0]
    v_pk_mul_f32 v[118:119], v[118:119], v[248:249] op_sel_hi:[1,0]
    v_cvt_pk_bf16_f32 v112, v112, v113
    v_cvt_pk_bf16_f32 v113, v114, v115
    v_cvt_pk_bf16_f32 v114, v116, v117
    v_cvt_pk_bf16_f32 v115, v118, v119
    buffer_store_dwordx4 v[112:115], v3, s[40:43], s12 offen offset:0 sc1
    v_mov_b32 v57, 20480
    s_waitcnt vmcnt(9) lgkmcnt(0)
    s_barrier
    ds_read_b128 v[224:227], v57
    ds_read_b64 v[228:229], v56 offset:4096
    ds_read_b128 v[208:211], v56 offset:0
    ds_read_b128 v[212:215], v56 offset:1024
    ds_read_b128 v[216:219], v56 offset:2048
    ds_read_b128 v[220:223], v56 offset:3072
    v_pk_mul_f32 v[128:129], v[128:129], v[248:249] op_sel_hi:[1,0]
    v_pk_mul_f32 v[130:131], v[130:131], v[248:249] op_sel_hi:[1,0]
    v_pk_mul_f32 v[132:133], v[132:133], v[248:249] op_sel_hi:[1,0]
    v_pk_mul_f32 v[134:135], v[134:135], v[248:249] op_sel_hi:[1,0]
    v_cvt_pk_bf16_f32 v128, v128, v129
    v_cvt_pk_bf16_f32 v129, v130, v131
    v_cvt_pk_bf16_f32 v130, v132, v133
    v_cvt_pk_bf16_f32 v131, v134, v135
    buffer_store_dwordx4 v[128:131], v3, s[40:43], s12 offen offset:2048 sc1
    v_pk_mul_f32 v[144:145], v[144:145], v[62:63] op_sel_hi:[1,0]
    v_pk_mul_f32 v[146:147], v[146:147], v[62:63] op_sel_hi:[1,0]
    v_pk_mul_f32 v[148:149], v[148:149], v[62:63] op_sel_hi:[1,0]
    v_pk_mul_f32 v[150:151], v[150:151], v[62:63] op_sel_hi:[1,0]
    v_cvt_pk_bf16_f32 v144, v144, v145
    v_cvt_pk_bf16_f32 v145, v146, v147
    v_cvt_pk_bf16_f32 v146, v148, v149
    v_cvt_pk_bf16_f32 v147, v150, v151
    buffer_store_dwordx4 v[144:147], v3, s[40:43], s13 offen offset:0 sc1
    s_waitcnt lgkmcnt(5)
    v_or3_b32 v224, v224, v225, v226
    v_or_b32 v224, v224, v227
    v_cmp_ne_u32 vcc, 0, v224
    s_waitcnt lgkmcnt(4)
    v_min_f32 v57, v251, v229
    v_sub_f32 v251, v57, v251
    v_sub_f32 v229, v57, v229
    v_exp_f32 v251, v251
    v_exp_f32 v229, v229
    s_cbranch_vccnz standalone__gqa_block_cached__near_ridge_a_fb
    v_mul_f32 v250, v250, v251
    v_fma_f32 v250, v228, v229, v250
    v_rcp_f32 v57, v250
    v_pk_mul_f32 v[160:161], v[160:161], v[62:63] op_sel_hi:[1,0]
    v_pk_mul_f32 v[162:163], v[162:163], v[62:63] op_sel_hi:[1,0]
    v_pk_mul_f32 v[164:165], v[164:165], v[62:63] op_sel_hi:[1,0]
    v_pk_mul_f32 v[166:167], v[166:167], v[62:63] op_sel_hi:[1,0]
    v_cvt_pk_bf16_f32 v160, v160, v161
    v_cvt_pk_bf16_f32 v161, v162, v163
    v_cvt_pk_bf16_f32 v162, v164, v165
    v_cvt_pk_bf16_f32 v163, v166, v167
    buffer_store_dwordx4 v[160:163], v3, s[40:43], s13 offen offset:2048 sc1
    v_mul_f32 v250, v251, v57
    v_mul_f32 v228, v229, v57
    v_pk_mul_f32 v[176:177], v[176:177], v[250:251] op_sel_hi:[1,0]
    v_pk_mul_f32 v[178:179], v[178:179], v[250:251] op_sel_hi:[1,0]
    v_pk_mul_f32 v[180:181], v[180:181], v[250:251] op_sel_hi:[1,0]
    v_pk_mul_f32 v[182:183], v[182:183], v[250:251] op_sel_hi:[1,0]
    s_waitcnt lgkmcnt(3)
    v_pk_fma_f32 v[176:177], v[208:209], v[228:229], v[176:177] op_sel_hi:[1,0,1]
    v_pk_fma_f32 v[178:179], v[210:211], v[228:229], v[178:179] op_sel_hi:[1,0,1]
    s_waitcnt lgkmcnt(2)
    v_pk_fma_f32 v[180:181], v[212:213], v[228:229], v[180:181] op_sel_hi:[1,0,1]
    v_pk_fma_f32 v[182:183], v[214:215], v[228:229], v[182:183] op_sel_hi:[1,0,1]
    v_cvt_pk_bf16_f32 v176, v176, v177
    v_cvt_pk_bf16_f32 v177, v178, v179
    v_cvt_pk_bf16_f32 v178, v180, v181
    v_cvt_pk_bf16_f32 v179, v182, v183
    buffer_store_dwordx4 v[176:179], v3, s[40:43], s14 offen offset:0 sc1
    v_pk_mul_f32 v[120:121], v[120:121], v[248:249] op_sel_hi:[1,0]
    v_pk_mul_f32 v[122:123], v[122:123], v[248:249] op_sel_hi:[1,0]
    v_pk_mul_f32 v[124:125], v[124:125], v[248:249] op_sel_hi:[1,0]
    v_pk_mul_f32 v[126:127], v[126:127], v[248:249] op_sel_hi:[1,0]
    v_cvt_pk_bf16_f32 v120, v120, v121
    v_cvt_pk_bf16_f32 v121, v122, v123
    v_cvt_pk_bf16_f32 v122, v124, v125
    v_cvt_pk_bf16_f32 v123, v126, v127
    buffer_store_dwordx4 v[120:123], v3, s[40:43], s12 offen offset:1024 sc1
    v_pk_mul_f32 v[152:153], v[152:153], v[62:63] op_sel_hi:[1,0]
    v_pk_mul_f32 v[154:155], v[154:155], v[62:63] op_sel_hi:[1,0]
    v_pk_mul_f32 v[156:157], v[156:157], v[62:63] op_sel_hi:[1,0]
    v_pk_mul_f32 v[158:159], v[158:159], v[62:63] op_sel_hi:[1,0]
    v_cvt_pk_bf16_f32 v152, v152, v153
    v_cvt_pk_bf16_f32 v153, v154, v155
    v_cvt_pk_bf16_f32 v154, v156, v157
    v_cvt_pk_bf16_f32 v155, v158, v159
    buffer_store_dwordx4 v[152:155], v3, s[40:43], s13 offen offset:1024 sc1
    v_pk_mul_f32 v[184:185], v[184:185], v[250:251] op_sel_hi:[1,0]
    v_pk_mul_f32 v[186:187], v[186:187], v[250:251] op_sel_hi:[1,0]
    v_pk_mul_f32 v[188:189], v[188:189], v[250:251] op_sel_hi:[1,0]
    v_pk_mul_f32 v[190:191], v[190:191], v[250:251] op_sel_hi:[1,0]
    s_waitcnt lgkmcnt(1)
    v_pk_fma_f32 v[184:185], v[216:217], v[228:229], v[184:185] op_sel_hi:[1,0,1]
    v_pk_fma_f32 v[186:187], v[218:219], v[228:229], v[186:187] op_sel_hi:[1,0,1]
    s_waitcnt lgkmcnt(0)
    v_pk_fma_f32 v[188:189], v[220:221], v[228:229], v[188:189] op_sel_hi:[1,0,1]
    v_pk_fma_f32 v[190:191], v[222:223], v[228:229], v[190:191] op_sel_hi:[1,0,1]
    v_cvt_pk_bf16_f32 v184, v184, v185
    v_cvt_pk_bf16_f32 v185, v186, v187
    v_cvt_pk_bf16_f32 v186, v188, v189
    v_cvt_pk_bf16_f32 v187, v190, v191
    buffer_store_dwordx4 v[184:187], v3, s[40:43], s14 offen offset:1024 sc1
    v_pk_mul_f32 v[136:137], v[136:137], v[248:249] op_sel_hi:[1,0]
    v_pk_mul_f32 v[138:139], v[138:139], v[248:249] op_sel_hi:[1,0]
    v_pk_mul_f32 v[140:141], v[140:141], v[248:249] op_sel_hi:[1,0]
    v_pk_mul_f32 v[142:143], v[142:143], v[248:249] op_sel_hi:[1,0]
    v_cvt_pk_bf16_f32 v136, v136, v137
    v_cvt_pk_bf16_f32 v137, v138, v139
    v_cvt_pk_bf16_f32 v138, v140, v141
    v_cvt_pk_bf16_f32 v139, v142, v143
    buffer_store_dwordx4 v[136:139], v3, s[40:43], s12 offen offset:3072 sc1
    v_pk_mul_f32 v[168:169], v[168:169], v[62:63] op_sel_hi:[1,0]
    v_pk_mul_f32 v[170:171], v[170:171], v[62:63] op_sel_hi:[1,0]
    v_pk_mul_f32 v[172:173], v[172:173], v[62:63] op_sel_hi:[1,0]
    v_pk_mul_f32 v[174:175], v[174:175], v[62:63] op_sel_hi:[1,0]
    v_cvt_pk_bf16_f32 v168, v168, v169
    v_cvt_pk_bf16_f32 v169, v170, v171
    v_cvt_pk_bf16_f32 v170, v172, v173
    v_cvt_pk_bf16_f32 v171, v174, v175
    buffer_store_dwordx4 v[168:171], v3, s[40:43], s13 offen offset:3072 sc1
    ds_read_b64_tr_b16 a[128:129], v17 offset:0
    ds_read_b64_tr_b16 a[130:131], v17 offset:4096
    ds_read_b64_tr_b16 a[132:133], v18 offset:0
    ds_read_b64_tr_b16 a[134:135], v18 offset:4096
    ds_read_b64_tr_b16 a[136:137], v19 offset:0
    ds_read_b64_tr_b16 a[138:139], v19 offset:4096
    ds_read_b64_tr_b16 a[140:141], v20 offset:0
    ds_read_b64_tr_b16 a[142:143], v20 offset:4096
    ds_read_b64_tr_b16 a[144:145], v21 offset:0
    ds_read_b64_tr_b16 a[146:147], v21 offset:4096
    ds_read_b64_tr_b16 a[148:149], v22 offset:0
    ds_read_b64_tr_b16 a[150:151], v22 offset:4096
    v_add_u32 v11, 4096, v3
    v_add_u32 v12, 8192, v3
    s_mov_b32 s64, s12
    s_waitcnt lgkmcnt(10)
    v_mfma_f32_16x16x32_bf16 v[64:67], a[128:131], v[112:115], 0
    v_mfma_f32_16x16x32_bf16 v[80:83], a[128:131], v[144:147], 0
    s_add_u32 s58, s9, 0
    s_add_u32 s58, s58, s16
    v_mfma_f32_16x16x32_bf16 v[96:99], a[128:131], v[176:179], 0
    s_lshl_b32 m0, s48, 11
    s_add_u32 m0, m0, 65536
    s_waitcnt lgkmcnt(8)
    v_mfma_f32_16x16x32_bf16 v[68:71], a[132:135], v[112:115], 0
    buffer_load_dwordx4 v8, s[36:39], s58 offen offset:0 lds
    v_mfma_f32_16x16x32_bf16 v[84:87], a[132:135], v[144:147], 0
    v_mfma_f32_16x16x32_bf16 v[100:103], a[132:135], v[176:179], 0
    s_waitcnt lgkmcnt(6)
    v_mfma_f32_16x16x32_bf16 v[72:75], a[136:139], v[112:115], 0
    ds_read_b64_tr_b16 a[152:153], v23 offset:0
    ds_read_b64_tr_b16 a[154:155], v23 offset:4096
    v_mfma_f32_16x16x32_bf16 v[88:91], a[136:139], v[144:147], 0
    s_waitcnt lgkmcnt(6)
    buffer_load_dwordx4 v9, s[36:39], s58 offen offset:1024 lds
    v_mfma_f32_16x16x32_bf16 v[208:211], a[136:139], v[176:179], 0
    s_barrier
    v_mfma_f32_16x16x32_bf16 v[76:79], a[140:143], v[112:115], 0
    s_add_u32 s58, s9, 36864
    ds_read_b64_tr_b16 a[156:157], v24 offset:0
    ds_read_b64_tr_b16 a[158:159], v24 offset:4096
    v_mfma_f32_16x16x32_bf16 v[92:95], a[140:143], v[144:147], 0
    s_add_u32 m0, s19, 0
    v_mfma_f32_16x16x32_bf16 v[212:215], a[140:143], v[176:179], 0
    s_xor_b32 s56, s48, 0
    buffer_load_dwordx4 v4, s[36:39], s58 offen offset:0 lds
    s_waitcnt lgkmcnt(6)
    v_mfma_f32_16x16x32_bf16 v[216:219], a[144:147], v[112:115], 0
    s_lshl_b32 s56, s56, 14
    ds_read_b64_tr_b16 a[160:161], v25 offset:16384
    ds_read_b64_tr_b16 a[162:163], v25 offset:17408
    v_mfma_f32_16x16x32_bf16 v[220:223], a[144:147], v[144:147], 0
    s_add_u32 s56, s56, 98304
    v_mfma_f32_16x16x32_bf16 v[224:227], a[144:147], v[176:179], 0
    s_waitcnt lgkmcnt(6)
    v_add_u32 v55, s56, v3
    v_mfma_f32_16x16x32_bf16 v[228:231], a[148:151], v[112:115], 0
    s_xor_b32 s56, s48, 1
    buffer_load_dwordx4 v5, s[36:39], s58 offen offset:1024 lds
    v_mfma_f32_16x16x32_bf16 v[232:235], a[148:151], v[144:147], 0
    s_lshl_b32 s56, s56, 14
    ds_read_b64_tr_b16 a[164:165], v26 offset:16384
    ds_read_b64_tr_b16 a[166:167], v26 offset:17408
    v_mfma_f32_16x16x32_bf16 v[236:239], a[148:151], v[176:179], 0
    s_add_u32 s56, s56, 98304
    s_waitcnt lgkmcnt(6)
    v_mfma_f32_16x16x32_bf16 v[240:243], a[152:155], v[112:115], 0
    ds_read_b64_tr_b16 a[168:169], v31 offset:0
    ds_read_b64_tr_b16 a[170:171], v31 offset:4096
    v_mfma_f32_16x16x32_bf16 v[244:247], a[152:155], v[144:147], 0
    buffer_load_dwordx4 v6, s[36:39], s58 offen offset:2048 lds
    v_mfma_f32_16x16x32_bf16 v[192:195], a[152:155], v[176:179], 0
    s_waitcnt lgkmcnt(6)
    ds_read_b64_tr_b16 a[172:173], v32 offset:0
    ds_read_b64_tr_b16 a[174:175], v32 offset:4096
    v_mfma_f32_16x16x32_bf16 v[196:199], a[156:159], v[112:115], 0
    s_waitcnt lgkmcnt(6)
    v_add_u32 v56, s56, v3
    v_mfma_f32_16x16x32_bf16 v[200:203], a[156:159], v[144:147], 0
    s_xor_b32 s56, s48, 2
    ds_read_b64_tr_b16 a[176:177], v33 offset:0
    ds_read_b64_tr_b16 a[178:179], v33 offset:4096
    v_mfma_f32_16x16x32_bf16 v[204:207], a[156:159], v[176:179], 0
    s_lshl_b32 s56, s56, 14
    v_mfma_f32_16x16x32_bf16 v[104:107], a[160:163], v[112:115], 0
    s_add_u32 s56, s56, 98304
    buffer_load_dwordx4 v7, s[36:39], s58 offen offset:3072 lds
    v_mfma_f32_16x16x32_bf16 v[116:119], a[160:163], v[144:147], 0
    s_waitcnt lgkmcnt(6)
    ds_read_b64_tr_b16 a[180:181], v34 offset:0
    ds_read_b64_tr_b16 a[182:183], v34 offset:4096
    v_mfma_f32_16x16x32_bf16 v[124:127], a[160:163], v[176:179], 0
    s_add_u32 s58, s9, 55296
    ds_read_b64_tr_b16 a[184:185], v35 offset:0
    ds_read_b64_tr_b16 a[186:187], v35 offset:4096
    v_mfma_f32_16x16x32_bf16 v[108:111], a[164:167], v[112:115], 0
    s_add_u32 m0, s19, 4096
    v_add_u32 v57, s56, v3
    v_mfma_f32_16x16x32_bf16 v[132:135], a[164:167], v[144:147], 0
    s_xor_b32 s56, s48, 3
    buffer_load_dwordx4 v4, s[36:39], s58 offen offset:0 lds
    v_mfma_f32_16x16x32_bf16 v[140:143], a[164:167], v[176:179], 0
    s_lshl_b32 s56, s56, 14
    ds_read_b64_tr_b16 a[188:189], v36 offset:0
    ds_read_b64_tr_b16 a[190:191], v36 offset:4096
    s_waitcnt lgkmcnt(10)
    v_mfma_f32_16x16x32_bf16 v[64:67], a[168:171], v[128:131], v[64:67]
    s_add_u32 s56, s56, 98304
    ds_read_b64_tr_b16 a[192:193], v37 offset:0
    ds_read_b64_tr_b16 a[194:195], v37 offset:4096
    v_mfma_f32_16x16x32_bf16 v[80:83], a[168:171], v[160:163], v[80:83]
    s_waitcnt lgkmcnt(10)
    v_add_u32 v58, s56, v3
    v_mfma_f32_16x16x32_bf16 v[68:71], a[172:175], v[128:131], v[68:71]
    buffer_load_dwordx4 v5, s[36:39], s58 offen offset:1024 lds
    v_mfma_f32_16x16x32_bf16 v[84:87], a[172:175], v[160:163], v[84:87]
    s_waitcnt lgkmcnt(8)
    ds_read_b64_tr_b16 a[196:197], v38 offset:0
    ds_read_b64_tr_b16 a[198:199], v38 offset:4096
    v_mfma_f32_16x16x32_bf16 v[72:75], a[176:179], v[128:131], v[72:75]
    ds_read_b64_tr_b16 a[200:201], v27 offset:16384
    ds_read_b64_tr_b16 a[202:203], v27 offset:17408
    v_mfma_f32_16x16x32_bf16 v[88:91], a[176:179], v[160:163], v[88:91]
    s_waitcnt lgkmcnt(10)
    v_bfe_u32 v60, v2, 4, 1
    v_mfma_f32_16x16x32_bf16 v[76:79], a[180:183], v[128:131], v[76:79]
    buffer_load_dwordx4 v6, s[36:39], s58 offen offset:2048 lds
    v_mfma_f32_16x16x32_bf16 v[92:95], a[180:183], v[160:163], v[92:95]
    s_waitcnt lgkmcnt(8)
    ds_read_b64_tr_b16 a[204:205], v28 offset:16384
    ds_read_b64_tr_b16 a[206:207], v28 offset:17408
    v_mfma_f32_16x16x32_bf16 v[216:219], a[184:187], v[128:131], v[216:219]
    s_waitcnt lgkmcnt(8)
    ds_read_b64_tr_b16 a[208:209], v17 offset:32768
    ds_read_b64_tr_b16 a[210:211], v17 offset:36864
    v_mfma_f32_16x16x32_bf16 v[220:223], a[184:187], v[160:163], v[220:223]
    s_mov_b64 exec, 0
    s_cmp_eq_u32 s48, 0
    s_cbranch_scc1 standalone__gqa_block_cached__near_ridge_a_h1_0
    s_cmp_eq_u32 s48, 1
    s_cbranch_scc1 standalone__gqa_block_cached__near_ridge_a_h1_1
    s_cmp_eq_u32 s48, 2
    s_cbranch_scc1 standalone__gqa_block_cached__near_ridge_a_h1_2
    s_branch standalone__gqa_block_cached__near_ridge_a_h1_r
standalone__gqa_block_cached__near_ridge_a_h1_r:
    s_mov_b64 exec, -1
    v_add_u32 v17, 4294868992, v17
    v_lshrrev_b32 v59, 5, v2
    v_mfma_f32_16x16x32_bf16 v[228:231], a[188:191], v[128:131], v[228:231]
    s_waitcnt vmcnt(9)
    buffer_load_dwordx4 v7, s[36:39], s58 offen offset:3072 lds
    v_mfma_f32_16x16x32_bf16 v[232:235], a[188:191], v[160:163], v[232:235]
    s_waitcnt lgkmcnt(8)
    s_mov_b64 exec, 17
    buffer_store_short v29, v10, s[40:43], s15 offen offset:1024
    buffer_store_short v29, v10, s[40:43], s15 offen sc1
    s_mov_b64 exec, -1
    v_mfma_f32_16x16x32_bf16 v[240:243], a[192:195], v[128:131], v[240:243]
    s_waitcnt lgkmcnt(6)
    ds_read_b64_tr_b16 a[212:213], v18 offset:32768
    ds_read_b64_tr_b16 a[214:215], v18 offset:36864
    v_mfma_f32_16x16x32_bf16 v[244:247], a[192:195], v[160:163], v[244:247]
    s_add_u32 s58, s9, 36864
    s_add_u32 s58, s58, s16
    buffer_load_ushort v30, v10, s[40:43], s15 offen offset:1024 sc1
    v_mfma_f32_16x16x32_bf16 v[196:199], a[196:199], v[128:131], v[196:199]
    s_lshl_b32 m0, s48, 11
    s_add_u32 m0, m0, 73728
    ds_read_b64_tr_b16 a[216:217], v19 offset:32768
    ds_read_b64_tr_b16 a[218:219], v19 offset:36864
    v_mfma_f32_16x16x32_bf16 v[200:203], a[196:199], v[160:163], v[200:203]
    s_waitcnt lgkmcnt(8)
    buffer_load_dwordx4 v8, s[36:39], s58 offen offset:0 lds
    v_mfma_f32_16x16x32_bf16 v[104:107], a[200:203], v[128:131], v[104:107]
    s_waitcnt lgkmcnt(4)
    v_add_u32 v18, 4294868992, v18
    v_add_u32 v19, 4294868992, v19
    v_mfma_f32_16x16x32_bf16 v[116:119], a[200:203], v[160:163], v[116:119]
    s_waitcnt lgkmcnt(6)
    ds_read_b64_tr_b16 a[220:221], v20 offset:32768
    ds_read_b64_tr_b16 a[222:223], v20 offset:36864
    v_mfma_f32_16x16x32_bf16 v[108:111], a[204:207], v[128:131], v[108:111]
    s_waitcnt vmcnt(12)
    v_add_u32 v20, 4294868992, v20
    v_lshl_add_u32 v59, v60, 1, v59
    v_mfma_f32_16x16x32_bf16 v[132:135], a[204:207], v[160:163], v[132:135]
    s_barrier
    buffer_load_dwordx4 v9, s[36:39], s58 offen offset:1024 lds
    v_mfma_f32_16x16x32_bf16 v[64:67], a[208:211], v[120:123], v[64:67]
    ds_read_b64_tr_b16 a[224:225], v21 offset:32768
    ds_read_b64_tr_b16 a[226:227], v21 offset:36864
    v_mfma_f32_16x16x32_bf16 v[80:83], a[208:211], v[152:155], v[80:83]
    v_add_u32 v21, 4294868992, v21
    v_lshlrev_b32 v59, 4, v59
    v_mfma_f32_16x16x32_bf16 v[96:99], a[208:211], v[184:187], v[96:99]
    s_waitcnt lgkmcnt(6)
    v_and_b32 v60, 15, v2
    v_mfma_f32_16x16x32_bf16 v[68:71], a[212:215], v[120:123], v[68:71]
    ds_read_b64_tr_b16 a[228:229], v22 offset:32768
    ds_read_b64_tr_b16 a[230:231], v22 offset:36864
    v_mfma_f32_16x16x32_bf16 v[84:87], a[212:215], v[152:155], v[84:87]
    v_add_u32 v22, 4294868992, v22
    v_mul_u32_u24 v60, 1152, v60
    v_mfma_f32_16x16x32_bf16 v[100:103], a[212:215], v[184:187], v[100:103]
    s_waitcnt lgkmcnt(6)
    v_add_u32 v59, v60, v59
    v_mfma_f32_16x16x32_bf16 v[72:75], a[216:219], v[120:123], v[72:75]
    s_mul_i32 s74, s53, 1310720
    ds_read_b64_tr_b16 a[232:233], v23 offset:32768
    ds_read_b64_tr_b16 a[234:235], v23 offset:36864
    v_mfma_f32_16x16x32_bf16 v[88:91], a[216:219], v[152:155], v[88:91]
    s_mul_i32 s56, s54, 66816
    v_add_u32 v23, 4294868992, v23
    v_mfma_f32_16x16x32_bf16 v[208:211], a[216:219], v[184:187], v[208:211]
    s_add_u32 s74, s74, s56
    s_waitcnt lgkmcnt(6)
    v_mfma_f32_16x16x32_bf16 v[76:79], a[220:223], v[120:123], v[76:79]
    s_add_u32 s74, s74, 41088
    ds_read_b64_tr_b16 a[236:237], v24 offset:32768
    ds_read_b64_tr_b16 a[238:239], v24 offset:36864
    v_mfma_f32_16x16x32_bf16 v[92:95], a[220:223], v[152:155], v[92:95]
    s_waitcnt vmcnt(2)
    v_cmp_ne_u32 vcc, 1, v30
    v_add_u32 v24, 4294868992, v24
    v_mfma_f32_16x16x32_bf16 v[212:215], a[220:223], v[184:187], v[212:215]
    s_mul_i32 s73, s48, 5120
    s_waitcnt lgkmcnt(6)
    v_mfma_f32_16x16x32_bf16 v[216:219], a[224:227], v[120:123], v[216:219]
    s_and_b32 s59, vcc_lo, 4
    s_cbranch_scc1 standalone__gqa_block_cached__near_ridge_a_aq1
standalone__gqa_block_cached__near_ridge_a_aq1_r:
    ds_read_b64_tr_b16 a[240:241], v25 offset:24576
    v_mfma_f32_16x16x32_bf16 v[220:223], a[224:227], v[152:155], v[220:223]
    s_add_u32 s73, s73, s74
    ds_read_b64_tr_b16 a[242:243], v25 offset:25600
    v_mfma_f32_16x16x32_bf16 v[224:227], a[224:227], v[184:187], v[224:227]
    s_xor_b32 s71, s48, 1
    buffer_load_dwordx4 a[0:3], v3, s[40:43], s66 offen offset:0 sc1
    s_waitcnt lgkmcnt(6)
    v_mfma_f32_16x16x32_bf16 v[228:231], a[228:231], v[120:123], v[228:231]
    s_mul_i32 s71, s71, 5120
    ds_read_b64_tr_b16 a[244:245], v26 offset:24576
    ds_read_b64_tr_b16 a[246:247], v26 offset:25600
    v_mfma_f32_16x16x32_bf16 v[232:235], a[228:231], v[152:155], v[232:235]
    s_add_u32 s71, s71, s74
    v_mfma_f32_16x16x32_bf16 v[236:239], a[228:231], v[184:187], v[236:239]
    s_lshl_b32 s56, s50, 1
    s_waitcnt lgkmcnt(6)
    v_mfma_f32_16x16x32_bf16 v[240:243], a[232:235], v[120:123], v[240:243]
    s_add_u32 s56, s56, s49
    buffer_load_dwordx4 a[16:19], v11, s[40:43], s66 offen offset:0 sc1
    v_mfma_f32_16x16x32_bf16 v[244:247], a[232:235], v[152:155], v[244:247]
    s_lshl_b32 s56, s56, 10
    ds_read_b64_tr_b16 a[248:249], v31 offset:32768
    ds_read_b64_tr_b16 a[250:251], v31 offset:36864
    v_mfma_f32_16x16x32_bf16 v[192:195], a[232:235], v[184:187], v[192:195]
    s_add_u32 s69, s73, s56
    ds_read_b64_tr_b16 a[252:253], v32 offset:32768
    ds_read_b64_tr_b16 a[254:255], v32 offset:36864
    s_waitcnt lgkmcnt(8)
    v_mfma_f32_16x16x32_bf16 v[196:199], a[236:239], v[120:123], v[196:199]
standalone__gqa_block_cached__near_ridge_a_h1_0:
    s_cbranch_execz standalone__gqa_block_cached__near_ridge_a_h1_r
    s_add_u32 s70, s71, s56
    v_add_u32 v31, 4294868992, v31
    v_add_u32 v32, 4294868992, v32
    v_mfma_f32_16x16x32_bf16 v[200:203], a[236:239], v[152:155], v[200:203]
    s_add_u32 s12, s74, s56
    buffer_load_dwordx4 a[32:35], v12, s[40:43], s66 offen offset:0 sc1
    v_mfma_f32_16x16x32_bf16 v[204:207], a[236:239], v[184:187], v[204:207]
    s_add_u32 s12, s12, 20480
    ds_read_b64_tr_b16 a[128:129], v33 offset:32768
    ds_read_b64_tr_b16 a[130:131], v33 offset:36864
    s_waitcnt lgkmcnt(8)
    v_mfma_f32_16x16x32_bf16 v[104:107], a[240:243], v[120:123], v[104:107]
    s_xor_b32 s56, s56, 1024
    ds_read_b64_tr_b16 a[132:133], v34 offset:32768
    ds_read_b64_tr_b16 a[134:135], v34 offset:36864
    v_mfma_f32_16x16x32_bf16 v[116:119], a[240:243], v[152:155], v[116:119]
    s_add_u32 s72, s71, s56
    v_add_u32 v33, 4294868992, v33
    v_add_u32 v34, 4294868992, v34
    v_mfma_f32_16x16x32_bf16 v[124:127], a[240:243], v[184:187], v[124:127]
    s_add_u32 s71, s73, s56
    buffer_load_dwordx4 a[8:11], v3, s[40:43], s66 offen offset:2048 sc1
    s_waitcnt lgkmcnt(8)
    v_mfma_f32_16x16x32_bf16 v[108:111], a[244:247], v[120:123], v[108:111]
    s_add_u32 s73, s73, 4096
    ds_read_b64_tr_b16 a[136:137], v35 offset:32768
    ds_read_b64_tr_b16 a[138:139], v35 offset:36864
    v_mfma_f32_16x16x32_bf16 v[132:135], a[244:247], v[152:155], v[132:135]
    s_add_u32 s13, s74, 24576
    ds_read_b64_tr_b16 a[140:141], v36 offset:32768
    ds_read_b64_tr_b16 a[142:143], v36 offset:36864
    v_mfma_f32_16x16x32_bf16 v[140:143], a[244:247], v[184:187], v[140:143]
    s_xor_b32 s56, s48, 3
    v_add_u32 v35, 4294868992, v35
    v_add_u32 v36, 4294868992, v36
    s_waitcnt lgkmcnt(10)
    v_mfma_f32_16x16x32_bf16 v[64:67], a[248:251], v[136:139], v[64:67]
    s_min_u32 s56, s56, 1
    buffer_load_dwordx4 a[24:27], v11, s[40:43], s66 offen offset:2048 sc1
    v_mfma_f32_16x16x32_bf16 v[80:83], a[248:251], v[168:171], v[80:83]
    s_lshl_b32 s56, s56, 30
    ds_read_b64_tr_b16 a[144:145], v37 offset:32768
    ds_read_b64_tr_b16 a[146:147], v37 offset:36864
    s_waitcnt lgkmcnt(10)
    v_mfma_f32_16x16x32_bf16 v[68:71], a[252:255], v[136:139], v[68:71]
    s_or_b32 s13, s13, s56
    ds_read_b64_tr_b16 a[148:149], v38 offset:32768
    ds_read_b64_tr_b16 a[150:151], v38 offset:36864
    v_mfma_f32_16x16x32_bf16 v[84:87], a[252:255], v[168:171], v[84:87]
    s_add_u32 s58, s10, 0
    v_add_u32 v37, 4294868992, v37
    v_add_u32 v38, 4294868992, v38
    s_waitcnt lgkmcnt(10)
    v_mfma_f32_16x16x32_bf16 v[72:75], a[128:131], v[136:139], v[72:75]
    s_add_u32 m0, s19, 98304
    ds_read_b64_tr_b16 a[152:153], v27 offset:24576
    ds_read_b64_tr_b16 a[154:155], v27 offset:25600
    v_mfma_f32_16x16x32_bf16 v[88:91], a[128:131], v[168:171], v[88:91]
    s_waitcnt lgkmcnt(10)
    buffer_load_dwordx4 v4, s[36:39], s58 offen offset:0 lds
    v_mfma_f32_16x16x32_bf16 v[76:79], a[132:135], v[136:139], v[76:79]
    ds_read_b64_tr_b16 a[156:157], v28 offset:24576
    ds_read_b64_tr_b16 a[158:159], v28 offset:25600
    v_mfma_f32_16x16x32_bf16 v[92:95], a[132:135], v[168:171], v[92:95]
    s_waitcnt lgkmcnt(10)
    v_lshrrev_b32 v48, 4, v2
    v_mfma_f32_16x16x32_bf16 v[216:219], a[136:139], v[136:139], v[216:219]
    buffer_load_dwordx4 v5, s[36:39], s58 offen offset:1024 lds
    v_mfma_f32_16x16x32_bf16 v[220:223], a[136:139], v[168:171], v[220:223]
    s_waitcnt lgkmcnt(8)
    ds_read_b64_tr_b16 a[160:161], v17 offset:32768
    ds_read_b64_tr_b16 a[162:163], v17 offset:36864
    v_mfma_f32_16x16x32_bf16 v[228:231], a[140:143], v[136:139], v[228:231]
    v_bfe_u32 v49, v2, 2, 2
    v_mfma_f32_16x16x32_bf16 v[232:235], a[140:143], v[168:171], v[232:235]
    s_waitcnt lgkmcnt(8)
    buffer_load_dwordx4 v6, s[36:39], s58 offen offset:2048 lds
    v_mfma_f32_16x16x32_bf16 v[240:243], a[144:147], v[136:139], v[240:243]
    ds_read_b64_tr_b16 a[164:165], v18 offset:32768
    ds_read_b64_tr_b16 a[166:167], v18 offset:36864
    v_mfma_f32_16x16x32_bf16 v[244:247], a[144:147], v[168:171], v[244:247]
    s_waitcnt lgkmcnt(8)
    v_xor_b32 v48, v48, v49
    v_mfma_f32_16x16x32_bf16 v[196:199], a[148:151], v[136:139], v[196:199]
    s_waitcnt lgkmcnt(4)
    ds_read_b64_tr_b16 a[168:169], v19 offset:32768
    ds_read_b64_tr_b16 a[170:171], v19 offset:36864
    v_mfma_f32_16x16x32_bf16 v[200:203], a[148:151], v[168:171], v[200:203]
    s_waitcnt lgkmcnt(8)
    buffer_load_dwordx4 v7, s[36:39], s58 offen offset:3072 lds
    v_mfma_f32_16x16x32_bf16 v[104:107], a[152:155], v[136:139], v[104:107]
    s_add_u32 s58, s10, 18432
    v_min_u32 v48, 1, v48
    v_mfma_f32_16x16x32_bf16 v[116:119], a[152:155], v[168:171], v[116:119]
    s_waitcnt vmcnt(6)
    ds_read_b64_tr_b16 a[172:173], v20 offset:32768
    ds_read_b64_tr_b16 a[174:175], v20 offset:36864
    v_mfma_f32_16x16x32_bf16 v[108:111], a[156:159], v[136:139], v[108:111]
    s_add_u32 m0, s19, 102400
    s_waitcnt lgkmcnt(6)
    v_sub_u32 v48, 1, v48
    v_mfma_f32_16x16x32_bf16 v[132:135], a[156:159], v[168:171], v[132:135]
    s_barrier
    buffer_load_dwordx4 v4, s[36:39], s58 offen offset:0 lds
    v_mfma_f32_16x16x32_bf16 v[64:67], a[160:163], a[0:3], v[64:67]
    ds_read_b64_tr_b16 a[176:177], v21 offset:32768
    ds_read_b64_tr_b16 a[178:179], v21 offset:36864
    v_mfma_f32_16x16x32_bf16 v[80:83], a[160:163], a[16:19], v[80:83]
    v_mul_u32_u24 v48, 0x3f80, v48
    v_mfma_f32_16x16x32_bf16 v[96:99], a[160:163], a[32:35], v[96:99]
    s_waitcnt lgkmcnt(6)
    buffer_load_dwordx4 v5, s[36:39], s58 offen offset:1024 lds
    v_mfma_f32_16x16x32_bf16 v[68:71], a[164:167], a[0:3], v[68:71]
    ds_read_b64_tr_b16 a[180:181], v22 offset:32768
    ds_read_b64_tr_b16 a[182:183], v22 offset:36864
    v_mfma_f32_16x16x32_bf16 v[84:87], a[164:167], a[16:19], v[84:87]
    v_and_b32 v49, 1, v2
    v_mfma_f32_16x16x32_bf16 v[100:103], a[164:167], a[32:35], v[100:103]
    s_waitcnt lgkmcnt(6)
    buffer_load_dwordx4 v6, s[36:39], s58 offen offset:2048 lds
    v_mfma_f32_16x16x32_bf16 v[72:75], a[168:171], a[0:3], v[72:75]
    ds_read_b64_tr_b16 a[184:185], v23 offset:32768
    ds_read_b64_tr_b16 a[186:187], v23 offset:36864
    v_mfma_f32_16x16x32_bf16 v[88:91], a[168:171], a[16:19], v[88:91]
    v_lshlrev_b32 v49, 4, v49
    v_mfma_f32_16x16x32_bf16 v[208:211], a[168:171], a[32:35], v[208:211]
    s_waitcnt lgkmcnt(6)
    buffer_load_dwordx4 v7, s[36:39], s58 offen offset:3072 lds
    v_mfma_f32_16x16x32_bf16 v[76:79], a[172:175], a[0:3], v[76:79]
    s_waitcnt lgkmcnt(4)
    ds_read_b64_tr_b16 a[188:189], v24 offset:32768
    ds_read_b64_tr_b16 a[190:191], v24 offset:36864
    v_mfma_f32_16x16x32_bf16 v[92:95], a[172:175], a[16:19], v[92:95]
    s_add_u32 s58, s10, 0
    s_add_u32 s58, s58, s16
    v_lshlrev_b32 v48, v49, v48
    v_mfma_f32_16x16x32_bf16 v[212:215], a[172:175], a[32:35], v[212:215]
    s_lshl_b32 m0, s48, 11
    s_add_u32 m0, m0, 81920
    v_bfe_u32 v49, v2, 1, 1
    v_mfma_f32_16x16x32_bf16 v[216:219], a[176:179], a[0:3], v[216:219]
    buffer_load_dwordx4 v8, s[36:39], s58 offen offset:0 lds
    v_mfma_f32_16x16x32_bf16 v[220:223], a[176:179], a[16:19], v[220:223]
    ds_read_b64_tr_b16 a[192:193], v25 offset:0
    ds_read_b64_tr_b16 a[194:195], v25 offset:1024
    v_mfma_f32_16x16x32_bf16 v[224:227], a[176:179], a[32:35], v[224:227]
    s_waitcnt lgkmcnt(6)
    v_sub_u32 v49, 0, v49
    v_mfma_f32_16x16x32_bf16 v[228:231], a[180:183], a[0:3], v[228:231]
    buffer_load_dwordx4 v9, s[36:39], s58 offen offset:1024 lds
    v_mfma_f32_16x16x32_bf16 v[232:235], a[180:183], a[16:19], v[232:235]
    ds_read_b64_tr_b16 a[196:197], v26 offset:0
    ds_read_b64_tr_b16 a[198:199], v26 offset:1024
    v_mfma_f32_16x16x32_bf16 v[236:239], a[180:183], a[32:35], v[236:239]
    s_waitcnt lgkmcnt(6)
    v_and_b32 v51, v48, v49
    v_mfma_f32_16x16x32_bf16 v[240:243], a[184:187], a[0:3], v[240:243]
    ds_read_b64_tr_b16 a[200:201], v31 offset:32768
    ds_read_b64_tr_b16 a[202:203], v31 offset:36864
    v_mfma_f32_16x16x32_bf16 v[244:247], a[184:187], a[16:19], v[244:247]
    buffer_load_dwordx4 a[4:7], v3, s[40:43], s66 offen offset:1024 sc1
    v_mfma_f32_16x16x32_bf16 v[192:195], a[184:187], a[32:35], v[192:195]
    s_waitcnt lgkmcnt(6)
    ds_read_b64_tr_b16 a[204:205], v32 offset:32768
    ds_read_b64_tr_b16 a[206:207], v32 offset:36864
    v_mfma_f32_16x16x32_bf16 v[196:199], a[188:191], a[0:3], v[196:199]
    v_xor_b32 v50, v48, v51
    v_mfma_f32_16x16x32_bf16 v[200:203], a[188:191], a[16:19], v[200:203]
    buffer_load_dwordx4 a[20:23], v11, s[40:43], s66 offen offset:1024 sc1
    v_mfma_f32_16x16x32_bf16 v[204:207], a[188:191], a[32:35], v[204:207]
    s_waitcnt lgkmcnt(6)
    ds_read_b64_tr_b16 a[208:209], v33 offset:32768
    ds_read_b64_tr_b16 a[210:211], v33 offset:36864
    v_mfma_f32_16x16x32_bf16 v[104:107], a[192:195], a[0:3], v[104:107]
    ds_read_b64_tr_b16 a[212:213], v34 offset:32768
    ds_read_b64_tr_b16 a[214:215], v34 offset:36864
    v_mfma_f32_16x16x32_bf16 v[116:119], a[192:195], a[16:19], v[116:119]
    buffer_load_dwordx4 a[36:39], v12, s[40:43], s66 offen offset:1024 sc1
    v_mfma_f32_16x16x32_bf16 v[124:127], a[192:195], a[32:35], v[124:127]
    s_waitcnt lgkmcnt(8)
    ds_read_b64_tr_b16 a[216:217], v35 offset:32768
    ds_read_b64_tr_b16 a[218:219], v35 offset:36864
    v_mfma_f32_16x16x32_bf16 v[108:111], a[196:199], a[0:3], v[108:111]
    s_waitcnt vmcnt(13)
    v_mov_b32 v48, 0
    v_mfma_f32_16x16x32_bf16 v[132:135], a[196:199], a[16:19], v[132:135]
    ds_read_b64_tr_b16 a[220:221], v36 offset:32768
    ds_read_b64_tr_b16 a[222:223], v36 offset:36864
    v_mfma_f32_16x16x32_bf16 v[140:143], a[196:199], a[32:35], v[140:143]
    s_waitcnt lgkmcnt(10)
    buffer_load_dwordx4 a[12:15], v3, s[40:43], s66 offen offset:3072 sc1
    v_mfma_f32_16x16x32_bf16 v[64:67], a[200:203], a[8:11], v[64:67]
    ds_read_b64_tr_b16 a[224:225], v37 offset:32768
    ds_read_b64_tr_b16 a[226:227], v37 offset:36864
    v_mfma_f32_16x16x32_bf16 v[80:83], a[200:203], a[24:27], v[80:83]
    s_waitcnt lgkmcnt(10)
    v_mov_b32 v49, 0
    v_mfma_f32_16x16x32_bf16 v[68:71], a[204:207], a[8:11], v[68:71]
    s_waitcnt lgkmcnt(6)
    buffer_load_dwordx4 a[28:31], v11, s[40:43], s66 offen offset:3072 sc1
    v_mfma_f32_16x16x32_bf16 v[84:87], a[204:207], a[24:27], v[84:87]
    s_waitcnt lgkmcnt(8)
    ds_read_b64_tr_b16 a[228:229], v38 offset:32768
    ds_read_b64_tr_b16 a[230:231], v38 offset:36864
    v_mfma_f32_16x16x32_bf16 v[72:75], a[208:211], a[8:11], v[72:75]
    s_add_u32 s58, s10, 36864
    ds_read_b64_tr_b16 a[232:233], v27 offset:0
    ds_read_b64_tr_b16 a[234:235], v27 offset:1024
    v_mfma_f32_16x16x32_bf16 v[88:91], a[208:211], a[24:27], v[88:91]
    s_add_u32 m0, s19, 131072
    v_mov_b32 v52, 0
    v_mfma_f32_16x16x32_bf16 v[76:79], a[212:215], a[8:11], v[76:79]
    buffer_load_dwordx4 v4, s[36:39], s58 offen offset:0 lds
    v_mfma_f32_16x16x32_bf16 v[92:95], a[212:215], a[24:27], v[92:95]
    s_waitcnt lgkmcnt(8)
    ds_read_b64_tr_b16 a[236:237], v28 offset:0
    ds_read_b64_tr_b16 a[238:239], v28 offset:1024
    v_mfma_f32_16x16x32_bf16 v[216:219], a[216:219], a[8:11], v[216:219]
    ds_read_b64_tr_b16 a[240:241], v17 offset:0
    ds_read_b64_tr_b16 a[242:243], v17 offset:4096
    v_mfma_f32_16x16x32_bf16 v[220:223], a[216:219], a[24:27], v[220:223]
    s_waitcnt lgkmcnt(10)
    buffer_load_dwordx4 v5, s[36:39], s58 offen offset:1024 lds
    v_mfma_f32_16x16x32_bf16 v[228:231], a[220:223], a[8:11], v[228:231]
    s_waitcnt lgkmcnt(8)
    v_add_u32 v17, 98304, v17
    v_mov_b32 v53, 0
    v_mfma_f32_16x16x32_bf16 v[232:235], a[220:223], a[24:27], v[232:235]
    s_mul_i32 s63, s53, 1310720
    ds_read_b64_tr_b16 a[244:245], v18 offset:0
    ds_read_b64_tr_b16 a[246:247], v18 offset:4096
    v_mfma_f32_16x16x32_bf16 v[240:243], a[224:227], a[8:11], v[240:243]
    s_lshl_b32 s56, s51, 11
    buffer_load_dwordx4 v6, s[36:39], s58 offen offset:2048 lds
    v_mfma_f32_16x16x32_bf16 v[244:247], a[224:227], a[24:27], v[244:247]
    s_add_u32 s62, s63, s56
    v_add_u32 v18, 98304, v18
    s_waitcnt lgkmcnt(8)
    v_mfma_f32_16x16x32_bf16 v[196:199], a[228:231], a[8:11], v[196:199]
    s_add_u32 s62, s62, 1101824
    ds_read_b64_tr_b16 a[248:249], v19 offset:0
    ds_read_b64_tr_b16 a[250:251], v19 offset:4096
    v_mfma_f32_16x16x32_bf16 v[200:203], a[228:231], a[24:27], v[200:203]
    s_waitcnt lgkmcnt(8)
    v_add_u32 v19, 98304, v19
    v_and_b32 v43, 3, v2
    v_mfma_f32_16x16x32_bf16 v[104:107], a[232:235], a[8:11], v[104:107]
    s_waitcnt lgkmcnt(6)
    buffer_load_dwordx4 v7, s[36:39], s58 offen offset:3072 lds
    v_mfma_f32_16x16x32_bf16 v[116:119], a[232:235], a[24:27], v[116:119]
    s_waitcnt vmcnt(6)
    ds_read_b64_tr_b16 a[252:253], v20 offset:0
    ds_read_b64_tr_b16 a[254:255], v20 offset:4096
    v_mfma_f32_16x16x32_bf16 v[108:111], a[236:239], a[8:11], v[108:111]
    s_waitcnt lgkmcnt(6)
    v_add_u32 v20, 98304, v20
    v_xor_b32 v43, s52, v43
    v_mfma_f32_16x16x32_bf16 v[132:135], a[236:239], a[24:27], v[132:135]
    s_add_u32 s58, s10, 55296
    s_add_u32 m0, s19, 135168
    s_barrier
    v_mfma_f32_16x16x32_bf16 v[64:67], a[240:243], a[4:7], v[64:67]
    buffer_load_dwordx4 v4, s[36:39], s58 offen offset:0 lds
    v_mfma_f32_16x16x32_bf16 v[80:83], a[240:243], a[20:23], v[80:83]
    ds_read_b64_tr_b16 a[128:129], v21 offset:0
    ds_read_b64_tr_b16 a[130:131], v21 offset:4096
    v_mfma_f32_16x16x32_bf16 v[96:99], a[240:243], a[36:39], v[96:99]
    s_waitcnt lgkmcnt(6)
    v_add_u32 v21, 98304, v21
    v_lshlrev_b32 v43, 2, v43
    v_mfma_f32_16x16x32_bf16 v[68:71], a[244:247], a[4:7], v[68:71]
    s_mul_i32 s56, s51, 66816
    buffer_load_dwordx4 v5, s[36:39], s58 offen offset:1024 lds
    v_mfma_f32_16x16x32_bf16 v[84:87], a[244:247], a[20:23], v[84:87]
    s_add_u32 s63, s63, s56
    ds_read_b64_tr_b16 a[132:133], v22 offset:0
    ds_read_b64_tr_b16 a[134:135], v22 offset:4096
    v_mfma_f32_16x16x32_bf16 v[100:103], a[244:247], a[36:39], v[100:103]
    s_add_u32 s63, s63, 41088
    v_add_u32 v22, 98304, v22
    s_waitcnt lgkmcnt(6)
    v_mfma_f32_16x16x32_bf16 v[72:75], a[248:251], a[4:7], v[72:75]
    s_mul_i32 s14, s53, 92160
    buffer_load_dwordx4 v6, s[36:39], s58 offen offset:2048 lds
    v_mfma_f32_16x16x32_bf16 v[88:91], a[248:251], a[20:23], v[88:91]
    s_add_u32 s14, s14, s75
    ds_read_b64_tr_b16 a[136:137], v23 offset:0
    ds_read_b64_tr_b16 a[138:139], v23 offset:4096
    v_mfma_f32_16x16x32_bf16 v[208:211], a[248:251], a[36:39], v[208:211]
    s_lshl_b32 s56, s48, 2
    v_add_u32 v23, 98304, v23
    s_waitcnt lgkmcnt(6)
    v_mfma_f32_16x16x32_bf16 v[76:79], a[252:255], a[4:7], v[76:79]
    s_add_u32 s56, s56, s52
    buffer_load_dwordx4 v7, s[36:39], s58 offen offset:3072 lds
    v_mfma_f32_16x16x32_bf16 v[92:95], a[252:255], a[20:23], v[92:95]
    s_mul_i32 s64, s56, 52
    ds_read_b64_tr_b16 a[140:141], v24 offset:0
    ds_read_b64_tr_b16 a[142:143], v24 offset:4096
    v_mfma_f32_16x16x32_bf16 v[212:215], a[252:255], a[36:39], v[212:215]
    s_add_u32 s58, s10, 36864
    s_add_u32 s58, s58, s16
    v_add_u32 v24, 98304, v24
    s_waitcnt lgkmcnt(6)
    v_mfma_f32_16x16x32_bf16 v[216:219], a[128:131], a[4:7], v[216:219]
    s_lshl_b32 m0, s48, 11
    s_add_u32 m0, m0, 90112
    ds_read_b64_tr_b16 a[144:145], v25 offset:8192
    ds_read_b64_tr_b16 a[146:147], v25 offset:9216
    v_mfma_f32_16x16x32_bf16 v[220:223], a[128:131], a[20:23], v[220:223]
    s_lshr_b32 s64, s64, 8
    buffer_load_dwordx4 v8, s[36:39], s58 offen offset:0 lds
    v_mfma_f32_16x16x32_bf16 v[224:227], a[128:131], a[36:39], v[224:227]
    s_mul_i32 s20, s64, 5
    s_waitcnt lgkmcnt(6)
    v_mfma_f32_16x16x32_bf16 v[228:231], a[132:135], a[4:7], v[228:231]
    s_sub_u32 s22, s56, s20
    ds_read_b64_tr_b16 a[148:149], v26 offset:8192
    ds_read_b64_tr_b16 a[150:151], v26 offset:9216
    v_mfma_f32_16x16x32_bf16 v[232:235], a[132:135], a[20:23], v[232:235]
    s_add_u32 s20, s20, s56
    buffer_load_dwordx4 v9, s[36:39], s58 offen offset:1024 lds
    v_mfma_f32_16x16x32_bf16 v[236:239], a[132:135], a[36:39], v[236:239]
    s_lshl_b32 s20, s20, 10
    s_waitcnt lgkmcnt(6)
    v_mfma_f32_16x16x32_bf16 v[240:243], a[136:139], a[4:7], v[240:243]
    s_add_u32 s58, s11, 0
    ds_read_b64_tr_b16 a[152:153], v31 offset:0
    ds_read_b64_tr_b16 a[154:155], v31 offset:4096
    v_mfma_f32_16x16x32_bf16 v[244:247], a[136:139], a[20:23], v[244:247]
    s_add_u32 m0, s19, 32768
    v_add_u32 v31, 98304, v31
    v_mfma_f32_16x16x32_bf16 v[192:195], a[136:139], a[36:39], v[192:195]
    s_mul_i32 s22, s22, 18432
    buffer_load_dwordx4 v4, s[36:39], s58 offen offset:0 lds
    s_waitcnt lgkmcnt(6)
    v_mfma_f32_16x16x32_bf16 v[196:199], a[140:143], a[4:7], v[196:199]
    s_lshl_b32 s56, s64, 7
    ds_read_b64_tr_b16 a[156:157], v32 offset:0
    ds_read_b64_tr_b16 a[158:159], v32 offset:4096
    v_mfma_f32_16x16x32_bf16 v[200:203], a[140:143], a[20:23], v[200:203]
    s_add_u32 s22, s22, s56
    buffer_load_dwordx4 v5, s[36:39], s58 offen offset:1024 lds
    v_mfma_f32_16x16x32_bf16 v[204:207], a[140:143], a[36:39], v[204:207]
    s_lshr_b32 s64, s64, 1
    ds_read_b64_tr_b16 a[160:161], v33 offset:0
    ds_read_b64_tr_b16 a[162:163], v33 offset:4096
    s_waitcnt lgkmcnt(8)
    v_mfma_f32_16x16x32_bf16 v[104:107], a[144:147], a[4:7], v[104:107]
    s_lshl_b32 s64, s64, 30
    ds_read_b64_tr_b16 a[164:165], v34 offset:0
    ds_read_b64_tr_b16 a[166:167], v34 offset:4096
    v_mfma_f32_16x16x32_bf16 v[116:119], a[144:147], a[20:23], v[116:119]
    s_or_b32 s20, s20, s64
    buffer_load_dwordx4 v6, s[36:39], s58 offen offset:2048 lds
    v_mfma_f32_16x16x32_bf16 v[124:127], a[144:147], a[36:39], v[124:127]
    s_or_b32 s22, s22, s64
    ds_read_b64_tr_b16 a[168:169], v35 offset:0
    ds_read_b64_tr_b16 a[170:171], v35 offset:4096
    s_waitcnt lgkmcnt(10)
    v_mfma_f32_16x16x32_bf16 v[108:111], a[148:151], a[4:7], v[108:111]
    s_waitcnt vmcnt(13)
    buffer_load_dwordx4 v7, s[36:39], s58 offen offset:3072 lds
    v_mfma_f32_16x16x32_bf16 v[132:135], a[148:151], a[20:23], v[132:135]
    s_add_u32 s58, s11, 18432
    ds_read_b64_tr_b16 a[172:173], v36 offset:0
    ds_read_b64_tr_b16 a[174:175], v36 offset:4096
    v_mfma_f32_16x16x32_bf16 v[140:143], a[148:151], a[36:39], v[140:143]
    s_add_u32 m0, s19, 36864
    v_add_u32 v32, 98304, v32
    v_add_u32 v33, 98304, v33
    s_waitcnt lgkmcnt(10)
    v_mfma_f32_16x16x32_bf16 v[64:67], a[152:155], a[12:15], v[64:67]
    s_add_u32 s21, s20, 5120
    buffer_load_dwordx4 v4, s[36:39], s58 offen offset:0 lds
    v_mfma_f32_16x16x32_bf16 v[80:83], a[152:155], a[28:31], v[80:83]
    s_add_u32 s23, s22, 64
    ds_read_b64_tr_b16 a[176:177], v37 offset:0
    ds_read_b64_tr_b16 a[178:179], v37 offset:4096
    s_waitcnt lgkmcnt(10)
    v_mfma_f32_16x16x32_bf16 v[68:71], a[156:159], a[12:15], v[68:71]
    s_lshl_b32 s56, s52, 10
    ds_read_b64_tr_b16 a[180:181], v38 offset:0
    ds_read_b64_tr_b16 a[182:183], v38 offset:4096
    v_mfma_f32_16x16x32_bf16 v[84:87], a[156:159], a[28:31], v[84:87]
    s_add_u32 s56, s56, 20480
    buffer_load_dwordx4 v5, s[36:39], s58 offen offset:1024 lds
    s_waitcnt lgkmcnt(10)
    v_mfma_f32_16x16x32_bf16 v[72:75], a[160:163], a[12:15], v[72:75]
    s_mul_i32 s64, s52, 18432
    ds_read_b64_tr_b16 a[184:185], v27 offset:8192
    ds_read_b64_tr_b16 a[186:187], v27 offset:9216
    v_mfma_f32_16x16x32_bf16 v[88:91], a[160:163], a[28:31], v[88:91]
    s_add_u32 s64, s64, s16
    buffer_load_dwordx4 v6, s[36:39], s58 offen offset:2048 lds
    s_waitcnt lgkmcnt(10)
    v_mfma_f32_16x16x32_bf16 v[76:79], a[164:167], a[12:15], v[76:79]
    s_cmp_eq_u32 s48, 3
    s_cselect_b32 s20, s56, s20
    s_cselect_b32 s22, s64, s22
    ds_read_b64_tr_b16 a[188:189], v28 offset:8192
    ds_read_b64_tr_b16 a[190:191], v28 offset:9216
    v_mfma_f32_16x16x32_bf16 v[92:95], a[164:167], a[28:31], v[92:95]
    s_add_u32 s64, s16, 73728
    v_add_u32 v34, 98304, v34
    v_add_u32 v35, 98304, v35
    s_waitcnt lgkmcnt(10)
    v_mfma_f32_16x16x32_bf16 v[216:219], a[168:171], a[12:15], v[216:219]
    s_lshl_b32 s56, s52, 2
    buffer_load_dwordx4 v7, s[36:39], s58 offen offset:3072 lds
    v_mfma_f32_16x16x32_bf16 v[220:223], a[168:171], a[28:31], v[220:223]
    s_add_u32 s58, s11, 0
    s_add_u32 s58, s58, s16
    ds_read_b64_tr_b16 a[192:193], v17 offset:0
    ds_read_b64_tr_b16 a[194:195], v17 offset:4096
    s_waitcnt lgkmcnt(10)
    v_mfma_f32_16x16x32_bf16 v[228:231], a[172:175], a[12:15], v[228:231]
    s_lshl_b32 m0, s48, 11
    s_add_u32 m0, m0, 65536
    v_add_u32 v36, 98304, v36
    v_add_u32 v37, 98304, v37
    v_mfma_f32_16x16x32_bf16 v[232:235], a[172:175], a[28:31], v[232:235]
    s_add_u32 s56, s56, s48
    buffer_load_dwordx4 v8, s[36:39], s58 offen offset:0 lds
    s_waitcnt lgkmcnt(8)
    v_mfma_f32_16x16x32_bf16 v[240:243], a[176:179], a[12:15], v[240:243]
    s_cmp_eq_u32 s56, 3
    s_cselect_b32 s21, 24576, s21
    s_cselect_b32 s23, s64, s23
    ds_read_b64_tr_b16 a[196:197], v18 offset:0
    ds_read_b64_tr_b16 a[198:199], v18 offset:4096
    v_mfma_f32_16x16x32_bf16 v[244:247], a[176:179], a[28:31], v[244:247]
    s_waitcnt lgkmcnt(8)
    buffer_load_dwordx4 v9, s[36:39], s58 offen offset:1024 lds
    v_mfma_f32_16x16x32_bf16 v[196:199], a[180:183], a[12:15], v[196:199]
    ds_read_b64_tr_b16 a[200:201], v19 offset:0
    ds_read_b64_tr_b16 a[202:203], v19 offset:4096
    v_mfma_f32_16x16x32_bf16 v[200:203], a[180:183], a[28:31], v[200:203]
    s_waitcnt lgkmcnt(8)
    v_add_u32 v38, 98304, v38
    v_add_u32 v17, 4294868992, v17
    v_mfma_f32_16x16x32_bf16 v[104:107], a[184:187], a[12:15], v[104:107]
    v_add_u32 v18, 4294868992, v18
    v_add_u32 v19, 4294868992, v19
    v_mfma_f32_16x16x32_bf16 v[116:119], a[184:187], a[28:31], v[116:119]
    s_waitcnt lgkmcnt(6)
    ds_read_b64_tr_b16 a[204:205], v20 offset:0
    ds_read_b64_tr_b16 a[206:207], v20 offset:4096
    v_mfma_f32_16x16x32_bf16 v[108:111], a[188:191], a[12:15], v[108:111]
    s_waitcnt lgkmcnt(6)
    v_add_u32 v20, 4294868992, v20
    v_add_u32 v39, 0, v3
    v_mfma_f32_16x16x32_bf16 v[132:135], a[188:191], a[28:31], v[132:135]
    s_barrier
    v_add_u32 v40, 267264, v3
    buffer_load_ushort v30, v10, s[40:43], s15 offen offset:1024 sc1
    s_waitcnt vmcnt(0)
    v_cmp_ne_u32 vcc, 1, v30
    s_nop 0
    s_and_b32 s59, vcc_lo, 32
    s_cbranch_scc1 standalone__gqa_block_cached__near_ridge_a_w2
standalone__gqa_block_cached__near_ridge_a_w2_r:
    s_and_b32 s17, vcc_lo, 128
    s_cselect_b32 s3, 2147418112, s68
    buffer_load_dwordx4 a[40:43], v3, s[40:43], s67 offen offset:0 sc1
    buffer_load_dwordx4 a[56:59], v11, s[40:43], s67 offen offset:0 sc1
    buffer_load_dwordx4 a[72:75], v12, s[40:43], s67 offen offset:0 sc1
    buffer_load_dwordx4 a[48:51], v3, s[40:43], s67 offen offset:2048 sc1
    buffer_load_dwordx4 a[64:67], v11, s[40:43], s67 offen offset:2048 sc1
    s_waitcnt vmcnt(2)
    v_mfma_f32_16x16x32_bf16 v[64:67], a[192:195], a[40:43], v[64:67]
    buffer_load_dwordx4 a[80:83], v3, s[40:43], s3 offen offset:0 sc1
    v_mfma_f32_16x16x32_bf16 v[80:83], a[192:195], a[56:59], v[80:83]
    ds_read_b64_tr_b16 a[208:209], v21 offset:0
    ds_read_b64_tr_b16 a[210:211], v21 offset:4096
    v_mfma_f32_16x16x32_bf16 v[96:99], a[192:195], a[72:75], v[96:99]
    s_waitcnt lgkmcnt(6)
    v_add_u32 v21, 4294868992, v21
    v_add_u32 v41, 534528, v3
    v_mfma_f32_16x16x32_bf16 v[68:71], a[196:199], a[40:43], v[68:71]
    ds_read_b64_tr_b16 a[212:213], v22 offset:0
    ds_read_b64_tr_b16 a[214:215], v22 offset:4096
    v_mfma_f32_16x16x32_bf16 v[84:87], a[196:199], a[56:59], v[84:87]
    buffer_load_dwordx4 a[96:99], v11, s[40:43], s3 offen offset:0 sc1
    v_mfma_f32_16x16x32_bf16 v[100:103], a[196:199], a[72:75], v[100:103]
    s_waitcnt lgkmcnt(6)
    v_add_u32 v22, 4294868992, v22
    v_add_u32 v42, 801792, v3
    v_mfma_f32_16x16x32_bf16 v[72:75], a[200:203], a[40:43], v[72:75]
    s_add_u32 s20, s20, s63
    ds_read_b64_tr_b16 a[216:217], v23 offset:0
    ds_read_b64_tr_b16 a[218:219], v23 offset:4096
    v_mfma_f32_16x16x32_bf16 v[88:91], a[200:203], a[56:59], v[88:91]
    s_add_u32 s22, s22, s14
    v_add_u32 v23, 4294868992, v23
    v_mfma_f32_16x16x32_bf16 v[208:211], a[200:203], a[72:75], v[208:211]
    s_add_u32 s21, s21, s63
    buffer_load_dwordx4 a[112:115], v12, s[40:43], s3 offen offset:0 sc1
    s_waitcnt lgkmcnt(6)
    v_mfma_f32_16x16x32_bf16 v[76:79], a[204:207], a[40:43], v[76:79]
    s_add_u32 s23, s23, s14
    ds_read_b64_tr_b16 a[220:221], v24 offset:0
    ds_read_b64_tr_b16 a[222:223], v24 offset:4096
    v_mfma_f32_16x16x32_bf16 v[92:95], a[204:207], a[56:59], v[92:95]
    v_add_u32 v24, 4294868992, v24
    v_mfma_f32_16x16x32_bf16 v[212:215], a[204:207], a[72:75], v[212:215]
    s_waitcnt lgkmcnt(6)
    v_mfma_f32_16x16x32_bf16 v[216:219], a[208:211], a[40:43], v[216:219]
    buffer_load_dwordx4 a[88:91], v3, s[40:43], s3 offen offset:2048 sc1
    v_mfma_f32_16x16x32_bf16 v[220:223], a[208:211], a[56:59], v[220:223]
    ds_read_b64_tr_b16 a[224:225], v25 offset:16384
    ds_read_b64_tr_b16 a[226:227], v25 offset:17408
    v_mfma_f32_16x16x32_bf16 v[224:227], a[208:211], a[72:75], v[224:227]
    s_waitcnt lgkmcnt(6)
    v_mfma_f32_16x16x32_bf16 v[228:231], a[212:215], a[40:43], v[228:231]
    ds_read_b64_tr_b16 a[228:229], v26 offset:16384
    ds_read_b64_tr_b16 a[230:231], v26 offset:17408
    v_mfma_f32_16x16x32_bf16 v[232:235], a[212:215], a[56:59], v[232:235]
    buffer_load_dwordx4 a[104:107], v11, s[40:43], s3 offen offset:2048 sc1
    v_mfma_f32_16x16x32_bf16 v[236:239], a[212:215], a[72:75], v[236:239]
    s_waitcnt lgkmcnt(6)
    v_mfma_f32_16x16x32_bf16 v[240:243], a[216:219], a[40:43], v[240:243]
    ds_read_b64_tr_b16 a[232:233], v31 offset:0
    ds_read_b64_tr_b16 a[234:235], v31 offset:4096
    v_mfma_f32_16x16x32_bf16 v[244:247], a[216:219], a[56:59], v[244:247]
    v_add_u32 v31, 4294868992, v31
    v_mfma_f32_16x16x32_bf16 v[192:195], a[216:219], a[72:75], v[192:195]
    s_waitcnt lgkmcnt(6)
    ds_read_b64_tr_b16 a[236:237], v32 offset:0
    ds_read_b64_tr_b16 a[238:239], v32 offset:4096
    v_mfma_f32_16x16x32_bf16 v[196:199], a[220:223], a[40:43], v[196:199]
    v_add_u32 v32, 4294868992, v32
    v_mfma_f32_16x16x32_bf16 v[200:203], a[220:223], a[56:59], v[200:203]
    ds_read_b64_tr_b16 a[240:241], v33 offset:0
    ds_read_b64_tr_b16 a[242:243], v33 offset:4096
    v_mfma_f32_16x16x32_bf16 v[204:207], a[220:223], a[72:75], v[204:207]
    s_waitcnt lgkmcnt(8)
    v_add_u32 v33, 4294868992, v33
    v_mfma_f32_16x16x32_bf16 v[104:107], a[224:227], a[40:43], v[104:107]
    ds_read_b64_tr_b16 a[244:245], v34 offset:0
    ds_read_b64_tr_b16 a[246:247], v34 offset:4096
    v_mfma_f32_16x16x32_bf16 v[116:119], a[224:227], a[56:59], v[116:119]
    s_waitcnt lgkmcnt(8)
    v_add_u32 v34, 4294868992, v34
    v_mfma_f32_16x16x32_bf16 v[124:127], a[224:227], a[72:75], v[124:127]
    s_cmp_lg_u32 s17, 0
    s_cbranch_scc1 standalone__gqa_block_cached__near_ridge_a_late
standalone__gqa_block_cached__near_ridge_a_late_r:
    ds_read_b64_tr_b16 a[248:249], v35 offset:0
    v_mfma_f32_16x16x32_bf16 v[108:111], a[228:231], a[40:43], v[108:111]
    s_waitcnt vmcnt(5)
    ds_read_b64_tr_b16 a[250:251], v35 offset:4096
    v_mfma_f32_16x16x32_bf16 v[132:135], a[228:231], a[56:59], v[132:135]
    s_waitcnt lgkmcnt(6)
    ds_read_b64_tr_b16 a[252:253], v36 offset:0
    ds_read_b64_tr_b16 a[254:255], v36 offset:4096
    v_mfma_f32_16x16x32_bf16 v[140:143], a[228:231], a[72:75], v[140:143]
    s_waitcnt lgkmcnt(10)
    v_add_u32 v35, 4294868992, v35
    v_add_u32 v36, 4294868992, v36
    v_mfma_f32_16x16x32_bf16 v[64:67], a[232:235], a[48:51], v[64:67]
    s_add_u32 s58, s11, 36864
    ds_read_b64_tr_b16 a[128:129], v37 offset:0
    ds_read_b64_tr_b16 a[130:131], v37 offset:4096
    v_mfma_f32_16x16x32_bf16 v[80:83], a[232:235], a[64:67], v[80:83]
    s_add_u32 m0, s19, 0
    buffer_load_ushort v30, v10, s[40:43], s15 offen offset:1024 sc1
    v_mfma_f32_16x16x32_bf16 v[68:71], a[236:239], a[48:51], v[68:71]
    buffer_load_dwordx4 v4, s[36:39], s58 offen offset:0 lds
    v_mfma_f32_16x16x32_bf16 v[84:87], a[236:239], a[64:67], v[84:87]
    s_waitcnt lgkmcnt(8)
    ds_read_b64_tr_b16 a[132:133], v38 offset:0
    ds_read_b64_tr_b16 a[134:135], v38 offset:4096
    v_mfma_f32_16x16x32_bf16 v[72:75], a[240:243], a[48:51], v[72:75]
    ds_read_b64_tr_b16 a[136:137], v27 offset:16384
    ds_read_b64_tr_b16 a[138:139], v27 offset:17408
    v_mfma_f32_16x16x32_bf16 v[88:91], a[240:243], a[64:67], v[88:91]
    s_waitcnt lgkmcnt(10)
    buffer_load_dwordx4 v5, s[36:39], s58 offen offset:1024 lds
    v_mfma_f32_16x16x32_bf16 v[76:79], a[244:247], a[48:51], v[76:79]
    s_waitcnt lgkmcnt(8)
    ds_read_b64_tr_b16 a[140:141], v28 offset:16384
    ds_read_b64_tr_b16 a[142:143], v28 offset:17408
    v_mfma_f32_16x16x32_bf16 v[92:95], a[244:247], a[64:67], v[92:95]
    s_barrier
    v_add_u32 v37, 4294868992, v37
    v_mfma_f32_16x16x32_bf16 v[216:219], a[248:251], a[48:51], v[216:219]
    buffer_load_dwordx4 v6, s[36:39], s58 offen offset:2048 lds
    v_mfma_f32_16x16x32_bf16 v[220:223], a[248:251], a[64:67], v[220:223]
standalone__gqa_block_cached__near_ridge_a_h1_1:
    s_cbranch_execz standalone__gqa_block_cached__near_ridge_a_h1_r
    s_waitcnt lgkmcnt(8)
    ds_read_b64_tr_b16 a[144:145], v17 offset:32768
    ds_read_b64_tr_b16 a[146:147], v17 offset:36864
    v_mfma_f32_16x16x32_bf16 v[228:231], a[252:255], a[48:51], v[228:231]
    v_add_u32 v38, 4294868992, v38
    v_add_u32 v17, 98304, v17
    v_mfma_f32_16x16x32_bf16 v[232:235], a[252:255], a[64:67], v[232:235]
    s_waitcnt lgkmcnt(8)
    buffer_load_dwordx4 v7, s[36:39], s58 offen offset:3072 lds
    v_mfma_f32_16x16x32_bf16 v[240:243], a[128:131], a[48:51], v[240:243]
    s_waitcnt vmcnt(4)
    ds_read_b64_tr_b16 a[148:149], v18 offset:32768
    v_cmp_ne_u32 vcc, 1, v30
    v_mfma_f32_16x16x32_bf16 v[244:247], a[128:131], a[64:67], v[244:247]
    s_waitcnt lgkmcnt(7)
    ds_read_b64_tr_b16 a[150:151], v18 offset:36864
    v_mfma_f32_16x16x32_bf16 v[196:199], a[132:135], a[48:51], v[196:199]
    s_and_b32 s59, vcc_lo, 10
    s_cbranch_scc1 standalone__gqa_block_cached__near_ridge_a_aq2
standalone__gqa_block_cached__near_ridge_a_aq2_r:
    ds_read_b64_tr_b16 a[152:153], v19 offset:32768
    v_mfma_f32_16x16x32_bf16 v[200:203], a[132:135], a[64:67], v[200:203]
    s_waitcnt lgkmcnt(7)
    ds_read_b64_tr_b16 a[154:155], v19 offset:36864
    v_add_u32 v18, 98304, v18
    v_mfma_f32_16x16x32_bf16 v[104:107], a[136:139], a[48:51], v[104:107]
    buffer_load_dwordx4 a[44:47], v3, s[40:43], s67 offen offset:1024 sc1
    v_mfma_f32_16x16x32_bf16 v[116:119], a[136:139], a[64:67], v[116:119]
    s_waitcnt lgkmcnt(6)
    ds_read_b64_tr_b16 a[156:157], v20 offset:32768
    ds_read_b64_tr_b16 a[158:159], v20 offset:36864
    v_mfma_f32_16x16x32_bf16 v[108:111], a[140:143], a[48:51], v[108:111]
    v_add_u32 v19, 98304, v19
    v_add_u32 v20, 98304, v20
    v_mfma_f32_16x16x32_bf16 v[132:135], a[140:143], a[64:67], v[132:135]
    s_waitcnt lgkmcnt(6)
    v_mfma_f32_16x16x32_bf16 v[64:67], a[144:147], a[80:83], v[64:67]
    buffer_load_dwordx4 a[60:63], v11, s[40:43], s67 offen offset:1024 sc1
    v_mfma_f32_16x16x32_bf16 v[80:83], a[144:147], a[96:99], v[80:83]
    ds_read_b64_tr_b16 a[160:161], v21 offset:32768
    ds_read_b64_tr_b16 a[162:163], v21 offset:36864
    v_mfma_f32_16x16x32_bf16 v[96:99], a[144:147], a[112:115], v[96:99]
    s_waitcnt lgkmcnt(6)
    v_add_u32 v21, 98304, v21
    v_mfma_f32_16x16x32_bf16 v[68:71], a[148:151], a[80:83], v[68:71]
    ds_read_b64_tr_b16 a[164:165], v22 offset:32768
    ds_read_b64_tr_b16 a[166:167], v22 offset:36864
    v_mfma_f32_16x16x32_bf16 v[84:87], a[148:151], a[96:99], v[84:87]
    buffer_load_dwordx4 a[76:79], v12, s[40:43], s67 offen offset:1024 sc1
    v_mfma_f32_16x16x32_bf16 v[100:103], a[148:151], a[112:115], v[100:103]
    s_waitcnt lgkmcnt(6)
    v_add_u32 v22, 98304, v22
    v_mfma_f32_16x16x32_bf16 v[72:75], a[152:155], a[80:83], v[72:75]
    ds_read_b64_tr_b16 a[168:169], v23 offset:32768
    ds_read_b64_tr_b16 a[170:171], v23 offset:36864
    v_mfma_f32_16x16x32_bf16 v[88:91], a[152:155], a[96:99], v[88:91]
    v_add_u32 v23, 98304, v23
    v_mfma_f32_16x16x32_bf16 v[208:211], a[152:155], a[112:115], v[208:211]
    s_waitcnt lgkmcnt(6)
    buffer_load_dwordx4 a[52:55], v3, s[40:43], s67 offen offset:3072 sc1
    v_mfma_f32_16x16x32_bf16 v[76:79], a[156:159], a[80:83], v[76:79]
    ds_read_b64_tr_b16 a[172:173], v24 offset:32768
    ds_read_b64_tr_b16 a[174:175], v24 offset:36864
    v_mfma_f32_16x16x32_bf16 v[92:95], a[156:159], a[96:99], v[92:95]
    v_add_u32 v24, 98304, v24
    v_mfma_f32_16x16x32_bf16 v[212:215], a[156:159], a[112:115], v[212:215]
    s_waitcnt lgkmcnt(6)
    v_mfma_f32_16x16x32_bf16 v[216:219], a[160:163], a[80:83], v[216:219]
    buffer_load_dwordx4 a[68:71], v11, s[40:43], s67 offen offset:3072 sc1
    v_mfma_f32_16x16x32_bf16 v[220:223], a[160:163], a[96:99], v[220:223]
    s_waitcnt lgkmcnt(4)
    ds_read_b64_tr_b16 a[176:177], v25 offset:0
    ds_read_b64_tr_b16 a[178:179], v25 offset:1024
    v_mfma_f32_16x16x32_bf16 v[224:227], a[160:163], a[112:115], v[224:227]
    s_add_u32 s58, s11, 55296
    v_mfma_f32_16x16x32_bf16 v[228:231], a[164:167], a[80:83], v[228:231]
    s_add_u32 m0, s19, 4096
    ds_read_b64_tr_b16 a[180:181], v26 offset:0
    ds_read_b64_tr_b16 a[182:183], v26 offset:1024
    v_mfma_f32_16x16x32_bf16 v[232:235], a[164:167], a[96:99], v[232:235]
    buffer_load_dwordx4 v4, s[36:39], s58 offen offset:0 lds
    v_mfma_f32_16x16x32_bf16 v[236:239], a[164:167], a[112:115], v[236:239]
    s_waitcnt lgkmcnt(6)
    v_mfma_f32_16x16x32_bf16 v[240:243], a[168:171], a[80:83], v[240:243]
    ds_read_b64_tr_b16 a[184:185], v31 offset:32768
    ds_read_b64_tr_b16 a[186:187], v31 offset:36864
    v_mfma_f32_16x16x32_bf16 v[244:247], a[168:171], a[96:99], v[244:247]
    v_add_u32 v31, 98304, v31
    v_mfma_f32_16x16x32_bf16 v[192:195], a[168:171], a[112:115], v[192:195]
    s_waitcnt lgkmcnt(6)
    buffer_load_dwordx4 v5, s[36:39], s58 offen offset:1024 lds
    v_mfma_f32_16x16x32_bf16 v[196:199], a[172:175], a[80:83], v[196:199]
    ds_read_b64_tr_b16 a[188:189], v32 offset:32768
    ds_read_b64_tr_b16 a[190:191], v32 offset:36864
    v_mfma_f32_16x16x32_bf16 v[200:203], a[172:175], a[96:99], v[200:203]
    ds_read_b64_tr_b16 a[192:193], v33 offset:32768
    ds_read_b64_tr_b16 a[194:195], v33 offset:36864
    v_mfma_f32_16x16x32_bf16 v[204:207], a[172:175], a[112:115], v[204:207]
    s_waitcnt lgkmcnt(8)
    v_add_u32 v32, 98304, v32
    v_add_u32 v33, 98304, v33
    v_mfma_f32_16x16x32_bf16 v[104:107], a[176:179], a[80:83], v[104:107]
    buffer_load_dwordx4 v6, s[36:39], s58 offen offset:2048 lds
    v_mfma_f32_16x16x32_bf16 v[116:119], a[176:179], a[96:99], v[116:119]
    ds_read_b64_tr_b16 a[196:197], v34 offset:32768
    ds_read_b64_tr_b16 a[198:199], v34 offset:36864
    v_mfma_f32_16x16x32_bf16 v[124:127], a[176:179], a[112:115], v[124:127]
    s_waitcnt lgkmcnt(8)
    ds_read_b64_tr_b16 a[200:201], v35 offset:32768
    ds_read_b64_tr_b16 a[202:203], v35 offset:36864
    v_mfma_f32_16x16x32_bf16 v[108:111], a[180:183], a[80:83], v[108:111]
    v_add_u32 v34, 98304, v34
    v_add_u32 v35, 98304, v35
    v_mfma_f32_16x16x32_bf16 v[132:135], a[180:183], a[96:99], v[132:135]
    buffer_load_dwordx4 v7, s[36:39], s58 offen offset:3072 lds
    v_mfma_f32_16x16x32_bf16 v[140:143], a[180:183], a[112:115], v[140:143]
    s_waitcnt lgkmcnt(8)
    ds_read_b64_tr_b16 a[204:205], v36 offset:32768
    ds_read_b64_tr_b16 a[206:207], v36 offset:36864
    v_mfma_f32_16x16x32_bf16 v[64:67], a[184:187], a[88:91], v[64:67]
    s_add_u32 s58, s11, 36864
    s_add_u32 s58, s58, s16
    ds_read_b64_tr_b16 a[208:209], v37 offset:32768
    ds_read_b64_tr_b16 a[210:211], v37 offset:36864
    v_mfma_f32_16x16x32_bf16 v[80:83], a[184:187], a[104:107], v[80:83]
    s_lshl_b32 m0, s48, 11
    s_add_u32 m0, m0, 73728
    v_add_u32 v36, 98304, v36
    v_add_u32 v37, 98304, v37
    s_waitcnt lgkmcnt(10)
    v_mfma_f32_16x16x32_bf16 v[68:71], a[188:191], a[88:91], v[68:71]
    buffer_load_dwordx4 v8, s[36:39], s58 offen offset:0 lds
    v_mfma_f32_16x16x32_bf16 v[84:87], a[188:191], a[104:107], v[84:87]
    s_waitcnt lgkmcnt(8)
    ds_read_b64_tr_b16 a[212:213], v38 offset:32768
    ds_read_b64_tr_b16 a[214:215], v38 offset:36864
    v_mfma_f32_16x16x32_bf16 v[72:75], a[192:195], a[88:91], v[72:75]
    ds_read_b64_tr_b16 a[216:217], v27 offset:0
    ds_read_b64_tr_b16 a[218:219], v27 offset:1024
    v_mfma_f32_16x16x32_bf16 v[88:91], a[192:195], a[104:107], v[88:91]
    s_waitcnt lgkmcnt(10)
    v_add_u32 v38, 98304, v38
    v_mfma_f32_16x16x32_bf16 v[76:79], a[196:199], a[88:91], v[76:79]
    buffer_load_dwordx4 v9, s[36:39], s58 offen offset:1024 lds
    v_mfma_f32_16x16x32_bf16 v[92:95], a[196:199], a[104:107], v[92:95]
    s_waitcnt lgkmcnt(8)
    ds_read_b64_tr_b16 a[220:221], v28 offset:0
    ds_read_b64_tr_b16 a[222:223], v28 offset:1024
    v_mfma_f32_16x16x32_bf16 v[216:219], a[200:203], a[88:91], v[216:219]
    ds_read_b64_tr_b16 a[224:225], v17 offset:32768
    ds_read_b64_tr_b16 a[226:227], v17 offset:36864
    v_mfma_f32_16x16x32_bf16 v[220:223], a[200:203], a[104:107], v[220:223]
    s_waitcnt lgkmcnt(10)
    v_add_u32 v17, 4294868992, v17
    v_mfma_f32_16x16x32_bf16 v[228:231], a[204:207], a[88:91], v[228:231]
    buffer_load_dwordx4 a[84:87], v3, s[40:43], s68 offen offset:1024 sc1
    v_mfma_f32_16x16x32_bf16 v[232:235], a[204:207], a[104:107], v[232:235]
    s_waitcnt lgkmcnt(8)
    ds_read_b64_tr_b16 a[228:229], v18 offset:32768
    ds_read_b64_tr_b16 a[230:231], v18 offset:36864
    v_mfma_f32_16x16x32_bf16 v[240:243], a[208:211], a[88:91], v[240:243]
    v_add_u32 v18, 4294868992, v18
    v_mfma_f32_16x16x32_bf16 v[244:247], a[208:211], a[104:107], v[244:247]
    s_waitcnt lgkmcnt(8)
    v_mfma_f32_16x16x32_bf16 v[196:199], a[212:215], a[88:91], v[196:199]
    buffer_load_dwordx4 a[100:103], v11, s[40:43], s68 offen offset:1024 sc1
    v_mfma_f32_16x16x32_bf16 v[200:203], a[212:215], a[104:107], v[200:203]
    s_waitcnt lgkmcnt(6)
    ds_read_b64_tr_b16 a[232:233], v19 offset:32768
    ds_read_b64_tr_b16 a[234:235], v19 offset:36864
    v_mfma_f32_16x16x32_bf16 v[104:107], a[216:219], a[88:91], v[104:107]
    s_waitcnt lgkmcnt(6)
    v_add_u32 v19, 4294868992, v19
    v_mfma_f32_16x16x32_bf16 v[116:119], a[216:219], a[104:107], v[116:119]
    s_waitcnt vmcnt(8)
    ds_read_b64_tr_b16 a[236:237], v20 offset:32768
    ds_read_b64_tr_b16 a[238:239], v20 offset:36864
    v_mfma_f32_16x16x32_bf16 v[108:111], a[220:223], a[88:91], v[108:111]
    buffer_load_dwordx4 a[116:119], v12, s[40:43], s68 offen offset:1024 sc1
    v_mfma_f32_16x16x32_bf16 v[132:135], a[220:223], a[104:107], v[132:135]
    s_waitcnt lgkmcnt(6)
    v_add_u32 v20, 4294868992, v20
    v_mfma_f32_16x16x32_bf16 v[64:67], a[224:227], a[44:47], v[64:67]
    ds_read_b64_tr_b16 a[240:241], v21 offset:32768
    ds_read_b64_tr_b16 a[242:243], v21 offset:36864
    v_mfma_f32_16x16x32_bf16 v[80:83], a[224:227], a[60:63], v[80:83]
    v_add_u32 v21, 4294868992, v21
    v_mfma_f32_16x16x32_bf16 v[96:99], a[224:227], a[76:79], v[96:99]
    s_waitcnt lgkmcnt(6)
    buffer_load_dwordx4 a[92:95], v3, s[40:43], s68 offen offset:3072 sc1
    v_mfma_f32_16x16x32_bf16 v[68:71], a[228:231], a[44:47], v[68:71]
    ds_read_b64_tr_b16 a[244:245], v22 offset:32768
    ds_read_b64_tr_b16 a[246:247], v22 offset:36864
    v_mfma_f32_16x16x32_bf16 v[84:87], a[228:231], a[60:63], v[84:87]
    v_add_u32 v22, 4294868992, v22
    v_mfma_f32_16x16x32_bf16 v[100:103], a[228:231], a[76:79], v[100:103]
    s_waitcnt lgkmcnt(6)
    v_mfma_f32_16x16x32_bf16 v[72:75], a[232:235], a[44:47], v[72:75]
    buffer_load_dwordx4 a[108:111], v11, s[40:43], s68 offen offset:3072 sc1
    v_mfma_f32_16x16x32_bf16 v[88:91], a[232:235], a[60:63], v[88:91]
    ds_read_b64_tr_b16 a[248:249], v23 offset:32768
    ds_read_b64_tr_b16 a[250:251], v23 offset:36864
    v_mfma_f32_16x16x32_bf16 v[208:211], a[232:235], a[76:79], v[208:211]
    s_waitcnt lgkmcnt(6)
    v_add_u32 v23, 4294868992, v23
    v_mfma_f32_16x16x32_bf16 v[76:79], a[236:239], a[44:47], v[76:79]
    ds_read_b64_tr_b16 a[252:253], v24 offset:32768
    ds_read_b64_tr_b16 a[254:255], v24 offset:36864
    v_mfma_f32_16x16x32_bf16 v[92:95], a[236:239], a[60:63], v[92:95]
    v_add_u32 v24, 4294868992, v24
    v_mfma_f32_16x16x32_bf16 v[212:215], a[236:239], a[76:79], v[212:215]
    s_waitcnt lgkmcnt(6)
    v_mfma_f32_16x16x32_bf16 v[216:219], a[240:243], a[44:47], v[216:219]
    ds_read_b64_tr_b16 a[128:129], v25 offset:24576
    ds_read_b64_tr_b16 a[130:131], v25 offset:25600
    v_mfma_f32_16x16x32_bf16 v[220:223], a[240:243], a[60:63], v[220:223]
    v_mfma_f32_16x16x32_bf16 v[224:227], a[240:243], a[76:79], v[224:227]
    s_waitcnt lgkmcnt(6)
    v_mfma_f32_16x16x32_bf16 v[228:231], a[244:247], a[44:47], v[228:231]
    ds_read_b64_tr_b16 a[132:133], v26 offset:24576
    ds_read_b64_tr_b16 a[134:135], v26 offset:25600
    v_mfma_f32_16x16x32_bf16 v[232:235], a[244:247], a[60:63], v[232:235]
    v_mfma_f32_16x16x32_bf16 v[236:239], a[244:247], a[76:79], v[236:239]
    s_waitcnt lgkmcnt(6)
    v_mfma_f32_16x16x32_bf16 v[240:243], a[248:251], a[44:47], v[240:243]
    ds_read_b64_tr_b16 a[136:137], v31 offset:32768
    ds_read_b64_tr_b16 a[138:139], v31 offset:36864
    v_mfma_f32_16x16x32_bf16 v[244:247], a[248:251], a[60:63], v[244:247]
    v_add_u32 v31, 4294868992, v31
    v_mfma_f32_16x16x32_bf16 v[192:195], a[248:251], a[76:79], v[192:195]
    s_waitcnt lgkmcnt(6)
    ds_read_b64_tr_b16 a[140:141], v32 offset:32768
    ds_read_b64_tr_b16 a[142:143], v32 offset:36864
    v_mfma_f32_16x16x32_bf16 v[196:199], a[252:255], a[44:47], v[196:199]
    v_add_u32 v32, 4294868992, v32
    v_mfma_f32_16x16x32_bf16 v[200:203], a[252:255], a[60:63], v[200:203]
    ds_read_b64_tr_b16 a[144:145], v33 offset:32768
    ds_read_b64_tr_b16 a[146:147], v33 offset:36864
    v_mfma_f32_16x16x32_bf16 v[204:207], a[252:255], a[76:79], v[204:207]
    s_waitcnt lgkmcnt(8)
    v_add_u32 v33, 4294868992, v33
    v_mfma_f32_16x16x32_bf16 v[104:107], a[128:131], a[44:47], v[104:107]
    ds_read_b64_tr_b16 a[148:149], v34 offset:32768
    ds_read_b64_tr_b16 a[150:151], v34 offset:36864
    v_mfma_f32_16x16x32_bf16 v[116:119], a[128:131], a[60:63], v[116:119]
    v_add_u32 v34, 4294868992, v34
    v_mfma_f32_16x16x32_bf16 v[124:127], a[128:131], a[76:79], v[124:127]
    s_waitcnt lgkmcnt(8)
    ds_read_b64_tr_b16 a[152:153], v35 offset:32768
    ds_read_b64_tr_b16 a[154:155], v35 offset:36864
    v_mfma_f32_16x16x32_bf16 v[108:111], a[132:135], a[44:47], v[108:111]
    v_add_u32 v35, 4294868992, v35
    v_mfma_f32_16x16x32_bf16 v[132:135], a[132:135], a[60:63], v[132:135]
    ds_read_b64_tr_b16 a[156:157], v36 offset:32768
    ds_read_b64_tr_b16 a[158:159], v36 offset:36864
    v_mfma_f32_16x16x32_bf16 v[140:143], a[132:135], a[76:79], v[140:143]
    s_waitcnt lgkmcnt(10)
    v_add_u32 v36, 4294868992, v36
    v_mfma_f32_16x16x32_bf16 v[64:67], a[136:139], a[52:55], v[64:67]
    ds_read_b64_tr_b16 a[160:161], v37 offset:32768
    ds_read_b64_tr_b16 a[162:163], v37 offset:36864
    v_mfma_f32_16x16x32_bf16 v[80:83], a[136:139], a[68:71], v[80:83]
    s_waitcnt lgkmcnt(10)
    v_add_u32 v37, 4294868992, v37
    v_mfma_f32_16x16x32_bf16 v[68:71], a[140:143], a[52:55], v[68:71]
    ds_read_b64_tr_b16 a[164:165], v38 offset:32768
    ds_read_b64_tr_b16 a[166:167], v38 offset:36864
    v_mfma_f32_16x16x32_bf16 v[84:87], a[140:143], a[68:71], v[84:87]
    s_waitcnt lgkmcnt(10)
    v_add_u32 v38, 4294868992, v38
    v_mfma_f32_16x16x32_bf16 v[72:75], a[144:147], a[52:55], v[72:75]
    s_waitcnt lgkmcnt(6)
    ds_read_b64_tr_b16 a[168:169], v27 offset:24576
    ds_read_b64_tr_b16 a[170:171], v27 offset:25600
    v_mfma_f32_16x16x32_bf16 v[88:91], a[144:147], a[68:71], v[88:91]
    s_waitcnt lgkmcnt(10)
    v_mfma_f32_16x16x32_bf16 v[76:79], a[148:151], a[52:55], v[76:79]
    s_waitcnt vmcnt(5)
    ds_read_b64_tr_b16 a[172:173], v28 offset:24576
    ds_read_b64_tr_b16 a[174:175], v28 offset:25600
    v_mfma_f32_16x16x32_bf16 v[92:95], a[148:151], a[68:71], v[92:95]
    s_barrier
    v_mfma_f32_16x16x32_bf16 v[216:219], a[152:155], a[52:55], v[216:219]
    ds_read_b64_tr_b16 a[176:177], v20 offset:0
    ds_read_b64_tr_b16 a[178:179], v20 offset:4096
    v_mfma_f32_16x16x32_bf16 v[220:223], a[152:155], a[68:71], v[220:223]
    s_waitcnt lgkmcnt(10)
    v_mfma_f32_16x16x32_bf16 v[228:231], a[156:159], a[52:55], v[228:231]
    v_mfma_f32_16x16x32_bf16 v[232:235], a[156:159], a[68:71], v[232:235]
    s_waitcnt lgkmcnt(8)
    ds_read_b64_tr_b16 a[180:181], v19 offset:0
    ds_read_b64_tr_b16 a[182:183], v19 offset:4096
    v_mfma_f32_16x16x32_bf16 v[240:243], a[160:163], a[52:55], v[240:243]
    v_mfma_f32_16x16x32_bf16 v[244:247], a[160:163], a[68:71], v[244:247]
    s_waitcnt lgkmcnt(8)
    ds_read_b64_tr_b16 a[184:185], v26 offset:8192
    ds_read_b64_tr_b16 a[186:187], v26 offset:9216
    v_mfma_f32_16x16x32_bf16 v[196:199], a[164:167], a[52:55], v[196:199]
    v_mfma_f32_16x16x32_bf16 v[200:203], a[164:167], a[68:71], v[200:203]
    s_waitcnt lgkmcnt(8)
    ds_read_b64_tr_b16 a[188:189], v28 offset:8192
    ds_read_b64_tr_b16 a[190:191], v28 offset:9216
    v_mfma_f32_16x16x32_bf16 v[104:107], a[168:171], a[52:55], v[104:107]
    s_waitcnt vmcnt(0)
    ds_read_b64_tr_b16 a[192:193], v25 offset:8192
    ds_read_b64_tr_b16 a[194:195], v25 offset:9216
    v_mfma_f32_16x16x32_bf16 v[116:119], a[168:171], a[68:71], v[116:119]
    s_waitcnt lgkmcnt(10)
    v_mfma_f32_16x16x32_bf16 v[108:111], a[172:175], a[52:55], v[108:111]
    s_waitcnt lgkmcnt(8)
    ds_read_b64_tr_b16 a[196:197], v27 offset:8192
    ds_read_b64_tr_b16 a[198:199], v27 offset:9216
    v_mfma_f32_16x16x32_bf16 v[132:135], a[172:175], a[68:71], v[132:135]
    s_barrier
    v_mfma_f32_16x16x32_bf16 v[76:79], a[176:179], a[84:87], v[76:79]
    ds_read_b64_tr_b16 a[200:201], v24 offset:0
    ds_read_b64_tr_b16 a[202:203], v24 offset:4096
    v_mfma_f32_16x16x32_bf16 v[92:95], a[176:179], a[100:103], v[92:95]
    v_mfma_f32_16x16x32_bf16 v[212:215], a[176:179], a[116:119], v[212:215]
    s_waitcnt lgkmcnt(10)
    ds_read_b64_tr_b16 a[204:205], v38 offset:0
    ds_read_b64_tr_b16 a[206:207], v38 offset:4096
    v_mfma_f32_16x16x32_bf16 v[72:75], a[180:183], a[84:87], v[72:75]
    ds_read_b64_tr_b16 a[208:209], v23 offset:0
    ds_read_b64_tr_b16 a[210:211], v23 offset:4096
    v_mfma_f32_16x16x32_bf16 v[88:91], a[180:183], a[100:103], v[88:91]
    v_mfma_f32_16x16x32_bf16 v[208:211], a[180:183], a[116:119], v[208:211]
    s_waitcnt lgkmcnt(12)
    ds_read_b64_tr_b16 a[212:213], v37 offset:0
    ds_read_b64_tr_b16 a[214:215], v37 offset:4096
    v_mfma_f32_16x16x32_bf16 v[108:111], a[184:187], a[84:87], v[108:111]
    v_cvt_pk_bf16_f32 v215, v214, v215
    v_cvt_pk_bf16_f32 v214, v212, v213
    v_mfma_f32_16x16x32_bf16 v[132:135], a[184:187], a[100:103], v[132:135]
    ds_read_b64_tr_b16 a[216:217], v22 offset:0
    ds_read_b64_tr_b16 a[218:219], v22 offset:4096
    v_mfma_f32_16x16x32_bf16 v[140:143], a[184:187], a[116:119], v[140:143]
    s_waitcnt lgkmcnt(12)
    v_mfma_f32_16x16x32_bf16 v[108:111], a[188:191], a[92:95], v[108:111]
    v_cvt_pk_bf16_f32 v212, v208, v209
    v_cvt_pk_bf16_f32 v213, v210, v211
    v_mfma_f32_16x16x32_bf16 v[132:135], a[188:191], a[108:111], v[132:135]
    ds_write_b128 v55, v[212:215] offset:4096
    v_mfma_f32_16x16x32_bf16 v[104:107], a[192:195], a[84:87], v[104:107]
    ds_read_b64_tr_b16 a[220:221], v36 offset:0
    ds_read_b64_tr_b16 a[222:223], v36 offset:4096
    v_mfma_f32_16x16x32_bf16 v[116:119], a[192:195], a[100:103], v[116:119]
    v_cvt_pk_bf16_f32 v143, v142, v143
    v_cvt_pk_bf16_f32 v142, v140, v141
    v_mfma_f32_16x16x32_bf16 v[124:127], a[192:195], a[116:119], v[124:127]
    s_waitcnt lgkmcnt(12)
    ds_read_b64_tr_b16 a[224:225], v21 offset:0
    ds_read_b64_tr_b16 a[226:227], v21 offset:4096
    v_mfma_f32_16x16x32_bf16 v[104:107], a[196:199], a[92:95], v[104:107]
    v_cvt_pk_bf16_f32 v135, v134, v135
    v_cvt_pk_bf16_f32 v134, v132, v133
    v_mfma_f32_16x16x32_bf16 v[116:119], a[196:199], a[108:111], v[116:119]
    s_waitcnt lgkmcnt(12)
    ds_read_b64_tr_b16 a[228:229], v35 offset:0
    ds_read_b64_tr_b16 a[230:231], v35 offset:4096
    v_mfma_f32_16x16x32_bf16 v[196:199], a[200:203], a[84:87], v[196:199]
    ds_read_b64_tr_b16 a[232:233], v34 offset:0
    ds_read_b64_tr_b16 a[234:235], v34 offset:4096
    v_mfma_f32_16x16x32_bf16 v[200:203], a[200:203], a[100:103], v[200:203]
    v_cvt_pk_bf16_f32 v140, v124, v125
    v_cvt_pk_bf16_f32 v141, v126, v127
    v_mfma_f32_16x16x32_bf16 v[204:207], a[200:203], a[116:119], v[204:207]
    s_waitcnt lgkmcnt(12)
    ds_write_b128 v55, v[140:143] offset:8192
    v_mfma_f32_16x16x32_bf16 v[196:199], a[204:207], a[92:95], v[196:199]
    v_cvt_pk_bf16_f32 v132, v116, v117
    v_cvt_pk_bf16_f32 v133, v118, v119
    v_mfma_f32_16x16x32_bf16 v[200:203], a[204:207], a[108:111], v[200:203]
    ds_write_b128 v55, v[132:135] offset:7168
    v_mfma_f32_16x16x32_bf16 v[240:243], a[208:211], a[84:87], v[240:243]
    ds_read_b64_tr_b16 a[236:237], v33 offset:0
    ds_read_b64_tr_b16 a[238:239], v33 offset:4096
    v_mfma_f32_16x16x32_bf16 v[244:247], a[208:211], a[100:103], v[244:247]
    v_cvt_pk_bf16_f32 v207, v206, v207
    v_cvt_pk_bf16_f32 v206, v204, v205
    v_mfma_f32_16x16x32_bf16 v[192:195], a[208:211], a[116:119], v[192:195]
    s_waitcnt lgkmcnt(12)
    v_cvt_pk_bf16_f32 v199, v198, v199
    v_cvt_pk_bf16_f32 v198, v196, v197
    v_mfma_f32_16x16x32_bf16 v[240:243], a[212:215], a[92:95], v[240:243]
    v_cvt_pk_bf16_f32 v203, v202, v203
    v_cvt_pk_bf16_f32 v202, v200, v201
    v_mfma_f32_16x16x32_bf16 v[244:247], a[212:215], a[108:111], v[244:247]
    ds_read_b64_tr_b16 a[240:241], v18 offset:0
    ds_read_b64_tr_b16 a[242:243], v18 offset:4096
    v_mfma_f32_16x16x32_bf16 v[228:231], a[216:219], a[84:87], v[228:231]
    ds_read_b64_tr_b16 a[244:245], v32 offset:0
    ds_read_b64_tr_b16 a[246:247], v32 offset:4096
    v_mfma_f32_16x16x32_bf16 v[232:235], a[216:219], a[100:103], v[232:235]
    v_cvt_pk_bf16_f32 v204, v192, v193
    v_cvt_pk_bf16_f32 v205, v194, v195
    v_mfma_f32_16x16x32_bf16 v[236:239], a[216:219], a[116:119], v[236:239]
    s_waitcnt lgkmcnt(12)
    ds_write_b128 v55, v[204:207] offset:6144
    v_mfma_f32_16x16x32_bf16 v[228:231], a[220:223], a[92:95], v[228:231]
    v_cvt_pk_bf16_f32 v196, v240, v241
    v_cvt_pk_bf16_f32 v197, v242, v243
    v_mfma_f32_16x16x32_bf16 v[232:235], a[220:223], a[108:111], v[232:235]
    ds_write_b128 v55, v[196:199] offset:1024
    v_mfma_f32_16x16x32_bf16 v[216:219], a[224:227], a[84:87], v[216:219]
    v_cvt_pk_bf16_f32 v200, v244, v245
    v_cvt_pk_bf16_f32 v201, v246, v247
    v_mfma_f32_16x16x32_bf16 v[220:223], a[224:227], a[100:103], v[220:223]
    ds_write_b128 v55, v[200:203] offset:3072
    v_mfma_f32_16x16x32_bf16 v[224:227], a[224:227], a[116:119], v[224:227]
    s_waitcnt lgkmcnt(12)
    v_cvt_pk_bf16_f32 v239, v238, v239
    v_cvt_pk_bf16_f32 v238, v236, v237
    v_mfma_f32_16x16x32_bf16 v[216:219], a[228:231], a[92:95], v[216:219]
    v_cvt_pk_bf16_f32 v231, v230, v231
    v_cvt_pk_bf16_f32 v230, v228, v229
    v_mfma_f32_16x16x32_bf16 v[220:223], a[228:231], a[108:111], v[220:223]
    s_waitcnt lgkmcnt(11)
    v_cvt_pk_bf16_f32 v235, v234, v235
    v_cvt_pk_bf16_f32 v234, v232, v233
    v_mfma_f32_16x16x32_bf16 v[76:79], a[232:235], a[92:95], v[76:79]
    ds_read_b64_tr_b16 a[248:249], v17 offset:0
    ds_read_b64_tr_b16 a[250:251], v17 offset:4096
    v_mfma_f32_16x16x32_bf16 v[92:95], a[232:235], a[108:111], v[92:95]
    s_waitcnt lgkmcnt(9)
    v_cvt_pk_bf16_f32 v236, v224, v225
    v_cvt_pk_bf16_f32 v237, v226, v227
    v_mfma_f32_16x16x32_bf16 v[72:75], a[236:239], a[92:95], v[72:75]
    ds_write_b128 v55, v[236:239] offset:5120
    v_mfma_f32_16x16x32_bf16 v[88:91], a[236:239], a[108:111], v[88:91]
    s_waitcnt lgkmcnt(8)
    v_cvt_pk_bf16_f32 v228, v216, v217
    v_cvt_pk_bf16_f32 v229, v218, v219
    v_mfma_f32_16x16x32_bf16 v[68:71], a[240:243], a[84:87], v[68:71]
    ds_write_b128 v55, v[228:231] offset:0
    v_mfma_f32_16x16x32_bf16 v[84:87], a[240:243], a[100:103], v[84:87]
    ds_read_b64_tr_b16 a[252:253], v31 offset:0
    ds_read_b64_tr_b16 a[254:255], v31 offset:4096
    v_cvt_pk_bf16_f32 v232, v220, v221
    v_cvt_pk_bf16_f32 v233, v222, v223
    v_mfma_f32_16x16x32_bf16 v[100:103], a[240:243], a[116:119], v[100:103]
    s_waitcnt lgkmcnt(9)
    ds_write_b128 v55, v[232:235] offset:2048
    v_mfma_f32_16x16x32_bf16 v[68:71], a[244:247], a[92:95], v[68:71]
    v_mfma_f32_16x16x32_bf16 v[84:87], a[244:247], a[108:111], v[84:87]
    s_waitcnt lgkmcnt(0)
    v_mfma_f32_16x16x32_bf16 v[64:67], a[248:251], a[84:87], v[64:67]
    s_barrier
    ds_read_b128 a[0:3], v57 offset:3072
    v_mfma_f32_16x16x32_bf16 v[80:83], a[248:251], a[100:103], v[80:83]
    ds_read_b128 a[4:7], v57 offset:1024
    ds_read_b128 a[8:11], v57 offset:7168
    v_mfma_f32_16x16x32_bf16 v[96:99], a[248:251], a[116:119], v[96:99]
    ds_read_b128 a[12:15], v57 offset:2048
    ds_read_b128 a[16:19], v57 offset:0
    v_mfma_f32_16x16x32_bf16 v[64:67], a[252:255], a[92:95], v[64:67]
    ds_read_b128 a[20:23], v55 offset:8192
    ds_read_b128 a[24:27], v56 offset:8192
    v_mfma_f32_16x16x32_bf16 v[80:83], a[252:255], a[108:111], v[80:83]
    ds_read_b128 a[28:31], v57 offset:8192
    ds_read_b128 a[32:35], v58 offset:8192
    s_waitcnt lgkmcnt(8)
    v_mfma_f32_16x16x32_bf16 v[72:75], v[50:53], a[0:3], v[72:75]
    ds_read_b128 a[36:39], v56 offset:4096
    ds_read_b128 a[40:43], v57 offset:5120
    v_mfma_f32_16x16x32_bf16 v[76:79], v[48:51], a[0:3], v[76:79]
    s_waitcnt lgkmcnt(9)
    ds_read_b128 a[44:47], v58 offset:6144
    v_mfma_f32_16x16x32_bf16 v[88:91], v[50:53], a[4:7], v[88:91]
    v_mfma_f32_16x16x32_bf16 v[92:95], v[48:51], a[4:7], v[92:95]
    s_waitcnt lgkmcnt(9)
    v_mfma_f32_16x16x32_bf16 v[104:107], v[50:53], a[8:11], v[104:107]
    v_mfma_f32_16x16x32_bf16 v[108:111], v[48:51], a[8:11], v[108:111]
    s_waitcnt lgkmcnt(8)
    v_cvt_pk_bf16_f32 v72, v72, v73
    v_cvt_pk_bf16_f32 v73, v74, v75
    v_mfma_f32_16x16x32_bf16 v[64:67], v[50:53], a[12:15], v[64:67]
    v_cvt_pk_bf16_f32 v74, v76, v77
    v_cvt_pk_bf16_f32 v75, v78, v79
    v_mfma_f32_16x16x32_bf16 v[68:71], v[48:51], a[12:15], v[68:71]
    s_waitcnt lgkmcnt(7)
    buffer_store_dwordx4 v[72:75], v3, s[40:43], s70 offen sc1
    v_mfma_f32_16x16x32_bf16 v[80:83], v[50:53], a[16:19], v[80:83]
    v_cvt_pk_bf16_f32 v88, v88, v89
    v_cvt_pk_bf16_f32 v89, v90, v91
    v_mfma_f32_16x16x32_bf16 v[84:87], v[48:51], a[16:19], v[84:87]
    s_waitcnt lgkmcnt(6)
    v_cvt_pk_bf16_f32 v90, v92, v93
    v_cvt_pk_bf16_f32 v91, v94, v95
    v_mfma_f32_16x16x32_bf16 v[112:115], v[50:53], a[20:23], 0
    buffer_store_dwordx4 v[88:91], v3, s[40:43], s72 offen sc1
    v_mfma_f32_16x16x32_bf16 v[120:123], v[48:51], a[20:23], 0
    s_waitcnt lgkmcnt(5)
    v_cvt_pk_bf16_f32 v104, v104, v105
    v_cvt_pk_bf16_f32 v105, v106, v107
    v_mfma_f32_16x16x32_bf16 v[112:115], v[50:53], a[24:27], v[112:115]
    v_cvt_pk_bf16_f32 v106, v108, v109
    v_cvt_pk_bf16_f32 v107, v110, v111
    v_mfma_f32_16x16x32_bf16 v[120:123], v[48:51], a[24:27], v[120:123]
    s_waitcnt lgkmcnt(4)
    buffer_store_dwordx4 v[104:107], v3, s[40:43], s12 offen sc1
    v_mfma_f32_16x16x32_bf16 v[112:115], v[50:53], a[28:31], v[112:115]
    v_cvt_pk_bf16_f32 v64, v64, v65
    v_cvt_pk_bf16_f32 v65, v66, v67
    v_mfma_f32_16x16x32_bf16 v[120:123], v[48:51], a[28:31], v[120:123]
    s_waitcnt lgkmcnt(3)
    v_cvt_pk_bf16_f32 v66, v68, v69
    v_cvt_pk_bf16_f32 v67, v70, v71
    v_mfma_f32_16x16x32_bf16 v[112:115], v[50:53], a[32:35], v[112:115]
    buffer_store_dwordx4 v[64:67], v3, s[40:43], s69 offen sc1
    v_mfma_f32_16x16x32_bf16 v[120:123], v[48:51], a[32:35], v[120:123]
    s_waitcnt lgkmcnt(2)
    v_cvt_pk_bf16_f32 v80, v80, v81
    v_cvt_pk_bf16_f32 v81, v82, v83
    v_mfma_f32_16x16x32_bf16 v[96:99], v[50:53], a[36:39], v[96:99]
    v_cvt_pk_bf16_f32 v82, v84, v85
    v_cvt_pk_bf16_f32 v83, v86, v87
    v_mfma_f32_16x16x32_bf16 v[100:103], v[48:51], a[36:39], v[100:103]
    s_waitcnt lgkmcnt(1)
    buffer_store_dwordx4 v[80:83], v3, s[40:43], s71 offen sc1
    v_mfma_f32_16x16x32_bf16 v[96:99], v[50:53], a[40:43], v[96:99]
    v_mfma_f32_16x16x32_bf16 v[100:103], v[48:51], a[40:43], v[100:103]
    s_waitcnt lgkmcnt(0)
    v_cvt_pk_bf16_f32 v112, v112, v113
    v_cvt_pk_bf16_f32 v113, v114, v115
    v_mfma_f32_16x16x32_bf16 v[96:99], v[50:53], a[44:47], v[96:99]
    s_nop 0
    v_cvt_pk_bf16_f32 v114, v120, v121
    v_cvt_pk_bf16_f32 v115, v122, v123
    v_mfma_f32_16x16x32_bf16 v[100:103], v[48:51], a[44:47], v[100:103]
    buffer_store_dwordx4 v[112:115], v3, s[40:43], s13 offen sc1
    s_nop 2
    v_cvt_pk_bf16_f32 v96, v96, v97
    v_cvt_pk_bf16_f32 v97, v98, v99
    s_nop 1
    v_cvt_pk_bf16_f32 v98, v100, v101
    v_cvt_pk_bf16_f32 v99, v102, v103
    buffer_store_dwordx4 v[96:99], v3, s[40:43], s73 offen sc1
    s_mov_b32 s65, 0
    s_waitcnt vmcnt(0)
    s_barrier
    s_cmp_lg_u32 s48, 0
    s_cbranch_scc1 standalone__gqa_block_cached__near_ridge_a_fq
    s_mov_b64 exec, 1
    buffer_store_dword v29, v43, s[40:43], s62 offen sc1
    s_mov_b64 exec, 14
standalone__gqa_block_cached__near_ridge_a_fp:
    buffer_load_dword v208, v43, s[40:43], s62 offen sc1
    s_waitcnt vmcnt(0)
    v_cmp_ne_u32 vcc, 1, v208
    s_add_u32 s65, s65, 1
    s_and_b32 s59, vcc_lo, 14
    s_cbranch_scc0 standalone__gqa_block_cached__near_ridge_a_fq
    s_cmp_lt_u32 s65, 200000
    s_cbranch_scc1 standalone__gqa_block_cached__near_ridge_a_fp
standalone__gqa_block_cached__near_ridge_a_fq:
    s_mov_b64 exec, -1
    s_barrier
    buffer_load_dwordx4 a[0:3], v39, s[40:43], s20 offen sc1
    buffer_load_dwordx4 a[16:19], v39, s[40:43], s21 offen sc1
    buffer_load_dwordx4 a[4:7], v40, s[40:43], s20 offen sc1
    buffer_load_dwordx4 a[20:23], v40, s[40:43], s21 offen sc1
    buffer_load_dwordx4 a[8:11], v41, s[40:43], s20 offen sc1
    buffer_load_dwordx4 a[24:27], v41, s[40:43], s21 offen sc1
    buffer_load_dwordx4 a[12:15], v42, s[40:43], s20 offen sc1
    buffer_load_dwordx4 a[28:31], v42, s[40:43], s21 offen sc1
    s_waitcnt vmcnt(6)
    v_mfma_f32_16x16x32_bf16 v[112:115], v[50:53], a[0:3], 0
standalone__gqa_block_cached__near_ridge_a_h1_2:
    s_cbranch_execz standalone__gqa_block_cached__near_ridge_a_h1_r
    v_mfma_f32_16x16x32_bf16 v[116:119], v[48:51], a[0:3], 0
    v_mfma_f32_16x16x32_bf16 v[120:123], v[50:53], a[16:19], 0
    v_mfma_f32_16x16x32_bf16 v[124:127], v[48:51], a[16:19], 0
    s_waitcnt vmcnt(4)
    v_mfma_f32_16x16x32_bf16 v[112:115], v[50:53], a[4:7], v[112:115]
    v_mfma_f32_16x16x32_bf16 v[116:119], v[48:51], a[4:7], v[116:119]
    v_mfma_f32_16x16x32_bf16 v[120:123], v[50:53], a[20:23], v[120:123]
    v_mfma_f32_16x16x32_bf16 v[124:127], v[48:51], a[20:23], v[124:127]
    s_waitcnt vmcnt(2)
    v_mfma_f32_16x16x32_bf16 v[112:115], v[50:53], a[8:11], v[112:115]
    v_mfma_f32_16x16x32_bf16 v[116:119], v[48:51], a[8:11], v[116:119]
    v_mfma_f32_16x16x32_bf16 v[120:123], v[50:53], a[24:27], v[120:123]
    v_mfma_f32_16x16x32_bf16 v[124:127], v[48:51], a[24:27], v[124:127]
    s_waitcnt vmcnt(0)
    v_mfma_f32_16x16x32_bf16 v[112:115], v[50:53], a[12:15], v[112:115]
    v_mfma_f32_16x16x32_bf16 v[116:119], v[48:51], a[12:15], v[116:119]
    v_mfma_f32_16x16x32_bf16 v[120:123], v[50:53], a[28:31], v[120:123]
    v_mfma_f32_16x16x32_bf16 v[124:127], v[48:51], a[28:31], v[124:127]
    s_nop 4
    v_cvt_pk_bf16_f32 v112, v112, v113
    v_cvt_pk_bf16_f32 v113, v114, v115
    v_cvt_pk_bf16_f32 v114, v116, v117
    v_cvt_pk_bf16_f32 v115, v118, v119
    v_cvt_pk_bf16_f32 v120, v120, v121
    v_cvt_pk_bf16_f32 v121, v122, v123
    v_cvt_pk_bf16_f32 v122, v124, v125
    v_cvt_pk_bf16_f32 v123, v126, v127
    v_permlane16_swap_b32 v112, v114
    v_permlane16_swap_b32 v113, v115
    buffer_store_dwordx4 v[112:115], v59, s[44:47], s22 offen
    v_permlane16_swap_b32 v120, v122
    v_permlane16_swap_b32 v121, v123
    buffer_store_dwordx4 v[120:123], v59, s[44:47], s23 offen
    s_endpgm
.p2align 12
standalone__gqa_block_cached__near_ridge_pb:
    s_mul_i32 s56, s48, 2560
    s_add_u32 s56, s56, 94208
    v_lshrrev_b32 v55, 4, v2
    v_and_b32 v56, 15, v2
    v_lshlrev_b32 v57, 1, v55
    v_xor_b32 v57, v56, v57
    v_lshlrev_b32 v57, 4, v57
    v_lshl_add_u32 v4, v55, 13, v57
    v_xor_b32 v6, 128, v4
    v_add_u32 v5, 31744, v4
    v_add_u32 v7, 95232, v6
    v_add_u32 v6, 63488, v6
    v_lshrrev_b32 v55, 3, v2
    v_and_b32 v56, 7, v2
    s_mul_i32 s57, s48, 20
    v_add_u32 v57, s57, v55
    v_bfe_u32 v58, v57, 1, 3
    v_xor_b32 v58, v56, v58
    v_mul_u32_u24 v57, 1152, v57
    v_lshl_add_u32 v8, v58, 4, v57
    v_xor_b32 v9, 64, v8
    v_add_u32 v9, 8192, v9
    v_add_u32 v10, 16384, v8
    v_lshrrev_b32 v55, 4, v2
    v_and_b32 v56, 15, v2
    v_bfe_u32 v57, v2, 2, 2
    v_and_b32 v58, 3, v2
    v_and_b32 v61, 1, v55
    v_lshl_add_u32 v60, v61, 2, v57
    v_lshlrev_b32 v60, 5, v60
    v_lshl_add_u32 v60, v58, 3, v60
    s_lshl_b32 s58, s50, 7
    v_xor_b32 v60, s58, v60
    v_lshl_add_u32 v59, v55, 3, v57
    v_lshl_add_u32 v59, v59, 8, v60
    s_lshl_b32 s57, s49, 13
    s_add_u32 s57, s57, 114688
    v_add_u32 v17, s57, v59
    v_xor_b32 v18, 32, v17
    v_xor_b32 v19, 64, v17
    v_xor_b32 v20, 96, v17
    v_xor_b32 v21, 128, v17
    v_xor_b32 v22, 160, v17
    v_xor_b32 v23, 192, v17
    v_xor_b32 v24, 224, v17
    v_lshl_add_u32 v59, v55, 2, v57
    v_lshl_add_u32 v59, v59, 8, v60
    s_lshl_b32 s57, s50, 13
    s_add_u32 s59, s57, 49152
    v_add_u32 v39, s59, v59
    v_xor_b32 v40, 32, v39
    v_xor_b32 v41, 64, v39
    v_xor_b32 v42, 96, v39
    v_xor_b32 v43, 128, v39
    v_xor_b32 v44, 160, v39
    v_xor_b32 v45, 192, v39
    v_xor_b32 v46, 224, v39
    v_xor_b32 v47, 8192, v39
    v_xor_b32 v48, 8224, v39
    v_xor_b32 v49, 8256, v39
    v_xor_b32 v50, 8288, v39
    v_xor_b32 v51, 8320, v39
    v_xor_b32 v52, 8352, v39
    v_xor_b32 v53, 8384, v39
    v_xor_b32 v54, 8416, v39
    v_lshrrev_b32 v59, 1, v55
    v_lshl_add_u32 v59, v61, 1, v59
    v_xor_b32 v59, v59, v56
    v_lshlrev_b32 v59, 4, v59
    v_xor_b32 v59, s58, v59
    v_lshl_add_u32 v59, v56, 8, v59
    v_add_u32 v31, s57, v59
    v_xor_b32 v32, 64, v31
    v_xor_b32 v33, 128, v31
    v_xor_b32 v34, 192, v31
    v_xor_b32 v35, 8192, v31
    v_xor_b32 v36, 8256, v31
    v_xor_b32 v37, 8320, v31
    v_xor_b32 v38, 8384, v31
    v_lshrrev_b32 v59, 1, v56
    v_xor_b32 v59, v59, v55
    v_lshlrev_b32 v59, 4, v59
    v_lshl_add_u32 v59, v56, 7, v59
    s_lshl_b32 s57, s50, 1
    s_add_u32 s57, s57, s49
    s_lshl_b32 s57, s57, 11
    s_xor_b32 s58, s57, 2048
    s_add_u32 s57, s57, 94208
    s_add_u32 s58, s58, 94208
    v_add_u32 v25, s57, v59
    v_add_u32 v27, s58, v59
    v_add_u32 v29, 102400, v59
    v_xor_b32 v26, 64, v25
    v_xor_b32 v28, 64, v27
    v_xor_b32 v30, 64, v29
    v_lshlrev_b32 v3, 4, v2
    v_mov_b32 v1, 0
    s_mov_b32 s60, 1040356334
    s_mov_b32 s61, 1040356334
    s_mov_b32 s64, 1
    v_mov_b32 v254, 0
    v_mov_b32 v59, 0x3f803f80
    v_accvgpr_write_b32 a204, v59
    v_accvgpr_write_b32 a205, v59
    v_accvgpr_write_b32 a206, v59
    v_accvgpr_write_b32 a207, v59
    s_mul_i32 s57, s52, 1179648
    s_add_u32 s36, s12, s57
    s_addc_u32 s37, s13, 0
    s_mov_b32 s38, 1179648
    s_mov_b32 s39, 0x20000
    s_mov_b32 s44, s14
    s_mov_b32 s45, s15
    s_mov_b32 s46, 1474560
    s_mov_b32 s47, 0x20000
    s_mov_b32 s4, s16
    s_mov_b32 s5, s17
    s_mov_b32 s6, 256
    s_mov_b32 s7, 0x20000
    s_lshl_b32 s18, s53, 4
    v_lshrrev_b32 v57, 3, v0
    v_mul_u32_u24 v57, 1152, v57
    v_and_b32 v58, 7, v0
    v_lshl_add_u32 v57, v58, 7, v57
    v_lshrrev_b32 v252, 2, v58
    v_lshl_add_u32 v252, v252, 30, v57
    v_add_u32 v58, 3, v58
    v_lshrrev_b32 v58, 3, v58
    v_lshl_add_u32 v253, v58, 30, v57
    s_bfe_u32 s74, s53, 0x10002
    s_lshl_b32 s74, s74, 4
    s_and_b32 s73, s53, 3
    s_lshl_b32 s73, s73, 1
    s_add_u32 s74, s74, s73
    s_lshr_b32 s73, s51, 1
    s_add_u32 s74, s74, s73
    s_mul_i32 s73, s74, 36864
    s_add_u32 s74, s73, 294912
    s_mov_b64 exec, 0
    s_cmp_eq_u32 s48, 0
    s_cbranch_scc1 standalone__gqa_block_cached__near_ridge_b_h0_0
    s_cmp_eq_u32 s48, 1
    s_cbranch_scc1 standalone__gqa_block_cached__near_ridge_b_h0_1
    s_cmp_eq_u32 s48, 2
    s_cbranch_scc1 standalone__gqa_block_cached__near_ridge_b_h0_2
    s_branch standalone__gqa_block_cached__near_ridge_b_h0_3
standalone__gqa_block_cached__near_ridge_b_h0_r:
    s_mov_b64 exec, -1
    s_add_u32 m0, s55, 0
    s_add_u32 s58, s55, 0
    buffer_load_dwordx4 v11, s[24:27], s58 offen offset:0 nt lds
    buffer_load_dwordx4 v12, s[24:27], s58 offen offset:1024 nt lds
    buffer_load_dwordx4 v13, s[24:27], s58 offen offset:2048 nt lds
    buffer_load_dwordx4 v14, s[24:27], s58 offen offset:3072 nt lds
    s_add_u32 m0, s55, 16384
    s_add_u32 s58, s55, 16384
    buffer_load_dwordx4 v11, s[24:27], s58 offen offset:0 nt lds
    buffer_load_dwordx4 v12, s[24:27], s58 offen offset:1024 nt lds
    buffer_load_dwordx4 v13, s[24:27], s58 offen offset:2048 nt lds
    buffer_load_dwordx4 v14, s[24:27], s58 offen offset:3072 nt lds
    s_mov_b32 s4, s16
    s_mov_b32 s5, s17
    s_mov_b32 s6, 256
    s_mov_b32 s7, 0x20000
    s_lshl_b32 s57, s53, 4
    v_mov_b32 v69, 1
    s_waitcnt vmcnt(13)
    buffer_store_dword v69, v68, s[4:7], s57 offen sc1
    s_add_u32 m0, s55, 49152
    s_add_u32 s58, s55, 0
    buffer_load_dwordx4 v15, s[28:31], s58 offen offset:0 nt lds
    buffer_load_dwordx4 v16, s[28:31], s58 offen offset:1024 nt lds
    buffer_load_dwordx4 v15, s[28:31], s58 offen offset:2048 nt lds
    buffer_load_dwordx4 v16, s[28:31], s58 offen offset:3072 nt lds
    s_add_u32 m0, s55, 32768
    s_add_u32 s58, s55, 32768
    buffer_load_dwordx4 v11, s[24:27], s58 offen offset:0 nt lds
    buffer_load_dwordx4 v12, s[24:27], s58 offen offset:1024 nt lds
    buffer_load_dwordx4 v13, s[24:27], s58 offen offset:2048 nt lds
    buffer_load_dwordx4 v14, s[24:27], s58 offen offset:3072 nt lds
    s_add_u32 m0, s55, 65536
    s_add_u32 s58, s55, 16384
    buffer_load_dwordx4 v15, s[28:31], s58 offen offset:0 nt lds
    buffer_load_dwordx4 v16, s[28:31], s58 offen offset:1024 nt lds
    buffer_load_dwordx4 v15, s[28:31], s58 offen offset:2048 nt lds
    buffer_load_dwordx4 v16, s[28:31], s58 offen offset:3072 nt lds
    s_add_u32 m0, s56, 10240
    s_mov_b32 s57, 0
    buffer_load_dwordx4 v8, s[20:23], s57 offen offset:0 lds
    buffer_load_dwordx4 v9, s[20:23], s57 offen offset:1024 lds
    s_mov_b32 exec_hi, 0
    buffer_load_dwordx4 v10, s[20:23], s57 offen offset:2048 lds
    s_mov_b32 exec_hi, -1
    s_add_u32 m0, s55, 114688
    s_mov_b32 s58, 0
    buffer_load_dwordx4 v4, s[32:35], s58 offen offset:0 lds
    buffer_load_dwordx4 v5, s[32:35], s58 offen offset:1024 lds
    buffer_load_dwordx4 v6, s[32:35], s58 offen offset:2048 lds
    buffer_load_dwordx4 v7, s[32:35], s58 offen offset:3072 lds
    s_add_u32 m0, s55, 131072
    s_mov_b32 s58, 262144
    buffer_load_dwordx4 v4, s[32:35], s58 offen offset:0 lds
    buffer_load_dwordx4 v5, s[32:35], s58 offen offset:1024 lds
    buffer_load_dwordx4 v6, s[32:35], s58 offen offset:2048 lds
    buffer_load_dwordx4 v7, s[32:35], s58 offen offset:3072 lds
    s_add_u32 m0, s56, 0
    s_mov_b32 s57, 128
    buffer_load_dwordx4 v8, s[20:23], s57 offen offset:0 lds
    buffer_load_dwordx4 v9, s[20:23], s57 offen offset:1024 lds
    s_mov_b32 exec_hi, 0
    buffer_load_dwordx4 v10, s[20:23], s57 offen offset:2048 lds
    s_mov_b32 exec_hi, -1
    s_add_u32 m0, s55, 147456
    s_mov_b32 s58, 524288
    buffer_load_dwordx4 v4, s[32:35], s58 offen offset:0 lds
    buffer_load_dwordx4 v5, s[32:35], s58 offen offset:1024 lds
    buffer_load_dwordx4 v6, s[32:35], s58 offen offset:2048 lds
    buffer_load_dwordx4 v7, s[32:35], s58 offen offset:3072 lds
    s_waitcnt vmcnt(11)
    s_barrier
    ds_read_b128 a[208:211], v25 offset:10240
    ds_read_b128 a[212:215], v27 offset:10240
    ds_read_b128 a[216:219], v29 offset:10240
    ds_read_b64_tr_b16 a[64:65], v17 offset:0
    ds_read_b64_tr_b16 a[66:67], v17 offset:1024
    ds_read_b64_tr_b16 a[68:69], v18 offset:0
    ds_read_b64_tr_b16 a[70:71], v18 offset:1024
    ds_read_b64_tr_b16 a[72:73], v19 offset:0
    ds_read_b64_tr_b16 a[74:75], v19 offset:1024
    ds_read_b64_tr_b16 a[76:77], v20 offset:0
    ds_read_b64_tr_b16 a[78:79], v20 offset:1024
    ds_read_b64_tr_b16 a[80:81], v21 offset:0
    ds_read_b64_tr_b16 a[82:83], v21 offset:1024
    ds_read_b64_tr_b16 a[84:85], v22 offset:0
    ds_read_b64_tr_b16 a[86:87], v22 offset:1024
    ds_read_b64_tr_b16 a[88:89], v23 offset:0
    ds_read_b64_tr_b16 a[90:91], v23 offset:1024
    ds_read_b64_tr_b16 a[92:93], v24 offset:0
    ds_read_b64_tr_b16 a[94:95], v24 offset:1024
    s_waitcnt lgkmcnt(12)
    v_mfma_f32_16x16x32_bf16 v[112:115], a[64:67], a[208:211], 0
    v_mfma_f32_16x16x32_bf16 v[144:147], a[64:67], a[212:215], 0
    v_mfma_f32_16x16x32_bf16 v[176:179], a[64:67], a[216:219], 0
    v_mfma_f32_16x16x32_bf16 v[116:119], a[68:71], a[208:211], 0
    v_mfma_f32_16x16x32_bf16 v[148:151], a[68:71], a[212:215], 0
    v_mfma_f32_16x16x32_bf16 v[180:183], a[68:71], a[216:219], 0
    s_waitcnt lgkmcnt(10)
    v_mfma_f32_16x16x32_bf16 v[120:123], a[72:75], a[208:211], 0
    v_mfma_f32_16x16x32_bf16 v[152:155], a[72:75], a[212:215], 0
    s_waitcnt vmcnt(7) lgkmcnt(0)
    v_mfma_f32_16x16x32_bf16 v[184:187], a[72:75], a[216:219], 0
    s_barrier
    ds_read_b128 a[220:223], v26 offset:10240
    v_mfma_f32_16x16x32_bf16 v[124:127], a[76:79], a[208:211], 0
    s_mov_b32 s58, 786432
    ds_read_b128 a[224:227], v28 offset:10240
    ds_read_b128 a[228:231], v30 offset:10240
    v_mfma_f32_16x16x32_bf16 v[156:159], a[76:79], a[212:215], 0
    s_add_u32 m0, s55, 114688
    ds_read_b64_tr_b16 a[96:97], v17 offset:16384
    ds_read_b64_tr_b16 a[98:99], v17 offset:17408
    v_mfma_f32_16x16x32_bf16 v[188:191], a[76:79], a[216:219], 0
    buffer_load_dwordx4 v4, s[32:35], s58 offen offset:0 lds
    v_mfma_f32_16x16x32_bf16 v[128:131], a[80:83], a[208:211], 0
    ds_read_b64_tr_b16 a[100:101], v18 offset:16384
    ds_read_b64_tr_b16 a[102:103], v18 offset:17408
    v_mfma_f32_16x16x32_bf16 v[160:163], a[80:83], a[212:215], 0
    ds_read_b64_tr_b16 a[104:105], v19 offset:16384
    ds_read_b64_tr_b16 a[106:107], v19 offset:17408
    v_mfma_f32_16x16x32_bf16 v[132:135], a[84:87], a[208:211], 0
    ds_read_b64_tr_b16 a[108:109], v20 offset:16384
    ds_read_b64_tr_b16 a[110:111], v20 offset:17408
    v_mfma_f32_16x16x32_bf16 v[164:167], a[84:87], a[212:215], 0
    ds_read_b64_tr_b16 a[112:113], v21 offset:16384
    ds_read_b64_tr_b16 a[114:115], v21 offset:17408
    v_mfma_f32_16x16x32_bf16 v[136:139], a[88:91], a[208:211], 0
    buffer_load_dwordx4 v5, s[32:35], s58 offen offset:1024 lds
    v_mfma_f32_16x16x32_bf16 v[168:171], a[88:91], a[212:215], 0
    ds_read_b64_tr_b16 a[116:117], v22 offset:16384
    ds_read_b64_tr_b16 a[118:119], v22 offset:17408
    v_mfma_f32_16x16x32_bf16 v[140:143], a[92:95], a[208:211], 0
    ds_read_b64_tr_b16 a[120:121], v23 offset:16384
    ds_read_b64_tr_b16 a[122:123], v23 offset:17408
    v_mfma_f32_16x16x32_bf16 v[172:175], a[92:95], a[212:215], 0
    s_waitcnt lgkmcnt(12)
    ds_read_b64_tr_b16 a[124:125], v24 offset:16384
    ds_read_b64_tr_b16 a[126:127], v24 offset:17408
    v_mfma_f32_16x16x32_bf16 v[112:115], a[96:99], a[220:223], v[112:115]
    v_mfma_f32_16x16x32_bf16 v[144:147], a[96:99], a[224:227], v[144:147]
    buffer_load_dwordx4 v6, s[32:35], s58 offen offset:2048 lds
    v_mfma_f32_16x16x32_bf16 v[176:179], a[96:99], a[228:231], v[176:179]
    s_waitcnt lgkmcnt(12)
    v_mfma_f32_16x16x32_bf16 v[116:119], a[100:103], a[220:223], v[116:119]
    v_mfma_f32_16x16x32_bf16 v[148:151], a[100:103], a[224:227], v[148:151]
    v_mfma_f32_16x16x32_bf16 v[180:183], a[100:103], a[228:231], v[180:183]
    s_waitcnt lgkmcnt(10)
    v_mfma_f32_16x16x32_bf16 v[120:123], a[104:107], a[220:223], v[120:123]
    buffer_load_dwordx4 v7, s[32:35], s58 offen offset:3072 lds
    v_mfma_f32_16x16x32_bf16 v[152:155], a[104:107], a[224:227], v[152:155]
    s_waitcnt vmcnt(4) lgkmcnt(0)
    v_mfma_f32_16x16x32_bf16 v[184:187], a[104:107], a[228:231], v[184:187]
    s_barrier
    ds_read_b128 a[208:211], v25 offset:0
    v_mfma_f32_16x16x32_bf16 v[124:127], a[108:111], a[220:223], v[124:127]
    s_mov_b32 s57, 256
    s_add_u32 m0, s56, 10240
    ds_read_b128 a[212:215], v27 offset:0
    v_mfma_f32_16x16x32_bf16 v[156:159], a[108:111], a[224:227], v[156:159]
    buffer_load_dwordx4 v8, s[20:23], s57 offen offset:0 lds
    v_mfma_f32_16x16x32_bf16 v[188:191], a[108:111], a[228:231], v[188:191]
    ds_read_b128 a[216:219], v29 offset:0
    ds_read_b64_tr_b16 a[64:65], v17 offset:32768
    v_mfma_f32_16x16x32_bf16 v[128:131], a[112:115], a[220:223], v[128:131]
    buffer_load_dwordx4 v9, s[20:23], s57 offen offset:1024 lds
    v_mfma_f32_16x16x32_bf16 v[160:163], a[112:115], a[224:227], v[160:163]
    ds_read_b64_tr_b16 a[66:67], v17 offset:33792
    ds_read_b64_tr_b16 a[68:69], v18 offset:32768
    v_mfma_f32_16x16x32_bf16 v[132:135], a[116:119], a[220:223], v[132:135]
    ds_read_b64_tr_b16 a[70:71], v18 offset:33792
    ds_read_b64_tr_b16 a[72:73], v19 offset:32768
    v_mfma_f32_16x16x32_bf16 v[164:167], a[116:119], a[224:227], v[164:167]
    s_mov_b32 exec_hi, 0
    buffer_load_dwordx4 v10, s[20:23], s57 offen offset:2048 lds
    s_mov_b32 exec_hi, -1
    v_mfma_f32_16x16x32_bf16 v[136:139], a[120:123], a[220:223], v[136:139]
    s_mov_b32 s58, 1048576
    ds_read_b64_tr_b16 a[74:75], v19 offset:33792
    ds_read_b64_tr_b16 a[76:77], v20 offset:32768
    v_mfma_f32_16x16x32_bf16 v[168:171], a[120:123], a[224:227], v[168:171]
    s_add_u32 m0, s55, 131072
    ds_read_b64_tr_b16 a[78:79], v20 offset:33792
    ds_read_b64_tr_b16 a[80:81], v21 offset:32768
    v_mfma_f32_16x16x32_bf16 v[140:143], a[124:127], a[220:223], v[140:143]
    buffer_load_dwordx4 v4, s[32:35], s58 offen offset:0 lds
    v_mfma_f32_16x16x32_bf16 v[172:175], a[124:127], a[224:227], v[172:175]
    s_waitcnt lgkmcnt(7)
    ds_read_b64_tr_b16 a[82:83], v21 offset:33792
    ds_read_b64_tr_b16 a[84:85], v22 offset:32768
    v_mfma_f32_16x16x32_bf16 v[112:115], a[64:67], a[208:211], v[112:115]
    ds_read_b64_tr_b16 a[86:87], v22 offset:33792
    ds_read_b64_tr_b16 a[88:89], v23 offset:32768
    v_mfma_f32_16x16x32_bf16 v[144:147], a[64:67], a[212:215], v[144:147]
    buffer_load_dwordx4 v5, s[32:35], s58 offen offset:1024 lds
    v_mfma_f32_16x16x32_bf16 v[176:179], a[64:67], a[216:219], v[176:179]
    s_waitcnt lgkmcnt(9)
    ds_read_b64_tr_b16 a[90:91], v23 offset:33792
    ds_read_b64_tr_b16 a[92:93], v24 offset:32768
    v_mfma_f32_16x16x32_bf16 v[116:119], a[68:71], a[208:211], v[116:119]
    ds_read_b128 a[0:3], v31 offset:0
    v_mfma_f32_16x16x32_bf16 v[148:151], a[68:71], a[212:215], v[148:151]
    ds_read_b128 a[4:7], v32 offset:0
    buffer_load_dwordx4 v6, s[32:35], s58 offen offset:2048 lds
    v_mfma_f32_16x16x32_bf16 v[180:183], a[68:71], a[216:219], v[180:183]
    s_waitcnt lgkmcnt(11)
    ds_read_b64_tr_b16 a[94:95], v24 offset:33792
    v_mfma_f32_16x16x32_bf16 v[120:123], a[72:75], a[208:211], v[120:123]
    v_mfma_f32_16x16x32_bf16 v[152:155], a[72:75], a[212:215], v[152:155]
    s_waitcnt vmcnt(6) lgkmcnt(0)
    buffer_load_dwordx4 v7, s[32:35], s58 offen offset:3072 lds
    v_mfma_f32_16x16x32_bf16 v[184:187], a[72:75], a[216:219], v[184:187]
    s_barrier
    ds_read_b128 a[220:223], v26 offset:0
    v_mfma_f32_16x16x32_bf16 v[124:127], a[76:79], a[208:211], v[124:127]
    s_mov_b32 s58, 1310720
    ds_read_b128 a[224:227], v28 offset:0
    ds_read_b128 a[228:231], v30 offset:0
    v_mfma_f32_16x16x32_bf16 v[156:159], a[76:79], a[212:215], v[156:159]
    s_add_u32 m0, s55, 147456
    ds_read_b64_tr_b16 a[96:97], v17 offset:0
    ds_read_b64_tr_b16 a[98:99], v17 offset:1024
    v_mfma_f32_16x16x32_bf16 v[188:191], a[76:79], a[216:219], v[188:191]
    buffer_load_dwordx4 v4, s[32:35], s58 offen offset:0 lds
    v_mfma_f32_16x16x32_bf16 v[128:131], a[80:83], a[208:211], v[128:131]
    ds_read_b64_tr_b16 a[100:101], v18 offset:0
    ds_read_b64_tr_b16 a[102:103], v18 offset:1024
    v_mfma_f32_16x16x32_bf16 v[160:163], a[80:83], a[212:215], v[160:163]
    ds_read_b64_tr_b16 a[104:105], v19 offset:0
    ds_read_b64_tr_b16 a[106:107], v19 offset:1024
    v_mfma_f32_16x16x32_bf16 v[132:135], a[84:87], a[208:211], v[132:135]
    ds_read_b64_tr_b16 a[108:109], v20 offset:0
    ds_read_b64_tr_b16 a[110:111], v20 offset:1024
    v_mfma_f32_16x16x32_bf16 v[164:167], a[84:87], a[212:215], v[164:167]
    ds_read_b64_tr_b16 a[112:113], v21 offset:0
    ds_read_b64_tr_b16 a[114:115], v21 offset:1024
    v_mfma_f32_16x16x32_bf16 v[136:139], a[88:91], a[208:211], v[136:139]
    buffer_load_dwordx4 v5, s[32:35], s58 offen offset:1024 lds
    v_mfma_f32_16x16x32_bf16 v[168:171], a[88:91], a[212:215], v[168:171]
    ds_read_b64_tr_b16 a[116:117], v22 offset:0
    ds_read_b64_tr_b16 a[118:119], v22 offset:1024
    v_mfma_f32_16x16x32_bf16 v[140:143], a[92:95], a[208:211], v[140:143]
    ds_read_b64_tr_b16 a[120:121], v23 offset:0
    ds_read_b64_tr_b16 a[122:123], v23 offset:1024
    v_mfma_f32_16x16x32_bf16 v[172:175], a[92:95], a[212:215], v[172:175]
    s_waitcnt lgkmcnt(12)
    ds_read_b64_tr_b16 a[124:125], v24 offset:0
    ds_read_b64_tr_b16 a[126:127], v24 offset:1024
    v_mfma_f32_16x16x32_bf16 v[112:115], a[96:99], a[220:223], v[112:115]
    v_mfma_f32_16x16x32_bf16 v[144:147], a[96:99], a[224:227], v[144:147]
    buffer_load_dwordx4 v6, s[32:35], s58 offen offset:2048 lds
    v_mfma_f32_16x16x32_bf16 v[176:179], a[96:99], a[228:231], v[176:179]
    s_waitcnt lgkmcnt(12)
    ds_read_b128 a[8:11], v33 offset:0
    v_mfma_f32_16x16x32_bf16 v[116:119], a[100:103], a[220:223], v[116:119]
    ds_read_b128 a[12:15], v34 offset:0
    v_mfma_f32_16x16x32_bf16 v[148:151], a[100:103], a[224:227], v[148:151]
    v_mfma_f32_16x16x32_bf16 v[180:183], a[100:103], a[228:231], v[180:183]
    s_waitcnt lgkmcnt(12)
    v_mfma_f32_16x16x32_bf16 v[120:123], a[104:107], a[220:223], v[120:123]
    buffer_load_dwordx4 v7, s[32:35], s58 offen offset:3072 lds
    v_mfma_f32_16x16x32_bf16 v[152:155], a[104:107], a[224:227], v[152:155]
    s_waitcnt vmcnt(4) lgkmcnt(0)
    v_mfma_f32_16x16x32_bf16 v[184:187], a[104:107], a[228:231], v[184:187]
    s_barrier
    ds_read_b128 a[208:211], v25 offset:10240
    v_mfma_f32_16x16x32_bf16 v[124:127], a[108:111], a[220:223], v[124:127]
    s_mov_b32 s57, 384
    s_add_u32 m0, s56, 0
    ds_read_b128 a[212:215], v27 offset:10240
    v_mfma_f32_16x16x32_bf16 v[156:159], a[108:111], a[224:227], v[156:159]
    buffer_load_dwordx4 v8, s[20:23], s57 offen offset:0 lds
    v_mfma_f32_16x16x32_bf16 v[188:191], a[108:111], a[228:231], v[188:191]
    ds_read_b128 a[216:219], v29 offset:10240
    ds_read_b64_tr_b16 a[64:65], v17 offset:16384
    v_mfma_f32_16x16x32_bf16 v[128:131], a[112:115], a[220:223], v[128:131]
    buffer_load_dwordx4 v9, s[20:23], s57 offen offset:1024 lds
    v_mfma_f32_16x16x32_bf16 v[160:163], a[112:115], a[224:227], v[160:163]
    ds_read_b64_tr_b16 a[66:67], v17 offset:17408
    ds_read_b64_tr_b16 a[68:69], v18 offset:16384
    v_mfma_f32_16x16x32_bf16 v[132:135], a[116:119], a[220:223], v[132:135]
    ds_read_b64_tr_b16 a[70:71], v18 offset:17408
    ds_read_b64_tr_b16 a[72:73], v19 offset:16384
    v_mfma_f32_16x16x32_bf16 v[164:167], a[116:119], a[224:227], v[164:167]
    s_mov_b32 exec_hi, 0
    buffer_load_dwordx4 v10, s[20:23], s57 offen offset:2048 lds
    s_mov_b32 exec_hi, -1
    v_mfma_f32_16x16x32_bf16 v[136:139], a[120:123], a[220:223], v[136:139]
    s_mov_b32 s58, 1572864
    ds_read_b64_tr_b16 a[74:75], v19 offset:17408
    ds_read_b64_tr_b16 a[76:77], v20 offset:16384
    v_mfma_f32_16x16x32_bf16 v[168:171], a[120:123], a[224:227], v[168:171]
    s_add_u32 m0, s55, 114688
    ds_read_b64_tr_b16 a[78:79], v20 offset:17408
    ds_read_b64_tr_b16 a[80:81], v21 offset:16384
    v_mfma_f32_16x16x32_bf16 v[140:143], a[124:127], a[220:223], v[140:143]
    buffer_load_dwordx4 v4, s[32:35], s58 offen offset:0 lds
    v_mfma_f32_16x16x32_bf16 v[172:175], a[124:127], a[224:227], v[172:175]
    s_waitcnt lgkmcnt(7)
    ds_read_b64_tr_b16 a[82:83], v21 offset:17408
    ds_read_b64_tr_b16 a[84:85], v22 offset:16384
    v_mfma_f32_16x16x32_bf16 v[112:115], a[64:67], a[208:211], v[112:115]
    ds_read_b64_tr_b16 a[86:87], v22 offset:17408
    ds_read_b64_tr_b16 a[88:89], v23 offset:16384
    v_mfma_f32_16x16x32_bf16 v[144:147], a[64:67], a[212:215], v[144:147]
    buffer_load_dwordx4 v5, s[32:35], s58 offen offset:1024 lds
    v_mfma_f32_16x16x32_bf16 v[176:179], a[64:67], a[216:219], v[176:179]
    s_waitcnt lgkmcnt(9)
    ds_read_b64_tr_b16 a[90:91], v23 offset:17408
    ds_read_b64_tr_b16 a[92:93], v24 offset:16384
    v_mfma_f32_16x16x32_bf16 v[116:119], a[68:71], a[208:211], v[116:119]
    ds_read_b128 a[16:19], v31 offset:4096
    v_mfma_f32_16x16x32_bf16 v[148:151], a[68:71], a[212:215], v[148:151]
    ds_read_b128 a[20:23], v32 offset:4096
    buffer_load_dwordx4 v6, s[32:35], s58 offen offset:2048 lds
    v_mfma_f32_16x16x32_bf16 v[180:183], a[68:71], a[216:219], v[180:183]
    s_waitcnt lgkmcnt(11)
    ds_read_b64_tr_b16 a[94:95], v24 offset:17408
    v_mfma_f32_16x16x32_bf16 v[120:123], a[72:75], a[208:211], v[120:123]
    v_mfma_f32_16x16x32_bf16 v[152:155], a[72:75], a[212:215], v[152:155]
    s_waitcnt vmcnt(6) lgkmcnt(0)
    buffer_load_dwordx4 v7, s[32:35], s58 offen offset:3072 lds
    v_mfma_f32_16x16x32_bf16 v[184:187], a[72:75], a[216:219], v[184:187]
    s_barrier
    ds_read_b128 a[220:223], v26 offset:10240
    v_mfma_f32_16x16x32_bf16 v[124:127], a[76:79], a[208:211], v[124:127]
    s_mov_b32 s58, 1835008
    ds_read_b128 a[224:227], v28 offset:10240
    ds_read_b128 a[228:231], v30 offset:10240
    v_mfma_f32_16x16x32_bf16 v[156:159], a[76:79], a[212:215], v[156:159]
    s_add_u32 m0, s55, 131072
    ds_read_b64_tr_b16 a[96:97], v17 offset:32768
    ds_read_b64_tr_b16 a[98:99], v17 offset:33792
    v_mfma_f32_16x16x32_bf16 v[188:191], a[76:79], a[216:219], v[188:191]
    buffer_load_dwordx4 v4, s[32:35], s58 offen offset:0 lds
    v_mfma_f32_16x16x32_bf16 v[128:131], a[80:83], a[208:211], v[128:131]
    ds_read_b64_tr_b16 a[100:101], v18 offset:32768
    ds_read_b64_tr_b16 a[102:103], v18 offset:33792
    v_mfma_f32_16x16x32_bf16 v[160:163], a[80:83], a[212:215], v[160:163]
    ds_read_b64_tr_b16 a[104:105], v19 offset:32768
    ds_read_b64_tr_b16 a[106:107], v19 offset:33792
    v_mfma_f32_16x16x32_bf16 v[132:135], a[84:87], a[208:211], v[132:135]
    ds_read_b64_tr_b16 a[108:109], v20 offset:32768
    ds_read_b64_tr_b16 a[110:111], v20 offset:33792
    v_mfma_f32_16x16x32_bf16 v[164:167], a[84:87], a[212:215], v[164:167]
    ds_read_b64_tr_b16 a[112:113], v21 offset:32768
    ds_read_b64_tr_b16 a[114:115], v21 offset:33792
    v_mfma_f32_16x16x32_bf16 v[136:139], a[88:91], a[208:211], v[136:139]
    buffer_load_dwordx4 v5, s[32:35], s58 offen offset:1024 lds
    v_mfma_f32_16x16x32_bf16 v[168:171], a[88:91], a[212:215], v[168:171]
    ds_read_b64_tr_b16 a[116:117], v22 offset:32768
    ds_read_b64_tr_b16 a[118:119], v22 offset:33792
    v_mfma_f32_16x16x32_bf16 v[140:143], a[92:95], a[208:211], v[140:143]
    ds_read_b64_tr_b16 a[120:121], v23 offset:32768
    ds_read_b64_tr_b16 a[122:123], v23 offset:33792
    v_mfma_f32_16x16x32_bf16 v[172:175], a[92:95], a[212:215], v[172:175]
    s_waitcnt lgkmcnt(12)
    ds_read_b64_tr_b16 a[124:125], v24 offset:32768
    ds_read_b64_tr_b16 a[126:127], v24 offset:33792
    v_mfma_f32_16x16x32_bf16 v[112:115], a[96:99], a[220:223], v[112:115]
    v_mfma_f32_16x16x32_bf16 v[144:147], a[96:99], a[224:227], v[144:147]
    buffer_load_dwordx4 v6, s[32:35], s58 offen offset:2048 lds
    v_mfma_f32_16x16x32_bf16 v[176:179], a[96:99], a[228:231], v[176:179]
    s_waitcnt lgkmcnt(12)
    ds_read_b128 a[24:27], v33 offset:4096
    v_mfma_f32_16x16x32_bf16 v[116:119], a[100:103], a[220:223], v[116:119]
    ds_read_b128 a[28:31], v34 offset:4096
    v_mfma_f32_16x16x32_bf16 v[148:151], a[100:103], a[224:227], v[148:151]
    v_mfma_f32_16x16x32_bf16 v[180:183], a[100:103], a[228:231], v[180:183]
    s_waitcnt lgkmcnt(12)
    v_mfma_f32_16x16x32_bf16 v[120:123], a[104:107], a[220:223], v[120:123]
    buffer_load_dwordx4 v7, s[32:35], s58 offen offset:3072 lds
    v_mfma_f32_16x16x32_bf16 v[152:155], a[104:107], a[224:227], v[152:155]
    s_waitcnt vmcnt(4) lgkmcnt(0)
    v_mfma_f32_16x16x32_bf16 v[184:187], a[104:107], a[228:231], v[184:187]
    s_barrier
    ds_read_b128 a[208:211], v25 offset:0
    v_mfma_f32_16x16x32_bf16 v[124:127], a[108:111], a[220:223], v[124:127]
    s_mov_b32 s57, 512
    s_add_u32 m0, s56, 10240
    ds_read_b128 a[212:215], v27 offset:0
    v_mfma_f32_16x16x32_bf16 v[156:159], a[108:111], a[224:227], v[156:159]
    buffer_load_dwordx4 v8, s[20:23], s57 offen offset:0 lds
    v_mfma_f32_16x16x32_bf16 v[188:191], a[108:111], a[228:231], v[188:191]
    ds_read_b128 a[216:219], v29 offset:0
    ds_read_b64_tr_b16 a[64:65], v17 offset:0
    v_mfma_f32_16x16x32_bf16 v[128:131], a[112:115], a[220:223], v[128:131]
    buffer_load_dwordx4 v9, s[20:23], s57 offen offset:1024 lds
    v_mfma_f32_16x16x32_bf16 v[160:163], a[112:115], a[224:227], v[160:163]
    ds_read_b64_tr_b16 a[66:67], v17 offset:1024
    ds_read_b64_tr_b16 a[68:69], v18 offset:0
    v_mfma_f32_16x16x32_bf16 v[132:135], a[116:119], a[220:223], v[132:135]
    ds_read_b64_tr_b16 a[70:71], v18 offset:1024
    ds_read_b64_tr_b16 a[72:73], v19 offset:0
    v_mfma_f32_16x16x32_bf16 v[164:167], a[116:119], a[224:227], v[164:167]
    s_mov_b32 exec_hi, 0
    buffer_load_dwordx4 v10, s[20:23], s57 offen offset:2048 lds
    s_mov_b32 exec_hi, -1
    v_mfma_f32_16x16x32_bf16 v[136:139], a[120:123], a[220:223], v[136:139]
    s_mov_b32 s58, 2097152
    ds_read_b64_tr_b16 a[74:75], v19 offset:1024
    ds_read_b64_tr_b16 a[76:77], v20 offset:0
    v_mfma_f32_16x16x32_bf16 v[168:171], a[120:123], a[224:227], v[168:171]
    s_add_u32 m0, s55, 147456
    ds_read_b64_tr_b16 a[78:79], v20 offset:1024
    ds_read_b64_tr_b16 a[80:81], v21 offset:0
    v_mfma_f32_16x16x32_bf16 v[140:143], a[124:127], a[220:223], v[140:143]
    buffer_load_dwordx4 v4, s[32:35], s58 offen offset:0 lds
    v_mfma_f32_16x16x32_bf16 v[172:175], a[124:127], a[224:227], v[172:175]
    s_waitcnt lgkmcnt(7)
    ds_read_b64_tr_b16 a[82:83], v21 offset:1024
    ds_read_b64_tr_b16 a[84:85], v22 offset:0
    v_mfma_f32_16x16x32_bf16 v[112:115], a[64:67], a[208:211], v[112:115]
    ds_read_b64_tr_b16 a[86:87], v22 offset:1024
    ds_read_b64_tr_b16 a[88:89], v23 offset:0
    v_mfma_f32_16x16x32_bf16 v[144:147], a[64:67], a[212:215], v[144:147]
    buffer_load_dwordx4 v5, s[32:35], s58 offen offset:1024 lds
    v_mfma_f32_16x16x32_bf16 v[176:179], a[64:67], a[216:219], v[176:179]
    s_waitcnt lgkmcnt(9)
    ds_read_b64_tr_b16 a[90:91], v23 offset:1024
    ds_read_b64_tr_b16 a[92:93], v24 offset:0
    v_mfma_f32_16x16x32_bf16 v[116:119], a[68:71], a[208:211], v[116:119]
    ds_read_b128 a[32:35], v35 offset:0
    v_mfma_f32_16x16x32_bf16 v[148:151], a[68:71], a[212:215], v[148:151]
    ds_read_b128 a[36:39], v36 offset:0
    buffer_load_dwordx4 v6, s[32:35], s58 offen offset:2048 lds
    v_mfma_f32_16x16x32_bf16 v[180:183], a[68:71], a[216:219], v[180:183]
    s_waitcnt lgkmcnt(11)
    ds_read_b64_tr_b16 a[94:95], v24 offset:1024
    v_mfma_f32_16x16x32_bf16 v[120:123], a[72:75], a[208:211], v[120:123]
standalone__gqa_block_cached__near_ridge_b_h0_0:
    s_cbranch_execz standalone__gqa_block_cached__near_ridge_b_h0_4
    v_mfma_f32_16x16x32_bf16 v[152:155], a[72:75], a[212:215], v[152:155]
    s_waitcnt vmcnt(6) lgkmcnt(0)
    buffer_load_dwordx4 v7, s[32:35], s58 offen offset:3072 lds
    v_mfma_f32_16x16x32_bf16 v[184:187], a[72:75], a[216:219], v[184:187]
    s_barrier
    ds_read_b128 a[220:223], v26 offset:0
    v_mfma_f32_16x16x32_bf16 v[124:127], a[76:79], a[208:211], v[124:127]
    s_mov_b32 s58, 2359296
    ds_read_b128 a[224:227], v28 offset:0
    ds_read_b128 a[228:231], v30 offset:0
    v_mfma_f32_16x16x32_bf16 v[156:159], a[76:79], a[212:215], v[156:159]
    s_add_u32 m0, s55, 114688
    ds_read_b64_tr_b16 a[96:97], v17 offset:16384
    ds_read_b64_tr_b16 a[98:99], v17 offset:17408
    v_mfma_f32_16x16x32_bf16 v[188:191], a[76:79], a[216:219], v[188:191]
    buffer_load_dwordx4 v4, s[32:35], s58 offen offset:0 lds
    v_mfma_f32_16x16x32_bf16 v[128:131], a[80:83], a[208:211], v[128:131]
    ds_read_b64_tr_b16 a[100:101], v18 offset:16384
    ds_read_b64_tr_b16 a[102:103], v18 offset:17408
    v_mfma_f32_16x16x32_bf16 v[160:163], a[80:83], a[212:215], v[160:163]
    ds_read_b64_tr_b16 a[104:105], v19 offset:16384
    ds_read_b64_tr_b16 a[106:107], v19 offset:17408
    v_mfma_f32_16x16x32_bf16 v[132:135], a[84:87], a[208:211], v[132:135]
    ds_read_b64_tr_b16 a[108:109], v20 offset:16384
    ds_read_b64_tr_b16 a[110:111], v20 offset:17408
    v_mfma_f32_16x16x32_bf16 v[164:167], a[84:87], a[212:215], v[164:167]
    ds_read_b64_tr_b16 a[112:113], v21 offset:16384
    ds_read_b64_tr_b16 a[114:115], v21 offset:17408
    v_mfma_f32_16x16x32_bf16 v[136:139], a[88:91], a[208:211], v[136:139]
    buffer_load_dwordx4 v5, s[32:35], s58 offen offset:1024 lds
    v_mfma_f32_16x16x32_bf16 v[168:171], a[88:91], a[212:215], v[168:171]
    ds_read_b64_tr_b16 a[116:117], v22 offset:16384
    ds_read_b64_tr_b16 a[118:119], v22 offset:17408
    v_mfma_f32_16x16x32_bf16 v[140:143], a[92:95], a[208:211], v[140:143]
    ds_read_b64_tr_b16 a[120:121], v23 offset:16384
    ds_read_b64_tr_b16 a[122:123], v23 offset:17408
    v_mfma_f32_16x16x32_bf16 v[172:175], a[92:95], a[212:215], v[172:175]
    s_waitcnt lgkmcnt(12)
    ds_read_b64_tr_b16 a[124:125], v24 offset:16384
    ds_read_b64_tr_b16 a[126:127], v24 offset:17408
    v_mfma_f32_16x16x32_bf16 v[112:115], a[96:99], a[220:223], v[112:115]
    v_mfma_f32_16x16x32_bf16 v[144:147], a[96:99], a[224:227], v[144:147]
    buffer_load_dwordx4 v6, s[32:35], s58 offen offset:2048 lds
    v_mfma_f32_16x16x32_bf16 v[176:179], a[96:99], a[228:231], v[176:179]
    s_waitcnt lgkmcnt(12)
    ds_read_b128 a[40:43], v37 offset:0
    v_mfma_f32_16x16x32_bf16 v[116:119], a[100:103], a[220:223], v[116:119]
    ds_read_b128 a[44:47], v38 offset:0
    v_mfma_f32_16x16x32_bf16 v[148:151], a[100:103], a[224:227], v[148:151]
    v_mfma_f32_16x16x32_bf16 v[180:183], a[100:103], a[228:231], v[180:183]
    s_waitcnt lgkmcnt(12)
    v_mfma_f32_16x16x32_bf16 v[120:123], a[104:107], a[220:223], v[120:123]
    buffer_load_dwordx4 v7, s[32:35], s58 offen offset:3072 lds
    v_mfma_f32_16x16x32_bf16 v[152:155], a[104:107], a[224:227], v[152:155]
    s_waitcnt vmcnt(4) lgkmcnt(0)
    v_mfma_f32_16x16x32_bf16 v[184:187], a[104:107], a[228:231], v[184:187]
    s_barrier
    ds_read_b128 a[208:211], v25 offset:10240
    v_mfma_f32_16x16x32_bf16 v[124:127], a[108:111], a[220:223], v[124:127]
    s_mov_b32 s57, 640
    s_add_u32 m0, s56, 0
    ds_read_b128 a[212:215], v27 offset:10240
    v_mfma_f32_16x16x32_bf16 v[156:159], a[108:111], a[224:227], v[156:159]
    buffer_load_dwordx4 v8, s[20:23], s57 offen offset:0 lds
    v_mfma_f32_16x16x32_bf16 v[188:191], a[108:111], a[228:231], v[188:191]
    ds_read_b128 a[216:219], v29 offset:10240
    ds_read_b64_tr_b16 a[64:65], v17 offset:32768
    v_mfma_f32_16x16x32_bf16 v[128:131], a[112:115], a[220:223], v[128:131]
    buffer_load_dwordx4 v9, s[20:23], s57 offen offset:1024 lds
    v_mfma_f32_16x16x32_bf16 v[160:163], a[112:115], a[224:227], v[160:163]
    ds_read_b64_tr_b16 a[66:67], v17 offset:33792
    ds_read_b64_tr_b16 a[68:69], v18 offset:32768
    v_mfma_f32_16x16x32_bf16 v[132:135], a[116:119], a[220:223], v[132:135]
    ds_read_b64_tr_b16 a[70:71], v18 offset:33792
    ds_read_b64_tr_b16 a[72:73], v19 offset:32768
    v_mfma_f32_16x16x32_bf16 v[164:167], a[116:119], a[224:227], v[164:167]
    s_mov_b32 exec_hi, 0
    buffer_load_dwordx4 v10, s[20:23], s57 offen offset:2048 lds
    s_mov_b32 exec_hi, -1
    v_mfma_f32_16x16x32_bf16 v[136:139], a[120:123], a[220:223], v[136:139]
    s_mov_b32 s58, 2621440
    ds_read_b64_tr_b16 a[74:75], v19 offset:33792
    ds_read_b64_tr_b16 a[76:77], v20 offset:32768
    v_mfma_f32_16x16x32_bf16 v[168:171], a[120:123], a[224:227], v[168:171]
    s_add_u32 m0, s55, 131072
    ds_read_b64_tr_b16 a[78:79], v20 offset:33792
    ds_read_b64_tr_b16 a[80:81], v21 offset:32768
    v_mfma_f32_16x16x32_bf16 v[140:143], a[124:127], a[220:223], v[140:143]
    buffer_load_dwordx4 v4, s[32:35], s58 offen offset:0 lds
    v_mfma_f32_16x16x32_bf16 v[172:175], a[124:127], a[224:227], v[172:175]
    s_waitcnt lgkmcnt(7)
    ds_read_b64_tr_b16 a[82:83], v21 offset:33792
    ds_read_b64_tr_b16 a[84:85], v22 offset:32768
    v_mfma_f32_16x16x32_bf16 v[112:115], a[64:67], a[208:211], v[112:115]
    ds_read_b64_tr_b16 a[86:87], v22 offset:33792
    ds_read_b64_tr_b16 a[88:89], v23 offset:32768
    v_mfma_f32_16x16x32_bf16 v[144:147], a[64:67], a[212:215], v[144:147]
    buffer_load_dwordx4 v5, s[32:35], s58 offen offset:1024 lds
    v_mfma_f32_16x16x32_bf16 v[176:179], a[64:67], a[216:219], v[176:179]
    s_waitcnt lgkmcnt(9)
    ds_read_b64_tr_b16 a[90:91], v23 offset:33792
    ds_read_b64_tr_b16 a[92:93], v24 offset:32768
    v_mfma_f32_16x16x32_bf16 v[116:119], a[68:71], a[208:211], v[116:119]
    ds_read_b128 a[48:51], v35 offset:4096
    v_mfma_f32_16x16x32_bf16 v[148:151], a[68:71], a[212:215], v[148:151]
    ds_read_b128 a[52:55], v36 offset:4096
    buffer_load_dwordx4 v6, s[32:35], s58 offen offset:2048 lds
    v_mfma_f32_16x16x32_bf16 v[180:183], a[68:71], a[216:219], v[180:183]
    s_waitcnt lgkmcnt(11)
    ds_read_b64_tr_b16 a[94:95], v24 offset:33792
    v_mfma_f32_16x16x32_bf16 v[120:123], a[72:75], a[208:211], v[120:123]
    v_mfma_f32_16x16x32_bf16 v[152:155], a[72:75], a[212:215], v[152:155]
    s_waitcnt vmcnt(6) lgkmcnt(0)
    buffer_load_dwordx4 v7, s[32:35], s58 offen offset:3072 lds
    v_mfma_f32_16x16x32_bf16 v[184:187], a[72:75], a[216:219], v[184:187]
    s_barrier
    ds_read_b128 a[220:223], v26 offset:10240
    v_mfma_f32_16x16x32_bf16 v[124:127], a[76:79], a[208:211], v[124:127]
    s_mov_b32 s58, 2883584
    ds_read_b128 a[224:227], v28 offset:10240
    ds_read_b128 a[228:231], v30 offset:10240
    v_mfma_f32_16x16x32_bf16 v[156:159], a[76:79], a[212:215], v[156:159]
    s_add_u32 m0, s55, 147456
    ds_read_b64_tr_b16 a[96:97], v17 offset:0
    ds_read_b64_tr_b16 a[98:99], v17 offset:1024
    v_mfma_f32_16x16x32_bf16 v[188:191], a[76:79], a[216:219], v[188:191]
    buffer_load_dwordx4 v4, s[32:35], s58 offen offset:0 lds
    v_mfma_f32_16x16x32_bf16 v[128:131], a[80:83], a[208:211], v[128:131]
    ds_read_b64_tr_b16 a[100:101], v18 offset:0
    ds_read_b64_tr_b16 a[102:103], v18 offset:1024
    v_mfma_f32_16x16x32_bf16 v[160:163], a[80:83], a[212:215], v[160:163]
    ds_read_b64_tr_b16 a[104:105], v19 offset:0
    ds_read_b64_tr_b16 a[106:107], v19 offset:1024
    v_mfma_f32_16x16x32_bf16 v[132:135], a[84:87], a[208:211], v[132:135]
    ds_read_b64_tr_b16 a[108:109], v20 offset:0
    ds_read_b64_tr_b16 a[110:111], v20 offset:1024
    v_mfma_f32_16x16x32_bf16 v[164:167], a[84:87], a[212:215], v[164:167]
    ds_read_b64_tr_b16 a[112:113], v21 offset:0
    ds_read_b64_tr_b16 a[114:115], v21 offset:1024
    v_mfma_f32_16x16x32_bf16 v[136:139], a[88:91], a[208:211], v[136:139]
    buffer_load_dwordx4 v5, s[32:35], s58 offen offset:1024 lds
    v_mfma_f32_16x16x32_bf16 v[168:171], a[88:91], a[212:215], v[168:171]
    ds_read_b64_tr_b16 a[116:117], v22 offset:0
    ds_read_b64_tr_b16 a[118:119], v22 offset:1024
    v_mfma_f32_16x16x32_bf16 v[140:143], a[92:95], a[208:211], v[140:143]
    ds_read_b64_tr_b16 a[120:121], v23 offset:0
    ds_read_b64_tr_b16 a[122:123], v23 offset:1024
    v_mfma_f32_16x16x32_bf16 v[172:175], a[92:95], a[212:215], v[172:175]
    s_waitcnt lgkmcnt(12)
    ds_read_b64_tr_b16 a[124:125], v24 offset:0
    ds_read_b64_tr_b16 a[126:127], v24 offset:1024
    v_mfma_f32_16x16x32_bf16 v[112:115], a[96:99], a[220:223], v[112:115]
    v_mfma_f32_16x16x32_bf16 v[144:147], a[96:99], a[224:227], v[144:147]
    buffer_load_dwordx4 v6, s[32:35], s58 offen offset:2048 lds
    v_mfma_f32_16x16x32_bf16 v[176:179], a[96:99], a[228:231], v[176:179]
    s_waitcnt lgkmcnt(12)
    ds_read_b128 a[56:59], v37 offset:4096
    v_mfma_f32_16x16x32_bf16 v[116:119], a[100:103], a[220:223], v[116:119]
    ds_read_b128 a[60:63], v38 offset:4096
    v_mfma_f32_16x16x32_bf16 v[148:151], a[100:103], a[224:227], v[148:151]
    v_mfma_f32_16x16x32_bf16 v[180:183], a[100:103], a[228:231], v[180:183]
    s_waitcnt lgkmcnt(12)
    v_mfma_f32_16x16x32_bf16 v[120:123], a[104:107], a[220:223], v[120:123]
    buffer_load_dwordx4 v7, s[32:35], s58 offen offset:3072 lds
    v_mfma_f32_16x16x32_bf16 v[152:155], a[104:107], a[224:227], v[152:155]
    s_waitcnt vmcnt(4) lgkmcnt(0)
    v_mfma_f32_16x16x32_bf16 v[184:187], a[104:107], a[228:231], v[184:187]
    s_barrier
    ds_read_b128 a[208:211], v25 offset:0
    v_mfma_f32_16x16x32_bf16 v[124:127], a[108:111], a[220:223], v[124:127]
    s_mov_b32 s57, 768
    s_add_u32 m0, s56, 10240
    ds_read_b128 a[212:215], v27 offset:0
    v_mfma_f32_16x16x32_bf16 v[156:159], a[108:111], a[224:227], v[156:159]
    buffer_load_dwordx4 v8, s[20:23], s57 offen offset:0 lds
    v_mfma_f32_16x16x32_bf16 v[188:191], a[108:111], a[228:231], v[188:191]
    ds_read_b128 a[216:219], v29 offset:0
    ds_read_b64_tr_b16 a[64:65], v17 offset:16384
    v_mfma_f32_16x16x32_bf16 v[128:131], a[112:115], a[220:223], v[128:131]
    buffer_load_dwordx4 v9, s[20:23], s57 offen offset:1024 lds
    v_mfma_f32_16x16x32_bf16 v[160:163], a[112:115], a[224:227], v[160:163]
    ds_read_b64_tr_b16 a[66:67], v17 offset:17408
    ds_read_b64_tr_b16 a[68:69], v18 offset:16384
    v_mfma_f32_16x16x32_bf16 v[132:135], a[116:119], a[220:223], v[132:135]
    ds_read_b64_tr_b16 a[70:71], v18 offset:17408
    ds_read_b64_tr_b16 a[72:73], v19 offset:16384
    v_mfma_f32_16x16x32_bf16 v[164:167], a[116:119], a[224:227], v[164:167]
    s_mov_b32 exec_hi, 0
    buffer_load_dwordx4 v10, s[20:23], s57 offen offset:2048 lds
    s_mov_b32 exec_hi, -1
    v_mfma_f32_16x16x32_bf16 v[136:139], a[120:123], a[220:223], v[136:139]
    s_mov_b32 s58, 3145728
    ds_read_b64_tr_b16 a[74:75], v19 offset:17408
    ds_read_b64_tr_b16 a[76:77], v20 offset:16384
    v_mfma_f32_16x16x32_bf16 v[168:171], a[120:123], a[224:227], v[168:171]
    s_add_u32 m0, s55, 114688
    ds_read_b64_tr_b16 a[78:79], v20 offset:17408
    ds_read_b64_tr_b16 a[80:81], v21 offset:16384
    v_mfma_f32_16x16x32_bf16 v[140:143], a[124:127], a[220:223], v[140:143]
    buffer_load_dwordx4 v4, s[32:35], s58 offen offset:0 lds
    v_mfma_f32_16x16x32_bf16 v[172:175], a[124:127], a[224:227], v[172:175]
    s_waitcnt lgkmcnt(7)
    ds_read_b64_tr_b16 a[82:83], v21 offset:17408
    ds_read_b64_tr_b16 a[84:85], v22 offset:16384
    v_mfma_f32_16x16x32_bf16 v[112:115], a[64:67], a[208:211], v[112:115]
    ds_read_b64_tr_b16 a[86:87], v22 offset:17408
    ds_read_b64_tr_b16 a[88:89], v23 offset:16384
    v_mfma_f32_16x16x32_bf16 v[144:147], a[64:67], a[212:215], v[144:147]
    buffer_load_dwordx4 v5, s[32:35], s58 offen offset:1024 lds
    v_mfma_f32_16x16x32_bf16 v[176:179], a[64:67], a[216:219], v[176:179]
    s_waitcnt lgkmcnt(9)
    ds_read_b64_tr_b16 a[90:91], v23 offset:17408
    ds_read_b64_tr_b16 a[92:93], v24 offset:16384
    v_mfma_f32_16x16x32_bf16 v[116:119], a[68:71], a[208:211], v[116:119]
    ds_read_b64_tr_b16 a[94:95], v24 offset:17408
    v_mfma_f32_16x16x32_bf16 v[148:151], a[68:71], a[212:215], v[148:151]
    buffer_load_dwordx4 v6, s[32:35], s58 offen offset:2048 lds
    v_mfma_f32_16x16x32_bf16 v[180:183], a[68:71], a[216:219], v[180:183]
    s_waitcnt lgkmcnt(10)
    v_mfma_f32_16x16x32_bf16 v[120:123], a[72:75], a[208:211], v[120:123]
    v_mfma_f32_16x16x32_bf16 v[152:155], a[72:75], a[212:215], v[152:155]
    s_waitcnt vmcnt(6) lgkmcnt(0)
    buffer_load_dwordx4 v7, s[32:35], s58 offen offset:3072 lds
    v_mfma_f32_16x16x32_bf16 v[184:187], a[72:75], a[216:219], v[184:187]
    s_barrier
    ds_read_b128 a[220:223], v26 offset:0
    v_mfma_f32_16x16x32_bf16 v[124:127], a[76:79], a[208:211], v[124:127]
    s_mov_b32 s58, 3407872
    ds_read_b128 a[224:227], v28 offset:0
    ds_read_b128 a[228:231], v30 offset:0
    v_mfma_f32_16x16x32_bf16 v[156:159], a[76:79], a[212:215], v[156:159]
    s_add_u32 m0, s55, 131072
    ds_read_b64_tr_b16 a[96:97], v17 offset:32768
    ds_read_b64_tr_b16 a[98:99], v17 offset:33792
    v_mfma_f32_16x16x32_bf16 v[188:191], a[76:79], a[216:219], v[188:191]
    buffer_load_dwordx4 v4, s[32:35], s58 offen offset:0 lds
    v_mfma_f32_16x16x32_bf16 v[128:131], a[80:83], a[208:211], v[128:131]
    ds_read_b64_tr_b16 a[100:101], v18 offset:32768
    ds_read_b64_tr_b16 a[102:103], v18 offset:33792
    v_mfma_f32_16x16x32_bf16 v[160:163], a[80:83], a[212:215], v[160:163]
    ds_read_b64_tr_b16 a[104:105], v19 offset:32768
    ds_read_b64_tr_b16 a[106:107], v19 offset:33792
    v_mfma_f32_16x16x32_bf16 v[132:135], a[84:87], a[208:211], v[132:135]
    ds_read_b64_tr_b16 a[108:109], v20 offset:32768
    ds_read_b64_tr_b16 a[110:111], v20 offset:33792
    v_mfma_f32_16x16x32_bf16 v[164:167], a[84:87], a[212:215], v[164:167]
    ds_read_b64_tr_b16 a[112:113], v21 offset:32768
    ds_read_b64_tr_b16 a[114:115], v21 offset:33792
    v_mfma_f32_16x16x32_bf16 v[136:139], a[88:91], a[208:211], v[136:139]
    buffer_load_dwordx4 v5, s[32:35], s58 offen offset:1024 lds
    v_mfma_f32_16x16x32_bf16 v[168:171], a[88:91], a[212:215], v[168:171]
    ds_read_b64_tr_b16 a[116:117], v22 offset:32768
    ds_read_b64_tr_b16 a[118:119], v22 offset:33792
    v_mfma_f32_16x16x32_bf16 v[140:143], a[92:95], a[208:211], v[140:143]
    ds_read_b64_tr_b16 a[120:121], v23 offset:32768
    ds_read_b64_tr_b16 a[122:123], v23 offset:33792
    v_mfma_f32_16x16x32_bf16 v[172:175], a[92:95], a[212:215], v[172:175]
    s_waitcnt lgkmcnt(12)
    ds_read_b64_tr_b16 a[124:125], v24 offset:32768
    ds_read_b64_tr_b16 a[126:127], v24 offset:33792
    v_mfma_f32_16x16x32_bf16 v[112:115], a[96:99], a[220:223], v[112:115]
    v_mfma_f32_16x16x32_bf16 v[144:147], a[96:99], a[224:227], v[144:147]
    buffer_load_dwordx4 v6, s[32:35], s58 offen offset:2048 lds
    v_mfma_f32_16x16x32_bf16 v[176:179], a[96:99], a[228:231], v[176:179]
    s_waitcnt lgkmcnt(12)
    v_mfma_f32_16x16x32_bf16 v[116:119], a[100:103], a[220:223], v[116:119]
    v_mfma_f32_16x16x32_bf16 v[148:151], a[100:103], a[224:227], v[148:151]
    v_mfma_f32_16x16x32_bf16 v[180:183], a[100:103], a[228:231], v[180:183]
    s_waitcnt lgkmcnt(10)
    v_mfma_f32_16x16x32_bf16 v[120:123], a[104:107], a[220:223], v[120:123]
    buffer_load_dwordx4 v7, s[32:35], s58 offen offset:3072 lds
    v_mfma_f32_16x16x32_bf16 v[152:155], a[104:107], a[224:227], v[152:155]
    s_waitcnt vmcnt(4) lgkmcnt(0)
    v_mfma_f32_16x16x32_bf16 v[184:187], a[104:107], a[228:231], v[184:187]
    s_barrier
    ds_read_b128 a[208:211], v25 offset:10240
    v_mfma_f32_16x16x32_bf16 v[124:127], a[108:111], a[220:223], v[124:127]
    s_mov_b32 s57, 896
    s_add_u32 m0, s56, 0
    ds_read_b128 a[212:215], v27 offset:10240
    v_mfma_f32_16x16x32_bf16 v[156:159], a[108:111], a[224:227], v[156:159]
    buffer_load_dwordx4 v8, s[20:23], s57 offen offset:0 lds
    v_mfma_f32_16x16x32_bf16 v[188:191], a[108:111], a[228:231], v[188:191]
    ds_read_b128 a[216:219], v29 offset:10240
    ds_read_b64_tr_b16 a[64:65], v17 offset:0
    v_mfma_f32_16x16x32_bf16 v[128:131], a[112:115], a[220:223], v[128:131]
    buffer_load_dwordx4 v9, s[20:23], s57 offen offset:1024 lds
    v_mfma_f32_16x16x32_bf16 v[160:163], a[112:115], a[224:227], v[160:163]
    ds_read_b64_tr_b16 a[66:67], v17 offset:1024
    ds_read_b64_tr_b16 a[68:69], v18 offset:0
    v_mfma_f32_16x16x32_bf16 v[132:135], a[116:119], a[220:223], v[132:135]
    ds_read_b64_tr_b16 a[70:71], v18 offset:1024
    ds_read_b64_tr_b16 a[72:73], v19 offset:0
    v_mfma_f32_16x16x32_bf16 v[164:167], a[116:119], a[224:227], v[164:167]
    s_mov_b32 exec_hi, 0
    buffer_load_dwordx4 v10, s[20:23], s57 offen offset:2048 lds
    s_mov_b32 exec_hi, -1
    v_mfma_f32_16x16x32_bf16 v[136:139], a[120:123], a[220:223], v[136:139]
    s_mov_b32 s58, 3670016
    ds_read_b64_tr_b16 a[74:75], v19 offset:1024
    ds_read_b64_tr_b16 a[76:77], v20 offset:0
    v_mfma_f32_16x16x32_bf16 v[168:171], a[120:123], a[224:227], v[168:171]
    s_add_u32 m0, s55, 147456
    ds_read_b64_tr_b16 a[78:79], v20 offset:1024
    ds_read_b64_tr_b16 a[80:81], v21 offset:0
    v_mfma_f32_16x16x32_bf16 v[140:143], a[124:127], a[220:223], v[140:143]
    buffer_load_dwordx4 v4, s[32:35], s58 offen offset:0 lds
    v_mfma_f32_16x16x32_bf16 v[172:175], a[124:127], a[224:227], v[172:175]
    s_waitcnt lgkmcnt(7)
    ds_read_b64_tr_b16 a[82:83], v21 offset:1024
    ds_read_b64_tr_b16 a[84:85], v22 offset:0
    v_mfma_f32_16x16x32_bf16 v[112:115], a[64:67], a[208:211], v[112:115]
    ds_read_b64_tr_b16 a[86:87], v22 offset:1024
    ds_read_b64_tr_b16 a[88:89], v23 offset:0
    v_mfma_f32_16x16x32_bf16 v[144:147], a[64:67], a[212:215], v[144:147]
    buffer_load_dwordx4 v5, s[32:35], s58 offen offset:1024 lds
    v_mfma_f32_16x16x32_bf16 v[176:179], a[64:67], a[216:219], v[176:179]
    s_waitcnt lgkmcnt(9)
    ds_read_b64_tr_b16 a[90:91], v23 offset:1024
    ds_read_b64_tr_b16 a[92:93], v24 offset:0
    v_mfma_f32_16x16x32_bf16 v[116:119], a[68:71], a[208:211], v[116:119]
    ds_read_b64_tr_b16 a[94:95], v24 offset:1024
    v_mfma_f32_16x16x32_bf16 v[148:151], a[68:71], a[212:215], v[148:151]
    buffer_load_dwordx4 v6, s[32:35], s58 offen offset:2048 lds
    v_mfma_f32_16x16x32_bf16 v[180:183], a[68:71], a[216:219], v[180:183]
    s_waitcnt lgkmcnt(10)
    v_mfma_f32_16x16x32_bf16 v[120:123], a[72:75], a[208:211], v[120:123]
    v_mfma_f32_16x16x32_bf16 v[152:155], a[72:75], a[212:215], v[152:155]
    s_waitcnt vmcnt(6) lgkmcnt(0)
    buffer_load_dwordx4 v7, s[32:35], s58 offen offset:3072 lds
    v_mfma_f32_16x16x32_bf16 v[184:187], a[72:75], a[216:219], v[184:187]
    s_barrier
    ds_read_b128 a[220:223], v26 offset:10240
    v_mfma_f32_16x16x32_bf16 v[124:127], a[76:79], a[208:211], v[124:127]
    s_mov_b32 s58, 3932160
    ds_read_b128 a[224:227], v28 offset:10240
    ds_read_b128 a[228:231], v30 offset:10240
    v_mfma_f32_16x16x32_bf16 v[156:159], a[76:79], a[212:215], v[156:159]
    s_add_u32 m0, s55, 114688
    ds_read_b64_tr_b16 a[96:97], v17 offset:16384
    ds_read_b64_tr_b16 a[98:99], v17 offset:17408
    v_mfma_f32_16x16x32_bf16 v[188:191], a[76:79], a[216:219], v[188:191]
    buffer_load_dwordx4 v4, s[32:35], s58 offen offset:0 lds
    v_mfma_f32_16x16x32_bf16 v[128:131], a[80:83], a[208:211], v[128:131]
    ds_read_b64_tr_b16 a[100:101], v18 offset:16384
    ds_read_b64_tr_b16 a[102:103], v18 offset:17408
    v_mfma_f32_16x16x32_bf16 v[160:163], a[80:83], a[212:215], v[160:163]
    ds_read_b64_tr_b16 a[104:105], v19 offset:16384
    ds_read_b64_tr_b16 a[106:107], v19 offset:17408
    v_mfma_f32_16x16x32_bf16 v[132:135], a[84:87], a[208:211], v[132:135]
    ds_read_b64_tr_b16 a[108:109], v20 offset:16384
    ds_read_b64_tr_b16 a[110:111], v20 offset:17408
    v_mfma_f32_16x16x32_bf16 v[164:167], a[84:87], a[212:215], v[164:167]
    ds_read_b64_tr_b16 a[112:113], v21 offset:16384
    ds_read_b64_tr_b16 a[114:115], v21 offset:17408
    v_mfma_f32_16x16x32_bf16 v[136:139], a[88:91], a[208:211], v[136:139]
    buffer_load_dwordx4 v5, s[32:35], s58 offen offset:1024 lds
    v_mfma_f32_16x16x32_bf16 v[168:171], a[88:91], a[212:215], v[168:171]
    ds_read_b64_tr_b16 a[116:117], v22 offset:16384
    ds_read_b64_tr_b16 a[118:119], v22 offset:17408
    v_mfma_f32_16x16x32_bf16 v[140:143], a[92:95], a[208:211], v[140:143]
    ds_read_b64_tr_b16 a[120:121], v23 offset:16384
    ds_read_b64_tr_b16 a[122:123], v23 offset:17408
    v_mfma_f32_16x16x32_bf16 v[172:175], a[92:95], a[212:215], v[172:175]
    s_waitcnt lgkmcnt(12)
    ds_read_b64_tr_b16 a[124:125], v24 offset:16384
    ds_read_b64_tr_b16 a[126:127], v24 offset:17408
    v_mfma_f32_16x16x32_bf16 v[112:115], a[96:99], a[220:223], v[112:115]
    v_mfma_f32_16x16x32_bf16 v[144:147], a[96:99], a[224:227], v[144:147]
    buffer_load_dwordx4 v6, s[32:35], s58 offen offset:2048 lds
    v_mfma_f32_16x16x32_bf16 v[176:179], a[96:99], a[228:231], v[176:179]
    s_waitcnt lgkmcnt(12)
    v_mfma_f32_16x16x32_bf16 v[116:119], a[100:103], a[220:223], v[116:119]
    v_mfma_f32_16x16x32_bf16 v[148:151], a[100:103], a[224:227], v[148:151]
    v_mfma_f32_16x16x32_bf16 v[180:183], a[100:103], a[228:231], v[180:183]
    s_waitcnt lgkmcnt(10)
    v_mfma_f32_16x16x32_bf16 v[120:123], a[104:107], a[220:223], v[120:123]
    buffer_load_dwordx4 v7, s[32:35], s58 offen offset:3072 lds
    v_mfma_f32_16x16x32_bf16 v[152:155], a[104:107], a[224:227], v[152:155]
    s_waitcnt vmcnt(4) lgkmcnt(0)
    v_mfma_f32_16x16x32_bf16 v[184:187], a[104:107], a[228:231], v[184:187]
    s_barrier
    ds_read_b128 a[208:211], v25 offset:0
    v_mfma_f32_16x16x32_bf16 v[124:127], a[108:111], a[220:223], v[124:127]
    s_mov_b32 s57, 1024
    s_add_u32 m0, s56, 10240
    ds_read_b128 a[212:215], v27 offset:0
    v_mfma_f32_16x16x32_bf16 v[156:159], a[108:111], a[224:227], v[156:159]
    buffer_load_dwordx4 v8, s[20:23], s57 offen offset:0 lds
    v_mfma_f32_16x16x32_bf16 v[188:191], a[108:111], a[228:231], v[188:191]
    ds_read_b128 a[216:219], v29 offset:0
    ds_read_b64_tr_b16 a[64:65], v17 offset:32768
    v_mfma_f32_16x16x32_bf16 v[128:131], a[112:115], a[220:223], v[128:131]
    buffer_load_dwordx4 v9, s[20:23], s57 offen offset:1024 lds
    v_mfma_f32_16x16x32_bf16 v[160:163], a[112:115], a[224:227], v[160:163]
    ds_read_b64_tr_b16 a[66:67], v17 offset:33792
    ds_read_b64_tr_b16 a[68:69], v18 offset:32768
    v_mfma_f32_16x16x32_bf16 v[132:135], a[116:119], a[220:223], v[132:135]
    ds_read_b64_tr_b16 a[70:71], v18 offset:33792
    ds_read_b64_tr_b16 a[72:73], v19 offset:32768
    v_mfma_f32_16x16x32_bf16 v[164:167], a[116:119], a[224:227], v[164:167]
    s_mov_b32 exec_hi, 0
    buffer_load_dwordx4 v10, s[20:23], s57 offen offset:2048 lds
    s_mov_b32 exec_hi, -1
    v_mfma_f32_16x16x32_bf16 v[136:139], a[120:123], a[220:223], v[136:139]
    s_mov_b32 s58, 4194304
    ds_read_b64_tr_b16 a[74:75], v19 offset:33792
    ds_read_b64_tr_b16 a[76:77], v20 offset:32768
    v_mfma_f32_16x16x32_bf16 v[168:171], a[120:123], a[224:227], v[168:171]
    s_add_u32 m0, s55, 131072
    ds_read_b64_tr_b16 a[78:79], v20 offset:33792
    ds_read_b64_tr_b16 a[80:81], v21 offset:32768
    v_mfma_f32_16x16x32_bf16 v[140:143], a[124:127], a[220:223], v[140:143]
    buffer_load_dwordx4 v4, s[32:35], s58 offen offset:0 lds
    v_mfma_f32_16x16x32_bf16 v[172:175], a[124:127], a[224:227], v[172:175]
    s_waitcnt lgkmcnt(7)
    ds_read_b64_tr_b16 a[82:83], v21 offset:33792
    ds_read_b64_tr_b16 a[84:85], v22 offset:32768
    v_mfma_f32_16x16x32_bf16 v[112:115], a[64:67], a[208:211], v[112:115]
    ds_read_b64_tr_b16 a[86:87], v22 offset:33792
    ds_read_b64_tr_b16 a[88:89], v23 offset:32768
    v_mfma_f32_16x16x32_bf16 v[144:147], a[64:67], a[212:215], v[144:147]
    buffer_load_dwordx4 v5, s[32:35], s58 offen offset:1024 lds
    v_mfma_f32_16x16x32_bf16 v[176:179], a[64:67], a[216:219], v[176:179]
    s_waitcnt lgkmcnt(9)
    ds_read_b64_tr_b16 a[90:91], v23 offset:33792
    ds_read_b64_tr_b16 a[92:93], v24 offset:32768
    v_mfma_f32_16x16x32_bf16 v[116:119], a[68:71], a[208:211], v[116:119]
    ds_read_b64_tr_b16 a[94:95], v24 offset:33792
    v_mfma_f32_16x16x32_bf16 v[148:151], a[68:71], a[212:215], v[148:151]
    buffer_load_dwordx4 v6, s[32:35], s58 offen offset:2048 lds
    v_mfma_f32_16x16x32_bf16 v[180:183], a[68:71], a[216:219], v[180:183]
    s_waitcnt lgkmcnt(10)
    v_mfma_f32_16x16x32_bf16 v[120:123], a[72:75], a[208:211], v[120:123]
    v_mfma_f32_16x16x32_bf16 v[152:155], a[72:75], a[212:215], v[152:155]
    s_waitcnt vmcnt(6) lgkmcnt(0)
    buffer_load_dwordx4 v7, s[32:35], s58 offen offset:3072 lds
    v_mfma_f32_16x16x32_bf16 v[184:187], a[72:75], a[216:219], v[184:187]
    s_barrier
    ds_read_b128 a[220:223], v26 offset:0
    v_mfma_f32_16x16x32_bf16 v[124:127], a[76:79], a[208:211], v[124:127]
    s_mov_b32 s58, 4456448
    ds_read_b128 a[224:227], v28 offset:0
    ds_read_b128 a[228:231], v30 offset:0
    v_mfma_f32_16x16x32_bf16 v[156:159], a[76:79], a[212:215], v[156:159]
    s_add_u32 m0, s55, 147456
    ds_read_b64_tr_b16 a[96:97], v17 offset:0
    ds_read_b64_tr_b16 a[98:99], v17 offset:1024
    v_mfma_f32_16x16x32_bf16 v[188:191], a[76:79], a[216:219], v[188:191]
    buffer_load_dwordx4 v4, s[32:35], s58 offen offset:0 lds
    v_mfma_f32_16x16x32_bf16 v[128:131], a[80:83], a[208:211], v[128:131]
    ds_read_b64_tr_b16 a[100:101], v18 offset:0
    ds_read_b64_tr_b16 a[102:103], v18 offset:1024
    v_mfma_f32_16x16x32_bf16 v[160:163], a[80:83], a[212:215], v[160:163]
    ds_read_b64_tr_b16 a[104:105], v19 offset:0
    ds_read_b64_tr_b16 a[106:107], v19 offset:1024
    v_mfma_f32_16x16x32_bf16 v[132:135], a[84:87], a[208:211], v[132:135]
    ds_read_b64_tr_b16 a[108:109], v20 offset:0
    ds_read_b64_tr_b16 a[110:111], v20 offset:1024
    v_mfma_f32_16x16x32_bf16 v[164:167], a[84:87], a[212:215], v[164:167]
    ds_read_b64_tr_b16 a[112:113], v21 offset:0
    ds_read_b64_tr_b16 a[114:115], v21 offset:1024
    v_mfma_f32_16x16x32_bf16 v[136:139], a[88:91], a[208:211], v[136:139]
    buffer_load_dwordx4 v5, s[32:35], s58 offen offset:1024 lds
    v_mfma_f32_16x16x32_bf16 v[168:171], a[88:91], a[212:215], v[168:171]
    ds_read_b64_tr_b16 a[116:117], v22 offset:0
    ds_read_b64_tr_b16 a[118:119], v22 offset:1024
    v_mfma_f32_16x16x32_bf16 v[140:143], a[92:95], a[208:211], v[140:143]
    ds_read_b64_tr_b16 a[120:121], v23 offset:0
    ds_read_b64_tr_b16 a[122:123], v23 offset:1024
    v_mfma_f32_16x16x32_bf16 v[172:175], a[92:95], a[212:215], v[172:175]
    s_waitcnt lgkmcnt(12)
    ds_read_b64_tr_b16 a[124:125], v24 offset:0
    ds_read_b64_tr_b16 a[126:127], v24 offset:1024
    v_mfma_f32_16x16x32_bf16 v[112:115], a[96:99], a[220:223], v[112:115]
    v_mfma_f32_16x16x32_bf16 v[144:147], a[96:99], a[224:227], v[144:147]
    buffer_load_dwordx4 v6, s[32:35], s58 offen offset:2048 lds
    v_mfma_f32_16x16x32_bf16 v[176:179], a[96:99], a[228:231], v[176:179]
    s_waitcnt lgkmcnt(12)
    v_mfma_f32_16x16x32_bf16 v[116:119], a[100:103], a[220:223], v[116:119]
    v_mfma_f32_16x16x32_bf16 v[148:151], a[100:103], a[224:227], v[148:151]
    v_mfma_f32_16x16x32_bf16 v[180:183], a[100:103], a[228:231], v[180:183]
    s_waitcnt lgkmcnt(10)
    v_mfma_f32_16x16x32_bf16 v[120:123], a[104:107], a[220:223], v[120:123]
    buffer_load_dwordx4 v7, s[32:35], s58 offen offset:3072 lds
    v_mfma_f32_16x16x32_bf16 v[152:155], a[104:107], a[224:227], v[152:155]
    s_waitcnt vmcnt(4) lgkmcnt(0)
    v_mfma_f32_16x16x32_bf16 v[184:187], a[104:107], a[228:231], v[184:187]
    s_barrier
    ds_read_b128 a[208:211], v25 offset:10240
    v_mfma_f32_16x16x32_bf16 v[124:127], a[108:111], a[220:223], v[124:127]
    s_add_u32 s58, s55, 49152
    ds_read_b128 a[212:215], v27 offset:10240
    ds_read_b128 a[216:219], v29 offset:10240
    v_mfma_f32_16x16x32_bf16 v[156:159], a[108:111], a[224:227], v[156:159]
    s_add_u32 m0, s55, 0
    ds_read_b64_tr_b16 a[64:65], v17 offset:16384
    ds_read_b64_tr_b16 a[66:67], v17 offset:17408
    v_mfma_f32_16x16x32_bf16 v[188:191], a[108:111], a[228:231], v[188:191]
    buffer_load_dwordx4 v11, s[24:27], s58 offen offset:0 nt lds
    v_mfma_f32_16x16x32_bf16 v[128:131], a[112:115], a[220:223], v[128:131]
    ds_read_b64_tr_b16 a[68:69], v18 offset:16384
    ds_read_b64_tr_b16 a[70:71], v18 offset:17408
    v_mfma_f32_16x16x32_bf16 v[160:163], a[112:115], a[224:227], v[160:163]
    ds_read_b64_tr_b16 a[72:73], v19 offset:16384
    ds_read_b64_tr_b16 a[74:75], v19 offset:17408
    v_mfma_f32_16x16x32_bf16 v[132:135], a[116:119], a[220:223], v[132:135]
    ds_read_b64_tr_b16 a[76:77], v20 offset:16384
    ds_read_b64_tr_b16 a[78:79], v20 offset:17408
    v_mfma_f32_16x16x32_bf16 v[164:167], a[116:119], a[224:227], v[164:167]
    ds_read_b64_tr_b16 a[80:81], v21 offset:16384
    ds_read_b64_tr_b16 a[82:83], v21 offset:17408
    v_mfma_f32_16x16x32_bf16 v[136:139], a[120:123], a[220:223], v[136:139]
    buffer_load_dwordx4 v12, s[24:27], s58 offen offset:1024 nt lds
    v_mfma_f32_16x16x32_bf16 v[168:171], a[120:123], a[224:227], v[168:171]
    ds_read_b64_tr_b16 a[84:85], v22 offset:16384
    ds_read_b64_tr_b16 a[86:87], v22 offset:17408
    v_mfma_f32_16x16x32_bf16 v[140:143], a[124:127], a[220:223], v[140:143]
    ds_read_b64_tr_b16 a[88:89], v23 offset:16384
    ds_read_b64_tr_b16 a[90:91], v23 offset:17408
    v_mfma_f32_16x16x32_bf16 v[172:175], a[124:127], a[224:227], v[172:175]
    s_waitcnt lgkmcnt(12)
    ds_read_b64_tr_b16 a[92:93], v24 offset:16384
    ds_read_b64_tr_b16 a[94:95], v24 offset:17408
    v_mfma_f32_16x16x32_bf16 v[112:115], a[64:67], a[208:211], v[112:115]
    v_mfma_f32_16x16x32_bf16 v[144:147], a[64:67], a[212:215], v[144:147]
    buffer_load_dwordx4 v13, s[24:27], s58 offen offset:2048 nt lds
    v_mfma_f32_16x16x32_bf16 v[176:179], a[64:67], a[216:219], v[176:179]
    s_waitcnt lgkmcnt(12)
    v_mfma_f32_16x16x32_bf16 v[116:119], a[68:71], a[208:211], v[116:119]
    v_mfma_f32_16x16x32_bf16 v[148:151], a[68:71], a[212:215], v[148:151]
    v_mfma_f32_16x16x32_bf16 v[180:183], a[68:71], a[216:219], v[180:183]
    s_waitcnt lgkmcnt(10)
    v_mfma_f32_16x16x32_bf16 v[120:123], a[72:75], a[208:211], v[120:123]
    buffer_load_dwordx4 v14, s[24:27], s58 offen offset:3072 nt lds
    v_mfma_f32_16x16x32_bf16 v[152:155], a[72:75], a[212:215], v[152:155]
    s_waitcnt vmcnt(4) lgkmcnt(0)
    v_mfma_f32_16x16x32_bf16 v[184:187], a[72:75], a[216:219], v[184:187]
    s_barrier
    ds_read_b128 a[220:223], v26 offset:10240
    v_mfma_f32_16x16x32_bf16 v[124:127], a[76:79], a[208:211], v[124:127]
    ds_read_b128 a[224:227], v28 offset:10240
    ds_read_b128 a[228:231], v30 offset:10240
    v_mfma_f32_16x16x32_bf16 v[156:159], a[76:79], a[212:215], v[156:159]
standalone__gqa_block_cached__near_ridge_b_h0_1:
    s_cbranch_execz standalone__gqa_block_cached__near_ridge_b_h0_r
    ds_read_b64_tr_b16 a[96:97], v17 offset:32768
    ds_read_b64_tr_b16 a[98:99], v17 offset:33792
    v_mfma_f32_16x16x32_bf16 v[188:191], a[76:79], a[216:219], v[188:191]
    ds_read_b64_tr_b16 a[100:101], v18 offset:32768
    ds_read_b64_tr_b16 a[102:103], v18 offset:33792
    v_mfma_f32_16x16x32_bf16 v[128:131], a[80:83], a[208:211], v[128:131]
    ds_read_b64_tr_b16 a[104:105], v19 offset:32768
    ds_read_b64_tr_b16 a[106:107], v19 offset:33792
    v_mfma_f32_16x16x32_bf16 v[160:163], a[80:83], a[212:215], v[160:163]
    ds_read_b64_tr_b16 a[108:109], v20 offset:32768
    ds_read_b64_tr_b16 a[110:111], v20 offset:33792
    v_mfma_f32_16x16x32_bf16 v[132:135], a[84:87], a[208:211], v[132:135]
    ds_read_b64_tr_b16 a[112:113], v21 offset:32768
    ds_read_b64_tr_b16 a[114:115], v21 offset:33792
    v_mfma_f32_16x16x32_bf16 v[164:167], a[84:87], a[212:215], v[164:167]
    ds_read_b64_tr_b16 a[116:117], v22 offset:32768
    ds_read_b64_tr_b16 a[118:119], v22 offset:33792
    v_mfma_f32_16x16x32_bf16 v[136:139], a[88:91], a[208:211], v[136:139]
    ds_read_b64_tr_b16 a[120:121], v23 offset:32768
    ds_read_b64_tr_b16 a[122:123], v23 offset:33792
    v_mfma_f32_16x16x32_bf16 v[168:171], a[88:91], a[212:215], v[168:171]
    ds_read_b64_tr_b16 a[124:125], v24 offset:32768
    ds_read_b64_tr_b16 a[126:127], v24 offset:33792
    v_mfma_f32_16x16x32_bf16 v[140:143], a[92:95], a[208:211], v[140:143]
    v_mfma_f32_16x16x32_bf16 v[172:175], a[92:95], a[212:215], v[172:175]
    s_waitcnt lgkmcnt(12)
    v_mfma_f32_16x16x32_bf16 v[112:115], a[96:99], a[220:223], v[112:115]
    v_mfma_f32_16x16x32_bf16 v[144:147], a[96:99], a[224:227], v[144:147]
    v_mfma_f32_16x16x32_bf16 v[176:179], a[96:99], a[228:231], v[176:179]
    v_mfma_f32_16x16x32_bf16 v[116:119], a[100:103], a[220:223], v[116:119]
    v_mfma_f32_16x16x32_bf16 v[148:151], a[100:103], a[224:227], v[148:151]
    v_mfma_f32_16x16x32_bf16 v[180:183], a[100:103], a[228:231], v[180:183]
    s_waitcnt lgkmcnt(10)
    v_mfma_f32_16x16x32_bf16 v[120:123], a[104:107], a[220:223], v[120:123]
    v_mfma_f32_16x16x32_bf16 v[152:155], a[104:107], a[224:227], v[152:155]
    v_mfma_f32_16x16x32_bf16 v[184:187], a[104:107], a[228:231], v[184:187]
    s_waitcnt lgkmcnt(8)
    v_mfma_f32_16x16x32_bf16 v[124:127], a[108:111], a[220:223], v[124:127]
    v_mfma_f32_16x16x32_bf16 v[156:159], a[108:111], a[224:227], v[156:159]
    v_mfma_f32_16x16x32_bf16 v[188:191], a[108:111], a[228:231], v[188:191]
    s_waitcnt lgkmcnt(6)
    v_mfma_f32_16x16x32_bf16 v[128:131], a[112:115], a[220:223], v[128:131]
    v_mfma_f32_16x16x32_bf16 v[160:163], a[112:115], a[224:227], v[160:163]
    s_waitcnt lgkmcnt(4)
    v_mfma_f32_16x16x32_bf16 v[132:135], a[116:119], a[220:223], v[132:135]
    v_mfma_f32_16x16x32_bf16 v[164:167], a[116:119], a[224:227], v[164:167]
    s_waitcnt lgkmcnt(2)
    v_mfma_f32_16x16x32_bf16 v[136:139], a[120:123], a[220:223], v[136:139]
    v_mfma_f32_16x16x32_bf16 v[168:171], a[120:123], a[224:227], v[168:171]
    s_waitcnt lgkmcnt(0)
    v_mfma_f32_16x16x32_bf16 v[140:143], a[124:127], a[220:223], v[140:143]
    v_mfma_f32_16x16x32_bf16 v[172:175], a[124:127], a[224:227], v[172:175]
    s_lshl_b32 s57, s48, 11
    s_add_u32 s57, s57, 114688
    v_add_u32 v55, s57, v3
    v_xor_b32 v56, 2048, v55
    v_pk_mul_f32 v[176:177], v[176:177], s[60:61]
    v_pk_mul_f32 v[178:179], v[178:179], s[60:61]
    v_pk_mul_f32 v[180:181], v[180:181], s[60:61]
    v_pk_mul_f32 v[182:183], v[182:183], s[60:61]
    v_cvt_pk_bf16_f32 v96, v176, v177
    v_cvt_pk_bf16_f32 v97, v178, v179
    v_cvt_pk_bf16_f32 v98, v180, v181
    v_cvt_pk_bf16_f32 v99, v182, v183
    v_pk_mul_f32 v[184:185], v[184:185], s[60:61]
    v_pk_mul_f32 v[186:187], v[186:187], s[60:61]
    v_pk_mul_f32 v[188:189], v[188:189], s[60:61]
    v_pk_mul_f32 v[190:191], v[190:191], s[60:61]
    v_cvt_pk_bf16_f32 v100, v184, v185
    v_cvt_pk_bf16_f32 v101, v186, v187
    v_cvt_pk_bf16_f32 v102, v188, v189
    v_cvt_pk_bf16_f32 v103, v190, v191
    v_permlane16_swap_b32 v96, v98
    v_permlane16_swap_b32 v97, v99
    ds_write_b128 v55, v[96:99] offset:0
    v_pk_mul_f32 v[112:113], v[112:113], s[60:61]
    v_pk_mul_f32 v[114:115], v[114:115], s[60:61]
    v_pk_mul_f32 v[116:117], v[116:117], s[60:61]
    v_pk_mul_f32 v[118:119], v[118:119], s[60:61]
    v_cvt_pk_bf16_f32 v64, v112, v113
    v_cvt_pk_bf16_f32 v65, v114, v115
    v_cvt_pk_bf16_f32 v66, v116, v117
    v_cvt_pk_bf16_f32 v67, v118, v119
    v_permlane16_swap_b32 v100, v102
    v_permlane16_swap_b32 v101, v103
    ds_write_b128 v55, v[100:103] offset:1024
    v_pk_mul_f32 v[120:121], v[120:121], s[60:61]
    v_pk_mul_f32 v[122:123], v[122:123], s[60:61]
    v_pk_mul_f32 v[124:125], v[124:125], s[60:61]
    v_pk_mul_f32 v[126:127], v[126:127], s[60:61]
    v_cvt_pk_bf16_f32 v68, v120, v121
    v_cvt_pk_bf16_f32 v69, v122, v123
    v_cvt_pk_bf16_f32 v70, v124, v125
    v_cvt_pk_bf16_f32 v71, v126, v127
    v_permlane16_swap_b32 v64, v66
    v_permlane16_swap_b32 v65, v67
    v_pk_mul_f32 v[128:129], v[128:129], s[60:61]
    v_pk_mul_f32 v[130:131], v[130:131], s[60:61]
    v_pk_mul_f32 v[132:133], v[132:133], s[60:61]
    v_pk_mul_f32 v[134:135], v[134:135], s[60:61]
    v_cvt_pk_bf16_f32 v72, v128, v129
    v_cvt_pk_bf16_f32 v73, v130, v131
    v_cvt_pk_bf16_f32 v74, v132, v133
    v_cvt_pk_bf16_f32 v75, v134, v135
    v_permlane16_swap_b32 v68, v70
    v_permlane16_swap_b32 v69, v71
    v_pk_mul_f32 v[136:137], v[136:137], s[60:61]
    v_pk_mul_f32 v[138:139], v[138:139], s[60:61]
    v_pk_mul_f32 v[140:141], v[140:141], s[60:61]
    v_pk_mul_f32 v[142:143], v[142:143], s[60:61]
    v_cvt_pk_bf16_f32 v76, v136, v137
    v_cvt_pk_bf16_f32 v77, v138, v139
    v_cvt_pk_bf16_f32 v78, v140, v141
    v_cvt_pk_bf16_f32 v79, v142, v143
    v_permlane16_swap_b32 v72, v74
    v_permlane16_swap_b32 v73, v75
    v_pk_mul_f32 v[144:145], v[144:145], s[60:61]
    v_pk_mul_f32 v[146:147], v[146:147], s[60:61]
    v_pk_mul_f32 v[148:149], v[148:149], s[60:61]
    v_pk_mul_f32 v[150:151], v[150:151], s[60:61]
    v_cvt_pk_bf16_f32 v80, v144, v145
    v_cvt_pk_bf16_f32 v81, v146, v147
    v_cvt_pk_bf16_f32 v82, v148, v149
    v_cvt_pk_bf16_f32 v83, v150, v151
    v_permlane16_swap_b32 v76, v78
    v_permlane16_swap_b32 v77, v79
    v_pk_mul_f32 v[152:153], v[152:153], s[60:61]
    v_pk_mul_f32 v[154:155], v[154:155], s[60:61]
    v_pk_mul_f32 v[156:157], v[156:157], s[60:61]
    v_pk_mul_f32 v[158:159], v[158:159], s[60:61]
    v_cvt_pk_bf16_f32 v84, v152, v153
    v_cvt_pk_bf16_f32 v85, v154, v155
    v_cvt_pk_bf16_f32 v86, v156, v157
    v_cvt_pk_bf16_f32 v87, v158, v159
    v_permlane16_swap_b32 v80, v82
    v_permlane16_swap_b32 v81, v83
    v_pk_mul_f32 v[160:161], v[160:161], s[60:61]
    v_pk_mul_f32 v[162:163], v[162:163], s[60:61]
    v_pk_mul_f32 v[164:165], v[164:165], s[60:61]
    v_pk_mul_f32 v[166:167], v[166:167], s[60:61]
    v_cvt_pk_bf16_f32 v88, v160, v161
    v_cvt_pk_bf16_f32 v89, v162, v163
    v_cvt_pk_bf16_f32 v90, v164, v165
    v_cvt_pk_bf16_f32 v91, v166, v167
    v_permlane16_swap_b32 v84, v86
    v_permlane16_swap_b32 v85, v87
    v_pk_mul_f32 v[168:169], v[168:169], s[60:61]
    v_pk_mul_f32 v[170:171], v[170:171], s[60:61]
    v_pk_mul_f32 v[172:173], v[172:173], s[60:61]
    v_pk_mul_f32 v[174:175], v[174:175], s[60:61]
    v_cvt_pk_bf16_f32 v92, v168, v169
    v_cvt_pk_bf16_f32 v93, v170, v171
    v_cvt_pk_bf16_f32 v94, v172, v173
    v_cvt_pk_bf16_f32 v95, v174, v175
    v_permlane16_swap_b32 v88, v90
    v_permlane16_swap_b32 v89, v91
    v_permlane16_swap_b32 v92, v94
    v_permlane16_swap_b32 v93, v95
    s_waitcnt lgkmcnt(0)
    s_barrier
    ds_read_b128 v[104:107], v56 offset:0
    ds_read_b128 v[108:111], v56 offset:1024
    v_mfma_f32_16x16x32_bf16 v[208:211], a[0:3], v[64:67], 0
    s_add_u32 s58, s55, 32768
    ds_read_b64_tr_b16 a[128:129], v39 offset:0
    ds_read_b64_tr_b16 a[130:131], v39 offset:4096
    v_mfma_f32_16x16x32_bf16 v[208:211], a[4:7], v[68:71], v[208:211]
    s_add_u32 m0, s55, 81920
    ds_read_b64_tr_b16 a[132:133], v40 offset:0
    ds_read_b64_tr_b16 a[134:135], v40 offset:4096
    v_mfma_f32_16x16x32_bf16 v[208:211], a[8:11], v[72:75], v[208:211]
    buffer_load_dwordx4 v15, s[28:31], s58 offen offset:0 nt lds
    v_mfma_f32_16x16x32_bf16 v[208:211], a[12:15], v[76:79], v[208:211]
    ds_read_b64_tr_b16 a[136:137], v41 offset:0
    ds_read_b64_tr_b16 a[138:139], v41 offset:4096
    v_mfma_f32_16x16x32_bf16 v[212:215], a[16:19], v[64:67], 0
    ds_read_b64_tr_b16 a[140:141], v42 offset:0
    ds_read_b64_tr_b16 a[142:143], v42 offset:4096
    v_mfma_f32_16x16x32_bf16 v[212:215], a[20:23], v[68:71], v[212:215]
    ds_read_b64_tr_b16 a[144:145], v43 offset:0
    ds_read_b64_tr_b16 a[146:147], v43 offset:4096
    v_mfma_f32_16x16x32_bf16 v[212:215], a[24:27], v[72:75], v[212:215]
    ds_read_b64_tr_b16 a[148:149], v44 offset:0
    ds_read_b64_tr_b16 a[150:151], v44 offset:4096
    v_mfma_f32_16x16x32_bf16 v[212:215], a[28:31], v[76:79], v[212:215]
    ds_read_b64_tr_b16 a[152:153], v45 offset:0
    ds_read_b64_tr_b16 a[154:155], v45 offset:4096
    v_mfma_f32_16x16x32_bf16 v[216:219], a[0:3], v[80:83], 0
    buffer_load_dwordx4 v16, s[28:31], s58 offen offset:1024 nt lds
    v_mfma_f32_16x16x32_bf16 v[216:219], a[4:7], v[84:87], v[216:219]
    ds_read_b64_tr_b16 a[156:157], v46 offset:0
    ds_read_b64_tr_b16 a[158:159], v46 offset:4096
    v_mfma_f32_16x16x32_bf16 v[216:219], a[8:11], v[88:91], v[216:219]
    ds_read_b64_tr_b16 a[160:161], v47 offset:0
    ds_read_b64_tr_b16 a[162:163], v47 offset:4096
    v_mfma_f32_16x16x32_bf16 v[216:219], a[12:15], v[92:95], v[216:219]
    ds_read_b64_tr_b16 a[164:165], v48 offset:0
    ds_read_b64_tr_b16 a[166:167], v48 offset:4096
    v_mfma_f32_16x16x32_bf16 v[220:223], a[16:19], v[80:83], 0
    ds_read_b64_tr_b16 a[168:169], v49 offset:0
    ds_read_b64_tr_b16 a[170:171], v49 offset:4096
    v_mfma_f32_16x16x32_bf16 v[220:223], a[20:23], v[84:87], v[220:223]
    ds_read_b64_tr_b16 a[172:173], v50 offset:0
    ds_read_b64_tr_b16 a[174:175], v50 offset:4096
    v_mfma_f32_16x16x32_bf16 v[220:223], a[24:27], v[88:91], v[220:223]
    buffer_load_dwordx4 v15, s[28:31], s58 offen offset:2048 nt lds
    v_mfma_f32_16x16x32_bf16 v[220:223], a[28:31], v[92:95], v[220:223]
    v_exp_f32 v208, v208
    v_mfma_f32_16x16x32_bf16 v[224:227], a[0:3], v[96:99], 0
    v_exp_f32 v209, v209
    v_mfma_f32_16x16x32_bf16 v[224:227], a[4:7], v[100:103], v[224:227]
    s_waitcnt lgkmcnt(12)
    ds_read_b128 a[64:67], v31 offset:16384
    v_cvt_pk_bf16_f32 v208, v208, v209
    v_mfma_f32_16x16x32_bf16 v[224:227], a[8:11], v[104:107], v[224:227]
    v_exp_f32 v210, v210
    v_mfma_f32_16x16x32_bf16 v[224:227], a[12:15], v[108:111], v[224:227]
    v_exp_f32 v211, v211
    v_mfma_f32_16x16x32_bf16 v[228:231], a[16:19], v[96:99], 0
    buffer_load_dwordx4 v16, s[28:31], s58 offen offset:3072 nt lds
    v_mfma_f32_16x16x32_bf16 v[228:231], a[20:23], v[100:103], v[228:231]
    ds_read_b128 a[68:71], v32 offset:16384
    v_cvt_pk_bf16_f32 v209, v210, v211
    v_mfma_f32_16x16x32_bf16 v[228:231], a[24:27], v[104:107], v[228:231]
    ds_read_b64_tr_b16 a[176:177], v51 offset:0
    ds_read_b64_tr_b16 a[178:179], v51 offset:4096
    v_mfma_f32_16x16x32_bf16 v[228:231], a[28:31], v[108:111], v[228:231]
    v_exp_f32 v212, v212
    v_mfma_f32_16x16x32_bf16 v[232:235], a[32:35], v[64:67], 0
    v_exp_f32 v213, v213
    v_mfma_f32_16x16x32_bf16 v[232:235], a[36:39], v[68:71], v[232:235]
    ds_read_b128 a[72:75], v33 offset:16384
    v_cvt_pk_bf16_f32 v210, v212, v213
    v_mfma_f32_16x16x32_bf16 v[232:235], a[40:43], v[72:75], v[232:235]
    v_exp_f32 v214, v214
    v_mfma_f32_16x16x32_bf16 v[232:235], a[44:47], v[76:79], v[232:235]
    v_exp_f32 v216, v216
    v_mfma_f32_16x16x32_bf16 v[236:239], a[48:51], v[64:67], 0
    v_exp_f32 v215, v215
    v_mfma_f32_16x16x32_bf16 v[236:239], a[52:55], v[68:71], v[236:239]
    ds_read_b128 a[76:79], v34 offset:16384
    v_cvt_pk_bf16_f32 v211, v214, v215
    v_mfma_f32_16x16x32_bf16 v[236:239], a[56:59], v[72:75], v[236:239]
    ds_read_b128 a[80:83], v31 offset:20480
    v_lshrrev_b32 v57, 4, v2
    v_mfma_f32_16x16x32_bf16 v[236:239], a[60:63], v[76:79], v[236:239]
    ds_read_b128 a[84:87], v32 offset:20480
    v_mul_u32_u24 v57, 896, v57
    v_mfma_f32_16x16x32_bf16 v[240:243], a[32:35], v[80:83], 0
    ds_read_b64_tr_b16 a[180:181], v52 offset:0
    ds_read_b64_tr_b16 a[182:183], v52 offset:4096
    v_mfma_f32_16x16x32_bf16 v[240:243], a[36:39], v[84:87], v[240:243]
    ds_read_b128 a[88:91], v33 offset:20480
    v_add_u32 v4, v15, v57
    v_mfma_f32_16x16x32_bf16 v[240:243], a[40:43], v[88:91], v[240:243]
    ds_read_b128 a[92:95], v34 offset:20480
    v_add_u32 v5, v16, v57
    v_mfma_f32_16x16x32_bf16 v[240:243], a[44:47], v[92:95], v[240:243]
    ds_read_b128 a[96:99], v35 offset:16384
    v_add_u32 v6, 7168, v4
    v_mfma_f32_16x16x32_bf16 v[244:247], a[48:51], v[80:83], 0
    v_exp_f32 v217, v217
    v_mfma_f32_16x16x32_bf16 v[244:247], a[52:55], v[84:87], v[244:247]
    ds_read_b128 a[100:103], v36 offset:16384
    v_cvt_pk_bf16_f32 v216, v216, v217
    v_mfma_f32_16x16x32_bf16 v[244:247], a[56:59], v[88:91], v[244:247]
    v_exp_f32 v218, v218
    v_mfma_f32_16x16x32_bf16 v[244:247], a[60:63], v[92:95], v[244:247]
    v_exp_f32 v219, v219
    v_mfma_f32_16x16x32_bf16 v[112:115], a[128:131], v[208:211], 0
    ds_read_b128 a[104:107], v37 offset:16384
    v_cvt_pk_bf16_f32 v217, v218, v219
    v_mfma_f32_16x16x32_bf16 v[116:119], a[132:135], v[208:211], 0
    v_exp_f32 v220, v220
    v_mfma_f32_16x16x32_bf16 v[120:123], a[136:139], v[208:211], 0
    ds_read_b64_tr_b16 a[184:185], v53 offset:0
    ds_read_b64_tr_b16 a[186:187], v53 offset:4096
    v_exp_f32 v221, v221
    v_mfma_f32_16x16x32_bf16 v[124:127], a[140:143], v[208:211], 0
    ds_read_b128 a[108:111], v38 offset:16384
    v_cvt_pk_bf16_f32 v218, v220, v221
    v_mfma_f32_16x16x32_bf16 v[128:131], a[144:147], v[208:211], 0
    v_exp_f32 v222, v222
    v_exp_f32 v224, v224
    v_mfma_f32_16x16x32_bf16 v[132:135], a[148:151], v[208:211], 0
    s_waitcnt lgkmcnt(12)
    v_exp_f32 v223, v223
    v_exp_f32 v225, v225
    v_mfma_f32_16x16x32_bf16 v[136:139], a[152:155], v[208:211], 0
    ds_read_b128 a[112:115], v35 offset:20480
    v_cvt_pk_bf16_f32 v219, v222, v223
    v_mfma_f32_16x16x32_bf16 v[140:143], a[156:159], v[208:211], 0
    v_exp_f32 v226, v226
    v_cvt_pk_bf16_f32 v224, v224, v225
    v_mfma_f32_16x16x32_bf16 a[192:195], a[204:207], v[208:211], 0
    v_exp_f32 v227, v227
    v_mfma_f32_16x16x32_bf16 v[144:147], a[128:131], v[216:219], 0
    ds_read_b128 a[116:119], v36 offset:20480
    v_cvt_pk_bf16_f32 v225, v226, v227
    v_mfma_f32_16x16x32_bf16 v[148:151], a[132:135], v[216:219], 0
    v_exp_f32 v228, v228
    v_mfma_f32_16x16x32_bf16 v[152:155], a[136:139], v[216:219], 0
    v_exp_f32 v229, v229
    v_mfma_f32_16x16x32_bf16 v[156:159], a[140:143], v[216:219], 0
    ds_read_b64_tr_b16 a[188:189], v54 offset:0
    ds_read_b64_tr_b16 a[190:191], v54 offset:4096
    v_mfma_f32_16x16x32_bf16 v[160:163], a[144:147], v[216:219], 0
    v_exp_f32 v230, v230
    v_cvt_pk_bf16_f32 v226, v228, v229
    v_exp_f32 v232, v232
    v_mfma_f32_16x16x32_bf16 v[164:167], a[148:151], v[216:219], 0
    v_exp_f32 v231, v231
    v_exp_f32 v233, v233
    v_mfma_f32_16x16x32_bf16 v[168:171], a[152:155], v[216:219], 0
    ds_read_b128 a[120:123], v37 offset:20480
    v_cvt_pk_bf16_f32 v227, v230, v231
    v_mfma_f32_16x16x32_bf16 v[172:175], a[156:159], v[216:219], 0
    v_exp_f32 v234, v234
    v_cvt_pk_bf16_f32 v232, v232, v233
    v_mfma_f32_16x16x32_bf16 a[196:199], a[204:207], v[216:219], 0
    v_exp_f32 v235, v235
    v_mfma_f32_16x16x32_bf16 v[176:179], a[128:131], v[224:227], 0
    ds_read_b128 a[124:127], v38 offset:20480
    v_cvt_pk_bf16_f32 v233, v234, v235
    v_mfma_f32_16x16x32_bf16 v[180:183], a[132:135], v[224:227], 0
    v_exp_f32 v236, v236
    v_mfma_f32_16x16x32_bf16 v[184:187], a[136:139], v[224:227], 0
    v_exp_f32 v237, v237
    v_mfma_f32_16x16x32_bf16 v[188:191], a[140:143], v[224:227], 0
    v_exp_f32 v238, v238
    v_mfma_f32_16x16x32_bf16 v[192:195], a[144:147], v[224:227], 0
    v_cvt_pk_bf16_f32 v234, v236, v237
    v_exp_f32 v240, v240
    v_mfma_f32_16x16x32_bf16 v[196:199], a[148:151], v[224:227], 0
    v_exp_f32 v239, v239
    v_exp_f32 v241, v241
    v_mfma_f32_16x16x32_bf16 v[200:203], a[152:155], v[224:227], 0
    v_cvt_pk_bf16_f32 v235, v238, v239
    v_cvt_pk_bf16_f32 v240, v240, v241
    v_mfma_f32_16x16x32_bf16 v[204:207], a[156:159], v[224:227], 0
    v_exp_f32 v242, v242
    v_mfma_f32_16x16x32_bf16 a[200:203], a[204:207], v[224:227], 0
    v_exp_f32 v243, v243
    v_mfma_f32_16x16x32_bf16 v[112:115], a[160:163], v[232:235], v[112:115]
    v_exp_f32 v244, v244
    v_mfma_f32_16x16x32_bf16 v[116:119], a[164:167], v[232:235], v[116:119]
    v_cvt_pk_bf16_f32 v241, v242, v243
    v_add_u32 v7, 10752, v5
    v_mfma_f32_16x16x32_bf16 v[120:123], a[168:171], v[232:235], v[120:123]
    v_exp_f32 v245, v245
    v_mfma_f32_16x16x32_bf16 v[124:127], a[172:175], v[232:235], v[124:127]
    s_waitcnt lgkmcnt(7)
    v_exp_f32 v246, v246
    v_mfma_f32_16x16x32_bf16 v[128:131], a[176:179], v[232:235], v[128:131]
    s_waitcnt lgkmcnt(12)
    v_cvt_pk_bf16_f32 v242, v244, v245
    v_add_u32 v5, 3584, v5
    v_mfma_f32_16x16x32_bf16 v[132:135], a[180:183], v[232:235], v[132:135]
    s_lshl_b32 s19, s48, 13
    v_exp_f32 v247, v247
    v_mfma_f32_16x16x32_bf16 v[136:139], a[184:187], v[232:235], v[136:139]
    s_lshr_b32 s59, s51, 1
    v_cvt_pk_bf16_f32 v243, v246, v247
    s_waitcnt lgkmcnt(2)
    v_mfma_f32_16x16x32_bf16 v[140:143], a[188:191], v[232:235], v[140:143]
    s_waitcnt lgkmcnt(0)
    v_mfma_f32_16x16x32_bf16 a[192:195], a[204:207], v[232:235], a[192:195]
    s_barrier
    ds_read_b64_tr_b16 a[128:129], v39 offset:16384
    v_mfma_f32_16x16x32_bf16 v[144:147], a[160:163], v[240:243], v[144:147]
    s_add_u32 s58, s55, 65536
    ds_read_b64_tr_b16 a[130:131], v39 offset:20480
    ds_read_b64_tr_b16 a[132:133], v40 offset:16384
    v_mfma_f32_16x16x32_bf16 v[148:151], a[164:167], v[240:243], v[148:151]
    s_add_u32 m0, s55, 16384
    ds_read_b64_tr_b16 a[134:135], v40 offset:20480
    ds_read_b64_tr_b16 a[136:137], v41 offset:16384
    v_mfma_f32_16x16x32_bf16 v[152:155], a[168:171], v[240:243], v[152:155]
    s_mul_i32 s59, s59, 256
    buffer_load_dwordx4 v11, s[24:27], s58 offen offset:0 nt lds
    v_mfma_f32_16x16x32_bf16 v[156:159], a[172:175], v[240:243], v[156:159]
    s_add_u32 s75, s59, 0
    ds_read_b64_tr_b16 a[138:139], v41 offset:20480
    ds_read_b64_tr_b16 a[140:141], v42 offset:16384
    v_mfma_f32_16x16x32_bf16 v[160:163], a[176:179], v[240:243], v[160:163]
    s_mul_i32 s59, s48, 73728
    ds_read_b64_tr_b16 a[142:143], v42 offset:20480
    ds_read_b64_tr_b16 a[144:145], v43 offset:16384
    v_mfma_f32_16x16x32_bf16 v[164:167], a[180:183], v[240:243], v[164:167]
    s_add_u32 s59, s59, s75
    ds_read_b64_tr_b16 a[146:147], v43 offset:20480
    ds_read_b64_tr_b16 a[148:149], v44 offset:16384
    v_mfma_f32_16x16x32_bf16 v[168:171], a[184:187], v[240:243], v[168:171]
    s_xor_b32 s8, s51, 0
    buffer_load_dwordx4 v12, s[24:27], s58 offen offset:1024 nt lds
    v_mfma_f32_16x16x32_bf16 v[172:175], a[188:191], v[240:243], v[172:175]
    s_mul_i32 s8, s8, 294912
    ds_read_b64_tr_b16 a[150:151], v44 offset:20480
    ds_read_b64_tr_b16 a[152:153], v45 offset:16384
    v_mfma_f32_16x16x32_bf16 a[196:199], a[204:207], v[240:243], a[196:199]
    s_add_u32 s8, s8, s59
    ds_read_b64_tr_b16 a[154:155], v45 offset:20480
    ds_read_b64_tr_b16 a[156:157], v46 offset:16384
    v_mfma_f32_16x16x32_bf16 v[208:211], a[64:67], v[64:67], 0
    s_xor_b32 s9, s51, 1
    ds_read_b64_tr_b16 a[158:159], v46 offset:20480
    ds_read_b64_tr_b16 a[160:161], v47 offset:16384
    v_mfma_f32_16x16x32_bf16 v[208:211], a[68:71], v[68:71], v[208:211]
    s_mul_i32 s9, s9, 294912
    buffer_load_dwordx4 v13, s[24:27], s58 offen offset:2048 nt lds
    v_mfma_f32_16x16x32_bf16 v[208:211], a[72:75], v[72:75], v[208:211]
    s_add_u32 s9, s9, s59
    ds_read_b64_tr_b16 a[162:163], v47 offset:20480
    ds_read_b64_tr_b16 a[164:165], v48 offset:16384
    v_mfma_f32_16x16x32_bf16 v[208:211], a[76:79], v[76:79], v[208:211]
    s_xor_b32 s10, s51, 3
    ds_read_b64_tr_b16 a[166:167], v48 offset:20480
    ds_read_b64_tr_b16 a[168:169], v49 offset:16384
    v_mfma_f32_16x16x32_bf16 v[212:215], a[80:83], v[64:67], 0
    s_mul_i32 s10, s10, 294912
    ds_read_b64_tr_b16 a[170:171], v49 offset:20480
    ds_read_b64_tr_b16 a[172:173], v50 offset:16384
    v_mfma_f32_16x16x32_bf16 v[212:215], a[84:87], v[68:71], v[212:215]
    s_add_u32 s10, s10, s59
    buffer_load_dwordx4 v14, s[24:27], s58 offen offset:3072 nt lds
    v_mfma_f32_16x16x32_bf16 v[212:215], a[88:91], v[72:75], v[212:215]
    s_xor_b32 s11, s51, 2
    ds_read_b64_tr_b16 a[174:175], v50 offset:20480
    v_mfma_f32_16x16x32_bf16 v[212:215], a[92:95], v[76:79], v[212:215]
    s_mul_i32 s11, s11, 294912
    v_exp_f32 v208, v208
    v_mfma_f32_16x16x32_bf16 v[216:219], a[64:67], v[80:83], 0
    s_add_u32 s11, s11, s59
    v_exp_f32 v209, v209
    v_mfma_f32_16x16x32_bf16 v[216:219], a[68:71], v[84:87], v[216:219]
    s_mul_i32 s59, s53, 1310720
    ds_read_b128 a[0:3], v31 offset:32768
    v_cvt_pk_bf16_f32 v208, v208, v209
    v_mfma_f32_16x16x32_bf16 v[216:219], a[72:75], v[88:91], v[216:219]
    s_mul_i32 s12, s48, 10240
    v_exp_f32 v210, v210
    v_mfma_f32_16x16x32_bf16 v[216:219], a[76:79], v[92:95], v[216:219]
    s_add_u32 s59, s59, s12
    v_exp_f32 v211, v211
    v_mfma_f32_16x16x32_bf16 v[220:223], a[80:83], v[80:83], 0
    s_mul_i32 s12, s54, 66816
    ds_read_b128 a[4:7], v32 offset:32768
    v_cvt_pk_bf16_f32 v209, v210, v211
    v_mfma_f32_16x16x32_bf16 v[220:223], a[84:87], v[84:87], v[220:223]
    s_add_u32 s12, s12, s59
    v_exp_f32 v212, v212
    v_mfma_f32_16x16x32_bf16 v[220:223], a[88:91], v[88:91], v[220:223]
    s_add_u32 s13, s12, 4096
    v_exp_f32 v213, v213
    v_mfma_f32_16x16x32_bf16 v[220:223], a[92:95], v[92:95], v[220:223]
    s_add_u32 s14, s12, 8192
    ds_read_b128 a[8:11], v33 offset:32768
    v_cvt_pk_bf16_f32 v210, v212, v213
    v_mfma_f32_16x16x32_bf16 v[224:227], a[64:67], v[96:99], 0
    s_xor_b32 s66, s54, 1
    v_exp_f32 v214, v214
    v_mfma_f32_16x16x32_bf16 v[224:227], a[68:71], v[100:103], v[224:227]
    s_add_u32 s58, s55, 49152
    v_exp_f32 v216, v216
    v_mfma_f32_16x16x32_bf16 v[224:227], a[72:75], v[104:107], v[224:227]
    s_add_u32 m0, s55, 49152
    v_exp_f32 v215, v215
    v_mfma_f32_16x16x32_bf16 v[224:227], a[76:79], v[108:111], v[224:227]
    s_mul_i32 s66, s66, 66816
    buffer_load_dwordx4 v15, s[28:31], s58 offen offset:0 nt lds
    v_mfma_f32_16x16x32_bf16 v[228:231], a[80:83], v[96:99], 0
    s_add_u32 s66, s66, s59
    ds_read_b128 a[12:15], v34 offset:32768
    v_cvt_pk_bf16_f32 v211, v214, v215
    v_mfma_f32_16x16x32_bf16 v[228:231], a[84:87], v[100:103], v[228:231]
    s_xor_b32 s67, s54, 3
    v_exp_f32 v217, v217
    v_mfma_f32_16x16x32_bf16 v[228:231], a[88:91], v[104:107], v[228:231]
    s_mul_i32 s67, s67, 66816
    ds_read_b64_tr_b16 a[176:177], v51 offset:16384
    ds_read_b64_tr_b16 a[178:179], v51 offset:20480
    v_mfma_f32_16x16x32_bf16 v[228:231], a[92:95], v[108:111], v[228:231]
    s_add_u32 s67, s67, s59
    ds_read_b128 a[16:19], v31 offset:36864
    v_cvt_pk_bf16_f32 v216, v216, v217
    v_mfma_f32_16x16x32_bf16 v[232:235], a[96:99], v[64:67], 0
    s_xor_b32 s68, s54, 2
    v_exp_f32 v218, v218
    v_mfma_f32_16x16x32_bf16 v[232:235], a[100:103], v[68:71], v[232:235]
    s_mul_i32 s68, s68, 66816
    v_exp_f32 v219, v219
    v_mfma_f32_16x16x32_bf16 v[232:235], a[104:107], v[72:75], v[232:235]
    s_add_u32 s68, s68, s59
    ds_read_b128 a[20:23], v32 offset:36864
    v_cvt_pk_bf16_f32 v217, v218, v219
    v_mfma_f32_16x16x32_bf16 v[232:235], a[108:111], v[76:79], v[232:235]
    s_lshl_b32 s15, s52, 2
    v_exp_f32 v220, v220
    v_mfma_f32_16x16x32_bf16 v[236:239], a[112:115], v[64:67], 0
    s_add_u32 s15, s15, s48
    v_exp_f32 v221, v221
    v_mfma_f32_16x16x32_bf16 v[236:239], a[116:119], v[68:71], v[236:239]
    s_lshl_b32 s15, s15, 11
    ds_read_b128 a[24:27], v33 offset:36864
    v_cvt_pk_bf16_f32 v218, v220, v221
    v_mfma_f32_16x16x32_bf16 v[236:239], a[120:123], v[72:75], v[236:239]
    s_mul_i32 s59, s53, 1310720
    v_exp_f32 v222, v222
    v_mfma_f32_16x16x32_bf16 v[236:239], a[124:127], v[76:79], v[236:239]
    s_add_u32 s15, s15, s59
    buffer_load_dwordx4 v16, s[28:31], s58 offen offset:1024 nt lds
    v_mfma_f32_16x16x32_bf16 v[240:243], a[96:99], v[80:83], 0
    s_add_u32 s15, s15, 1069056
    ds_read_b64_tr_b16 a[180:181], v52 offset:16384
    ds_read_b64_tr_b16 a[182:183], v52 offset:20480
    v_mfma_f32_16x16x32_bf16 v[240:243], a[100:103], v[84:87], v[240:243]
    ds_read_b128 a[28:31], v34 offset:36864
    v_and_b32 v10, 7, v2
    v_mfma_f32_16x16x32_bf16 v[240:243], a[104:107], v[88:91], v[240:243]
    ds_read_b128 a[32:35], v35 offset:32768
    v_xor_b32 v10, s51, v10
    v_mfma_f32_16x16x32_bf16 v[240:243], a[108:111], v[92:95], v[240:243]
    ds_read_b128 a[36:39], v36 offset:32768
    v_lshlrev_b32 v10, 1, v10
    v_mfma_f32_16x16x32_bf16 v[244:247], a[112:115], v[80:83], 0
    s_lshl_b32 s59, s50, 7
    v_exp_f32 v224, v224
    v_mfma_f32_16x16x32_bf16 v[244:247], a[116:119], v[84:87], v[244:247]
    s_lshl_b32 s16, s48, 6
    v_exp_f32 v223, v223
    v_mfma_f32_16x16x32_bf16 v[244:247], a[120:123], v[88:91], v[244:247]
    s_xor_b32 s59, s59, s16
    ds_read_b128 a[40:43], v37 offset:32768
    v_cvt_pk_bf16_f32 v219, v222, v223
    v_mfma_f32_16x16x32_bf16 v[244:247], a[124:127], v[92:95], v[244:247]
    s_waitcnt lgkmcnt(12)
    ds_read_b128 a[44:47], v38 offset:32768
    v_xor_b32 v17, s59, v39
    v_mfma_f32_16x16x32_bf16 v[112:115], a[128:131], v[208:211], v[112:115]
    s_lshl_b32 s59, s49, 14
    v_exp_f32 v225, v225
    v_mfma_f32_16x16x32_bf16 v[116:119], a[132:135], v[208:211], v[116:119]
    s_add_u32 s59, s59, 49152
    ds_read_b128 a[48:51], v35 offset:36864
    v_cvt_pk_bf16_f32 v224, v224, v225
    v_mfma_f32_16x16x32_bf16 v[120:123], a[136:139], v[208:211], v[120:123]
    ds_read_b64_tr_b16 a[184:185], v53 offset:16384
    ds_read_b64_tr_b16 a[186:187], v53 offset:20480
    v_mfma_f32_16x16x32_bf16 v[124:127], a[140:143], v[208:211], v[124:127]
    buffer_load_dwordx4 v15, s[28:31], s58 offen offset:2048 nt lds
    v_mfma_f32_16x16x32_bf16 v[128:131], a[144:147], v[208:211], v[128:131]
    ds_read_b128 a[52:55], v36 offset:36864
    v_add_u32 v17, s59, v17
    v_mfma_f32_16x16x32_bf16 v[132:135], a[148:151], v[208:211], v[132:135]
    ds_read_b128 a[56:59], v37 offset:36864
    v_xor_b32 v18, 32, v17
    v_mfma_f32_16x16x32_bf16 v[136:139], a[152:155], v[208:211], v[136:139]
    ds_read_b128 a[60:63], v38 offset:36864
    v_xor_b32 v19, 64, v17
    v_mfma_f32_16x16x32_bf16 v[140:143], a[156:159], v[208:211], v[140:143]
    v_exp_f32 v226, v226
    v_mfma_f32_16x16x32_bf16 a[192:195], a[204:207], v[208:211], a[192:195]
    v_exp_f32 v227, v227
    v_mfma_f32_16x16x32_bf16 v[144:147], a[128:131], v[216:219], v[144:147]
    v_exp_f32 v228, v228
    v_mfma_f32_16x16x32_bf16 v[148:151], a[132:135], v[216:219], v[148:151]
    ds_read_b64_tr_b16 a[188:189], v54 offset:16384
    v_cvt_pk_bf16_f32 v225, v226, v227
    v_mfma_f32_16x16x32_bf16 v[152:155], a[136:139], v[216:219], v[152:155]
    v_exp_f32 v229, v229
    v_mfma_f32_16x16x32_bf16 v[156:159], a[140:143], v[216:219], v[156:159]
    ds_read_b64_tr_b16 a[190:191], v54 offset:20480
    v_cvt_pk_bf16_f32 v226, v228, v229
    v_mfma_f32_16x16x32_bf16 v[160:163], a[144:147], v[216:219], v[160:163]
    v_exp_f32 v230, v230
    v_exp_f32 v232, v232
    v_mfma_f32_16x16x32_bf16 v[164:167], a[148:151], v[216:219], v[164:167]
    v_exp_f32 v231, v231
    v_exp_f32 v233, v233
    v_mfma_f32_16x16x32_bf16 v[168:171], a[152:155], v[216:219], v[168:171]
    buffer_load_dwordx4 v16, s[28:31], s58 offen offset:3072 nt lds
    v_mfma_f32_16x16x32_bf16 v[172:175], a[156:159], v[216:219], v[172:175]
standalone__gqa_block_cached__near_ridge_b_h0_2:
    s_cbranch_execz standalone__gqa_block_cached__near_ridge_b_h0_r
    v_cvt_pk_bf16_f32 v227, v230, v231
    v_exp_f32 v234, v234
    v_cvt_pk_bf16_f32 v232, v232, v233
    v_mfma_f32_16x16x32_bf16 a[196:199], a[204:207], v[216:219], a[196:199]
    s_add_u32 s58, s8, 0
    v_exp_f32 v235, v235
    v_mfma_f32_16x16x32_bf16 v[176:179], a[128:131], v[224:227], v[176:179]
    s_add_u32 m0, s19, 98304
    v_exp_f32 v236, v236
    v_mfma_f32_16x16x32_bf16 v[180:183], a[132:135], v[224:227], v[180:183]
    buffer_load_dwordx4 v4, s[36:39], s58 offen offset:0 lds
    v_cvt_pk_bf16_f32 v233, v234, v235
    v_mfma_f32_16x16x32_bf16 v[184:187], a[136:139], v[224:227], v[184:187]
    v_exp_f32 v237, v237
    v_mfma_f32_16x16x32_bf16 v[188:191], a[140:143], v[224:227], v[188:191]
    v_exp_f32 v238, v238
    v_mfma_f32_16x16x32_bf16 v[192:195], a[144:147], v[224:227], v[192:195]
    v_cvt_pk_bf16_f32 v234, v236, v237
    v_exp_f32 v240, v240
    v_mfma_f32_16x16x32_bf16 v[196:199], a[148:151], v[224:227], v[196:199]
    buffer_load_dwordx4 v5, s[36:39], s58 offen offset:1024 lds
    v_exp_f32 v239, v239
    v_exp_f32 v241, v241
    v_mfma_f32_16x16x32_bf16 v[200:203], a[152:155], v[224:227], v[200:203]
    v_cvt_pk_bf16_f32 v235, v238, v239
    v_cvt_pk_bf16_f32 v240, v240, v241
    v_mfma_f32_16x16x32_bf16 v[204:207], a[156:159], v[224:227], v[204:207]
    v_exp_f32 v242, v242
    v_mfma_f32_16x16x32_bf16 a[200:203], a[204:207], v[224:227], a[200:203]
    v_exp_f32 v243, v243
    v_mfma_f32_16x16x32_bf16 v[112:115], a[160:163], v[232:235], v[112:115]
    buffer_load_dwordx4 v6, s[36:39], s58 offen offset:2048 lds
    v_mfma_f32_16x16x32_bf16 v[116:119], a[164:167], v[232:235], v[116:119]
    v_exp_f32 v244, v244
    v_cvt_pk_bf16_f32 v241, v242, v243
    v_mfma_f32_16x16x32_bf16 v[120:123], a[168:171], v[232:235], v[120:123]
    v_exp_f32 v245, v245
    v_mfma_f32_16x16x32_bf16 v[124:127], a[172:175], v[232:235], v[124:127]
    s_waitcnt lgkmcnt(12)
    v_exp_f32 v246, v246
    v_mfma_f32_16x16x32_bf16 v[128:131], a[176:179], v[232:235], v[128:131]
    buffer_load_dwordx4 v7, s[36:39], s58 offen offset:3072 lds
    v_cvt_pk_bf16_f32 v242, v244, v245
    v_mfma_f32_16x16x32_bf16 v[132:135], a[180:183], v[232:235], v[132:135]
    s_waitcnt lgkmcnt(5)
    v_exp_f32 v247, v247
    v_mfma_f32_16x16x32_bf16 v[136:139], a[184:187], v[232:235], v[136:139]
    s_waitcnt lgkmcnt(0)
    v_cvt_pk_bf16_f32 v243, v246, v247
    v_xor_b32 v20, 96, v17
    v_mfma_f32_16x16x32_bf16 v[140:143], a[188:191], v[232:235], v[140:143]
    s_waitcnt vmcnt(12) lgkmcnt(0)
    v_xor_b32 v21, 128, v17
    v_mfma_f32_16x16x32_bf16 a[192:195], a[204:207], v[232:235], a[192:195]
    s_barrier
    ds_read_b64_tr_b16 a[128:129], v39 offset:32768
    v_mfma_f32_16x16x32_bf16 v[144:147], a[160:163], v[240:243], v[144:147]
    s_add_u32 s58, s55, 81920
    ds_read_b64_tr_b16 a[130:131], v39 offset:36864
    ds_read_b64_tr_b16 a[132:133], v40 offset:32768
    v_mfma_f32_16x16x32_bf16 v[148:151], a[164:167], v[240:243], v[148:151]
    s_add_u32 m0, s55, 32768
    ds_read_b64_tr_b16 a[134:135], v40 offset:36864
    ds_read_b64_tr_b16 a[136:137], v41 offset:32768
    v_mfma_f32_16x16x32_bf16 v[152:155], a[168:171], v[240:243], v[152:155]
    buffer_load_dwordx4 v11, s[24:27], s58 offen offset:0 nt lds
    v_mfma_f32_16x16x32_bf16 v[156:159], a[172:175], v[240:243], v[156:159]
    ds_read_b64_tr_b16 a[138:139], v41 offset:36864
    ds_read_b64_tr_b16 a[140:141], v42 offset:32768
    v_mfma_f32_16x16x32_bf16 v[160:163], a[176:179], v[240:243], v[160:163]
    ds_read_b64_tr_b16 a[142:143], v42 offset:36864
    ds_read_b64_tr_b16 a[144:145], v43 offset:32768
    v_mfma_f32_16x16x32_bf16 v[164:167], a[180:183], v[240:243], v[164:167]
    ds_read_b64_tr_b16 a[146:147], v43 offset:36864
    ds_read_b64_tr_b16 a[148:149], v44 offset:32768
    v_mfma_f32_16x16x32_bf16 v[168:171], a[184:187], v[240:243], v[168:171]
    buffer_load_dwordx4 v12, s[24:27], s58 offen offset:1024 nt lds
    v_mfma_f32_16x16x32_bf16 v[172:175], a[188:191], v[240:243], v[172:175]
    ds_read_b64_tr_b16 a[150:151], v44 offset:36864
    ds_read_b64_tr_b16 a[152:153], v45 offset:32768
    v_mfma_f32_16x16x32_bf16 a[196:199], a[204:207], v[240:243], a[196:199]
    ds_read_b64_tr_b16 a[154:155], v45 offset:36864
    ds_read_b64_tr_b16 a[156:157], v46 offset:32768
    v_mfma_f32_16x16x32_bf16 v[208:211], a[0:3], v[64:67], 0
    ds_read_b64_tr_b16 a[158:159], v46 offset:36864
    ds_read_b64_tr_b16 a[160:161], v47 offset:32768
    v_mfma_f32_16x16x32_bf16 v[208:211], a[4:7], v[68:71], v[208:211]
    buffer_load_dwordx4 v13, s[24:27], s58 offen offset:2048 nt lds
    v_mfma_f32_16x16x32_bf16 v[208:211], a[8:11], v[72:75], v[208:211]
    ds_read_b64_tr_b16 a[162:163], v47 offset:36864
    ds_read_b64_tr_b16 a[164:165], v48 offset:32768
    v_mfma_f32_16x16x32_bf16 v[208:211], a[12:15], v[76:79], v[208:211]
    ds_read_b64_tr_b16 a[166:167], v48 offset:36864
    ds_read_b64_tr_b16 a[168:169], v49 offset:32768
    v_mfma_f32_16x16x32_bf16 v[212:215], a[16:19], v[64:67], 0
    ds_read_b64_tr_b16 a[170:171], v49 offset:36864
    ds_read_b64_tr_b16 a[172:173], v50 offset:32768
    v_mfma_f32_16x16x32_bf16 v[212:215], a[20:23], v[68:71], v[212:215]
    buffer_load_dwordx4 v14, s[24:27], s58 offen offset:3072 nt lds
    v_mfma_f32_16x16x32_bf16 v[212:215], a[24:27], v[72:75], v[212:215]
    ds_read_b64_tr_b16 a[174:175], v50 offset:36864
    v_xor_b32 v22, 160, v17
    v_mfma_f32_16x16x32_bf16 v[212:215], a[28:31], v[76:79], v[212:215]
    v_exp_f32 v208, v208
    v_mfma_f32_16x16x32_bf16 v[216:219], a[0:3], v[80:83], 0
    v_exp_f32 v209, v209
    v_mfma_f32_16x16x32_bf16 v[216:219], a[4:7], v[84:87], v[216:219]
    ds_read_b128 a[64:67], v31 offset:0
    v_cvt_pk_bf16_f32 v208, v208, v209
    v_mfma_f32_16x16x32_bf16 v[216:219], a[8:11], v[88:91], v[216:219]
    ds_read_b128 a[68:71], v32 offset:0
    v_xor_b32 v23, 192, v17
    v_mfma_f32_16x16x32_bf16 v[216:219], a[12:15], v[92:95], v[216:219]
    ds_read_b128 a[72:75], v33 offset:0
    v_xor_b32 v24, 224, v17
    v_mfma_f32_16x16x32_bf16 v[220:223], a[16:19], v[80:83], 0
    v_exp_f32 v210, v210
    v_mfma_f32_16x16x32_bf16 v[220:223], a[20:23], v[84:87], v[220:223]
    v_exp_f32 v211, v211
    v_mfma_f32_16x16x32_bf16 v[220:223], a[24:27], v[88:91], v[220:223]
    ds_read_b128 a[76:79], v34 offset:0
    v_cvt_pk_bf16_f32 v209, v210, v211
    v_mfma_f32_16x16x32_bf16 v[220:223], a[28:31], v[92:95], v[220:223]
    v_exp_f32 v212, v212
    v_mfma_f32_16x16x32_bf16 v[224:227], a[0:3], v[96:99], 0
    v_exp_f32 v213, v213
    v_mfma_f32_16x16x32_bf16 v[224:227], a[4:7], v[100:103], v[224:227]
    s_add_u32 s58, s55, 65536
    ds_read_b128 a[80:83], v31 offset:4096
    v_cvt_pk_bf16_f32 v210, v212, v213
    v_mfma_f32_16x16x32_bf16 v[224:227], a[8:11], v[104:107], v[224:227]
    s_add_u32 m0, s55, 65536
    v_exp_f32 v214, v214
    v_mfma_f32_16x16x32_bf16 v[224:227], a[12:15], v[108:111], v[224:227]
    buffer_load_dwordx4 v15, s[28:31], s58 offen offset:0 nt lds
    v_mfma_f32_16x16x32_bf16 v[228:231], a[16:19], v[96:99], 0
    v_exp_f32 v216, v216
    v_mfma_f32_16x16x32_bf16 v[228:231], a[20:23], v[100:103], v[228:231]
    v_exp_f32 v215, v215
    v_mfma_f32_16x16x32_bf16 v[228:231], a[24:27], v[104:107], v[228:231]
    ds_read_b64_tr_b16 a[176:177], v51 offset:32768
    ds_read_b64_tr_b16 a[178:179], v51 offset:36864
    v_mfma_f32_16x16x32_bf16 v[228:231], a[28:31], v[108:111], v[228:231]
    ds_read_b128 a[84:87], v32 offset:4096
    v_cvt_pk_bf16_f32 v211, v214, v215
    v_mfma_f32_16x16x32_bf16 v[232:235], a[32:35], v[64:67], 0
    v_exp_f32 v217, v217
    v_mfma_f32_16x16x32_bf16 v[232:235], a[36:39], v[68:71], v[232:235]
    ds_read_b128 a[88:91], v33 offset:4096
    v_cvt_pk_bf16_f32 v216, v216, v217
    v_mfma_f32_16x16x32_bf16 v[232:235], a[40:43], v[72:75], v[232:235]
    v_exp_f32 v218, v218
    v_mfma_f32_16x16x32_bf16 v[232:235], a[44:47], v[76:79], v[232:235]
    v_exp_f32 v219, v219
    v_mfma_f32_16x16x32_bf16 v[236:239], a[48:51], v[64:67], 0
    ds_read_b128 a[92:95], v34 offset:4096
    v_cvt_pk_bf16_f32 v217, v218, v219
    v_mfma_f32_16x16x32_bf16 v[236:239], a[52:55], v[68:71], v[236:239]
    v_exp_f32 v220, v220
    v_mfma_f32_16x16x32_bf16 v[236:239], a[56:59], v[72:75], v[236:239]
    v_exp_f32 v221, v221
    v_mfma_f32_16x16x32_bf16 v[236:239], a[60:63], v[76:79], v[236:239]
    buffer_load_dwordx4 v16, s[28:31], s58 offen offset:1024 nt lds
    v_mfma_f32_16x16x32_bf16 v[240:243], a[32:35], v[80:83], 0
    ds_read_b64_tr_b16 a[180:181], v52 offset:32768
    ds_read_b64_tr_b16 a[182:183], v52 offset:36864
    v_mfma_f32_16x16x32_bf16 v[240:243], a[36:39], v[84:87], v[240:243]
    ds_read_b128 a[96:99], v35 offset:0
    v_cvt_pk_bf16_f32 v218, v220, v221
    v_mfma_f32_16x16x32_bf16 v[240:243], a[40:43], v[88:91], v[240:243]
    v_exp_f32 v222, v222
    v_mfma_f32_16x16x32_bf16 v[240:243], a[44:47], v[92:95], v[240:243]
    v_exp_f32 v224, v224
    v_mfma_f32_16x16x32_bf16 v[244:247], a[48:51], v[80:83], 0
    v_exp_f32 v223, v223
    v_mfma_f32_16x16x32_bf16 v[244:247], a[52:55], v[84:87], v[244:247]
    ds_read_b128 a[100:103], v36 offset:0
    v_cvt_pk_bf16_f32 v219, v222, v223
    v_mfma_f32_16x16x32_bf16 v[244:247], a[56:59], v[88:91], v[244:247]
    v_exp_f32 v225, v225
    v_mfma_f32_16x16x32_bf16 v[244:247], a[60:63], v[92:95], v[244:247]
    s_waitcnt lgkmcnt(12)
    ds_read_b128 a[104:107], v37 offset:0
    v_cvt_pk_bf16_f32 v224, v224, v225
    v_mfma_f32_16x16x32_bf16 v[112:115], a[128:131], v[208:211], v[112:115]
    v_exp_f32 v226, v226
    v_mfma_f32_16x16x32_bf16 v[116:119], a[132:135], v[208:211], v[116:119]
    v_exp_f32 v227, v227
    v_mfma_f32_16x16x32_bf16 v[120:123], a[136:139], v[208:211], v[120:123]
    ds_read_b64_tr_b16 a[184:185], v53 offset:32768
    ds_read_b64_tr_b16 a[186:187], v53 offset:36864
    v_mfma_f32_16x16x32_bf16 v[124:127], a[140:143], v[208:211], v[124:127]
    buffer_load_dwordx4 v15, s[28:31], s58 offen offset:2048 nt lds
    v_mfma_f32_16x16x32_bf16 v[128:131], a[144:147], v[208:211], v[128:131]
    ds_read_b128 a[108:111], v38 offset:0
    v_cvt_pk_bf16_f32 v225, v226, v227
    v_mfma_f32_16x16x32_bf16 v[132:135], a[148:151], v[208:211], v[132:135]
    v_exp_f32 v228, v228
    v_mfma_f32_16x16x32_bf16 v[136:139], a[152:155], v[208:211], v[136:139]
    v_exp_f32 v229, v229
    v_mfma_f32_16x16x32_bf16 v[140:143], a[156:159], v[208:211], v[140:143]
    ds_read_b128 a[112:115], v35 offset:4096
    v_cvt_pk_bf16_f32 v226, v228, v229
    v_mfma_f32_16x16x32_bf16 a[192:195], a[204:207], v[208:211], a[192:195]
    v_exp_f32 v230, v230
    v_mfma_f32_16x16x32_bf16 v[144:147], a[128:131], v[216:219], v[144:147]
    v_exp_f32 v232, v232
    v_mfma_f32_16x16x32_bf16 v[148:151], a[132:135], v[216:219], v[148:151]
    v_exp_f32 v231, v231
    v_mfma_f32_16x16x32_bf16 v[152:155], a[136:139], v[216:219], v[152:155]
    ds_read_b128 a[116:119], v36 offset:4096
    v_cvt_pk_bf16_f32 v227, v230, v231
    v_mfma_f32_16x16x32_bf16 v[156:159], a[140:143], v[216:219], v[156:159]
    ds_read_b64_tr_b16 a[188:189], v54 offset:32768
    ds_read_b64_tr_b16 a[190:191], v54 offset:36864
    v_mfma_f32_16x16x32_bf16 v[160:163], a[144:147], v[216:219], v[160:163]
    v_exp_f32 v233, v233
    v_mfma_f32_16x16x32_bf16 v[164:167], a[148:151], v[216:219], v[164:167]
    ds_read_b128 a[120:123], v37 offset:4096
    v_cvt_pk_bf16_f32 v232, v232, v233
    v_mfma_f32_16x16x32_bf16 v[168:171], a[152:155], v[216:219], v[168:171]
    buffer_load_dwordx4 v16, s[28:31], s58 offen offset:3072 nt lds
    v_mfma_f32_16x16x32_bf16 v[172:175], a[156:159], v[216:219], v[172:175]
    v_exp_f32 v234, v234
    v_mfma_f32_16x16x32_bf16 a[196:199], a[204:207], v[216:219], a[196:199]
    s_add_u32 s58, s8, 18432
    v_exp_f32 v235, v235
    v_mfma_f32_16x16x32_bf16 v[176:179], a[128:131], v[224:227], v[176:179]
    s_add_u32 m0, s19, 102400
    ds_read_b128 a[124:127], v38 offset:4096
    v_cvt_pk_bf16_f32 v233, v234, v235
    v_mfma_f32_16x16x32_bf16 v[180:183], a[132:135], v[224:227], v[180:183]
    buffer_load_dwordx4 v4, s[36:39], s58 offen offset:0 lds
    v_exp_f32 v236, v236
    v_mfma_f32_16x16x32_bf16 v[184:187], a[136:139], v[224:227], v[184:187]
    v_exp_f32 v237, v237
    v_mfma_f32_16x16x32_bf16 v[188:191], a[140:143], v[224:227], v[188:191]
    v_exp_f32 v238, v238
    v_mfma_f32_16x16x32_bf16 v[192:195], a[144:147], v[224:227], v[192:195]
    v_cvt_pk_bf16_f32 v234, v236, v237
    v_exp_f32 v240, v240
    v_mfma_f32_16x16x32_bf16 v[196:199], a[148:151], v[224:227], v[196:199]
    buffer_load_dwordx4 v5, s[36:39], s58 offen offset:1024 lds
    v_exp_f32 v239, v239
    v_exp_f32 v241, v241
    v_mfma_f32_16x16x32_bf16 v[200:203], a[152:155], v[224:227], v[200:203]
    v_cvt_pk_bf16_f32 v235, v238, v239
    v_cvt_pk_bf16_f32 v240, v240, v241
    v_mfma_f32_16x16x32_bf16 v[204:207], a[156:159], v[224:227], v[204:207]
    v_exp_f32 v242, v242
    v_mfma_f32_16x16x32_bf16 a[200:203], a[204:207], v[224:227], a[200:203]
    v_exp_f32 v243, v243
    v_mfma_f32_16x16x32_bf16 v[112:115], a[160:163], v[232:235], v[112:115]
    buffer_load_dwordx4 v6, s[36:39], s58 offen offset:2048 lds
    v_mfma_f32_16x16x32_bf16 v[116:119], a[164:167], v[232:235], v[116:119]
    v_exp_f32 v244, v244
    v_cvt_pk_bf16_f32 v241, v242, v243
    v_mfma_f32_16x16x32_bf16 v[120:123], a[168:171], v[232:235], v[120:123]
    v_exp_f32 v245, v245
    v_mfma_f32_16x16x32_bf16 v[124:127], a[172:175], v[232:235], v[124:127]
    s_waitcnt lgkmcnt(12)
    v_exp_f32 v246, v246
    v_mfma_f32_16x16x32_bf16 v[128:131], a[176:179], v[232:235], v[128:131]
    buffer_load_dwordx4 v7, s[36:39], s58 offen offset:3072 lds
    v_cvt_pk_bf16_f32 v242, v244, v245
    v_mfma_f32_16x16x32_bf16 v[132:135], a[180:183], v[232:235], v[132:135]
    s_waitcnt lgkmcnt(7)
    v_exp_f32 v247, v247
    v_mfma_f32_16x16x32_bf16 v[136:139], a[184:187], v[232:235], v[136:139]
    s_waitcnt lgkmcnt(2)
    v_cvt_pk_bf16_f32 v243, v246, v247
    v_mfma_f32_16x16x32_bf16 v[140:143], a[188:191], v[232:235], v[140:143]
    s_waitcnt vmcnt(16) lgkmcnt(0)
    v_mfma_f32_16x16x32_bf16 a[192:195], a[204:207], v[232:235], a[192:195]
    s_barrier
    ds_read_b64_tr_b16 a[128:129], v39 offset:0
    v_mfma_f32_16x16x32_bf16 v[144:147], a[160:163], v[240:243], v[144:147]
    s_add_u32 s58, s55, 98304
    ds_read_b64_tr_b16 a[130:131], v39 offset:4096
    ds_read_b64_tr_b16 a[132:133], v40 offset:0
    v_mfma_f32_16x16x32_bf16 v[148:151], a[164:167], v[240:243], v[148:151]
    s_add_u32 m0, s55, 0
    ds_read_b64_tr_b16 a[134:135], v40 offset:4096
    ds_read_b64_tr_b16 a[136:137], v41 offset:0
    v_mfma_f32_16x16x32_bf16 v[152:155], a[168:171], v[240:243], v[152:155]
    buffer_load_dwordx4 v11, s[24:27], s58 offen offset:0 nt lds
    v_mfma_f32_16x16x32_bf16 v[156:159], a[172:175], v[240:243], v[156:159]
    ds_read_b64_tr_b16 a[138:139], v41 offset:4096
    ds_read_b64_tr_b16 a[140:141], v42 offset:0
    v_mfma_f32_16x16x32_bf16 v[160:163], a[176:179], v[240:243], v[160:163]
    ds_read_b64_tr_b16 a[142:143], v42 offset:4096
    ds_read_b64_tr_b16 a[144:145], v43 offset:0
    v_mfma_f32_16x16x32_bf16 v[164:167], a[180:183], v[240:243], v[164:167]
    ds_read_b64_tr_b16 a[146:147], v43 offset:4096
    ds_read_b64_tr_b16 a[148:149], v44 offset:0
    v_mfma_f32_16x16x32_bf16 v[168:171], a[184:187], v[240:243], v[168:171]
    buffer_load_dwordx4 v12, s[24:27], s58 offen offset:1024 nt lds
    v_mfma_f32_16x16x32_bf16 v[172:175], a[188:191], v[240:243], v[172:175]
    ds_read_b64_tr_b16 a[150:151], v44 offset:4096
    ds_read_b64_tr_b16 a[152:153], v45 offset:0
    v_mfma_f32_16x16x32_bf16 a[196:199], a[204:207], v[240:243], a[196:199]
    ds_read_b64_tr_b16 a[154:155], v45 offset:4096
    ds_read_b64_tr_b16 a[156:157], v46 offset:0
    v_mfma_f32_16x16x32_bf16 v[208:211], a[64:67], v[64:67], 0
    ds_read_b64_tr_b16 a[158:159], v46 offset:4096
    ds_read_b64_tr_b16 a[160:161], v47 offset:0
    v_mfma_f32_16x16x32_bf16 v[208:211], a[68:71], v[68:71], v[208:211]
    buffer_load_dwordx4 v13, s[24:27], s58 offen offset:2048 nt lds
    v_mfma_f32_16x16x32_bf16 v[208:211], a[72:75], v[72:75], v[208:211]
    ds_read_b64_tr_b16 a[162:163], v47 offset:4096
    ds_read_b64_tr_b16 a[164:165], v48 offset:0
    v_mfma_f32_16x16x32_bf16 v[208:211], a[76:79], v[76:79], v[208:211]
    ds_read_b64_tr_b16 a[166:167], v48 offset:4096
    ds_read_b64_tr_b16 a[168:169], v49 offset:0
    v_mfma_f32_16x16x32_bf16 v[212:215], a[80:83], v[64:67], 0
    ds_read_b64_tr_b16 a[170:171], v49 offset:4096
    ds_read_b64_tr_b16 a[172:173], v50 offset:0
    v_mfma_f32_16x16x32_bf16 v[212:215], a[84:87], v[68:71], v[212:215]
    buffer_load_dwordx4 v14, s[24:27], s58 offen offset:3072 nt lds
    v_mfma_f32_16x16x32_bf16 v[212:215], a[88:91], v[72:75], v[212:215]
    ds_read_b64_tr_b16 a[174:175], v50 offset:4096
    v_mfma_f32_16x16x32_bf16 v[212:215], a[92:95], v[76:79], v[212:215]
    v_exp_f32 v208, v208
    v_mfma_f32_16x16x32_bf16 v[216:219], a[64:67], v[80:83], 0
    v_exp_f32 v209, v209
    v_mfma_f32_16x16x32_bf16 v[216:219], a[68:71], v[84:87], v[216:219]
    ds_read_b128 a[0:3], v31 offset:16384
    v_cvt_pk_bf16_f32 v208, v208, v209
    v_mfma_f32_16x16x32_bf16 v[216:219], a[72:75], v[88:91], v[216:219]
    v_exp_f32 v210, v210
    v_mfma_f32_16x16x32_bf16 v[216:219], a[76:79], v[92:95], v[216:219]
    v_exp_f32 v211, v211
    v_mfma_f32_16x16x32_bf16 v[220:223], a[80:83], v[80:83], 0
    ds_read_b128 a[4:7], v32 offset:16384
    v_cvt_pk_bf16_f32 v209, v210, v211
    v_mfma_f32_16x16x32_bf16 v[220:223], a[84:87], v[84:87], v[220:223]
    v_exp_f32 v212, v212
    v_mfma_f32_16x16x32_bf16 v[220:223], a[88:91], v[88:91], v[220:223]
    v_exp_f32 v213, v213
    v_mfma_f32_16x16x32_bf16 v[220:223], a[92:95], v[92:95], v[220:223]
    ds_read_b128 a[8:11], v33 offset:16384
    v_cvt_pk_bf16_f32 v210, v212, v213
    v_mfma_f32_16x16x32_bf16 v[224:227], a[64:67], v[96:99], 0
    v_exp_f32 v214, v214
    v_mfma_f32_16x16x32_bf16 v[224:227], a[68:71], v[100:103], v[224:227]
    s_add_u32 s58, s55, 81920
    v_exp_f32 v216, v216
    v_mfma_f32_16x16x32_bf16 v[224:227], a[72:75], v[104:107], v[224:227]
    s_add_u32 m0, s55, 81920
    v_exp_f32 v215, v215
    v_mfma_f32_16x16x32_bf16 v[224:227], a[76:79], v[108:111], v[224:227]
    buffer_load_dwordx4 v15, s[28:31], s58 offen offset:0 nt lds
    v_mfma_f32_16x16x32_bf16 v[228:231], a[80:83], v[96:99], 0
    ds_read_b128 a[12:15], v34 offset:16384
    v_cvt_pk_bf16_f32 v211, v214, v215
    v_mfma_f32_16x16x32_bf16 v[228:231], a[84:87], v[100:103], v[228:231]
    v_exp_f32 v217, v217
    v_mfma_f32_16x16x32_bf16 v[228:231], a[88:91], v[104:107], v[228:231]
    ds_read_b64_tr_b16 a[176:177], v51 offset:0
    ds_read_b64_tr_b16 a[178:179], v51 offset:4096
    v_mfma_f32_16x16x32_bf16 v[228:231], a[92:95], v[108:111], v[228:231]
    ds_read_b128 a[16:19], v31 offset:20480
    v_cvt_pk_bf16_f32 v216, v216, v217
    v_mfma_f32_16x16x32_bf16 v[232:235], a[96:99], v[64:67], 0
    v_exp_f32 v218, v218
    v_mfma_f32_16x16x32_bf16 v[232:235], a[100:103], v[68:71], v[232:235]
    v_exp_f32 v219, v219
    v_mfma_f32_16x16x32_bf16 v[232:235], a[104:107], v[72:75], v[232:235]
    ds_read_b128 a[20:23], v32 offset:20480
    v_cvt_pk_bf16_f32 v217, v218, v219
    v_mfma_f32_16x16x32_bf16 v[232:235], a[108:111], v[76:79], v[232:235]
    v_exp_f32 v220, v220
    v_mfma_f32_16x16x32_bf16 v[236:239], a[112:115], v[64:67], 0
    v_exp_f32 v221, v221
    v_mfma_f32_16x16x32_bf16 v[236:239], a[116:119], v[68:71], v[236:239]
    ds_read_b128 a[24:27], v33 offset:20480
    v_cvt_pk_bf16_f32 v218, v220, v221
    v_mfma_f32_16x16x32_bf16 v[236:239], a[120:123], v[72:75], v[236:239]
    v_exp_f32 v222, v222
    v_mfma_f32_16x16x32_bf16 v[236:239], a[124:127], v[76:79], v[236:239]
    buffer_load_dwordx4 v16, s[28:31], s58 offen offset:1024 nt lds
    v_mfma_f32_16x16x32_bf16 v[240:243], a[96:99], v[80:83], 0
    ds_read_b64_tr_b16 a[180:181], v52 offset:0
    ds_read_b64_tr_b16 a[182:183], v52 offset:4096
    v_mfma_f32_16x16x32_bf16 v[240:243], a[100:103], v[84:87], v[240:243]
    v_exp_f32 v224, v224
    v_mfma_f32_16x16x32_bf16 v[240:243], a[104:107], v[88:91], v[240:243]
    v_exp_f32 v223, v223
    v_mfma_f32_16x16x32_bf16 v[240:243], a[108:111], v[92:95], v[240:243]
    ds_read_b128 a[28:31], v34 offset:20480
    v_cvt_pk_bf16_f32 v219, v222, v223
    v_mfma_f32_16x16x32_bf16 v[244:247], a[112:115], v[80:83], 0
    v_exp_f32 v225, v225
    v_mfma_f32_16x16x32_bf16 v[244:247], a[116:119], v[84:87], v[244:247]
    ds_read_b128 a[32:35], v35 offset:16384
    v_cvt_pk_bf16_f32 v224, v224, v225
    v_mfma_f32_16x16x32_bf16 v[244:247], a[120:123], v[88:91], v[244:247]
    v_exp_f32 v226, v226
    v_mfma_f32_16x16x32_bf16 v[244:247], a[124:127], v[92:95], v[244:247]
    s_waitcnt lgkmcnt(12)
    v_exp_f32 v227, v227
    v_mfma_f32_16x16x32_bf16 v[112:115], a[128:131], v[208:211], v[112:115]
    ds_read_b128 a[36:39], v36 offset:16384
    v_cvt_pk_bf16_f32 v225, v226, v227
    v_mfma_f32_16x16x32_bf16 v[116:119], a[132:135], v[208:211], v[116:119]
    v_exp_f32 v228, v228
    v_mfma_f32_16x16x32_bf16 v[120:123], a[136:139], v[208:211], v[120:123]
    ds_read_b64_tr_b16 a[184:185], v53 offset:0
    ds_read_b64_tr_b16 a[186:187], v53 offset:4096
    v_mfma_f32_16x16x32_bf16 v[124:127], a[140:143], v[208:211], v[124:127]
    buffer_load_dwordx4 v15, s[28:31], s58 offen offset:2048 nt lds
    v_mfma_f32_16x16x32_bf16 v[128:131], a[144:147], v[208:211], v[128:131]
    v_exp_f32 v229, v229
    v_mfma_f32_16x16x32_bf16 v[132:135], a[148:151], v[208:211], v[132:135]
    ds_read_b128 a[40:43], v37 offset:16384
    v_cvt_pk_bf16_f32 v226, v228, v229
    v_mfma_f32_16x16x32_bf16 v[136:139], a[152:155], v[208:211], v[136:139]
    v_exp_f32 v230, v230
    v_mfma_f32_16x16x32_bf16 v[140:143], a[156:159], v[208:211], v[140:143]
    v_exp_f32 v232, v232
    v_mfma_f32_16x16x32_bf16 a[192:195], a[204:207], v[208:211], a[192:195]
    v_exp_f32 v231, v231
    v_mfma_f32_16x16x32_bf16 v[144:147], a[128:131], v[216:219], v[144:147]
    ds_read_b128 a[44:47], v38 offset:16384
    v_cvt_pk_bf16_f32 v227, v230, v231
    v_mfma_f32_16x16x32_bf16 v[148:151], a[132:135], v[216:219], v[148:151]
    v_exp_f32 v233, v233
    v_mfma_f32_16x16x32_bf16 v[152:155], a[136:139], v[216:219], v[152:155]
    ds_read_b128 a[48:51], v35 offset:20480
    v_cvt_pk_bf16_f32 v232, v232, v233
    v_mfma_f32_16x16x32_bf16 v[156:159], a[140:143], v[216:219], v[156:159]
    ds_read_b64_tr_b16 a[188:189], v54 offset:0
    ds_read_b64_tr_b16 a[190:191], v54 offset:4096
    v_mfma_f32_16x16x32_bf16 v[160:163], a[144:147], v[216:219], v[160:163]
    v_exp_f32 v234, v234
    v_mfma_f32_16x16x32_bf16 v[164:167], a[148:151], v[216:219], v[164:167]
    v_exp_f32 v235, v235
    v_mfma_f32_16x16x32_bf16 v[168:171], a[152:155], v[216:219], v[168:171]
    buffer_load_dwordx4 v16, s[28:31], s58 offen offset:3072 nt lds
    v_mfma_f32_16x16x32_bf16 v[172:175], a[156:159], v[216:219], v[172:175]
    ds_read_b128 a[52:55], v36 offset:20480
    v_cvt_pk_bf16_f32 v233, v234, v235
    v_mfma_f32_16x16x32_bf16 a[196:199], a[204:207], v[216:219], a[196:199]
    v_exp_f32 v236, v236
    v_mfma_f32_16x16x32_bf16 v[176:179], a[128:131], v[224:227], v[176:179]
    v_exp_f32 v237, v237
    v_mfma_f32_16x16x32_bf16 v[180:183], a[132:135], v[224:227], v[180:183]
    ds_read_b128 a[56:59], v37 offset:20480
    v_cvt_pk_bf16_f32 v234, v236, v237
    v_mfma_f32_16x16x32_bf16 v[184:187], a[136:139], v[224:227], v[184:187]
    v_exp_f32 v238, v238
    v_mfma_f32_16x16x32_bf16 v[188:191], a[140:143], v[224:227], v[188:191]
    v_exp_f32 v240, v240
    v_mfma_f32_16x16x32_bf16 v[192:195], a[144:147], v[224:227], v[192:195]
    v_exp_f32 v239, v239
    v_mfma_f32_16x16x32_bf16 v[196:199], a[148:151], v[224:227], v[196:199]
    v_exp_f32 v241, v241
    v_mfma_f32_16x16x32_bf16 v[200:203], a[152:155], v[224:227], v[200:203]
    ds_read_b128 a[60:63], v38 offset:20480
    v_cvt_pk_bf16_f32 v235, v238, v239
    v_mfma_f32_16x16x32_bf16 v[204:207], a[156:159], v[224:227], v[204:207]
    v_exp_f32 v242, v242
    v_cvt_pk_bf16_f32 v240, v240, v241
    v_mfma_f32_16x16x32_bf16 a[200:203], a[204:207], v[224:227], a[200:203]
    v_exp_f32 v243, v243
    v_mfma_f32_16x16x32_bf16 v[112:115], a[160:163], v[232:235], v[112:115]
    v_exp_f32 v244, v244
    v_mfma_f32_16x16x32_bf16 v[116:119], a[164:167], v[232:235], v[116:119]
    v_cvt_pk_bf16_f32 v241, v242, v243
    v_mfma_f32_16x16x32_bf16 v[120:123], a[168:171], v[232:235], v[120:123]
    v_exp_f32 v245, v245
    v_mfma_f32_16x16x32_bf16 v[124:127], a[172:175], v[232:235], v[124:127]
    s_waitcnt lgkmcnt(12)
    v_exp_f32 v246, v246
    v_mfma_f32_16x16x32_bf16 v[128:131], a[176:179], v[232:235], v[128:131]
    buffer_load_dword v29, v1, s[4:7], s18 offen sc1
    v_cvt_pk_bf16_f32 v242, v244, v245
    v_mfma_f32_16x16x32_bf16 v[132:135], a[180:183], v[232:235], v[132:135]
    s_waitcnt lgkmcnt(8)
    v_exp_f32 v247, v247
    v_mfma_f32_16x16x32_bf16 v[136:139], a[184:187], v[232:235], v[136:139]
    s_waitcnt lgkmcnt(3)
    v_cvt_pk_bf16_f32 v243, v246, v247
    v_mfma_f32_16x16x32_bf16 v[140:143], a[188:191], v[232:235], v[140:143]
    s_waitcnt vmcnt(13) lgkmcnt(0)
    v_mfma_f32_16x16x32_bf16 a[192:195], a[204:207], v[232:235], a[192:195]
    s_barrier
    ds_read_b64_tr_b16 a[128:129], v39 offset:16384
    v_mfma_f32_16x16x32_bf16 v[144:147], a[160:163], v[240:243], v[144:147]
    s_add_u32 s58, s55, 114688
    ds_read_b64_tr_b16 a[130:131], v39 offset:20480
    ds_read_b64_tr_b16 a[132:133], v40 offset:16384
    v_mfma_f32_16x16x32_bf16 v[148:151], a[164:167], v[240:243], v[148:151]
    s_add_u32 m0, s55, 16384
    ds_read_b64_tr_b16 a[134:135], v40 offset:20480
    ds_read_b64_tr_b16 a[136:137], v41 offset:16384
    v_mfma_f32_16x16x32_bf16 v[152:155], a[168:171], v[240:243], v[152:155]
    buffer_load_dwordx4 v11, s[24:27], s58 offen offset:0 nt lds
    v_mfma_f32_16x16x32_bf16 v[156:159], a[172:175], v[240:243], v[156:159]
    ds_read_b64_tr_b16 a[138:139], v41 offset:20480
    ds_read_b64_tr_b16 a[140:141], v42 offset:16384
    v_mfma_f32_16x16x32_bf16 v[160:163], a[176:179], v[240:243], v[160:163]
    ds_read_b64_tr_b16 a[142:143], v42 offset:20480
    ds_read_b64_tr_b16 a[144:145], v43 offset:16384
    v_mfma_f32_16x16x32_bf16 v[164:167], a[180:183], v[240:243], v[164:167]
    ds_read_b64_tr_b16 a[146:147], v43 offset:20480
    ds_read_b64_tr_b16 a[148:149], v44 offset:16384
    v_mfma_f32_16x16x32_bf16 v[168:171], a[184:187], v[240:243], v[168:171]
    buffer_load_dwordx4 v12, s[24:27], s58 offen offset:1024 nt lds
    v_mfma_f32_16x16x32_bf16 v[172:175], a[188:191], v[240:243], v[172:175]
    ds_read_b64_tr_b16 a[150:151], v44 offset:20480
    ds_read_b64_tr_b16 a[152:153], v45 offset:16384
    v_mfma_f32_16x16x32_bf16 a[196:199], a[204:207], v[240:243], a[196:199]
    ds_read_b64_tr_b16 a[154:155], v45 offset:20480
    ds_read_b64_tr_b16 a[156:157], v46 offset:16384
    v_mfma_f32_16x16x32_bf16 v[208:211], a[0:3], v[64:67], 0
    ds_read_b64_tr_b16 a[158:159], v46 offset:20480
    ds_read_b64_tr_b16 a[160:161], v47 offset:16384
    v_mfma_f32_16x16x32_bf16 v[208:211], a[4:7], v[68:71], v[208:211]
    buffer_load_dwordx4 v13, s[24:27], s58 offen offset:2048 nt lds
    v_mfma_f32_16x16x32_bf16 v[208:211], a[8:11], v[72:75], v[208:211]
    ds_read_b64_tr_b16 a[162:163], v47 offset:20480
    ds_read_b64_tr_b16 a[164:165], v48 offset:16384
    v_mfma_f32_16x16x32_bf16 v[208:211], a[12:15], v[76:79], v[208:211]
    ds_read_b64_tr_b16 a[166:167], v48 offset:20480
    ds_read_b64_tr_b16 a[168:169], v49 offset:16384
    v_mfma_f32_16x16x32_bf16 v[212:215], a[16:19], v[64:67], 0
    ds_read_b64_tr_b16 a[170:171], v49 offset:20480
    ds_read_b64_tr_b16 a[172:173], v50 offset:16384
    v_mfma_f32_16x16x32_bf16 v[212:215], a[20:23], v[68:71], v[212:215]
    buffer_load_dwordx4 v14, s[24:27], s58 offen offset:3072 nt lds
    v_mfma_f32_16x16x32_bf16 v[212:215], a[24:27], v[72:75], v[212:215]
    ds_read_b64_tr_b16 a[174:175], v50 offset:20480
    v_mfma_f32_16x16x32_bf16 v[212:215], a[28:31], v[76:79], v[212:215]
    v_exp_f32 v208, v208
    v_mfma_f32_16x16x32_bf16 v[216:219], a[0:3], v[80:83], 0
    v_exp_f32 v209, v209
    v_mfma_f32_16x16x32_bf16 v[216:219], a[4:7], v[84:87], v[216:219]
    ds_read_b128 a[64:67], v31 offset:32768
    v_cvt_pk_bf16_f32 v208, v208, v209
    v_mfma_f32_16x16x32_bf16 v[216:219], a[8:11], v[88:91], v[216:219]
    v_exp_f32 v210, v210
    v_mfma_f32_16x16x32_bf16 v[216:219], a[12:15], v[92:95], v[216:219]
    v_exp_f32 v211, v211
    v_mfma_f32_16x16x32_bf16 v[220:223], a[16:19], v[80:83], 0
    ds_read_b128 a[68:71], v32 offset:32768
    v_cvt_pk_bf16_f32 v209, v210, v211
    v_mfma_f32_16x16x32_bf16 v[220:223], a[20:23], v[84:87], v[220:223]
    v_exp_f32 v212, v212
    v_mfma_f32_16x16x32_bf16 v[220:223], a[24:27], v[88:91], v[220:223]
    v_exp_f32 v213, v213
    v_mfma_f32_16x16x32_bf16 v[220:223], a[28:31], v[92:95], v[220:223]
    ds_read_b128 a[72:75], v33 offset:32768
    v_cvt_pk_bf16_f32 v210, v212, v213
    v_mfma_f32_16x16x32_bf16 v[224:227], a[0:3], v[96:99], 0
    v_exp_f32 v214, v214
    v_mfma_f32_16x16x32_bf16 v[224:227], a[4:7], v[100:103], v[224:227]
    s_add_u32 s58, s55, 98304
    v_exp_f32 v216, v216
    v_mfma_f32_16x16x32_bf16 v[224:227], a[8:11], v[104:107], v[224:227]
    s_add_u32 m0, s55, 49152
    v_exp_f32 v215, v215
    v_mfma_f32_16x16x32_bf16 v[224:227], a[12:15], v[108:111], v[224:227]
    buffer_load_dwordx4 v15, s[28:31], s58 offen offset:0 nt lds
    v_mfma_f32_16x16x32_bf16 v[228:231], a[16:19], v[96:99], 0
    ds_read_b128 a[76:79], v34 offset:32768
    v_cvt_pk_bf16_f32 v211, v214, v215
    v_mfma_f32_16x16x32_bf16 v[228:231], a[20:23], v[100:103], v[228:231]
    v_exp_f32 v217, v217
    v_mfma_f32_16x16x32_bf16 v[228:231], a[24:27], v[104:107], v[228:231]
    ds_read_b64_tr_b16 a[176:177], v51 offset:16384
    ds_read_b64_tr_b16 a[178:179], v51 offset:20480
    v_mfma_f32_16x16x32_bf16 v[228:231], a[28:31], v[108:111], v[228:231]
standalone__gqa_block_cached__near_ridge_b_h0_3:
    s_cbranch_execz standalone__gqa_block_cached__near_ridge_b_h0_r
    ds_read_b128 a[80:83], v31 offset:36864
    v_cvt_pk_bf16_f32 v216, v216, v217
    v_mfma_f32_16x16x32_bf16 v[232:235], a[32:35], v[64:67], 0
    v_exp_f32 v218, v218
    v_mfma_f32_16x16x32_bf16 v[232:235], a[36:39], v[68:71], v[232:235]
    v_exp_f32 v219, v219
    v_mfma_f32_16x16x32_bf16 v[232:235], a[40:43], v[72:75], v[232:235]
    ds_read_b128 a[84:87], v32 offset:36864
    v_cvt_pk_bf16_f32 v217, v218, v219
    v_mfma_f32_16x16x32_bf16 v[232:235], a[44:47], v[76:79], v[232:235]
    v_exp_f32 v220, v220
    v_mfma_f32_16x16x32_bf16 v[236:239], a[48:51], v[64:67], 0
    v_exp_f32 v221, v221
    v_mfma_f32_16x16x32_bf16 v[236:239], a[52:55], v[68:71], v[236:239]
    ds_read_b128 a[88:91], v33 offset:36864
    v_cvt_pk_bf16_f32 v218, v220, v221
    v_mfma_f32_16x16x32_bf16 v[236:239], a[56:59], v[72:75], v[236:239]
    v_exp_f32 v222, v222
    v_mfma_f32_16x16x32_bf16 v[236:239], a[60:63], v[76:79], v[236:239]
    buffer_load_dwordx4 v16, s[28:31], s58 offen offset:1024 nt lds
    v_mfma_f32_16x16x32_bf16 v[240:243], a[32:35], v[80:83], 0
    ds_read_b64_tr_b16 a[180:181], v52 offset:16384
    ds_read_b64_tr_b16 a[182:183], v52 offset:20480
    v_mfma_f32_16x16x32_bf16 v[240:243], a[36:39], v[84:87], v[240:243]
    v_exp_f32 v224, v224
    v_mfma_f32_16x16x32_bf16 v[240:243], a[40:43], v[88:91], v[240:243]
    v_exp_f32 v223, v223
    v_mfma_f32_16x16x32_bf16 v[240:243], a[44:47], v[92:95], v[240:243]
    ds_read_b128 a[92:95], v34 offset:36864
    v_cvt_pk_bf16_f32 v219, v222, v223
    v_mfma_f32_16x16x32_bf16 v[244:247], a[48:51], v[80:83], 0
    v_exp_f32 v225, v225
    v_mfma_f32_16x16x32_bf16 v[244:247], a[52:55], v[84:87], v[244:247]
    ds_read_b128 a[96:99], v35 offset:32768
    v_cvt_pk_bf16_f32 v224, v224, v225
    v_mfma_f32_16x16x32_bf16 v[244:247], a[56:59], v[88:91], v[244:247]
    v_exp_f32 v226, v226
    v_mfma_f32_16x16x32_bf16 v[244:247], a[60:63], v[92:95], v[244:247]
    s_waitcnt lgkmcnt(12)
    v_exp_f32 v227, v227
    v_mfma_f32_16x16x32_bf16 v[112:115], a[128:131], v[208:211], v[112:115]
    ds_read_b128 a[100:103], v36 offset:32768
    v_cvt_pk_bf16_f32 v225, v226, v227
    v_mfma_f32_16x16x32_bf16 v[116:119], a[132:135], v[208:211], v[116:119]
    v_exp_f32 v228, v228
    v_mfma_f32_16x16x32_bf16 v[120:123], a[136:139], v[208:211], v[120:123]
    ds_read_b64_tr_b16 a[184:185], v53 offset:16384
    ds_read_b64_tr_b16 a[186:187], v53 offset:20480
    v_mfma_f32_16x16x32_bf16 v[124:127], a[140:143], v[208:211], v[124:127]
    buffer_load_dwordx4 v15, s[28:31], s58 offen offset:2048 nt lds
    v_mfma_f32_16x16x32_bf16 v[128:131], a[144:147], v[208:211], v[128:131]
    v_exp_f32 v229, v229
    v_mfma_f32_16x16x32_bf16 v[132:135], a[148:151], v[208:211], v[132:135]
    ds_read_b128 a[104:107], v37 offset:32768
    v_cvt_pk_bf16_f32 v226, v228, v229
    v_mfma_f32_16x16x32_bf16 v[136:139], a[152:155], v[208:211], v[136:139]
    v_exp_f32 v230, v230
    v_mfma_f32_16x16x32_bf16 v[140:143], a[156:159], v[208:211], v[140:143]
    v_exp_f32 v232, v232
    v_mfma_f32_16x16x32_bf16 a[192:195], a[204:207], v[208:211], a[192:195]
    v_exp_f32 v231, v231
    v_mfma_f32_16x16x32_bf16 v[144:147], a[128:131], v[216:219], v[144:147]
    ds_read_b128 a[108:111], v38 offset:32768
    v_cvt_pk_bf16_f32 v227, v230, v231
    v_mfma_f32_16x16x32_bf16 v[148:151], a[132:135], v[216:219], v[148:151]
    v_exp_f32 v233, v233
    v_mfma_f32_16x16x32_bf16 v[152:155], a[136:139], v[216:219], v[152:155]
    ds_read_b128 a[112:115], v35 offset:36864
    v_cvt_pk_bf16_f32 v232, v232, v233
    v_mfma_f32_16x16x32_bf16 v[156:159], a[140:143], v[216:219], v[156:159]
    ds_read_b64_tr_b16 a[188:189], v54 offset:16384
    ds_read_b64_tr_b16 a[190:191], v54 offset:20480
    v_mfma_f32_16x16x32_bf16 v[160:163], a[144:147], v[216:219], v[160:163]
    v_exp_f32 v234, v234
    v_mfma_f32_16x16x32_bf16 v[164:167], a[148:151], v[216:219], v[164:167]
    v_exp_f32 v235, v235
    v_mfma_f32_16x16x32_bf16 v[168:171], a[152:155], v[216:219], v[168:171]
    buffer_load_dwordx4 v16, s[28:31], s58 offen offset:3072 nt lds
    v_mfma_f32_16x16x32_bf16 v[172:175], a[156:159], v[216:219], v[172:175]
    ds_read_b128 a[116:119], v36 offset:36864
    v_cvt_pk_bf16_f32 v233, v234, v235
    v_mfma_f32_16x16x32_bf16 a[196:199], a[204:207], v[216:219], a[196:199]
    v_exp_f32 v236, v236
    v_mfma_f32_16x16x32_bf16 v[176:179], a[128:131], v[224:227], v[176:179]
    v_exp_f32 v237, v237
    v_mfma_f32_16x16x32_bf16 v[180:183], a[132:135], v[224:227], v[180:183]
    ds_read_b128 a[120:123], v37 offset:36864
    v_cvt_pk_bf16_f32 v234, v236, v237
    v_mfma_f32_16x16x32_bf16 v[184:187], a[136:139], v[224:227], v[184:187]
    v_exp_f32 v238, v238
    v_mfma_f32_16x16x32_bf16 v[188:191], a[140:143], v[224:227], v[188:191]
    v_exp_f32 v240, v240
    v_mfma_f32_16x16x32_bf16 v[192:195], a[144:147], v[224:227], v[192:195]
    v_exp_f32 v239, v239
    v_mfma_f32_16x16x32_bf16 v[196:199], a[148:151], v[224:227], v[196:199]
    v_exp_f32 v241, v241
    v_mfma_f32_16x16x32_bf16 v[200:203], a[152:155], v[224:227], v[200:203]
    ds_read_b128 a[124:127], v38 offset:36864
    v_cvt_pk_bf16_f32 v235, v238, v239
    v_mfma_f32_16x16x32_bf16 v[204:207], a[156:159], v[224:227], v[204:207]
    v_exp_f32 v242, v242
    v_cvt_pk_bf16_f32 v240, v240, v241
    v_mfma_f32_16x16x32_bf16 a[200:203], a[204:207], v[224:227], a[200:203]
    v_exp_f32 v243, v243
    v_mfma_f32_16x16x32_bf16 v[112:115], a[160:163], v[232:235], v[112:115]
    v_exp_f32 v244, v244
    v_mfma_f32_16x16x32_bf16 v[116:119], a[164:167], v[232:235], v[116:119]
    v_cvt_pk_bf16_f32 v241, v242, v243
    v_mfma_f32_16x16x32_bf16 v[120:123], a[168:171], v[232:235], v[120:123]
    v_exp_f32 v245, v245
    v_mfma_f32_16x16x32_bf16 v[124:127], a[172:175], v[232:235], v[124:127]
    s_waitcnt lgkmcnt(12)
    v_exp_f32 v246, v246
    v_mfma_f32_16x16x32_bf16 v[128:131], a[176:179], v[232:235], v[128:131]
    v_cvt_pk_bf16_f32 v242, v244, v245
    v_mfma_f32_16x16x32_bf16 v[132:135], a[180:183], v[232:235], v[132:135]
    s_waitcnt lgkmcnt(8)
    v_exp_f32 v247, v247
    v_mfma_f32_16x16x32_bf16 v[136:139], a[184:187], v[232:235], v[136:139]
    s_waitcnt lgkmcnt(3)
    v_cvt_pk_bf16_f32 v243, v246, v247
    v_mfma_f32_16x16x32_bf16 v[140:143], a[188:191], v[232:235], v[140:143]
    s_waitcnt vmcnt(9) lgkmcnt(0)
    v_mfma_f32_16x16x32_bf16 a[192:195], a[204:207], v[232:235], a[192:195]
    s_barrier
    ds_read_b64_tr_b16 a[128:129], v39 offset:32768
    v_mfma_f32_16x16x32_bf16 v[144:147], a[160:163], v[240:243], v[144:147]
    s_add_u32 s58, s55, 114688
    ds_read_b64_tr_b16 a[130:131], v39 offset:36864
    ds_read_b64_tr_b16 a[132:133], v40 offset:32768
    v_mfma_f32_16x16x32_bf16 v[148:151], a[164:167], v[240:243], v[148:151]
    s_add_u32 m0, s55, 65536
    ds_read_b64_tr_b16 a[134:135], v40 offset:36864
    ds_read_b64_tr_b16 a[136:137], v41 offset:32768
    v_mfma_f32_16x16x32_bf16 v[152:155], a[168:171], v[240:243], v[152:155]
    buffer_load_dwordx4 v15, s[28:31], s58 offen offset:0 nt lds
    v_mfma_f32_16x16x32_bf16 v[156:159], a[172:175], v[240:243], v[156:159]
    ds_read_b64_tr_b16 a[138:139], v41 offset:36864
    ds_read_b64_tr_b16 a[140:141], v42 offset:32768
    v_mfma_f32_16x16x32_bf16 v[160:163], a[176:179], v[240:243], v[160:163]
    ds_read_b64_tr_b16 a[142:143], v42 offset:36864
    ds_read_b64_tr_b16 a[144:145], v43 offset:32768
    v_mfma_f32_16x16x32_bf16 v[164:167], a[180:183], v[240:243], v[164:167]
    ds_read_b64_tr_b16 a[146:147], v43 offset:36864
    ds_read_b64_tr_b16 a[148:149], v44 offset:32768
    v_mfma_f32_16x16x32_bf16 v[168:171], a[184:187], v[240:243], v[168:171]
    buffer_load_dwordx4 v16, s[28:31], s58 offen offset:1024 nt lds
    v_mfma_f32_16x16x32_bf16 v[172:175], a[188:191], v[240:243], v[172:175]
    ds_read_b64_tr_b16 a[150:151], v44 offset:36864
    ds_read_b64_tr_b16 a[152:153], v45 offset:32768
    v_mfma_f32_16x16x32_bf16 a[196:199], a[204:207], v[240:243], a[196:199]
    ds_read_b64_tr_b16 a[154:155], v45 offset:36864
    ds_read_b64_tr_b16 a[156:157], v46 offset:32768
    v_mfma_f32_16x16x32_bf16 v[208:211], a[64:67], v[64:67], 0
    ds_read_b64_tr_b16 a[158:159], v46 offset:36864
    ds_read_b64_tr_b16 a[160:161], v47 offset:32768
    v_mfma_f32_16x16x32_bf16 v[208:211], a[68:71], v[68:71], v[208:211]
    buffer_load_dwordx4 v15, s[28:31], s58 offen offset:2048 nt lds
    v_mfma_f32_16x16x32_bf16 v[208:211], a[72:75], v[72:75], v[208:211]
    ds_read_b64_tr_b16 a[162:163], v47 offset:36864
    ds_read_b64_tr_b16 a[164:165], v48 offset:32768
    v_mfma_f32_16x16x32_bf16 v[208:211], a[76:79], v[76:79], v[208:211]
    ds_read_b64_tr_b16 a[166:167], v48 offset:36864
    ds_read_b64_tr_b16 a[168:169], v49 offset:32768
    v_mfma_f32_16x16x32_bf16 v[212:215], a[80:83], v[64:67], 0
    ds_read_b64_tr_b16 a[170:171], v49 offset:36864
    ds_read_b64_tr_b16 a[172:173], v50 offset:32768
    v_mfma_f32_16x16x32_bf16 v[212:215], a[84:87], v[68:71], v[212:215]
    buffer_load_dwordx4 v16, s[28:31], s58 offen offset:3072 nt lds
    v_mfma_f32_16x16x32_bf16 v[212:215], a[88:91], v[72:75], v[212:215]
    ds_read_b64_tr_b16 a[174:175], v50 offset:36864
    v_mfma_f32_16x16x32_bf16 v[212:215], a[92:95], v[76:79], v[212:215]
    v_exp_f32 v208, v208
    v_mfma_f32_16x16x32_bf16 v[216:219], a[64:67], v[80:83], 0
    buffer_load_dword v255, v252, s[36:39], s73 offen offset:0
    v_mfma_f32_16x16x32_bf16 v[216:219], a[68:71], v[84:87], v[216:219]
    v_exp_f32 v209, v209
    v_mfma_f32_16x16x32_bf16 v[216:219], a[72:75], v[88:91], v[216:219]
    s_mul_i32 s57, s48, 5120
    ds_read_b128 a[0:3], v31 offset:0
    v_cvt_pk_bf16_f32 v208, v208, v209
    v_mfma_f32_16x16x32_bf16 v[216:219], a[76:79], v[92:95], v[216:219]
    s_add_u32 s57, s57, 65536
    ds_read_b128 a[4:7], v32 offset:0
    v_add_u32 v55, s57, v3
    v_mfma_f32_16x16x32_bf16 v[220:223], a[80:83], v[80:83], 0
    s_xor_b32 s57, s48, 1
    buffer_load_dword v255, v253, s[36:39], s74 offen offset:512
    v_mfma_f32_16x16x32_bf16 v[220:223], a[84:87], v[84:87], v[220:223]
    s_mul_i32 s57, s57, 5120
    v_exp_f32 v210, v210
    v_mfma_f32_16x16x32_bf16 v[220:223], a[88:91], v[88:91], v[220:223]
    s_add_u32 s57, s57, 65536
    ds_read_b128 a[8:11], v33 offset:0
    v_add_u32 v56, s57, v3
    v_mfma_f32_16x16x32_bf16 v[220:223], a[92:95], v[92:95], v[220:223]
    s_lshl_b32 s57, s48, 2
    v_exp_f32 v211, v211
    v_mfma_f32_16x16x32_bf16 v[224:227], a[64:67], v[96:99], 0
    s_add_u32 s57, s57, 86016
    ds_read_b128 a[12:15], v34 offset:0
    v_cvt_pk_bf16_f32 v209, v210, v211
    v_mfma_f32_16x16x32_bf16 v[224:227], a[68:71], v[100:103], v[224:227]
    ds_read_b128 a[16:19], v31 offset:4096
    v_mov_b32 v57, s57
    v_mfma_f32_16x16x32_bf16 v[224:227], a[72:75], v[104:107], v[224:227]
    ds_read_b128 a[20:23], v32 offset:4096
    v_mov_b32 v251, v254
    v_mfma_f32_16x16x32_bf16 v[224:227], a[76:79], v[108:111], v[224:227]
    v_exp_f32 v212, v212
    v_mfma_f32_16x16x32_bf16 v[228:231], a[80:83], v[96:99], 0
    v_exp_f32 v213, v213
    v_mfma_f32_16x16x32_bf16 v[228:231], a[84:87], v[100:103], v[228:231]
    ds_read_b128 a[24:27], v33 offset:4096
    v_cvt_pk_bf16_f32 v210, v212, v213
    v_mfma_f32_16x16x32_bf16 v[228:231], a[88:91], v[104:107], v[228:231]
    ds_read_b64_tr_b16 a[176:177], v51 offset:32768
    ds_read_b64_tr_b16 a[178:179], v51 offset:36864
    v_mfma_f32_16x16x32_bf16 v[228:231], a[92:95], v[108:111], v[228:231]
    v_exp_f32 v214, v214
    v_mfma_f32_16x16x32_bf16 v[232:235], a[96:99], v[64:67], 0
    v_exp_f32 v216, v216
    v_mfma_f32_16x16x32_bf16 v[232:235], a[100:103], v[68:71], v[232:235]
    v_exp_f32 v215, v215
    v_mfma_f32_16x16x32_bf16 v[232:235], a[104:107], v[72:75], v[232:235]
    ds_read_b128 a[28:31], v34 offset:4096
    v_cvt_pk_bf16_f32 v211, v214, v215
    v_mfma_f32_16x16x32_bf16 v[232:235], a[108:111], v[76:79], v[232:235]
    v_exp_f32 v217, v217
    v_mfma_f32_16x16x32_bf16 v[236:239], a[112:115], v[64:67], 0
    ds_read_b128 a[32:35], v35 offset:0
    v_cvt_pk_bf16_f32 v216, v216, v217
    v_mfma_f32_16x16x32_bf16 v[236:239], a[116:119], v[68:71], v[236:239]
    v_exp_f32 v218, v218
    v_mfma_f32_16x16x32_bf16 v[236:239], a[120:123], v[72:75], v[236:239]
    v_exp_f32 v219, v219
    v_mfma_f32_16x16x32_bf16 v[236:239], a[124:127], v[76:79], v[236:239]
    ds_read_b128 a[36:39], v36 offset:0
    v_cvt_pk_bf16_f32 v217, v218, v219
    v_mfma_f32_16x16x32_bf16 v[240:243], a[96:99], v[80:83], 0
    ds_read_b64_tr_b16 a[180:181], v52 offset:32768
    ds_read_b64_tr_b16 a[182:183], v52 offset:36864
    v_mfma_f32_16x16x32_bf16 v[240:243], a[100:103], v[84:87], v[240:243]
    v_exp_f32 v220, v220
    v_mfma_f32_16x16x32_bf16 v[240:243], a[104:107], v[88:91], v[240:243]
    v_exp_f32 v221, v221
    v_mfma_f32_16x16x32_bf16 v[240:243], a[108:111], v[92:95], v[240:243]
    ds_read_b128 a[40:43], v37 offset:0
    v_cvt_pk_bf16_f32 v218, v220, v221
    v_mfma_f32_16x16x32_bf16 v[244:247], a[112:115], v[80:83], 0
    v_exp_f32 v222, v222
    v_mfma_f32_16x16x32_bf16 v[244:247], a[116:119], v[84:87], v[244:247]
    v_exp_f32 v224, v224
    v_mfma_f32_16x16x32_bf16 v[244:247], a[120:123], v[88:91], v[244:247]
    v_exp_f32 v223, v223
    v_mfma_f32_16x16x32_bf16 v[244:247], a[124:127], v[92:95], v[244:247]
    s_waitcnt lgkmcnt(12)
    ds_read_b128 a[44:47], v38 offset:0
    v_cvt_pk_bf16_f32 v219, v222, v223
    v_mfma_f32_16x16x32_bf16 v[112:115], a[128:131], v[208:211], v[112:115]
    v_exp_f32 v225, v225
    v_mfma_f32_16x16x32_bf16 v[116:119], a[132:135], v[208:211], v[116:119]
    ds_read_b128 a[48:51], v35 offset:4096
    v_cvt_pk_bf16_f32 v224, v224, v225
    v_mfma_f32_16x16x32_bf16 v[120:123], a[136:139], v[208:211], v[120:123]
    ds_read_b64_tr_b16 a[184:185], v53 offset:32768
    ds_read_b64_tr_b16 a[186:187], v53 offset:36864
    v_mfma_f32_16x16x32_bf16 v[124:127], a[140:143], v[208:211], v[124:127]
    v_exp_f32 v226, v226
    v_mfma_f32_16x16x32_bf16 v[128:131], a[144:147], v[208:211], v[128:131]
    v_exp_f32 v227, v227
    v_mfma_f32_16x16x32_bf16 v[132:135], a[148:151], v[208:211], v[132:135]
    ds_read_b128 a[52:55], v36 offset:4096
    v_cvt_pk_bf16_f32 v225, v226, v227
    v_mfma_f32_16x16x32_bf16 v[136:139], a[152:155], v[208:211], v[136:139]
    v_exp_f32 v228, v228
    v_mfma_f32_16x16x32_bf16 v[140:143], a[156:159], v[208:211], v[140:143]
    v_exp_f32 v229, v229
    v_mfma_f32_16x16x32_bf16 a[192:195], a[204:207], v[208:211], a[192:195]
    ds_read_b128 a[56:59], v37 offset:4096
    v_cvt_pk_bf16_f32 v226, v228, v229
    v_mfma_f32_16x16x32_bf16 v[144:147], a[128:131], v[216:219], v[144:147]
    v_exp_f32 v230, v230
    v_mfma_f32_16x16x32_bf16 v[148:151], a[132:135], v[216:219], v[148:151]
    v_exp_f32 v232, v232
    v_mfma_f32_16x16x32_bf16 v[152:155], a[136:139], v[216:219], v[152:155]
    v_exp_f32 v231, v231
    v_mfma_f32_16x16x32_bf16 v[156:159], a[140:143], v[216:219], v[156:159]
    ds_read_b64_tr_b16 a[188:189], v54 offset:32768
    ds_read_b64_tr_b16 a[190:191], v54 offset:36864
    v_mfma_f32_16x16x32_bf16 v[160:163], a[144:147], v[216:219], v[160:163]
    ds_read_b128 a[60:63], v38 offset:4096
    v_cvt_pk_bf16_f32 v227, v230, v231
    v_mfma_f32_16x16x32_bf16 v[164:167], a[148:151], v[216:219], v[164:167]
    v_exp_f32 v233, v233
    v_mfma_f32_16x16x32_bf16 v[168:171], a[152:155], v[216:219], v[168:171]
    v_exp_f32 v234, v234
    v_mfma_f32_16x16x32_bf16 v[172:175], a[156:159], v[216:219], v[172:175]
    v_cvt_pk_bf16_f32 v232, v232, v233
    v_mfma_f32_16x16x32_bf16 a[196:199], a[204:207], v[216:219], a[196:199]
    v_exp_f32 v235, v235
    v_mfma_f32_16x16x32_bf16 v[176:179], a[128:131], v[224:227], v[176:179]
    v_exp_f32 v236, v236
    v_mfma_f32_16x16x32_bf16 v[180:183], a[132:135], v[224:227], v[180:183]
    v_cvt_pk_bf16_f32 v233, v234, v235
    v_mfma_f32_16x16x32_bf16 v[184:187], a[136:139], v[224:227], v[184:187]
    v_exp_f32 v237, v237
    v_mfma_f32_16x16x32_bf16 v[188:191], a[140:143], v[224:227], v[188:191]
    v_exp_f32 v238, v238
    v_mfma_f32_16x16x32_bf16 v[192:195], a[144:147], v[224:227], v[192:195]
    v_cvt_pk_bf16_f32 v234, v236, v237
    v_exp_f32 v240, v240
    v_mfma_f32_16x16x32_bf16 v[196:199], a[148:151], v[224:227], v[196:199]
    v_exp_f32 v239, v239
    v_exp_f32 v241, v241
    v_mfma_f32_16x16x32_bf16 v[200:203], a[152:155], v[224:227], v[200:203]
    v_cvt_pk_bf16_f32 v235, v238, v239
    v_cvt_pk_bf16_f32 v240, v240, v241
    v_mfma_f32_16x16x32_bf16 v[204:207], a[156:159], v[224:227], v[204:207]
    v_exp_f32 v242, v242
    v_mfma_f32_16x16x32_bf16 a[200:203], a[204:207], v[224:227], a[200:203]
    v_exp_f32 v243, v243
    v_mfma_f32_16x16x32_bf16 v[112:115], a[160:163], v[232:235], v[112:115]
    v_exp_f32 v244, v244
    v_mfma_f32_16x16x32_bf16 v[116:119], a[164:167], v[232:235], v[116:119]
    v_cvt_pk_bf16_f32 v241, v242, v243
    v_mfma_f32_16x16x32_bf16 v[120:123], a[168:171], v[232:235], v[120:123]
    v_exp_f32 v245, v245
    v_mfma_f32_16x16x32_bf16 v[124:127], a[172:175], v[232:235], v[124:127]
    s_waitcnt lgkmcnt(12)
    v_exp_f32 v246, v246
    v_mfma_f32_16x16x32_bf16 v[128:131], a[176:179], v[232:235], v[128:131]
    s_waitcnt lgkmcnt(10)
    v_cvt_pk_bf16_f32 v242, v244, v245
    v_mfma_f32_16x16x32_bf16 v[132:135], a[180:183], v[232:235], v[132:135]
    s_waitcnt lgkmcnt(5)
    v_exp_f32 v247, v247
    v_mfma_f32_16x16x32_bf16 v[136:139], a[184:187], v[232:235], v[136:139]
    s_waitcnt lgkmcnt(1)
    v_cvt_pk_bf16_f32 v243, v246, v247
    v_mfma_f32_16x16x32_bf16 v[140:143], a[188:191], v[232:235], v[140:143]
    s_waitcnt vmcnt(6) lgkmcnt(0)
    v_mfma_f32_16x16x32_bf16 a[192:195], a[204:207], v[232:235], a[192:195]
    s_barrier
    ds_read_b64_tr_b16 a[128:129], v39 offset:0
    v_mfma_f32_16x16x32_bf16 v[144:147], a[160:163], v[240:243], v[144:147]
    ds_read_b64_tr_b16 a[130:131], v39 offset:4096
    ds_read_b64_tr_b16 a[132:133], v40 offset:0
    v_mfma_f32_16x16x32_bf16 v[148:151], a[164:167], v[240:243], v[148:151]
    ds_read_b64_tr_b16 a[134:135], v40 offset:4096
    ds_read_b64_tr_b16 a[136:137], v41 offset:0
    v_mfma_f32_16x16x32_bf16 v[152:155], a[168:171], v[240:243], v[152:155]
    ds_read_b64_tr_b16 a[138:139], v41 offset:4096
    ds_read_b64_tr_b16 a[140:141], v42 offset:0
    v_mfma_f32_16x16x32_bf16 v[156:159], a[172:175], v[240:243], v[156:159]
    ds_read_b64_tr_b16 a[142:143], v42 offset:4096
    ds_read_b64_tr_b16 a[144:145], v43 offset:0
    v_mfma_f32_16x16x32_bf16 v[160:163], a[176:179], v[240:243], v[160:163]
    ds_read_b64_tr_b16 a[146:147], v43 offset:4096
    ds_read_b64_tr_b16 a[148:149], v44 offset:0
    v_mfma_f32_16x16x32_bf16 v[164:167], a[180:183], v[240:243], v[164:167]
    ds_read_b64_tr_b16 a[150:151], v44 offset:4096
    ds_read_b64_tr_b16 a[152:153], v45 offset:0
    v_mfma_f32_16x16x32_bf16 v[168:171], a[184:187], v[240:243], v[168:171]
    ds_read_b64_tr_b16 a[154:155], v45 offset:4096
    ds_read_b64_tr_b16 a[156:157], v46 offset:0
    v_mfma_f32_16x16x32_bf16 v[172:175], a[188:191], v[240:243], v[172:175]
    ds_read_b64_tr_b16 a[158:159], v46 offset:4096
    ds_read_b64_tr_b16 a[160:161], v47 offset:0
    v_mfma_f32_16x16x32_bf16 a[196:199], a[204:207], v[240:243], a[196:199]
    ds_read_b64_tr_b16 a[162:163], v47 offset:4096
    ds_read_b64_tr_b16 a[164:165], v48 offset:0
    v_mfma_f32_16x16x32_bf16 v[208:211], a[0:3], v[64:67], 0
    ds_read_b64_tr_b16 a[166:167], v48 offset:4096
    v_cmp_ne_u32 vcc, 1, v29
    v_mfma_f32_16x16x32_bf16 v[208:211], a[4:7], v[68:71], v[208:211]
    ds_read_b64_tr_b16 a[168:169], v49 offset:0
    ds_read_b64_tr_b16 a[170:171], v49 offset:4096
    v_mfma_f32_16x16x32_bf16 v[208:211], a[8:11], v[72:75], v[208:211]
    ds_read_b64_tr_b16 a[172:173], v50 offset:0
    ds_read_b64_tr_b16 a[174:175], v50 offset:4096
    v_mfma_f32_16x16x32_bf16 v[208:211], a[12:15], v[76:79], v[208:211]
    s_cbranch_vccnz standalone__gqa_block_cached__near_ridge_b_rdy
standalone__gqa_block_cached__near_ridge_b_rdy_r:
    v_mfma_f32_16x16x32_bf16 v[212:215], a[16:19], v[64:67], 0
    v_mfma_f32_16x16x32_bf16 v[212:215], a[20:23], v[68:71], v[212:215]
    v_mfma_f32_16x16x32_bf16 v[212:215], a[24:27], v[72:75], v[212:215]
    s_nop 0
    s_nop 0
    v_mfma_f32_16x16x32_bf16 v[212:215], a[28:31], v[76:79], v[212:215]
    s_nop 0
    v_exp_f32 v208, v208
    v_mfma_f32_16x16x32_bf16 v[216:219], a[0:3], v[80:83], 0
    v_exp_f32 v209, v209
    v_mfma_f32_16x16x32_bf16 v[216:219], a[4:7], v[84:87], v[216:219]
    ds_read_b128 a[64:67], v31 offset:16384
    v_cvt_pk_bf16_f32 v208, v208, v209
    v_mfma_f32_16x16x32_bf16 v[216:219], a[8:11], v[88:91], v[216:219]
    v_exp_f32 v210, v210
    v_mfma_f32_16x16x32_bf16 v[216:219], a[12:15], v[92:95], v[216:219]
    v_exp_f32 v211, v211
    v_mfma_f32_16x16x32_bf16 v[220:223], a[16:19], v[80:83], 0
    ds_read_b128 a[68:71], v32 offset:16384
    v_cvt_pk_bf16_f32 v209, v210, v211
    v_mfma_f32_16x16x32_bf16 v[220:223], a[20:23], v[84:87], v[220:223]
    v_exp_f32 v212, v212
    v_mfma_f32_16x16x32_bf16 v[220:223], a[24:27], v[88:91], v[220:223]
    v_exp_f32 v213, v213
    v_mfma_f32_16x16x32_bf16 v[220:223], a[28:31], v[92:95], v[220:223]
    ds_read_b128 a[72:75], v33 offset:16384
    v_cvt_pk_bf16_f32 v210, v212, v213
    v_mfma_f32_16x16x32_bf16 v[224:227], a[0:3], v[96:99], 0
    v_exp_f32 v214, v214
    v_mfma_f32_16x16x32_bf16 v[224:227], a[4:7], v[100:103], v[224:227]
    v_exp_f32 v216, v216
    v_mfma_f32_16x16x32_bf16 v[224:227], a[8:11], v[104:107], v[224:227]
    v_exp_f32 v215, v215
    v_mfma_f32_16x16x32_bf16 v[224:227], a[12:15], v[108:111], v[224:227]
    ds_read_b128 a[76:79], v34 offset:16384
    v_cvt_pk_bf16_f32 v211, v214, v215
    v_mfma_f32_16x16x32_bf16 v[228:231], a[16:19], v[96:99], 0
    v_exp_f32 v217, v217
    v_mfma_f32_16x16x32_bf16 v[228:231], a[20:23], v[100:103], v[228:231]
    ds_read_b128 a[80:83], v31 offset:20480
    v_cvt_pk_bf16_f32 v216, v216, v217
    v_mfma_f32_16x16x32_bf16 v[228:231], a[24:27], v[104:107], v[228:231]
    ds_read_b64_tr_b16 a[176:177], v51 offset:0
    ds_read_b64_tr_b16 a[178:179], v51 offset:4096
    v_mfma_f32_16x16x32_bf16 v[228:231], a[28:31], v[108:111], v[228:231]
    v_exp_f32 v218, v218
    v_mfma_f32_16x16x32_bf16 v[232:235], a[32:35], v[64:67], 0
    v_exp_f32 v219, v219
    v_mfma_f32_16x16x32_bf16 v[232:235], a[36:39], v[68:71], v[232:235]
    ds_read_b128 a[84:87], v32 offset:20480
    v_cvt_pk_bf16_f32 v217, v218, v219
    v_mfma_f32_16x16x32_bf16 v[232:235], a[40:43], v[72:75], v[232:235]
    v_exp_f32 v220, v220
    v_mfma_f32_16x16x32_bf16 v[232:235], a[44:47], v[76:79], v[232:235]
    v_exp_f32 v221, v221
    v_mfma_f32_16x16x32_bf16 v[236:239], a[48:51], v[64:67], 0
    ds_read_b128 a[88:91], v33 offset:20480
    v_cvt_pk_bf16_f32 v218, v220, v221
    v_mfma_f32_16x16x32_bf16 v[236:239], a[52:55], v[68:71], v[236:239]
    v_exp_f32 v222, v222
    v_mfma_f32_16x16x32_bf16 v[236:239], a[56:59], v[72:75], v[236:239]
    v_exp_f32 v224, v224
    v_mfma_f32_16x16x32_bf16 v[236:239], a[60:63], v[76:79], v[236:239]
    v_exp_f32 v223, v223
    v_mfma_f32_16x16x32_bf16 v[240:243], a[32:35], v[80:83], 0
    ds_read_b64_tr_b16 a[180:181], v52 offset:0
    ds_read_b64_tr_b16 a[182:183], v52 offset:4096
    v_mfma_f32_16x16x32_bf16 v[240:243], a[36:39], v[84:87], v[240:243]
    ds_read_b128 a[92:95], v34 offset:20480
    v_cvt_pk_bf16_f32 v219, v222, v223
    v_mfma_f32_16x16x32_bf16 v[240:243], a[40:43], v[88:91], v[240:243]
    v_exp_f32 v225, v225
    v_mfma_f32_16x16x32_bf16 v[240:243], a[44:47], v[92:95], v[240:243]
    ds_read_b128 a[96:99], v35 offset:16384
    v_cvt_pk_bf16_f32 v224, v224, v225
    v_mfma_f32_16x16x32_bf16 v[244:247], a[48:51], v[80:83], 0
    v_exp_f32 v226, v226
    v_mfma_f32_16x16x32_bf16 v[244:247], a[52:55], v[84:87], v[244:247]
    s_waitcnt lgkmcnt(12)
    v_exp_f32 v227, v227
    v_mfma_f32_16x16x32_bf16 v[244:247], a[56:59], v[88:91], v[244:247]
    s_add_u32 s58, s8, 36864
    ds_read_b128 a[100:103], v36 offset:16384
    v_cvt_pk_bf16_f32 v225, v226, v227
    v_mfma_f32_16x16x32_bf16 v[244:247], a[60:63], v[92:95], v[244:247]
    s_add_u32 m0, s19, 131072
    v_exp_f32 v228, v228
    v_mfma_f32_16x16x32_bf16 v[112:115], a[128:131], v[208:211], v[112:115]
    buffer_load_dwordx4 v4, s[36:39], s58 offen offset:0 lds
    v_mfma_f32_16x16x32_bf16 v[116:119], a[132:135], v[208:211], v[116:119]
    v_exp_f32 v229, v229
    v_mfma_f32_16x16x32_bf16 v[120:123], a[136:139], v[208:211], v[120:123]
    ds_read_b64_tr_b16 a[184:185], v53 offset:0
    ds_read_b64_tr_b16 a[186:187], v53 offset:4096
    v_mfma_f32_16x16x32_bf16 v[124:127], a[140:143], v[208:211], v[124:127]
    buffer_load_dwordx4 v5, s[36:39], s58 offen offset:1024 lds
    v_mfma_f32_16x16x32_bf16 v[128:131], a[144:147], v[208:211], v[128:131]
    ds_read_b128 a[104:107], v37 offset:16384
    v_cvt_pk_bf16_f32 v226, v228, v229
    v_mfma_f32_16x16x32_bf16 v[132:135], a[148:151], v[208:211], v[132:135]
    v_exp_f32 v230, v230
    v_mfma_f32_16x16x32_bf16 v[136:139], a[152:155], v[208:211], v[136:139]
    v_exp_f32 v232, v232
    v_mfma_f32_16x16x32_bf16 v[140:143], a[156:159], v[208:211], v[140:143]
    v_exp_f32 v231, v231
    v_mfma_f32_16x16x32_bf16 a[192:195], a[204:207], v[208:211], a[192:195]
    buffer_load_dwordx4 v6, s[36:39], s58 offen offset:2048 lds
    v_mfma_f32_16x16x32_bf16 v[144:147], a[128:131], v[216:219], v[144:147]
    ds_read_b128 a[108:111], v38 offset:16384
    v_cvt_pk_bf16_f32 v227, v230, v231
    v_mfma_f32_16x16x32_bf16 v[148:151], a[132:135], v[216:219], v[148:151]
    v_exp_f32 v233, v233
    v_mfma_f32_16x16x32_bf16 v[152:155], a[136:139], v[216:219], v[152:155]
    ds_read_b128 a[112:115], v35 offset:20480
    v_cvt_pk_bf16_f32 v232, v232, v233
    v_mfma_f32_16x16x32_bf16 v[156:159], a[140:143], v[216:219], v[156:159]
    ds_read_b64_tr_b16 a[188:189], v54 offset:0
    ds_read_b64_tr_b16 a[190:191], v54 offset:4096
    buffer_load_dwordx4 v7, s[36:39], s58 offen offset:3072 lds
    v_mfma_f32_16x16x32_bf16 v[160:163], a[144:147], v[216:219], v[160:163]
    s_add_u32 s58, s8, 55296
    v_exp_f32 v234, v234
    v_mfma_f32_16x16x32_bf16 v[164:167], a[148:151], v[216:219], v[164:167]
    s_add_u32 m0, s19, 135168
    v_exp_f32 v235, v235
    v_mfma_f32_16x16x32_bf16 v[168:171], a[152:155], v[216:219], v[168:171]
    buffer_load_dwordx4 v4, s[36:39], s58 offen offset:0 lds
    v_mfma_f32_16x16x32_bf16 v[172:175], a[156:159], v[216:219], v[172:175]
    ds_read_b128 a[116:119], v36 offset:20480
    v_cvt_pk_bf16_f32 v233, v234, v235
    v_mfma_f32_16x16x32_bf16 a[196:199], a[204:207], v[216:219], a[196:199]
    v_exp_f32 v236, v236
    v_mfma_f32_16x16x32_bf16 v[176:179], a[128:131], v[224:227], v[176:179]
    v_exp_f32 v237, v237
    v_mfma_f32_16x16x32_bf16 v[180:183], a[132:135], v[224:227], v[180:183]
    ds_read_b128 a[120:123], v37 offset:20480
    v_cvt_pk_bf16_f32 v234, v236, v237
    v_mfma_f32_16x16x32_bf16 v[184:187], a[136:139], v[224:227], v[184:187]
    buffer_load_dwordx4 v5, s[36:39], s58 offen offset:1024 lds
    v_mfma_f32_16x16x32_bf16 v[188:191], a[140:143], v[224:227], v[188:191]
    v_exp_f32 v238, v238
    v_mfma_f32_16x16x32_bf16 v[192:195], a[144:147], v[224:227], v[192:195]
    v_exp_f32 v240, v240
    v_mfma_f32_16x16x32_bf16 v[196:199], a[148:151], v[224:227], v[196:199]
    v_exp_f32 v239, v239
    v_exp_f32 v241, v241
    v_mfma_f32_16x16x32_bf16 v[200:203], a[152:155], v[224:227], v[200:203]
    buffer_load_dwordx4 v6, s[36:39], s58 offen offset:2048 lds
    v_mfma_f32_16x16x32_bf16 v[204:207], a[156:159], v[224:227], v[204:207]
    v_cvt_pk_bf16_f32 v235, v238, v239
    v_exp_f32 v242, v242
    v_cvt_pk_bf16_f32 v240, v240, v241
    v_mfma_f32_16x16x32_bf16 a[200:203], a[204:207], v[224:227], a[200:203]
    v_exp_f32 v243, v243
    v_mfma_f32_16x16x32_bf16 v[112:115], a[160:163], v[232:235], v[112:115]
    ds_read_b128 a[124:127], v38 offset:20480
    v_cvt_pk_bf16_f32 v241, v242, v243
    v_mfma_f32_16x16x32_bf16 v[116:119], a[164:167], v[232:235], v[116:119]
    buffer_load_dwordx4 v7, s[36:39], s58 offen offset:3072 lds
    v_exp_f32 v244, v244
    v_mfma_f32_16x16x32_bf16 v[120:123], a[168:171], v[232:235], v[120:123]
    v_exp_f32 v245, v245
    v_mfma_f32_16x16x32_bf16 v[124:127], a[172:175], v[232:235], v[124:127]
    s_waitcnt lgkmcnt(12)
    v_exp_f32 v246, v246
    v_mfma_f32_16x16x32_bf16 v[128:131], a[176:179], v[232:235], v[128:131]
    v_cvt_pk_bf16_f32 v242, v244, v245
    v_mfma_f32_16x16x32_bf16 v[132:135], a[180:183], v[232:235], v[132:135]
    s_waitcnt lgkmcnt(8)
    v_exp_f32 v247, v247
    v_mfma_f32_16x16x32_bf16 v[136:139], a[184:187], v[232:235], v[136:139]
    s_waitcnt lgkmcnt(3)
    v_cvt_pk_bf16_f32 v243, v246, v247
    v_mfma_f32_16x16x32_bf16 v[140:143], a[188:191], v[232:235], v[140:143]
    s_waitcnt vmcnt(10) lgkmcnt(0)
    v_mfma_f32_16x16x32_bf16 a[192:195], a[204:207], v[232:235], a[192:195]
    s_barrier
    ds_read_b64_tr_b16 a[128:129], v39 offset:16384
    v_mfma_f32_16x16x32_bf16 v[144:147], a[160:163], v[240:243], v[144:147]
    s_add_u32 s58, s9, 0
    s_add_u32 m0, s19, 32768
    ds_read_b64_tr_b16 a[130:131], v39 offset:20480
    v_mfma_f32_16x16x32_bf16 v[148:151], a[164:167], v[240:243], v[148:151]
    buffer_load_dwordx4 v4, s[36:39], s58 offen offset:0 lds
    v_mfma_f32_16x16x32_bf16 v[152:155], a[168:171], v[240:243], v[152:155]
    ds_read_b64_tr_b16 a[132:133], v40 offset:16384
    ds_read_b64_tr_b16 a[134:135], v40 offset:20480
    v_mfma_f32_16x16x32_bf16 v[156:159], a[172:175], v[240:243], v[156:159]
    ds_read_b64_tr_b16 a[136:137], v41 offset:16384
    ds_read_b64_tr_b16 a[138:139], v41 offset:20480
    v_mfma_f32_16x16x32_bf16 v[160:163], a[176:179], v[240:243], v[160:163]
    buffer_load_dwordx4 v5, s[36:39], s58 offen offset:1024 lds
    v_mfma_f32_16x16x32_bf16 v[164:167], a[180:183], v[240:243], v[164:167]
    ds_read_b64_tr_b16 a[140:141], v42 offset:16384
    ds_read_b64_tr_b16 a[142:143], v42 offset:20480
    v_mfma_f32_16x16x32_bf16 v[168:171], a[184:187], v[240:243], v[168:171]
    ds_read_b64_tr_b16 a[144:145], v43 offset:16384
    ds_read_b64_tr_b16 a[146:147], v43 offset:20480
    v_mfma_f32_16x16x32_bf16 v[172:175], a[188:191], v[240:243], v[172:175]
standalone__gqa_block_cached__near_ridge_b_h0_4:
    s_cbranch_execz standalone__gqa_block_cached__near_ridge_b_h0_r
    ds_read_b64_tr_b16 a[148:149], v44 offset:16384
    ds_read_b64_tr_b16 a[150:151], v44 offset:20480
    v_mfma_f32_16x16x32_bf16 a[196:199], a[204:207], v[240:243], a[196:199]
    buffer_load_dwordx4 v6, s[36:39], s58 offen offset:2048 lds
    v_mfma_f32_16x16x32_bf16 v[208:211], a[64:67], v[64:67], 0
    ds_read_b64_tr_b16 a[152:153], v45 offset:16384
    ds_read_b64_tr_b16 a[154:155], v45 offset:20480
    v_mfma_f32_16x16x32_bf16 v[208:211], a[68:71], v[68:71], v[208:211]
    ds_read_b64_tr_b16 a[156:157], v46 offset:16384
    ds_read_b64_tr_b16 a[158:159], v46 offset:20480
    v_mfma_f32_16x16x32_bf16 v[208:211], a[72:75], v[72:75], v[208:211]
    ds_read_b64_tr_b16 a[160:161], v47 offset:16384
    ds_read_b64_tr_b16 a[162:163], v47 offset:20480
    v_mfma_f32_16x16x32_bf16 v[208:211], a[76:79], v[76:79], v[208:211]
    buffer_load_dwordx4 v7, s[36:39], s58 offen offset:3072 lds
    v_mfma_f32_16x16x32_bf16 v[212:215], a[80:83], v[64:67], 0
    ds_read_b64_tr_b16 a[164:165], v48 offset:16384
    ds_read_b64_tr_b16 a[166:167], v48 offset:20480
    v_mfma_f32_16x16x32_bf16 v[212:215], a[84:87], v[68:71], v[212:215]
    s_add_u32 s58, s9, 18432
    ds_read_b64_tr_b16 a[168:169], v49 offset:16384
    ds_read_b64_tr_b16 a[170:171], v49 offset:20480
    v_mfma_f32_16x16x32_bf16 v[212:215], a[88:91], v[72:75], v[212:215]
    s_add_u32 m0, s19, 36864
    ds_read_b64_tr_b16 a[172:173], v50 offset:16384
    ds_read_b64_tr_b16 a[174:175], v50 offset:20480
    v_mfma_f32_16x16x32_bf16 v[212:215], a[92:95], v[76:79], v[212:215]
    buffer_load_dwordx4 v4, s[36:39], s58 offen offset:0 lds
    v_mfma_f32_16x16x32_bf16 v[216:219], a[64:67], v[80:83], 0
    v_exp_f32 v208, v208
    v_mfma_f32_16x16x32_bf16 v[216:219], a[68:71], v[84:87], v[216:219]
    v_exp_f32 v209, v209
    v_mfma_f32_16x16x32_bf16 v[216:219], a[72:75], v[88:91], v[216:219]
    v_exp_f32 v210, v210
    v_mfma_f32_16x16x32_bf16 v[216:219], a[76:79], v[92:95], v[216:219]
    buffer_load_dwordx4 v5, s[36:39], s58 offen offset:1024 lds
    v_mfma_f32_16x16x32_bf16 v[220:223], a[80:83], v[80:83], 0
    v_cvt_pk_bf16_f32 v208, v208, v209
    v_xor_b32 v31, 8192, v17
    v_mfma_f32_16x16x32_bf16 v[220:223], a[84:87], v[84:87], v[220:223]
    v_exp_f32 v211, v211
    v_mfma_f32_16x16x32_bf16 v[220:223], a[88:91], v[88:91], v[220:223]
    v_exp_f32 v212, v212
    v_mfma_f32_16x16x32_bf16 v[220:223], a[92:95], v[92:95], v[220:223]
    buffer_load_dwordx4 v6, s[36:39], s58 offen offset:2048 lds
    v_mfma_f32_16x16x32_bf16 v[224:227], a[64:67], v[96:99], 0
    v_cvt_pk_bf16_f32 v209, v210, v211
    v_xor_b32 v32, 8192, v18
    v_mfma_f32_16x16x32_bf16 v[224:227], a[68:71], v[100:103], v[224:227]
    v_exp_f32 v213, v213
    v_mfma_f32_16x16x32_bf16 v[224:227], a[72:75], v[104:107], v[224:227]
    v_exp_f32 v214, v214
    v_mfma_f32_16x16x32_bf16 v[224:227], a[76:79], v[108:111], v[224:227]
    buffer_load_dwordx4 v7, s[36:39], s58 offen offset:3072 lds
    v_mfma_f32_16x16x32_bf16 v[228:231], a[80:83], v[96:99], 0
    ds_read_b64_tr_b16 a[176:177], v51 offset:16384
    ds_read_b64_tr_b16 a[178:179], v51 offset:20480
    v_mfma_f32_16x16x32_bf16 v[228:231], a[84:87], v[100:103], v[228:231]
    s_add_u32 s58, s9, 36864
    v_cvt_pk_bf16_f32 v210, v212, v213
    v_xor_b32 v33, 8192, v19
    v_mfma_f32_16x16x32_bf16 v[228:231], a[88:91], v[104:107], v[228:231]
    s_add_u32 m0, s19, 0
    v_exp_f32 v216, v216
    v_mfma_f32_16x16x32_bf16 v[228:231], a[92:95], v[108:111], v[228:231]
    buffer_load_dwordx4 v4, s[36:39], s58 offen offset:0 lds
    v_mfma_f32_16x16x32_bf16 v[232:235], a[96:99], v[64:67], 0
    v_exp_f32 v215, v215
    v_mfma_f32_16x16x32_bf16 v[232:235], a[100:103], v[68:71], v[232:235]
    v_exp_f32 v217, v217
    v_mfma_f32_16x16x32_bf16 v[232:235], a[104:107], v[72:75], v[232:235]
    v_cvt_pk_bf16_f32 v211, v214, v215
    v_cvt_pk_bf16_f32 v216, v216, v217
    v_mfma_f32_16x16x32_bf16 v[232:235], a[108:111], v[76:79], v[232:235]
    buffer_load_dwordx4 v5, s[36:39], s58 offen offset:1024 lds
    v_mfma_f32_16x16x32_bf16 v[236:239], a[112:115], v[64:67], 0
    v_exp_f32 v218, v218
    v_mfma_f32_16x16x32_bf16 v[236:239], a[116:119], v[68:71], v[236:239]
    v_exp_f32 v219, v219
    v_mfma_f32_16x16x32_bf16 v[236:239], a[120:123], v[72:75], v[236:239]
    ds_read_b64_tr_b16 a[180:181], v52 offset:16384
    ds_read_b64_tr_b16 a[182:183], v52 offset:20480
    v_mfma_f32_16x16x32_bf16 v[236:239], a[124:127], v[76:79], v[236:239]
    buffer_load_dwordx4 v6, s[36:39], s58 offen offset:2048 lds
    v_mfma_f32_16x16x32_bf16 v[240:243], a[96:99], v[80:83], 0
    v_exp_f32 v220, v220
    v_mfma_f32_16x16x32_bf16 v[240:243], a[100:103], v[84:87], v[240:243]
    v_cvt_pk_bf16_f32 v217, v218, v219
    v_xor_b32 v34, 8192, v20
    v_mfma_f32_16x16x32_bf16 v[240:243], a[104:107], v[88:91], v[240:243]
    v_exp_f32 v221, v221
    v_mfma_f32_16x16x32_bf16 v[240:243], a[108:111], v[92:95], v[240:243]
    buffer_load_dwordx4 v7, s[36:39], s58 offen offset:3072 lds
    v_mfma_f32_16x16x32_bf16 v[244:247], a[112:115], v[80:83], 0
    v_exp_f32 v222, v222
    v_mfma_f32_16x16x32_bf16 v[244:247], a[116:119], v[84:87], v[244:247]
    s_add_u32 s58, s9, 55296
    v_cvt_pk_bf16_f32 v218, v220, v221
    v_xor_b32 v35, 8192, v21
    v_mfma_f32_16x16x32_bf16 v[244:247], a[120:123], v[88:91], v[244:247]
    s_add_u32 m0, s19, 4096
    v_exp_f32 v224, v224
    v_mfma_f32_16x16x32_bf16 v[244:247], a[124:127], v[92:95], v[244:247]
    buffer_load_dwordx4 v4, s[36:39], s58 offen offset:0 lds
    v_mfma_f32_16x16x32_bf16 a[192:195], a[204:207], v[208:211], a[192:195]
    s_waitcnt lgkmcnt(12)
    ds_read_b64_tr_b16 a[184:185], v53 offset:16384
    ds_read_b64_tr_b16 a[186:187], v53 offset:20480
    v_mfma_f32_16x16x32_bf16 v[112:115], a[128:131], v[208:211], v[112:115]
    v_exp_f32 v223, v223
    v_mfma_f32_16x16x32_bf16 v[116:119], a[132:135], v[208:211], v[116:119]
    v_exp_f32 v225, v225
    v_mfma_f32_16x16x32_bf16 v[120:123], a[136:139], v[208:211], v[120:123]
    buffer_load_dwordx4 v5, s[36:39], s58 offen offset:1024 lds
    v_mfma_f32_16x16x32_bf16 v[124:127], a[140:143], v[208:211], v[124:127]
    v_cvt_pk_bf16_f32 v219, v222, v223
    v_cvt_pk_bf16_f32 v224, v224, v225
    v_mfma_f32_16x16x32_bf16 v[128:131], a[144:147], v[208:211], v[128:131]
    buffer_load_ushort v30, v10, s[40:43], s15 offen offset:1024 sc1
    v_mfma_f32_16x16x32_bf16 v[132:135], a[148:151], v[208:211], v[132:135]
    v_exp_f32 v226, v226
    v_mfma_f32_16x16x32_bf16 v[136:139], a[152:155], v[208:211], v[136:139]
    buffer_load_dwordx4 v6, s[36:39], s58 offen offset:2048 lds
    v_mfma_f32_16x16x32_bf16 v[140:143], a[156:159], v[208:211], v[140:143]
    v_exp_f32 v227, v227
    v_mfma_f32_16x16x32_bf16 a[196:199], a[204:207], v[216:219], a[196:199]
    v_exp_f32 v228, v228
    v_mfma_f32_16x16x32_bf16 v[144:147], a[128:131], v[216:219], v[144:147]
    ds_read_b64_tr_b16 a[188:189], v54 offset:16384
    v_cvt_pk_bf16_f32 v225, v226, v227
    v_mfma_f32_16x16x32_bf16 v[148:151], a[132:135], v[216:219], v[148:151]
    buffer_load_dwordx4 v7, s[36:39], s58 offen offset:3072 lds
    v_exp_f32 v229, v229
    v_mfma_f32_16x16x32_bf16 v[152:155], a[136:139], v[216:219], v[152:155]
    ds_read_b64_tr_b16 a[190:191], v54 offset:20480
    v_cvt_pk_bf16_f32 v226, v228, v229
    v_mfma_f32_16x16x32_bf16 v[156:159], a[140:143], v[216:219], v[156:159]
    v_exp_f32 v230, v230
    v_exp_f32 v232, v232
    v_mfma_f32_16x16x32_bf16 v[160:163], a[144:147], v[216:219], v[160:163]
    v_exp_f32 v231, v231
    v_exp_f32 v233, v233
    v_mfma_f32_16x16x32_bf16 v[164:167], a[148:151], v[216:219], v[164:167]
    v_cvt_pk_bf16_f32 v227, v230, v231
    v_cvt_pk_bf16_f32 v232, v232, v233
    v_mfma_f32_16x16x32_bf16 v[168:171], a[152:155], v[216:219], v[168:171]
    v_exp_f32 v234, v234
    v_mfma_f32_16x16x32_bf16 v[172:175], a[156:159], v[216:219], v[172:175]
    v_exp_f32 v235, v235
    v_mfma_f32_16x16x32_bf16 a[200:203], a[204:207], v[224:227], a[200:203]
    v_exp_f32 v236, v236
    v_mfma_f32_16x16x32_bf16 v[176:179], a[128:131], v[224:227], v[176:179]
    v_cvt_pk_bf16_f32 v233, v234, v235
    v_xor_b32 v36, 8192, v22
    v_mfma_f32_16x16x32_bf16 v[180:183], a[132:135], v[224:227], v[180:183]
    v_exp_f32 v237, v237
    v_mfma_f32_16x16x32_bf16 v[184:187], a[136:139], v[224:227], v[184:187]
    v_exp_f32 v238, v238
    v_mfma_f32_16x16x32_bf16 v[188:191], a[140:143], v[224:227], v[188:191]
    s_waitcnt lgkmcnt(0)
    v_cvt_pk_bf16_f32 v234, v236, v237
    v_exp_f32 v240, v240
    v_mfma_f32_16x16x32_bf16 v[192:195], a[144:147], v[224:227], v[192:195]
    v_exp_f32 v239, v239
    v_exp_f32 v241, v241
    v_mfma_f32_16x16x32_bf16 v[196:199], a[148:151], v[224:227], v[196:199]
    v_cvt_pk_bf16_f32 v235, v238, v239
    v_cvt_pk_bf16_f32 v240, v240, v241
    v_mfma_f32_16x16x32_bf16 v[200:203], a[152:155], v[224:227], v[200:203]
    v_exp_f32 v242, v242
    v_accvgpr_read_b32 v250, a200
    v_subrev_u32 v60, 729808896, v250
    v_mfma_f32_16x16x32_bf16 v[204:207], a[156:159], v[224:227], v[204:207]
    v_exp_f32 v243, v243
    v_mfma_f32_16x16x32_bf16 a[192:195], a[204:207], v[232:235], a[192:195]
    v_exp_f32 v244, v244
    v_mfma_f32_16x16x32_bf16 v[112:115], a[160:163], v[232:235], v[112:115]
    s_barrier
    ds_write_b64 v55, v[250:251] offset:4096
    v_cvt_pk_bf16_f32 v241, v242, v243
    v_mfma_f32_16x16x32_bf16 v[116:119], a[164:167], v[232:235], v[116:119]
    v_exp_f32 v245, v245
    v_mfma_f32_16x16x32_bf16 v[120:123], a[168:171], v[232:235], v[120:123]
    v_exp_f32 v246, v246
    v_mfma_f32_16x16x32_bf16 v[124:127], a[172:175], v[232:235], v[124:127]
    v_cvt_pk_bf16_f32 v242, v244, v245
    v_xor_b32 v37, 8192, v23
    v_mfma_f32_16x16x32_bf16 v[128:131], a[176:179], v[232:235], v[128:131]
    ds_write_b128 v55, v[192:195] offset:0
    v_exp_f32 v247, v247
    v_mfma_f32_16x16x32_bf16 v[132:135], a[180:183], v[232:235], v[132:135]
    v_cvt_pk_bf16_f32 v243, v246, v247
    v_accvgpr_read_b32 v248, a192
    v_mfma_f32_16x16x32_bf16 v[136:139], a[184:187], v[232:235], v[136:139]
    v_subrev_u32 v58, 729808896, v248
    v_xor_b32 v38, 8192, v24
    v_mfma_f32_16x16x32_bf16 v[140:143], a[188:191], v[232:235], v[140:143]
    ds_write_b128 v55, v[196:199] offset:1024
    v_mfma_f32_16x16x32_bf16 a[196:199], a[204:207], v[240:243], a[196:199]
    ds_write_b128 v55, v[200:203] offset:2048
    v_mfma_f32_16x16x32_bf16 v[144:147], a[160:163], v[240:243], v[144:147]
    v_mfma_f32_16x16x32_bf16 v[148:151], a[164:167], v[240:243], v[148:151]
    ds_write_b128 v55, v[204:207] offset:3072
    v_mfma_f32_16x16x32_bf16 v[152:155], a[168:171], v[240:243], v[152:155]
    v_rcp_f32 v248, v248
    v_mfma_f32_16x16x32_bf16 v[156:159], a[172:175], v[240:243], v[156:159]
    s_nop 0
    v_accvgpr_read_b32 v249, a196
    v_subrev_u32 v59, 729808896, v249
    v_mfma_f32_16x16x32_bf16 v[160:163], a[176:179], v[240:243], v[160:163]
    v_max3_u32 v58, v58, v59, v60
    v_cmp_lt_u32 vcc, 671088640, v58
    v_mfma_f32_16x16x32_bf16 v[164:167], a[180:183], v[240:243], v[164:167]
    v_rcp_f32 v62, v249
    v_mfma_f32_16x16x32_bf16 v[168:171], a[184:187], v[240:243], v[168:171]
    s_cmp_lg_u64 vcc, 0
    s_cselect_b32 s57, s64, 0
    v_mov_b32 v58, s57
    v_mfma_f32_16x16x32_bf16 v[172:175], a[188:191], v[240:243], v[172:175]
    ds_write_b32 v57, v58
standalone__gqa_block_cached__near_ridge_b_x:
    v_pk_mul_f32 v[112:113], v[112:113], v[248:249] op_sel_hi:[1,0]
    v_pk_mul_f32 v[114:115], v[114:115], v[248:249] op_sel_hi:[1,0]
    v_pk_mul_f32 v[116:117], v[116:117], v[248:249] op_sel_hi:[1,0]
    v_pk_mul_f32 v[118:119], v[118:119], v[248:249] op_sel_hi:[1,0]
    v_cvt_pk_bf16_f32 v112, v112, v113
    v_cvt_pk_bf16_f32 v113, v114, v115
    v_cvt_pk_bf16_f32 v114, v116, v117
    v_cvt_pk_bf16_f32 v115, v118, v119
    buffer_store_dwordx4 v[112:115], v3, s[40:43], s12 offen offset:0 sc1
    v_mov_b32 v57, 86016
    s_waitcnt vmcnt(18) lgkmcnt(0)
    s_barrier
    ds_read_b128 v[224:227], v57
    ds_read_b64 v[228:229], v56 offset:4096
    ds_read_b128 v[208:211], v56 offset:0
    ds_read_b128 v[212:215], v56 offset:1024
    ds_read_b128 v[216:219], v56 offset:2048
    ds_read_b128 v[220:223], v56 offset:3072
    v_pk_mul_f32 v[128:129], v[128:129], v[248:249] op_sel_hi:[1,0]
    v_pk_mul_f32 v[130:131], v[130:131], v[248:249] op_sel_hi:[1,0]
    v_pk_mul_f32 v[132:133], v[132:133], v[248:249] op_sel_hi:[1,0]
    v_pk_mul_f32 v[134:135], v[134:135], v[248:249] op_sel_hi:[1,0]
    v_cvt_pk_bf16_f32 v128, v128, v129
    v_cvt_pk_bf16_f32 v129, v130, v131
    v_cvt_pk_bf16_f32 v130, v132, v133
    v_cvt_pk_bf16_f32 v131, v134, v135
    buffer_store_dwordx4 v[128:131], v3, s[40:43], s12 offen offset:2048 sc1
    v_pk_mul_f32 v[144:145], v[144:145], v[62:63] op_sel_hi:[1,0]
    v_pk_mul_f32 v[146:147], v[146:147], v[62:63] op_sel_hi:[1,0]
    v_pk_mul_f32 v[148:149], v[148:149], v[62:63] op_sel_hi:[1,0]
    v_pk_mul_f32 v[150:151], v[150:151], v[62:63] op_sel_hi:[1,0]
    v_cvt_pk_bf16_f32 v144, v144, v145
    v_cvt_pk_bf16_f32 v145, v146, v147
    v_cvt_pk_bf16_f32 v146, v148, v149
    v_cvt_pk_bf16_f32 v147, v150, v151
    buffer_store_dwordx4 v[144:147], v3, s[40:43], s13 offen offset:0 sc1
    s_waitcnt lgkmcnt(5)
    v_or3_b32 v224, v224, v225, v226
    v_or_b32 v224, v224, v227
    v_cmp_ne_u32 vcc, 0, v224
    s_waitcnt lgkmcnt(4)
    v_min_f32 v57, v251, v229
    v_sub_f32 v251, v57, v251
    v_sub_f32 v229, v57, v229
    v_exp_f32 v251, v251
    v_exp_f32 v229, v229
    s_cbranch_vccnz standalone__gqa_block_cached__near_ridge_b_fb
    v_mul_f32 v250, v250, v251
    v_fma_f32 v250, v228, v229, v250
    v_rcp_f32 v57, v250
    v_pk_mul_f32 v[160:161], v[160:161], v[62:63] op_sel_hi:[1,0]
    v_pk_mul_f32 v[162:163], v[162:163], v[62:63] op_sel_hi:[1,0]
    v_pk_mul_f32 v[164:165], v[164:165], v[62:63] op_sel_hi:[1,0]
    v_pk_mul_f32 v[166:167], v[166:167], v[62:63] op_sel_hi:[1,0]
    v_cvt_pk_bf16_f32 v160, v160, v161
    v_cvt_pk_bf16_f32 v161, v162, v163
    v_cvt_pk_bf16_f32 v162, v164, v165
    v_cvt_pk_bf16_f32 v163, v166, v167
    buffer_store_dwordx4 v[160:163], v3, s[40:43], s13 offen offset:2048 sc1
    v_mul_f32 v250, v251, v57
    v_mul_f32 v228, v229, v57
    v_pk_mul_f32 v[176:177], v[176:177], v[250:251] op_sel_hi:[1,0]
    v_pk_mul_f32 v[178:179], v[178:179], v[250:251] op_sel_hi:[1,0]
    v_pk_mul_f32 v[180:181], v[180:181], v[250:251] op_sel_hi:[1,0]
    v_pk_mul_f32 v[182:183], v[182:183], v[250:251] op_sel_hi:[1,0]
    s_waitcnt lgkmcnt(3)
    v_pk_fma_f32 v[176:177], v[208:209], v[228:229], v[176:177] op_sel_hi:[1,0,1]
    v_pk_fma_f32 v[178:179], v[210:211], v[228:229], v[178:179] op_sel_hi:[1,0,1]
    s_waitcnt lgkmcnt(2)
    v_pk_fma_f32 v[180:181], v[212:213], v[228:229], v[180:181] op_sel_hi:[1,0,1]
    v_pk_fma_f32 v[182:183], v[214:215], v[228:229], v[182:183] op_sel_hi:[1,0,1]
    v_cvt_pk_bf16_f32 v176, v176, v177
    v_cvt_pk_bf16_f32 v177, v178, v179
    v_cvt_pk_bf16_f32 v178, v180, v181
    v_cvt_pk_bf16_f32 v179, v182, v183
    buffer_store_dwordx4 v[176:179], v3, s[40:43], s14 offen offset:0 sc1
    v_pk_mul_f32 v[120:121], v[120:121], v[248:249] op_sel_hi:[1,0]
    v_pk_mul_f32 v[122:123], v[122:123], v[248:249] op_sel_hi:[1,0]
    v_pk_mul_f32 v[124:125], v[124:125], v[248:249] op_sel_hi:[1,0]
    v_pk_mul_f32 v[126:127], v[126:127], v[248:249] op_sel_hi:[1,0]
    v_cvt_pk_bf16_f32 v120, v120, v121
    v_cvt_pk_bf16_f32 v121, v122, v123
    v_cvt_pk_bf16_f32 v122, v124, v125
    v_cvt_pk_bf16_f32 v123, v126, v127
    buffer_store_dwordx4 v[120:123], v3, s[40:43], s12 offen offset:1024 sc1
    v_pk_mul_f32 v[152:153], v[152:153], v[62:63] op_sel_hi:[1,0]
    v_pk_mul_f32 v[154:155], v[154:155], v[62:63] op_sel_hi:[1,0]
    v_pk_mul_f32 v[156:157], v[156:157], v[62:63] op_sel_hi:[1,0]
    v_pk_mul_f32 v[158:159], v[158:159], v[62:63] op_sel_hi:[1,0]
    v_cvt_pk_bf16_f32 v152, v152, v153
    v_cvt_pk_bf16_f32 v153, v154, v155
    v_cvt_pk_bf16_f32 v154, v156, v157
    v_cvt_pk_bf16_f32 v155, v158, v159
    buffer_store_dwordx4 v[152:155], v3, s[40:43], s13 offen offset:1024 sc1
    v_pk_mul_f32 v[184:185], v[184:185], v[250:251] op_sel_hi:[1,0]
    v_pk_mul_f32 v[186:187], v[186:187], v[250:251] op_sel_hi:[1,0]
    v_pk_mul_f32 v[188:189], v[188:189], v[250:251] op_sel_hi:[1,0]
    v_pk_mul_f32 v[190:191], v[190:191], v[250:251] op_sel_hi:[1,0]
    s_waitcnt lgkmcnt(1)
    v_pk_fma_f32 v[184:185], v[216:217], v[228:229], v[184:185] op_sel_hi:[1,0,1]
    v_pk_fma_f32 v[186:187], v[218:219], v[228:229], v[186:187] op_sel_hi:[1,0,1]
    s_waitcnt lgkmcnt(0)
    v_pk_fma_f32 v[188:189], v[220:221], v[228:229], v[188:189] op_sel_hi:[1,0,1]
    v_pk_fma_f32 v[190:191], v[222:223], v[228:229], v[190:191] op_sel_hi:[1,0,1]
    v_cvt_pk_bf16_f32 v184, v184, v185
    v_cvt_pk_bf16_f32 v185, v186, v187
    v_cvt_pk_bf16_f32 v186, v188, v189
    v_cvt_pk_bf16_f32 v187, v190, v191
    buffer_store_dwordx4 v[184:187], v3, s[40:43], s14 offen offset:1024 sc1
    v_pk_mul_f32 v[136:137], v[136:137], v[248:249] op_sel_hi:[1,0]
    v_pk_mul_f32 v[138:139], v[138:139], v[248:249] op_sel_hi:[1,0]
    v_pk_mul_f32 v[140:141], v[140:141], v[248:249] op_sel_hi:[1,0]
    v_pk_mul_f32 v[142:143], v[142:143], v[248:249] op_sel_hi:[1,0]
    v_cvt_pk_bf16_f32 v136, v136, v137
    v_cvt_pk_bf16_f32 v137, v138, v139
    v_cvt_pk_bf16_f32 v138, v140, v141
    v_cvt_pk_bf16_f32 v139, v142, v143
    buffer_store_dwordx4 v[136:139], v3, s[40:43], s12 offen offset:3072 sc1
    v_pk_mul_f32 v[168:169], v[168:169], v[62:63] op_sel_hi:[1,0]
    v_pk_mul_f32 v[170:171], v[170:171], v[62:63] op_sel_hi:[1,0]
    v_pk_mul_f32 v[172:173], v[172:173], v[62:63] op_sel_hi:[1,0]
    v_pk_mul_f32 v[174:175], v[174:175], v[62:63] op_sel_hi:[1,0]
    v_cvt_pk_bf16_f32 v168, v168, v169
    v_cvt_pk_bf16_f32 v169, v170, v171
    v_cvt_pk_bf16_f32 v170, v172, v173
    v_cvt_pk_bf16_f32 v171, v174, v175
    buffer_store_dwordx4 v[168:171], v3, s[40:43], s13 offen offset:3072 sc1
    ds_read_b64_tr_b16 a[128:129], v17 offset:0
    ds_read_b64_tr_b16 a[130:131], v17 offset:4096
    ds_read_b64_tr_b16 a[132:133], v18 offset:0
    ds_read_b64_tr_b16 a[134:135], v18 offset:4096
    ds_read_b64_tr_b16 a[136:137], v19 offset:0
    ds_read_b64_tr_b16 a[138:139], v19 offset:4096
    ds_read_b64_tr_b16 a[140:141], v20 offset:0
    ds_read_b64_tr_b16 a[142:143], v20 offset:4096
    ds_read_b64_tr_b16 a[144:145], v21 offset:0
    ds_read_b64_tr_b16 a[146:147], v21 offset:4096
    ds_read_b64_tr_b16 a[148:149], v22 offset:0
    ds_read_b64_tr_b16 a[150:151], v22 offset:4096
    v_add_u32 v11, 4096, v3
    v_add_u32 v12, 8192, v3
    s_mov_b32 s64, s12
    s_waitcnt lgkmcnt(10)
    v_mfma_f32_16x16x32_bf16 v[64:67], a[128:131], v[112:115], 0
    v_mfma_f32_16x16x32_bf16 v[80:83], a[128:131], v[144:147], 0
    v_mfma_f32_16x16x32_bf16 v[96:99], a[128:131], v[176:179], 0
    s_waitcnt lgkmcnt(8)
    v_mfma_f32_16x16x32_bf16 v[68:71], a[132:135], v[112:115], 0
    v_mfma_f32_16x16x32_bf16 v[84:87], a[132:135], v[144:147], 0
    v_mfma_f32_16x16x32_bf16 v[100:103], a[132:135], v[176:179], 0
    s_waitcnt lgkmcnt(6)
    v_mfma_f32_16x16x32_bf16 v[72:75], a[136:139], v[112:115], 0
    ds_read_b64_tr_b16 a[152:153], v23 offset:0
    ds_read_b64_tr_b16 a[154:155], v23 offset:4096
    v_mfma_f32_16x16x32_bf16 v[88:91], a[136:139], v[144:147], 0
    s_mov_b64 exec, 0
    s_cmp_eq_u32 s48, 0
    s_cbranch_scc1 standalone__gqa_block_cached__near_ridge_b_h1_0
    s_cmp_eq_u32 s48, 1
    s_cbranch_scc1 standalone__gqa_block_cached__near_ridge_b_h1_1
    s_cmp_eq_u32 s48, 2
    s_cbranch_scc1 standalone__gqa_block_cached__near_ridge_b_h1_r
    s_branch standalone__gqa_block_cached__near_ridge_b_h1_r
standalone__gqa_block_cached__near_ridge_b_h1_r:
    s_mov_b64 exec, -1
    v_mfma_f32_16x16x32_bf16 v[208:211], a[136:139], v[176:179], 0
    s_waitcnt vmcnt(5)
    s_waitcnt lgkmcnt(6)
    v_mfma_f32_16x16x32_bf16 v[76:79], a[140:143], v[112:115], 0
    s_xor_b32 s56, s48, 0
    s_mov_b64 exec, 16
    buffer_store_short v29, v10, s[40:43], s15 offen offset:1024
    s_mov_b64 exec, -1
    v_mfma_f32_16x16x32_bf16 v[92:95], a[140:143], v[144:147], 0
    s_lshl_b32 s56, s56, 14
    ds_read_b64_tr_b16 a[156:157], v24 offset:0
    ds_read_b64_tr_b16 a[158:159], v24 offset:4096
    v_mfma_f32_16x16x32_bf16 v[212:215], a[140:143], v[176:179], 0
    s_add_u32 s56, s56, 98304
    s_waitcnt lgkmcnt(6)
    v_mfma_f32_16x16x32_bf16 v[216:219], a[144:147], v[112:115], 0
    ds_read_b64_tr_b16 a[160:161], v31 offset:0
    ds_read_b64_tr_b16 a[162:163], v31 offset:4096
    v_mfma_f32_16x16x32_bf16 v[220:223], a[144:147], v[144:147], 0
    v_add_u32 v55, s56, v3
    v_mfma_f32_16x16x32_bf16 v[224:227], a[144:147], v[176:179], 0
    s_waitcnt lgkmcnt(6)
    ds_read_b64_tr_b16 a[164:165], v32 offset:0
    v_cmp_ne_u32 vcc, 1, v30
    v_mfma_f32_16x16x32_bf16 v[228:231], a[148:151], v[112:115], 0
    s_xor_b32 s56, s48, 1
    ds_read_b64_tr_b16 a[166:167], v32 offset:4096
    v_mfma_f32_16x16x32_bf16 v[232:235], a[148:151], v[144:147], 0
    s_and_b32 s17, vcc_lo, 10
    s_cselect_b32 s3, 2147418112, s66
    ds_read_b64_tr_b16 a[168:169], v33 offset:0
    v_mfma_f32_16x16x32_bf16 v[236:239], a[148:151], v[176:179], 0
    s_lshl_b32 s56, s56, 14
    buffer_load_dwordx4 a[0:3], v3, s[40:43], s3 offen offset:0 sc1
    s_waitcnt lgkmcnt(7)
    v_mfma_f32_16x16x32_bf16 v[240:243], a[152:155], v[112:115], 0
    s_add_u32 s56, s56, 98304
    ds_read_b64_tr_b16 a[170:171], v33 offset:4096
    ds_read_b64_tr_b16 a[172:173], v34 offset:0
    v_mfma_f32_16x16x32_bf16 v[244:247], a[152:155], v[144:147], 0
    buffer_load_dwordx4 a[16:19], v11, s[40:43], s3 offen offset:0 sc1
    v_mfma_f32_16x16x32_bf16 v[192:195], a[152:155], v[176:179], 0
    s_waitcnt lgkmcnt(7)
    ds_read_b64_tr_b16 a[174:175], v34 offset:4096
    ds_read_b64_tr_b16 a[176:177], v35 offset:0
    v_mfma_f32_16x16x32_bf16 v[196:199], a[156:159], v[112:115], 0
    s_waitcnt lgkmcnt(7)
    ds_read_b64_tr_b16 a[178:179], v35 offset:4096
    v_add_u32 v56, s56, v3
    v_mfma_f32_16x16x32_bf16 v[200:203], a[156:159], v[144:147], 0
    s_xor_b32 s56, s48, 2
    buffer_load_dwordx4 a[32:35], v12, s[40:43], s3 offen offset:0 sc1
    v_mfma_f32_16x16x32_bf16 v[204:207], a[156:159], v[176:179], 0
    s_lshl_b32 s56, s56, 14
    ds_read_b64_tr_b16 a[180:181], v36 offset:0
    ds_read_b64_tr_b16 a[182:183], v36 offset:4096
    v_mfma_f32_16x16x32_bf16 v[64:67], a[160:163], v[128:131], v[64:67]
    s_add_u32 s56, s56, 98304
    ds_read_b64_tr_b16 a[184:185], v37 offset:0
    ds_read_b64_tr_b16 a[186:187], v37 offset:4096
    v_mfma_f32_16x16x32_bf16 v[80:83], a[160:163], v[160:163], v[80:83]
    s_waitcnt lgkmcnt(10)
    buffer_load_dwordx4 a[8:11], v3, s[40:43], s3 offen offset:2048 sc1
    v_mfma_f32_16x16x32_bf16 v[68:71], a[164:167], v[128:131], v[68:71]
    ds_read_b64_tr_b16 a[188:189], v38 offset:0
    ds_read_b64_tr_b16 a[190:191], v38 offset:4096
    v_mfma_f32_16x16x32_bf16 v[84:87], a[164:167], v[160:163], v[84:87]
    s_waitcnt lgkmcnt(10)
    buffer_load_dwordx4 a[24:27], v11, s[40:43], s3 offen offset:2048 sc1
    v_mfma_f32_16x16x32_bf16 v[72:75], a[168:171], v[128:131], v[72:75]
    ds_read_b64_tr_b16 a[192:193], v17 offset:32768
    ds_read_b64_tr_b16 a[194:195], v17 offset:36864
    v_mfma_f32_16x16x32_bf16 v[88:91], a[168:171], v[160:163], v[88:91]
    s_waitcnt lgkmcnt(10)
    v_add_u32 v17, 4294868992, v17
    v_add_u32 v57, s56, v3
    v_mfma_f32_16x16x32_bf16 v[76:79], a[172:175], v[128:131], v[76:79]
    s_xor_b32 s56, s48, 3
    buffer_load_dwordx4 a[4:7], v3, s[40:43], s3 offen offset:1024 sc1
    v_mfma_f32_16x16x32_bf16 v[92:95], a[172:175], v[160:163], v[92:95]
    s_lshl_b32 s56, s56, 14
    ds_read_b64_tr_b16 a[196:197], v18 offset:32768
    ds_read_b64_tr_b16 a[198:199], v18 offset:36864
    s_waitcnt lgkmcnt(10)
    v_mfma_f32_16x16x32_bf16 v[216:219], a[176:179], v[128:131], v[216:219]
    s_add_u32 s56, s56, 98304
    v_add_u32 v18, 4294868992, v18
    v_mfma_f32_16x16x32_bf16 v[220:223], a[176:179], v[160:163], v[220:223]
    s_waitcnt lgkmcnt(8)
    buffer_load_dwordx4 a[20:23], v11, s[40:43], s3 offen offset:1024 sc1
    v_mfma_f32_16x16x32_bf16 v[228:231], a[180:183], v[128:131], v[228:231]
    ds_read_b64_tr_b16 a[200:201], v19 offset:32768
    ds_read_b64_tr_b16 a[202:203], v19 offset:36864
    v_mfma_f32_16x16x32_bf16 v[232:235], a[180:183], v[160:163], v[232:235]
    s_waitcnt lgkmcnt(8)
    buffer_load_dwordx4 a[36:39], v12, s[40:43], s3 offen offset:1024 sc1
    v_mfma_f32_16x16x32_bf16 v[240:243], a[184:187], v[128:131], v[240:243]
    v_add_u32 v19, 4294868992, v19
    v_add_u32 v58, s56, v3
    v_mfma_f32_16x16x32_bf16 v[244:247], a[184:187], v[160:163], v[244:247]
    s_waitcnt lgkmcnt(6)
    ds_read_b64_tr_b16 a[204:205], v20 offset:32768
    ds_read_b64_tr_b16 a[206:207], v20 offset:36864
    v_mfma_f32_16x16x32_bf16 v[196:199], a[188:191], v[128:131], v[196:199]
    s_waitcnt lgkmcnt(6)
    buffer_load_dwordx4 a[12:15], v3, s[40:43], s3 offen offset:3072 sc1
    v_mfma_f32_16x16x32_bf16 v[200:203], a[188:191], v[160:163], v[200:203]
    s_barrier
    v_add_u32 v20, 4294868992, v20
    v_mfma_f32_16x16x32_bf16 v[64:67], a[192:195], v[120:123], v[64:67]
    ds_read_b64_tr_b16 a[208:209], v21 offset:32768
    ds_read_b64_tr_b16 a[210:211], v21 offset:36864
    v_mfma_f32_16x16x32_bf16 v[80:83], a[192:195], v[152:155], v[80:83]
    s_waitcnt lgkmcnt(6)
    buffer_load_dwordx4 a[28:31], v11, s[40:43], s3 offen offset:3072 sc1
    v_mfma_f32_16x16x32_bf16 v[96:99], a[192:195], v[184:187], v[96:99]
    s_cmp_lg_u32 s17, 0
    s_cbranch_scc1 standalone__gqa_block_cached__near_ridge_b_late
standalone__gqa_block_cached__near_ridge_b_late_r:
    v_add_u32 v21, 4294868992, v21
    v_mfma_f32_16x16x32_bf16 v[68:71], a[196:199], v[120:123], v[68:71]
    s_add_u32 s58, s10, 0
    ds_read_b64_tr_b16 a[212:213], v22 offset:32768
    ds_read_b64_tr_b16 a[214:215], v22 offset:36864
    v_mfma_f32_16x16x32_bf16 v[84:87], a[196:199], v[152:155], v[84:87]
    s_add_u32 m0, s19, 98304
    v_add_u32 v22, 4294868992, v22
    v_bfe_u32 v60, v2, 4, 1
    v_mfma_f32_16x16x32_bf16 v[100:103], a[196:199], v[184:187], v[100:103]
    s_waitcnt lgkmcnt(6)
    buffer_load_dwordx4 v4, s[36:39], s58 offen offset:0 lds
    v_mfma_f32_16x16x32_bf16 v[72:75], a[200:203], v[120:123], v[72:75]
    ds_read_b64_tr_b16 a[216:217], v23 offset:32768
    ds_read_b64_tr_b16 a[218:219], v23 offset:36864
    v_mfma_f32_16x16x32_bf16 v[88:91], a[200:203], v[152:155], v[88:91]
    v_add_u32 v23, 4294868992, v23
    v_lshrrev_b32 v59, 5, v2
    v_mfma_f32_16x16x32_bf16 v[208:211], a[200:203], v[184:187], v[208:211]
    s_waitcnt lgkmcnt(6)
    buffer_load_dwordx4 v5, s[36:39], s58 offen offset:1024 lds
    v_mfma_f32_16x16x32_bf16 v[76:79], a[204:207], v[120:123], v[76:79]
    ds_read_b64_tr_b16 a[220:221], v24 offset:32768
    ds_read_b64_tr_b16 a[222:223], v24 offset:36864
    v_mfma_f32_16x16x32_bf16 v[92:95], a[204:207], v[152:155], v[92:95]
    s_waitcnt vmcnt(13)
    v_add_u32 v24, 4294868992, v24
    v_lshl_add_u32 v59, v60, 1, v59
    v_mfma_f32_16x16x32_bf16 v[212:215], a[204:207], v[184:187], v[212:215]
    s_waitcnt lgkmcnt(6)
    s_mov_b64 exec, 17
    buffer_store_short v29, v10, s[40:43], s15 offen offset:1024
    buffer_store_short v29, v10, s[40:43], s15 offen sc1
    s_mov_b64 exec, -1
    v_mfma_f32_16x16x32_bf16 v[216:219], a[208:211], v[120:123], v[216:219]
    buffer_load_dwordx4 v6, s[36:39], s58 offen offset:2048 lds
    v_mfma_f32_16x16x32_bf16 v[220:223], a[208:211], v[152:155], v[220:223]
    ds_read_b64_tr_b16 a[224:225], v31 offset:32768
    ds_read_b64_tr_b16 a[226:227], v31 offset:36864
    v_mfma_f32_16x16x32_bf16 v[224:227], a[208:211], v[184:187], v[224:227]
    s_waitcnt lgkmcnt(6)
    ds_read_b64_tr_b16 a[228:229], v32 offset:32768
    ds_read_b64_tr_b16 a[230:231], v32 offset:36864
    v_mfma_f32_16x16x32_bf16 v[228:231], a[212:215], v[120:123], v[228:231]
    v_add_u32 v31, 4294868992, v31
    v_add_u32 v32, 4294868992, v32
    v_mfma_f32_16x16x32_bf16 v[232:235], a[212:215], v[152:155], v[232:235]
    buffer_load_dwordx4 v7, s[36:39], s58 offen offset:3072 lds
    v_mfma_f32_16x16x32_bf16 v[236:239], a[212:215], v[184:187], v[236:239]
    s_waitcnt lgkmcnt(6)
    ds_read_b64_tr_b16 a[232:233], v33 offset:32768
    ds_read_b64_tr_b16 a[234:235], v33 offset:36864
    v_mfma_f32_16x16x32_bf16 v[240:243], a[216:219], v[120:123], v[240:243]
    s_add_u32 s58, s10, 18432
    ds_read_b64_tr_b16 a[236:237], v34 offset:32768
    ds_read_b64_tr_b16 a[238:239], v34 offset:36864
    v_mfma_f32_16x16x32_bf16 v[244:247], a[216:219], v[152:155], v[244:247]
    s_add_u32 m0, s19, 102400
    v_add_u32 v33, 4294868992, v33
    v_add_u32 v34, 4294868992, v34
    v_mfma_f32_16x16x32_bf16 v[192:195], a[216:219], v[184:187], v[192:195]
    s_waitcnt lgkmcnt(8)
    buffer_load_dwordx4 v4, s[36:39], s58 offen offset:0 lds
    v_mfma_f32_16x16x32_bf16 v[196:199], a[220:223], v[120:123], v[196:199]
    ds_read_b64_tr_b16 a[240:241], v35 offset:32768
    ds_read_b64_tr_b16 a[242:243], v35 offset:36864
    v_mfma_f32_16x16x32_bf16 v[200:203], a[220:223], v[152:155], v[200:203]
    ds_read_b64_tr_b16 a[244:245], v36 offset:32768
    ds_read_b64_tr_b16 a[246:247], v36 offset:36864
    v_mfma_f32_16x16x32_bf16 v[204:207], a[220:223], v[184:187], v[204:207]
    s_waitcnt lgkmcnt(10)
    v_add_u32 v35, 4294868992, v35
    v_add_u32 v36, 4294868992, v36
    v_mfma_f32_16x16x32_bf16 v[64:67], a[224:227], v[136:139], v[64:67]
    ds_read_b64_tr_b16 a[248:249], v37 offset:32768
    ds_read_b64_tr_b16 a[250:251], v37 offset:36864
    v_mfma_f32_16x16x32_bf16 v[80:83], a[224:227], v[168:171], v[80:83]
standalone__gqa_block_cached__near_ridge_b_h1_0:
    s_cbranch_execz standalone__gqa_block_cached__near_ridge_b_h1_r
    s_waitcnt lgkmcnt(10)
    buffer_load_dwordx4 v5, s[36:39], s58 offen offset:1024 lds
    v_mfma_f32_16x16x32_bf16 v[68:71], a[228:231], v[136:139], v[68:71]
    ds_read_b64_tr_b16 a[252:253], v38 offset:32768
    ds_read_b64_tr_b16 a[254:255], v38 offset:36864
    v_mfma_f32_16x16x32_bf16 v[84:87], a[228:231], v[168:171], v[84:87]
    s_waitcnt lgkmcnt(10)
    v_add_u32 v37, 4294868992, v37
    v_add_u32 v38, 4294868992, v38
    v_mfma_f32_16x16x32_bf16 v[72:75], a[232:235], v[136:139], v[72:75]
    ds_read_b64_tr_b16 a[128:129], v17 offset:32768
    ds_read_b64_tr_b16 a[130:131], v17 offset:36864
    v_mfma_f32_16x16x32_bf16 v[88:91], a[232:235], v[168:171], v[88:91]
    s_waitcnt lgkmcnt(10)
    buffer_load_dwordx4 v6, s[36:39], s58 offen offset:2048 lds
    v_mfma_f32_16x16x32_bf16 v[76:79], a[236:239], v[136:139], v[76:79]
    v_lshlrev_b32 v59, 4, v59
    v_mfma_f32_16x16x32_bf16 v[92:95], a[236:239], v[168:171], v[92:95]
    s_waitcnt lgkmcnt(8)
    ds_read_b64_tr_b16 a[132:133], v18 offset:32768
    ds_read_b64_tr_b16 a[134:135], v18 offset:36864
    v_mfma_f32_16x16x32_bf16 v[216:219], a[240:243], v[136:139], v[216:219]
    v_and_b32 v60, 15, v2
    v_mfma_f32_16x16x32_bf16 v[220:223], a[240:243], v[168:171], v[220:223]
    s_waitcnt lgkmcnt(8)
    buffer_load_dwordx4 v7, s[36:39], s58 offen offset:3072 lds
    v_mfma_f32_16x16x32_bf16 v[228:231], a[244:247], v[136:139], v[228:231]
    ds_read_b64_tr_b16 a[136:137], v19 offset:32768
    ds_read_b64_tr_b16 a[138:139], v19 offset:36864
    v_mfma_f32_16x16x32_bf16 v[232:235], a[244:247], v[168:171], v[232:235]
    s_waitcnt lgkmcnt(8)
    v_mul_u32_u24 v60, 1152, v60
    v_mfma_f32_16x16x32_bf16 v[240:243], a[248:251], v[136:139], v[240:243]
    s_waitcnt lgkmcnt(6)
    v_add_u32 v59, v60, v59
    v_mfma_f32_16x16x32_bf16 v[244:247], a[248:251], v[168:171], v[244:247]
    s_waitcnt vmcnt(10)
    ds_read_b64_tr_b16 a[140:141], v20 offset:32768
    ds_read_b64_tr_b16 a[142:143], v20 offset:36864
    v_mfma_f32_16x16x32_bf16 v[196:199], a[252:255], v[136:139], v[196:199]
    s_waitcnt lgkmcnt(6)
    v_mfma_f32_16x16x32_bf16 v[200:203], a[252:255], v[168:171], v[200:203]
    s_barrier
    v_mfma_f32_16x16x32_bf16 v[64:67], a[128:131], a[0:3], v[64:67]
    s_add_u32 s58, s10, 36864
    ds_read_b64_tr_b16 a[144:145], v21 offset:32768
    ds_read_b64_tr_b16 a[146:147], v21 offset:36864
    v_mfma_f32_16x16x32_bf16 v[80:83], a[128:131], a[16:19], v[80:83]
    s_add_u32 m0, s19, 131072
    v_mfma_f32_16x16x32_bf16 v[96:99], a[128:131], a[32:35], v[96:99]
    s_mul_i32 s74, s53, 1310720
    buffer_load_dwordx4 v4, s[36:39], s58 offen offset:0 lds
    s_waitcnt lgkmcnt(6)
    v_mfma_f32_16x16x32_bf16 v[68:71], a[132:135], a[0:3], v[68:71]
    s_mul_i32 s56, s54, 66816
    ds_read_b64_tr_b16 a[148:149], v22 offset:32768
    ds_read_b64_tr_b16 a[150:151], v22 offset:36864
    v_mfma_f32_16x16x32_bf16 v[84:87], a[132:135], a[16:19], v[84:87]
    s_add_u32 s74, s74, s56
    v_mfma_f32_16x16x32_bf16 v[100:103], a[132:135], a[32:35], v[100:103]
    s_add_u32 s74, s74, 41088
    buffer_load_dwordx4 v5, s[36:39], s58 offen offset:1024 lds
    s_waitcnt lgkmcnt(6)
    v_mfma_f32_16x16x32_bf16 v[72:75], a[136:139], a[0:3], v[72:75]
    s_mul_i32 s73, s48, 5120
    ds_read_b64_tr_b16 a[152:153], v23 offset:32768
    ds_read_b64_tr_b16 a[154:155], v23 offset:36864
    v_mfma_f32_16x16x32_bf16 v[88:91], a[136:139], a[16:19], v[88:91]
    s_add_u32 s73, s73, s74
    v_mfma_f32_16x16x32_bf16 v[208:211], a[136:139], a[32:35], v[208:211]
    s_xor_b32 s71, s48, 1
    s_waitcnt lgkmcnt(6)
    v_mfma_f32_16x16x32_bf16 v[76:79], a[140:143], a[0:3], v[76:79]
    s_mul_i32 s71, s71, 5120
    buffer_load_dwordx4 v6, s[36:39], s58 offen offset:2048 lds
    v_mfma_f32_16x16x32_bf16 v[92:95], a[140:143], a[16:19], v[92:95]
    s_add_u32 s71, s71, s74
    ds_read_b64_tr_b16 a[156:157], v24 offset:32768
    ds_read_b64_tr_b16 a[158:159], v24 offset:36864
    v_mfma_f32_16x16x32_bf16 v[212:215], a[140:143], a[32:35], v[212:215]
    s_lshl_b32 s56, s50, 1
    s_waitcnt lgkmcnt(6)
    v_mfma_f32_16x16x32_bf16 v[216:219], a[144:147], a[0:3], v[216:219]
    s_add_u32 s56, s56, s49
    ds_read_b64_tr_b16 a[160:161], v31 offset:32768
    ds_read_b64_tr_b16 a[162:163], v31 offset:36864
    v_mfma_f32_16x16x32_bf16 v[220:223], a[144:147], a[16:19], v[220:223]
    s_lshl_b32 s56, s56, 10
    buffer_load_dwordx4 v7, s[36:39], s58 offen offset:3072 lds
    v_mfma_f32_16x16x32_bf16 v[224:227], a[144:147], a[32:35], v[224:227]
    s_add_u32 s69, s73, s56
    ds_read_b64_tr_b16 a[164:165], v32 offset:32768
    ds_read_b64_tr_b16 a[166:167], v32 offset:36864
    s_waitcnt lgkmcnt(8)
    v_mfma_f32_16x16x32_bf16 v[228:231], a[148:151], a[0:3], v[228:231]
    s_add_u32 s58, s10, 55296
    v_mfma_f32_16x16x32_bf16 v[232:235], a[148:151], a[16:19], v[232:235]
    s_add_u32 m0, s19, 135168
    ds_read_b64_tr_b16 a[168:169], v33 offset:32768
    ds_read_b64_tr_b16 a[170:171], v33 offset:36864
    v_mfma_f32_16x16x32_bf16 v[236:239], a[148:151], a[32:35], v[236:239]
    s_add_u32 s70, s71, s56
    buffer_load_dwordx4 v4, s[36:39], s58 offen offset:0 lds
    s_waitcnt lgkmcnt(8)
    v_mfma_f32_16x16x32_bf16 v[240:243], a[152:155], a[0:3], v[240:243]
    s_add_u32 s12, s74, s56
    ds_read_b64_tr_b16 a[172:173], v34 offset:32768
    ds_read_b64_tr_b16 a[174:175], v34 offset:36864
    v_mfma_f32_16x16x32_bf16 v[244:247], a[152:155], a[16:19], v[244:247]
    s_add_u32 s12, s12, 20480
    v_mfma_f32_16x16x32_bf16 v[192:195], a[152:155], a[32:35], v[192:195]
    s_xor_b32 s56, s56, 1024
    ds_read_b64_tr_b16 a[176:177], v35 offset:32768
    ds_read_b64_tr_b16 a[178:179], v35 offset:36864
    s_waitcnt lgkmcnt(10)
    v_mfma_f32_16x16x32_bf16 v[196:199], a[156:159], a[0:3], v[196:199]
    s_add_u32 s72, s71, s56
    v_mfma_f32_16x16x32_bf16 v[200:203], a[156:159], a[16:19], v[200:203]
    s_add_u32 s71, s73, s56
    buffer_load_dwordx4 v5, s[36:39], s58 offen offset:1024 lds
    v_mfma_f32_16x16x32_bf16 v[204:207], a[156:159], a[32:35], v[204:207]
    s_add_u32 s73, s73, 4096
    ds_read_b64_tr_b16 a[180:181], v36 offset:32768
    ds_read_b64_tr_b16 a[182:183], v36 offset:36864
    s_waitcnt lgkmcnt(10)
    v_mfma_f32_16x16x32_bf16 v[64:67], a[160:163], a[8:11], v[64:67]
    s_add_u32 s13, s74, 24576
    ds_read_b64_tr_b16 a[184:185], v37 offset:32768
    ds_read_b64_tr_b16 a[186:187], v37 offset:36864
    v_mfma_f32_16x16x32_bf16 v[80:83], a[160:163], a[24:27], v[80:83]
    s_xor_b32 s56, s48, 3
    s_waitcnt lgkmcnt(10)
    v_mfma_f32_16x16x32_bf16 v[68:71], a[164:167], a[8:11], v[68:71]
    s_min_u32 s56, s56, 1
    buffer_load_dwordx4 v6, s[36:39], s58 offen offset:2048 lds
    v_mfma_f32_16x16x32_bf16 v[84:87], a[164:167], a[24:27], v[84:87]
    s_lshl_b32 s56, s56, 30
    ds_read_b64_tr_b16 a[188:189], v38 offset:32768
    ds_read_b64_tr_b16 a[190:191], v38 offset:36864
    s_waitcnt lgkmcnt(10)
    v_mfma_f32_16x16x32_bf16 v[72:75], a[168:171], a[8:11], v[72:75]
    s_or_b32 s13, s13, s56
    ds_read_b64_tr_b16 a[192:193], v17 offset:0
    ds_read_b64_tr_b16 a[194:195], v17 offset:4096
    v_mfma_f32_16x16x32_bf16 v[88:91], a[168:171], a[24:27], v[88:91]
    s_waitcnt lgkmcnt(10)
    v_add_u32 v17, 98304, v17
    v_lshrrev_b32 v48, 4, v2
    v_mfma_f32_16x16x32_bf16 v[76:79], a[172:175], a[8:11], v[76:79]
    buffer_load_dwordx4 v7, s[36:39], s58 offen offset:3072 lds
    v_mfma_f32_16x16x32_bf16 v[92:95], a[172:175], a[24:27], v[92:95]
    s_waitcnt lgkmcnt(8)
    ds_read_b64_tr_b16 a[196:197], v18 offset:0
    ds_read_b64_tr_b16 a[198:199], v18 offset:4096
    v_mfma_f32_16x16x32_bf16 v[216:219], a[176:179], a[8:11], v[216:219]
    v_add_u32 v18, 98304, v18
    v_bfe_u32 v49, v2, 2, 2
    v_mfma_f32_16x16x32_bf16 v[220:223], a[176:179], a[24:27], v[220:223]
    s_waitcnt lgkmcnt(8)
    v_xor_b32 v48, v48, v49
    v_mfma_f32_16x16x32_bf16 v[228:231], a[180:183], a[8:11], v[228:231]
    buffer_load_dwordx4 a[40:43], v3, s[40:43], s67 offen offset:0 sc1
    v_mfma_f32_16x16x32_bf16 v[232:235], a[180:183], a[24:27], v[232:235]
    s_waitcnt lgkmcnt(6)
    ds_read_b64_tr_b16 a[200:201], v19 offset:0
    ds_read_b64_tr_b16 a[202:203], v19 offset:4096
    v_mfma_f32_16x16x32_bf16 v[240:243], a[184:187], a[8:11], v[240:243]
    s_waitcnt lgkmcnt(4)
    v_add_u32 v19, 98304, v19
    v_min_u32 v48, 1, v48
    v_mfma_f32_16x16x32_bf16 v[244:247], a[184:187], a[24:27], v[244:247]
    s_waitcnt lgkmcnt(6)
    ds_read_b64_tr_b16 a[204:205], v20 offset:0
    ds_read_b64_tr_b16 a[206:207], v20 offset:4096
    v_mfma_f32_16x16x32_bf16 v[196:199], a[188:191], a[8:11], v[196:199]
    s_waitcnt vmcnt(9)
    buffer_load_dwordx4 a[56:59], v11, s[40:43], s67 offen offset:0 sc1
    v_mfma_f32_16x16x32_bf16 v[200:203], a[188:191], a[24:27], v[200:203]
    s_barrier
    v_add_u32 v20, 98304, v20
    v_mfma_f32_16x16x32_bf16 v[64:67], a[192:195], a[4:7], v[64:67]
    ds_read_b64_tr_b16 a[208:209], v21 offset:0
    ds_read_b64_tr_b16 a[210:211], v21 offset:4096
    v_mfma_f32_16x16x32_bf16 v[80:83], a[192:195], a[20:23], v[80:83]
    v_add_u32 v21, 98304, v21
    v_sub_u32 v48, 1, v48
    v_mfma_f32_16x16x32_bf16 v[96:99], a[192:195], a[36:39], v[96:99]
    s_waitcnt lgkmcnt(6)
    v_mul_u32_u24 v48, 0x3f80, v48
    v_mfma_f32_16x16x32_bf16 v[68:71], a[196:199], a[4:7], v[68:71]
    buffer_load_dwordx4 a[72:75], v12, s[40:43], s67 offen offset:0 sc1
    v_mfma_f32_16x16x32_bf16 v[84:87], a[196:199], a[20:23], v[84:87]
    ds_read_b64_tr_b16 a[212:213], v22 offset:0
    ds_read_b64_tr_b16 a[214:215], v22 offset:4096
    v_mfma_f32_16x16x32_bf16 v[100:103], a[196:199], a[36:39], v[100:103]
    s_waitcnt lgkmcnt(6)
    v_add_u32 v22, 98304, v22
    v_and_b32 v49, 1, v2
    v_mfma_f32_16x16x32_bf16 v[72:75], a[200:203], a[4:7], v[72:75]
    ds_read_b64_tr_b16 a[216:217], v23 offset:0
    ds_read_b64_tr_b16 a[218:219], v23 offset:4096
    v_mfma_f32_16x16x32_bf16 v[88:91], a[200:203], a[20:23], v[88:91]
    buffer_load_dwordx4 a[48:51], v3, s[40:43], s67 offen offset:2048 sc1
    v_mfma_f32_16x16x32_bf16 v[208:211], a[200:203], a[36:39], v[208:211]
    s_waitcnt lgkmcnt(6)
    v_add_u32 v23, 98304, v23
    v_lshlrev_b32 v49, 4, v49
    v_mfma_f32_16x16x32_bf16 v[76:79], a[204:207], a[4:7], v[76:79]
    ds_read_b64_tr_b16 a[220:221], v24 offset:0
    ds_read_b64_tr_b16 a[222:223], v24 offset:4096
    v_mfma_f32_16x16x32_bf16 v[92:95], a[204:207], a[20:23], v[92:95]
    v_add_u32 v24, 98304, v24
    v_lshlrev_b32 v48, v49, v48
    v_mfma_f32_16x16x32_bf16 v[212:215], a[204:207], a[36:39], v[212:215]
    s_waitcnt lgkmcnt(6)
    buffer_load_dwordx4 a[64:67], v11, s[40:43], s67 offen offset:2048 sc1
    v_mfma_f32_16x16x32_bf16 v[216:219], a[208:211], a[4:7], v[216:219]
    ds_read_b64_tr_b16 a[224:225], v31 offset:0
    ds_read_b64_tr_b16 a[226:227], v31 offset:4096
    v_mfma_f32_16x16x32_bf16 v[220:223], a[208:211], a[20:23], v[220:223]
    v_add_u32 v31, 98304, v31
    v_bfe_u32 v49, v2, 1, 1
    v_mfma_f32_16x16x32_bf16 v[224:227], a[208:211], a[36:39], v[224:227]
    s_waitcnt lgkmcnt(6)
    ds_read_b64_tr_b16 a[228:229], v32 offset:0
    ds_read_b64_tr_b16 a[230:231], v32 offset:4096
    v_mfma_f32_16x16x32_bf16 v[228:231], a[212:215], a[4:7], v[228:231]
    buffer_load_dwordx4 a[44:47], v3, s[40:43], s67 offen offset:1024 sc1
    v_mfma_f32_16x16x32_bf16 v[232:235], a[212:215], a[20:23], v[232:235]
    ds_read_b64_tr_b16 a[232:233], v33 offset:0
    ds_read_b64_tr_b16 a[234:235], v33 offset:4096
    v_mfma_f32_16x16x32_bf16 v[236:239], a[212:215], a[36:39], v[236:239]
    s_waitcnt lgkmcnt(8)
    v_add_u32 v32, 98304, v32
    v_add_u32 v33, 98304, v33
    v_mfma_f32_16x16x32_bf16 v[240:243], a[216:219], a[4:7], v[240:243]
    ds_read_b64_tr_b16 a[236:237], v34 offset:0
    ds_read_b64_tr_b16 a[238:239], v34 offset:4096
    v_mfma_f32_16x16x32_bf16 v[244:247], a[216:219], a[20:23], v[244:247]
    buffer_load_dwordx4 a[60:63], v11, s[40:43], s67 offen offset:1024 sc1
    v_mfma_f32_16x16x32_bf16 v[192:195], a[216:219], a[36:39], v[192:195]
    s_waitcnt lgkmcnt(8)
    ds_read_b64_tr_b16 a[240:241], v35 offset:0
    ds_read_b64_tr_b16 a[242:243], v35 offset:4096
    v_mfma_f32_16x16x32_bf16 v[196:199], a[220:223], a[4:7], v[196:199]
    buffer_load_ushort v30, v10, s[40:43], s15 offen offset:1024 sc1
    v_mfma_f32_16x16x32_bf16 v[200:203], a[220:223], a[20:23], v[200:203]
    ds_read_b64_tr_b16 a[244:245], v36 offset:0
    ds_read_b64_tr_b16 a[246:247], v36 offset:4096
    v_mfma_f32_16x16x32_bf16 v[204:207], a[220:223], a[36:39], v[204:207]
    s_waitcnt lgkmcnt(10)
    v_add_u32 v34, 98304, v34
    v_add_u32 v35, 98304, v35
    v_mfma_f32_16x16x32_bf16 v[64:67], a[224:227], a[12:15], v[64:67]
    buffer_load_dwordx4 a[76:79], v12, s[40:43], s67 offen offset:1024 sc1
    v_mfma_f32_16x16x32_bf16 v[80:83], a[224:227], a[28:31], v[80:83]
    s_waitcnt lgkmcnt(8)
    ds_read_b64_tr_b16 a[248:249], v37 offset:0
    ds_read_b64_tr_b16 a[250:251], v37 offset:4096
    v_mfma_f32_16x16x32_bf16 v[68:71], a[228:231], a[12:15], v[68:71]
    ds_read_b64_tr_b16 a[252:253], v38 offset:0
    ds_read_b64_tr_b16 a[254:255], v38 offset:4096
    v_mfma_f32_16x16x32_bf16 v[84:87], a[228:231], a[28:31], v[84:87]
    s_waitcnt lgkmcnt(10)
    v_add_u32 v36, 98304, v36
    v_add_u32 v37, 98304, v37
    v_mfma_f32_16x16x32_bf16 v[72:75], a[232:235], a[12:15], v[72:75]
    buffer_load_dwordx4 a[52:55], v3, s[40:43], s67 offen offset:3072 sc1
    v_mfma_f32_16x16x32_bf16 v[88:91], a[232:235], a[28:31], v[88:91]
    s_waitcnt lgkmcnt(8)
    ds_read_b64_tr_b16 a[128:129], v17 offset:0
    ds_read_b64_tr_b16 a[130:131], v17 offset:4096
    v_mfma_f32_16x16x32_bf16 v[76:79], a[236:239], a[12:15], v[76:79]
    v_add_u32 v38, 98304, v38
    v_sub_u32 v49, 0, v49
    v_mfma_f32_16x16x32_bf16 v[92:95], a[236:239], a[28:31], v[92:95]
    s_waitcnt lgkmcnt(8)
    ds_read_b64_tr_b16 a[132:133], v18 offset:0
    ds_read_b64_tr_b16 a[134:135], v18 offset:4096
    v_mfma_f32_16x16x32_bf16 v[216:219], a[240:243], a[12:15], v[216:219]
    buffer_load_dwordx4 a[68:71], v11, s[40:43], s67 offen offset:3072 sc1
    v_mfma_f32_16x16x32_bf16 v[220:223], a[240:243], a[28:31], v[220:223]
    s_waitcnt lgkmcnt(8)
    v_and_b32 v51, v48, v49
    v_mfma_f32_16x16x32_bf16 v[228:231], a[244:247], a[12:15], v[228:231]
    s_add_u32 s58, s11, 0
    ds_read_b64_tr_b16 a[136:137], v19 offset:0
    ds_read_b64_tr_b16 a[138:139], v19 offset:4096
    v_mfma_f32_16x16x32_bf16 v[232:235], a[244:247], a[28:31], v[232:235]
    s_add_u32 m0, s19, 32768
    v_xor_b32 v50, v48, v51
    s_waitcnt lgkmcnt(8)
    v_mfma_f32_16x16x32_bf16 v[240:243], a[248:251], a[12:15], v[240:243]
    s_waitcnt lgkmcnt(6)
    buffer_load_dwordx4 v4, s[36:39], s58 offen offset:0 lds
    v_mfma_f32_16x16x32_bf16 v[244:247], a[248:251], a[28:31], v[244:247]
    s_waitcnt vmcnt(9)
    ds_read_b64_tr_b16 a[140:141], v20 offset:0
    ds_read_b64_tr_b16 a[142:143], v20 offset:4096
    v_mfma_f32_16x16x32_bf16 v[196:199], a[252:255], a[12:15], v[196:199]
    s_waitcnt lgkmcnt(6)
    v_mov_b32 v48, 0
    v_mfma_f32_16x16x32_bf16 v[200:203], a[252:255], a[28:31], v[200:203]
    s_barrier
    v_mov_b32 v49, 0
    v_mfma_f32_16x16x32_bf16 v[64:67], a[128:131], a[40:43], v[64:67]
    buffer_load_dwordx4 v5, s[36:39], s58 offen offset:1024 lds
    v_mfma_f32_16x16x32_bf16 v[80:83], a[128:131], a[56:59], v[80:83]
    ds_read_b64_tr_b16 a[144:145], v21 offset:0
    ds_read_b64_tr_b16 a[146:147], v21 offset:4096
    v_mfma_f32_16x16x32_bf16 v[96:99], a[128:131], a[72:75], v[96:99]
    s_waitcnt lgkmcnt(6)
    v_mov_b32 v52, 0
    v_mfma_f32_16x16x32_bf16 v[68:71], a[132:135], a[40:43], v[68:71]
    ds_read_b64_tr_b16 a[148:149], v22 offset:0
    ds_read_b64_tr_b16 a[150:151], v22 offset:4096
    v_mfma_f32_16x16x32_bf16 v[84:87], a[132:135], a[56:59], v[84:87]
    buffer_load_dwordx4 v6, s[36:39], s58 offen offset:2048 lds
    v_mfma_f32_16x16x32_bf16 v[100:103], a[132:135], a[72:75], v[100:103]
    s_waitcnt lgkmcnt(6)
    v_mov_b32 v53, 0
    v_mfma_f32_16x16x32_bf16 v[72:75], a[136:139], a[40:43], v[72:75]
    s_mul_i32 s63, s53, 1310720
    ds_read_b64_tr_b16 a[152:153], v23 offset:0
    ds_read_b64_tr_b16 a[154:155], v23 offset:4096
    v_mfma_f32_16x16x32_bf16 v[88:91], a[136:139], a[56:59], v[88:91]
    s_lshl_b32 s56, s51, 11
    v_mfma_f32_16x16x32_bf16 v[208:211], a[136:139], a[72:75], v[208:211]
    s_waitcnt vmcnt(6)
    v_cmp_ne_u32 vcc, 1, v30
    s_waitcnt lgkmcnt(6)
    v_mfma_f32_16x16x32_bf16 v[76:79], a[140:143], a[40:43], v[76:79]
    s_add_u32 s62, s63, s56
    buffer_load_dwordx4 v7, s[36:39], s58 offen offset:3072 lds
    v_mfma_f32_16x16x32_bf16 v[92:95], a[140:143], a[56:59], v[92:95]
    s_and_b32 s59, vcc_lo, 4
    s_cbranch_scc1 standalone__gqa_block_cached__near_ridge_b_aq1
standalone__gqa_block_cached__near_ridge_b_aq1_r:
    ds_read_b64_tr_b16 a[156:157], v24 offset:0
    v_mfma_f32_16x16x32_bf16 v[212:215], a[140:143], a[72:75], v[212:215]
    s_add_u32 s58, s11, 18432
    ds_read_b64_tr_b16 a[158:159], v24 offset:4096
    s_waitcnt lgkmcnt(6)
    v_mfma_f32_16x16x32_bf16 v[216:219], a[144:147], a[40:43], v[216:219]
    s_add_u32 m0, s19, 36864
    ds_read_b64_tr_b16 a[160:161], v31 offset:0
    ds_read_b64_tr_b16 a[162:163], v31 offset:4096
    v_mfma_f32_16x16x32_bf16 v[220:223], a[144:147], a[56:59], v[220:223]
    s_add_u32 s62, s62, 1101824
    buffer_load_dwordx4 v4, s[36:39], s58 offen offset:0 lds
    v_mfma_f32_16x16x32_bf16 v[224:227], a[144:147], a[72:75], v[224:227]
    s_waitcnt lgkmcnt(6)
    ds_read_b64_tr_b16 a[164:165], v32 offset:0
    ds_read_b64_tr_b16 a[166:167], v32 offset:4096
    v_mfma_f32_16x16x32_bf16 v[228:231], a[148:151], a[40:43], v[228:231]
    v_and_b32 v43, 3, v2
    v_mfma_f32_16x16x32_bf16 v[232:235], a[148:151], a[56:59], v[232:235]
    ds_read_b64_tr_b16 a[168:169], v33 offset:0
    ds_read_b64_tr_b16 a[170:171], v33 offset:4096
    v_mfma_f32_16x16x32_bf16 v[236:239], a[148:151], a[72:75], v[236:239]
    s_waitcnt lgkmcnt(8)
    buffer_load_dwordx4 v5, s[36:39], s58 offen offset:1024 lds
    v_mfma_f32_16x16x32_bf16 v[240:243], a[152:155], a[40:43], v[240:243]
    ds_read_b64_tr_b16 a[172:173], v34 offset:0
    ds_read_b64_tr_b16 a[174:175], v34 offset:4096
    v_mfma_f32_16x16x32_bf16 v[244:247], a[152:155], a[56:59], v[244:247]
    v_xor_b32 v43, s52, v43
    v_mfma_f32_16x16x32_bf16 v[192:195], a[152:155], a[72:75], v[192:195]
    s_waitcnt lgkmcnt(8)
    ds_read_b64_tr_b16 a[176:177], v35 offset:0
    ds_read_b64_tr_b16 a[178:179], v35 offset:4096
    v_mfma_f32_16x16x32_bf16 v[196:199], a[156:159], a[40:43], v[196:199]
    buffer_load_dwordx4 v6, s[36:39], s58 offen offset:2048 lds
    v_mfma_f32_16x16x32_bf16 v[200:203], a[156:159], a[56:59], v[200:203]
    s_waitcnt lgkmcnt(6)
    ds_read_b64_tr_b16 a[180:181], v36 offset:0
    ds_read_b64_tr_b16 a[182:183], v36 offset:4096
    v_mfma_f32_16x16x32_bf16 v[204:207], a[156:159], a[72:75], v[204:207]
    s_waitcnt lgkmcnt(10)
    v_lshlrev_b32 v43, 2, v43
    v_mfma_f32_16x16x32_bf16 v[64:67], a[160:163], a[48:51], v[64:67]
    s_mul_i32 s56, s51, 66816
    ds_read_b64_tr_b16 a[184:185], v37 offset:0
    ds_read_b64_tr_b16 a[186:187], v37 offset:4096
    v_mfma_f32_16x16x32_bf16 v[80:83], a[160:163], a[64:67], v[80:83]
    s_add_u32 s63, s63, s56
    buffer_load_dwordx4 v7, s[36:39], s58 offen offset:3072 lds
    v_mfma_f32_16x16x32_bf16 v[68:71], a[164:167], a[48:51], v[68:71]
    s_add_u32 s63, s63, 41088
    ds_read_b64_tr_b16 a[188:189], v38 offset:0
    ds_read_b64_tr_b16 a[190:191], v38 offset:4096
    v_mfma_f32_16x16x32_bf16 v[84:87], a[164:167], a[64:67], v[84:87]
    s_mul_i32 s14, s53, 92160
    s_waitcnt lgkmcnt(10)
    v_mfma_f32_16x16x32_bf16 v[72:75], a[168:171], a[48:51], v[72:75]
    s_add_u32 s14, s14, s75
    ds_read_b64_tr_b16 a[192:193], v17 offset:32768
    ds_read_b64_tr_b16 a[194:195], v17 offset:36864
    v_mfma_f32_16x16x32_bf16 v[88:91], a[168:171], a[64:67], v[88:91]
    s_lshl_b32 s56, s48, 2
    v_add_u32 v17, 4294868992, v17
    s_waitcnt lgkmcnt(10)
    v_mfma_f32_16x16x32_bf16 v[76:79], a[172:175], a[48:51], v[76:79]
    s_add_u32 s56, s56, s52
    buffer_load_dwordx4 a[80:83], v3, s[40:43], s68 offen offset:0 sc1
    v_mfma_f32_16x16x32_bf16 v[92:95], a[172:175], a[64:67], v[92:95]
    s_mul_i32 s64, s56, 52
    ds_read_b64_tr_b16 a[196:197], v18 offset:32768
    ds_read_b64_tr_b16 a[198:199], v18 offset:36864
    s_waitcnt lgkmcnt(10)
    v_mfma_f32_16x16x32_bf16 v[216:219], a[176:179], a[48:51], v[216:219]
    s_lshr_b32 s64, s64, 8
    v_add_u32 v18, 4294868992, v18
    v_mfma_f32_16x16x32_bf16 v[220:223], a[176:179], a[64:67], v[220:223]
    s_mul_i32 s20, s64, 5
    s_waitcnt lgkmcnt(8)
    v_mfma_f32_16x16x32_bf16 v[228:231], a[180:183], a[48:51], v[228:231]
    s_sub_u32 s22, s56, s20
    buffer_load_dwordx4 a[96:99], v11, s[40:43], s68 offen offset:0 sc1
    v_mfma_f32_16x16x32_bf16 v[232:235], a[180:183], a[64:67], v[232:235]
    s_add_u32 s20, s20, s56
    ds_read_b64_tr_b16 a[200:201], v19 offset:32768
    ds_read_b64_tr_b16 a[202:203], v19 offset:36864
    s_waitcnt lgkmcnt(8)
    v_mfma_f32_16x16x32_bf16 v[240:243], a[184:187], a[48:51], v[240:243]
    s_lshl_b32 s20, s20, 10
    v_add_u32 v19, 4294868992, v19
    v_mfma_f32_16x16x32_bf16 v[244:247], a[184:187], a[64:67], v[244:247]
    s_waitcnt vmcnt(12)
    ds_read_b64_tr_b16 a[204:205], v20 offset:32768
    ds_read_b64_tr_b16 a[206:207], v20 offset:36864
    s_waitcnt lgkmcnt(8)
    v_mfma_f32_16x16x32_bf16 v[196:199], a[188:191], a[48:51], v[196:199]
    s_mul_i32 s22, s22, 18432
    buffer_load_dwordx4 a[112:115], v12, s[40:43], s68 offen offset:0 sc1
    v_mfma_f32_16x16x32_bf16 v[200:203], a[188:191], a[64:67], v[200:203]
    s_lshl_b32 s56, s64, 7
    v_add_u32 v20, 4294868992, v20
    s_waitcnt lgkmcnt(6)
    v_mfma_f32_16x16x32_bf16 v[64:67], a[192:195], a[44:47], v[64:67]
    s_add_u32 s22, s22, s56
    ds_read_b64_tr_b16 a[208:209], v21 offset:32768
    ds_read_b64_tr_b16 a[210:211], v21 offset:36864
    v_mfma_f32_16x16x32_bf16 v[80:83], a[192:195], a[60:63], v[80:83]
    s_lshr_b32 s64, s64, 1
    v_add_u32 v21, 4294868992, v21
    v_mfma_f32_16x16x32_bf16 v[96:99], a[192:195], a[76:79], v[96:99]
    s_lshl_b32 s64, s64, 30
    buffer_load_dwordx4 a[88:91], v3, s[40:43], s68 offen offset:2048 sc1
    s_waitcnt lgkmcnt(6)
    v_mfma_f32_16x16x32_bf16 v[68:71], a[196:199], a[44:47], v[68:71]
    s_or_b32 s20, s20, s64
    ds_read_b64_tr_b16 a[212:213], v22 offset:32768
    ds_read_b64_tr_b16 a[214:215], v22 offset:36864
    v_mfma_f32_16x16x32_bf16 v[84:87], a[196:199], a[60:63], v[84:87]
    s_or_b32 s22, s22, s64
    v_add_u32 v22, 4294868992, v22
    v_mfma_f32_16x16x32_bf16 v[100:103], a[196:199], a[76:79], v[100:103]
    s_add_u32 s21, s20, 5120
    s_waitcnt lgkmcnt(6)
    v_mfma_f32_16x16x32_bf16 v[72:75], a[200:203], a[44:47], v[72:75]
    s_add_u32 s23, s22, 64
    buffer_load_dwordx4 a[104:107], v11, s[40:43], s68 offen offset:2048 sc1
    v_mfma_f32_16x16x32_bf16 v[88:91], a[200:203], a[60:63], v[88:91]
    ds_read_b64_tr_b16 a[216:217], v23 offset:32768
    ds_read_b64_tr_b16 a[218:219], v23 offset:36864
    v_mfma_f32_16x16x32_bf16 v[208:211], a[200:203], a[76:79], v[208:211]
    s_waitcnt lgkmcnt(6)
    v_add_u32 v23, 4294868992, v23
    v_add_u32 v39, 0, v3
    v_mfma_f32_16x16x32_bf16 v[76:79], a[204:207], a[44:47], v[76:79]
    s_add_u32 s58, s11, 36864
    ds_read_b64_tr_b16 a[220:221], v24 offset:32768
    ds_read_b64_tr_b16 a[222:223], v24 offset:36864
    v_mfma_f32_16x16x32_bf16 v[92:95], a[204:207], a[60:63], v[92:95]
    s_add_u32 m0, s19, 0
    v_add_u32 v24, 4294868992, v24
    v_add_u32 v40, 267264, v3
    v_mfma_f32_16x16x32_bf16 v[212:215], a[204:207], a[76:79], v[212:215]
    s_waitcnt lgkmcnt(6)
    buffer_load_dwordx4 v4, s[36:39], s58 offen offset:0 lds
    v_mfma_f32_16x16x32_bf16 v[216:219], a[208:211], a[44:47], v[216:219]
    ds_read_b64_tr_b16 a[224:225], v31 offset:32768
    ds_read_b64_tr_b16 a[226:227], v31 offset:36864
    v_mfma_f32_16x16x32_bf16 v[220:223], a[208:211], a[60:63], v[220:223]
    v_add_u32 v31, 4294868992, v31
    v_add_u32 v41, 534528, v3
    v_mfma_f32_16x16x32_bf16 v[224:227], a[208:211], a[76:79], v[224:227]
    s_waitcnt lgkmcnt(6)
    ds_read_b64_tr_b16 a[228:229], v32 offset:32768
    ds_read_b64_tr_b16 a[230:231], v32 offset:36864
    v_mfma_f32_16x16x32_bf16 v[228:231], a[212:215], a[44:47], v[228:231]
    buffer_load_dwordx4 v5, s[36:39], s58 offen offset:1024 lds
    v_mfma_f32_16x16x32_bf16 v[232:235], a[212:215], a[60:63], v[232:235]
    ds_read_b64_tr_b16 a[232:233], v33 offset:32768
    ds_read_b64_tr_b16 a[234:235], v33 offset:36864
    v_mfma_f32_16x16x32_bf16 v[236:239], a[212:215], a[76:79], v[236:239]
    s_waitcnt lgkmcnt(8)
    v_add_u32 v32, 4294868992, v32
    v_add_u32 v33, 4294868992, v33
    v_mfma_f32_16x16x32_bf16 v[240:243], a[216:219], a[44:47], v[240:243]
    ds_read_b64_tr_b16 a[236:237], v34 offset:32768
    ds_read_b64_tr_b16 a[238:239], v34 offset:36864
    v_mfma_f32_16x16x32_bf16 v[244:247], a[216:219], a[60:63], v[244:247]
    buffer_load_dwordx4 v6, s[36:39], s58 offen offset:2048 lds
    v_mfma_f32_16x16x32_bf16 v[192:195], a[216:219], a[76:79], v[192:195]
    s_waitcnt lgkmcnt(8)
    ds_read_b64_tr_b16 a[240:241], v35 offset:32768
    ds_read_b64_tr_b16 a[242:243], v35 offset:36864
    v_mfma_f32_16x16x32_bf16 v[196:199], a[220:223], a[44:47], v[196:199]
    s_waitcnt vmcnt(16)
    v_add_u32 v34, 4294868992, v34
    v_add_u32 v35, 4294868992, v35
    v_mfma_f32_16x16x32_bf16 v[200:203], a[220:223], a[60:63], v[200:203]
    ds_read_b64_tr_b16 a[244:245], v36 offset:32768
    ds_read_b64_tr_b16 a[246:247], v36 offset:36864
    v_mfma_f32_16x16x32_bf16 v[204:207], a[220:223], a[76:79], v[204:207]
    s_waitcnt lgkmcnt(10)
    buffer_load_dwordx4 v7, s[36:39], s58 offen offset:3072 lds
    v_mfma_f32_16x16x32_bf16 v[64:67], a[224:227], a[52:55], v[64:67]
    s_waitcnt lgkmcnt(8)
    ds_read_b64_tr_b16 a[248:249], v37 offset:32768
    ds_read_b64_tr_b16 a[250:251], v37 offset:36864
    v_mfma_f32_16x16x32_bf16 v[80:83], a[224:227], a[68:71], v[80:83]
    s_add_u32 s58, s11, 55296
    v_add_u32 v36, 4294868992, v36
    v_add_u32 v37, 4294868992, v37
    v_mfma_f32_16x16x32_bf16 v[68:71], a[228:231], a[52:55], v[68:71]
    s_waitcnt vmcnt(9)
    ds_read_b64_tr_b16 a[252:253], v38 offset:32768
    ds_read_b64_tr_b16 a[254:255], v38 offset:36864
    v_mfma_f32_16x16x32_bf16 v[84:87], a[228:231], a[68:71], v[84:87]
    s_add_u32 m0, s19, 4096
    s_barrier
    s_waitcnt lgkmcnt(10)
    v_mfma_f32_16x16x32_bf16 v[72:75], a[232:235], a[52:55], v[72:75]
    buffer_load_dwordx4 v4, s[36:39], s58 offen offset:0 lds
    v_mfma_f32_16x16x32_bf16 v[88:91], a[232:235], a[68:71], v[88:91]
    s_waitcnt lgkmcnt(8)
    ds_read_b64_tr_b16 a[128:129], v17 offset:32768
    ds_read_b64_tr_b16 a[130:131], v17 offset:36864
    v_mfma_f32_16x16x32_bf16 v[76:79], a[236:239], a[52:55], v[76:79]
    s_waitcnt lgkmcnt(8)
    v_add_u32 v38, 4294868992, v38
    v_add_u32 v42, 801792, v3
    v_mfma_f32_16x16x32_bf16 v[92:95], a[236:239], a[68:71], v[92:95]
    s_add_u32 s20, s20, s63
    ds_read_b64_tr_b16 a[132:133], v18 offset:32768
    ds_read_b64_tr_b16 a[134:135], v18 offset:36864
    v_mfma_f32_16x16x32_bf16 v[216:219], a[240:243], a[52:55], v[216:219]
    s_add_u32 s22, s22, s14
    buffer_load_dwordx4 v5, s[36:39], s58 offen offset:1024 lds
    v_mfma_f32_16x16x32_bf16 v[220:223], a[240:243], a[68:71], v[220:223]
    s_add_u32 s21, s21, s63
    s_waitcnt lgkmcnt(8)
    v_mfma_f32_16x16x32_bf16 v[228:231], a[244:247], a[52:55], v[228:231]
    s_add_u32 s23, s23, s14
    ds_read_b64_tr_b16 a[136:137], v19 offset:32768
    ds_read_b64_tr_b16 a[138:139], v19 offset:36864
    v_mfma_f32_16x16x32_bf16 v[232:235], a[244:247], a[68:71], v[232:235]
    s_waitcnt lgkmcnt(8)
    v_mfma_f32_16x16x32_bf16 v[240:243], a[248:251], a[52:55], v[240:243]
    s_waitcnt lgkmcnt(6)
    buffer_load_dwordx4 v6, s[36:39], s58 offen offset:2048 lds
    v_mfma_f32_16x16x32_bf16 v[244:247], a[248:251], a[68:71], v[244:247]
    s_waitcnt vmcnt(9)
    ds_read_b64_tr_b16 a[140:141], v20 offset:32768
    ds_read_b64_tr_b16 a[142:143], v20 offset:36864
    v_mfma_f32_16x16x32_bf16 v[196:199], a[252:255], a[52:55], v[196:199]
    s_waitcnt lgkmcnt(6)
    v_mfma_f32_16x16x32_bf16 v[200:203], a[252:255], a[68:71], v[200:203]
    s_barrier
    v_mfma_f32_16x16x32_bf16 v[64:67], a[128:131], a[80:83], v[64:67]
    buffer_load_dwordx4 v7, s[36:39], s58 offen offset:3072 lds
    v_mfma_f32_16x16x32_bf16 v[80:83], a[128:131], a[96:99], v[80:83]
    ds_read_b64_tr_b16 a[144:145], v21 offset:32768
    ds_read_b64_tr_b16 a[146:147], v21 offset:36864
    v_mfma_f32_16x16x32_bf16 v[96:99], a[128:131], a[112:115], v[96:99]
    s_waitcnt lgkmcnt(6)
    v_mfma_f32_16x16x32_bf16 v[68:71], a[132:135], a[80:83], v[68:71]
    ds_read_b64_tr_b16 a[148:149], v22 offset:32768
    ds_read_b64_tr_b16 a[150:151], v22 offset:36864
    v_mfma_f32_16x16x32_bf16 v[84:87], a[132:135], a[96:99], v[84:87]
    buffer_load_dwordx4 a[84:87], v3, s[40:43], s68 offen offset:1024 sc1
    v_mfma_f32_16x16x32_bf16 v[100:103], a[132:135], a[112:115], v[100:103]
    s_waitcnt lgkmcnt(6)
    v_mfma_f32_16x16x32_bf16 v[72:75], a[136:139], a[80:83], v[72:75]
standalone__gqa_block_cached__near_ridge_b_h1_1:
    s_cbranch_execz standalone__gqa_block_cached__near_ridge_b_h1_r
    ds_read_b64_tr_b16 a[152:153], v23 offset:32768
    ds_read_b64_tr_b16 a[154:155], v23 offset:36864
    v_mfma_f32_16x16x32_bf16 v[88:91], a[136:139], a[96:99], v[88:91]
    v_mfma_f32_16x16x32_bf16 v[208:211], a[136:139], a[112:115], v[208:211]
    s_waitcnt lgkmcnt(6)
    buffer_load_dwordx4 a[100:103], v11, s[40:43], s68 offen offset:1024 sc1
    v_mfma_f32_16x16x32_bf16 v[76:79], a[140:143], a[80:83], v[76:79]
    ds_read_b64_tr_b16 a[156:157], v24 offset:32768
    ds_read_b64_tr_b16 a[158:159], v24 offset:36864
    v_mfma_f32_16x16x32_bf16 v[92:95], a[140:143], a[96:99], v[92:95]
    v_mfma_f32_16x16x32_bf16 v[212:215], a[140:143], a[112:115], v[212:215]
    s_waitcnt lgkmcnt(6)
    v_mfma_f32_16x16x32_bf16 v[216:219], a[144:147], a[80:83], v[216:219]
    ds_read_b64_tr_b16 a[160:161], v31 offset:32768
    ds_read_b64_tr_b16 a[162:163], v31 offset:36864
    v_mfma_f32_16x16x32_bf16 v[220:223], a[144:147], a[96:99], v[220:223]
    buffer_load_dwordx4 a[116:119], v12, s[40:43], s68 offen offset:1024 sc1
    v_mfma_f32_16x16x32_bf16 v[224:227], a[144:147], a[112:115], v[224:227]
    s_waitcnt lgkmcnt(6)
    ds_read_b64_tr_b16 a[164:165], v32 offset:32768
    ds_read_b64_tr_b16 a[166:167], v32 offset:36864
    v_mfma_f32_16x16x32_bf16 v[228:231], a[148:151], a[80:83], v[228:231]
    v_mfma_f32_16x16x32_bf16 v[232:235], a[148:151], a[96:99], v[232:235]
    ds_read_b64_tr_b16 a[168:169], v33 offset:32768
    ds_read_b64_tr_b16 a[170:171], v33 offset:36864
    v_mfma_f32_16x16x32_bf16 v[236:239], a[148:151], a[112:115], v[236:239]
    s_waitcnt lgkmcnt(8)
    buffer_load_dwordx4 a[92:95], v3, s[40:43], s68 offen offset:3072 sc1
    v_mfma_f32_16x16x32_bf16 v[240:243], a[152:155], a[80:83], v[240:243]
    ds_read_b64_tr_b16 a[172:173], v34 offset:32768
    ds_read_b64_tr_b16 a[174:175], v34 offset:36864
    v_mfma_f32_16x16x32_bf16 v[244:247], a[152:155], a[96:99], v[244:247]
    v_mfma_f32_16x16x32_bf16 v[192:195], a[152:155], a[112:115], v[192:195]
    s_waitcnt lgkmcnt(8)
    ds_read_b64_tr_b16 a[176:177], v35 offset:32768
    ds_read_b64_tr_b16 a[178:179], v35 offset:36864
    v_mfma_f32_16x16x32_bf16 v[196:199], a[156:159], a[80:83], v[196:199]
    s_waitcnt vmcnt(12)
    buffer_load_dwordx4 a[108:111], v11, s[40:43], s68 offen offset:3072 sc1
    v_mfma_f32_16x16x32_bf16 v[200:203], a[156:159], a[96:99], v[200:203]
    ds_read_b64_tr_b16 a[180:181], v36 offset:32768
    ds_read_b64_tr_b16 a[182:183], v36 offset:36864
    v_mfma_f32_16x16x32_bf16 v[204:207], a[156:159], a[112:115], v[204:207]
    s_waitcnt lgkmcnt(10)
    v_mfma_f32_16x16x32_bf16 v[64:67], a[160:163], a[88:91], v[64:67]
    s_waitcnt lgkmcnt(6)
    ds_read_b64_tr_b16 a[184:185], v37 offset:32768
    ds_read_b64_tr_b16 a[186:187], v37 offset:36864
    v_mfma_f32_16x16x32_bf16 v[80:83], a[160:163], a[104:107], v[80:83]
    s_waitcnt lgkmcnt(10)
    v_mfma_f32_16x16x32_bf16 v[68:71], a[164:167], a[88:91], v[68:71]
    s_waitcnt vmcnt(5)
    ds_read_b64_tr_b16 a[188:189], v38 offset:32768
    ds_read_b64_tr_b16 a[190:191], v38 offset:36864
    v_mfma_f32_16x16x32_bf16 v[84:87], a[164:167], a[104:107], v[84:87]
    s_barrier
    v_mfma_f32_16x16x32_bf16 v[72:75], a[168:171], a[88:91], v[72:75]
    ds_read_b64_tr_b16 a[192:193], v20 offset:0
    ds_read_b64_tr_b16 a[194:195], v20 offset:4096
    v_mfma_f32_16x16x32_bf16 v[88:91], a[168:171], a[104:107], v[88:91]
    s_waitcnt lgkmcnt(10)
    v_mfma_f32_16x16x32_bf16 v[76:79], a[172:175], a[88:91], v[76:79]
    v_mfma_f32_16x16x32_bf16 v[92:95], a[172:175], a[104:107], v[92:95]
    s_waitcnt lgkmcnt(8)
    ds_read_b64_tr_b16 a[196:197], v19 offset:0
    ds_read_b64_tr_b16 a[198:199], v19 offset:4096
    v_mfma_f32_16x16x32_bf16 v[216:219], a[176:179], a[88:91], v[216:219]
    v_mfma_f32_16x16x32_bf16 v[220:223], a[176:179], a[104:107], v[220:223]
    s_waitcnt lgkmcnt(8)
    ds_read_b64_tr_b16 a[200:201], v24 offset:0
    ds_read_b64_tr_b16 a[202:203], v24 offset:4096
    v_mfma_f32_16x16x32_bf16 v[228:231], a[180:183], a[88:91], v[228:231]
    v_mfma_f32_16x16x32_bf16 v[232:235], a[180:183], a[104:107], v[232:235]
    s_waitcnt lgkmcnt(8)
    ds_read_b64_tr_b16 a[204:205], v38 offset:0
    ds_read_b64_tr_b16 a[206:207], v38 offset:4096
    v_mfma_f32_16x16x32_bf16 v[240:243], a[184:187], a[88:91], v[240:243]
    s_waitcnt lgkmcnt(8)
    ds_read_b64_tr_b16 a[208:209], v23 offset:0
    ds_read_b64_tr_b16 a[210:211], v23 offset:4096
    v_mfma_f32_16x16x32_bf16 v[244:247], a[184:187], a[104:107], v[244:247]
    s_waitcnt vmcnt(0)
    v_mfma_f32_16x16x32_bf16 v[196:199], a[188:191], a[88:91], v[196:199]
    ds_read_b64_tr_b16 a[212:213], v37 offset:0
    ds_read_b64_tr_b16 a[214:215], v37 offset:4096
    v_mfma_f32_16x16x32_bf16 v[200:203], a[188:191], a[104:107], v[200:203]
    s_waitcnt lgkmcnt(10)
    v_mfma_f32_16x16x32_bf16 v[76:79], a[192:195], a[84:87], v[76:79]
    ds_read_b64_tr_b16 a[216:217], v22 offset:0
    ds_read_b64_tr_b16 a[218:219], v22 offset:4096
    v_mfma_f32_16x16x32_bf16 v[92:95], a[192:195], a[100:103], v[92:95]
    v_mfma_f32_16x16x32_bf16 v[212:215], a[192:195], a[116:119], v[212:215]
    s_waitcnt lgkmcnt(10)
    ds_read_b64_tr_b16 a[220:221], v36 offset:0
    ds_read_b64_tr_b16 a[222:223], v36 offset:4096
    v_mfma_f32_16x16x32_bf16 v[72:75], a[196:199], a[84:87], v[72:75]
    ds_read_b64_tr_b16 a[224:225], v21 offset:0
    ds_read_b64_tr_b16 a[226:227], v21 offset:4096
    v_mfma_f32_16x16x32_bf16 v[88:91], a[196:199], a[100:103], v[88:91]
    v_mfma_f32_16x16x32_bf16 v[208:211], a[196:199], a[116:119], v[208:211]
    s_waitcnt lgkmcnt(12)
    ds_read_b64_tr_b16 a[228:229], v35 offset:0
    ds_read_b64_tr_b16 a[230:231], v35 offset:4096
    v_mfma_f32_16x16x32_bf16 v[196:199], a[200:203], a[84:87], v[196:199]
    v_cvt_pk_bf16_f32 v215, v214, v215
    v_cvt_pk_bf16_f32 v214, v212, v213
    v_mfma_f32_16x16x32_bf16 v[200:203], a[200:203], a[100:103], v[200:203]
    ds_read_b64_tr_b16 a[232:233], v34 offset:0
    ds_read_b64_tr_b16 a[234:235], v34 offset:4096
    v_mfma_f32_16x16x32_bf16 v[204:207], a[200:203], a[116:119], v[204:207]
    s_waitcnt lgkmcnt(12)
    ds_read_b64_tr_b16 a[236:237], v33 offset:0
    ds_read_b64_tr_b16 a[238:239], v33 offset:4096
    v_mfma_f32_16x16x32_bf16 v[196:199], a[204:207], a[92:95], v[196:199]
    v_cvt_pk_bf16_f32 v212, v208, v209
    v_cvt_pk_bf16_f32 v213, v210, v211
    v_mfma_f32_16x16x32_bf16 v[200:203], a[204:207], a[108:111], v[200:203]
    ds_write_b128 v55, v[212:215] offset:4096
    v_mfma_f32_16x16x32_bf16 v[240:243], a[208:211], a[84:87], v[240:243]
    ds_read_b64_tr_b16 a[240:241], v18 offset:0
    ds_read_b64_tr_b16 a[242:243], v18 offset:4096
    v_mfma_f32_16x16x32_bf16 v[244:247], a[208:211], a[100:103], v[244:247]
    v_cvt_pk_bf16_f32 v207, v206, v207
    v_cvt_pk_bf16_f32 v206, v204, v205
    v_mfma_f32_16x16x32_bf16 v[192:195], a[208:211], a[116:119], v[192:195]
    s_waitcnt lgkmcnt(12)
    v_cvt_pk_bf16_f32 v199, v198, v199
    v_cvt_pk_bf16_f32 v198, v196, v197
    v_mfma_f32_16x16x32_bf16 v[240:243], a[212:215], a[92:95], v[240:243]
    v_cvt_pk_bf16_f32 v203, v202, v203
    v_cvt_pk_bf16_f32 v202, v200, v201
    v_mfma_f32_16x16x32_bf16 v[244:247], a[212:215], a[108:111], v[244:247]
    ds_read_b64_tr_b16 a[244:245], v32 offset:0
    ds_read_b64_tr_b16 a[246:247], v32 offset:4096
    v_mfma_f32_16x16x32_bf16 v[228:231], a[216:219], a[84:87], v[228:231]
    ds_read_b64_tr_b16 a[248:249], v17 offset:0
    ds_read_b64_tr_b16 a[250:251], v17 offset:4096
    v_mfma_f32_16x16x32_bf16 v[232:235], a[216:219], a[100:103], v[232:235]
    v_cvt_pk_bf16_f32 v204, v192, v193
    v_cvt_pk_bf16_f32 v205, v194, v195
    v_mfma_f32_16x16x32_bf16 v[236:239], a[216:219], a[116:119], v[236:239]
    s_waitcnt lgkmcnt(12)
    ds_write_b128 v55, v[204:207] offset:6144
    v_mfma_f32_16x16x32_bf16 v[228:231], a[220:223], a[92:95], v[228:231]
    v_cvt_pk_bf16_f32 v196, v240, v241
    v_cvt_pk_bf16_f32 v197, v242, v243
    v_mfma_f32_16x16x32_bf16 v[232:235], a[220:223], a[108:111], v[232:235]
    ds_write_b128 v55, v[196:199] offset:1024
    v_mfma_f32_16x16x32_bf16 v[216:219], a[224:227], a[84:87], v[216:219]
    v_cvt_pk_bf16_f32 v200, v244, v245
    v_cvt_pk_bf16_f32 v201, v246, v247
    v_mfma_f32_16x16x32_bf16 v[220:223], a[224:227], a[100:103], v[220:223]
    ds_write_b128 v55, v[200:203] offset:3072
    v_mfma_f32_16x16x32_bf16 v[224:227], a[224:227], a[116:119], v[224:227]
    s_waitcnt lgkmcnt(12)
    v_cvt_pk_bf16_f32 v239, v238, v239
    v_cvt_pk_bf16_f32 v238, v236, v237
    v_mfma_f32_16x16x32_bf16 v[216:219], a[228:231], a[92:95], v[216:219]
    v_cvt_pk_bf16_f32 v231, v230, v231
    v_cvt_pk_bf16_f32 v230, v228, v229
    v_mfma_f32_16x16x32_bf16 v[220:223], a[228:231], a[108:111], v[220:223]
    v_cvt_pk_bf16_f32 v235, v234, v235
    v_cvt_pk_bf16_f32 v234, v232, v233
    v_mfma_f32_16x16x32_bf16 v[76:79], a[232:235], a[92:95], v[76:79]
    ds_read_b64_tr_b16 a[252:253], v31 offset:0
    ds_read_b64_tr_b16 a[254:255], v31 offset:4096
    v_mfma_f32_16x16x32_bf16 v[92:95], a[232:235], a[108:111], v[92:95]
    s_waitcnt lgkmcnt(12)
    v_cvt_pk_bf16_f32 v236, v224, v225
    v_cvt_pk_bf16_f32 v237, v226, v227
    v_mfma_f32_16x16x32_bf16 v[72:75], a[236:239], a[92:95], v[72:75]
    ds_write_b128 v55, v[236:239] offset:5120
    v_mfma_f32_16x16x32_bf16 v[88:91], a[236:239], a[108:111], v[88:91]
    s_waitcnt lgkmcnt(10)
    v_cvt_pk_bf16_f32 v228, v216, v217
    v_cvt_pk_bf16_f32 v229, v218, v219
    v_mfma_f32_16x16x32_bf16 v[68:71], a[240:243], a[84:87], v[68:71]
    ds_write_b128 v55, v[228:231] offset:0
    v_mfma_f32_16x16x32_bf16 v[84:87], a[240:243], a[100:103], v[84:87]
    v_cvt_pk_bf16_f32 v232, v220, v221
    v_cvt_pk_bf16_f32 v233, v222, v223
    v_mfma_f32_16x16x32_bf16 v[100:103], a[240:243], a[116:119], v[100:103]
    s_waitcnt lgkmcnt(9)
    ds_write_b128 v55, v[232:235] offset:2048
    v_mfma_f32_16x16x32_bf16 v[68:71], a[244:247], a[92:95], v[68:71]
    v_mfma_f32_16x16x32_bf16 v[84:87], a[244:247], a[108:111], v[84:87]
    s_waitcnt lgkmcnt(0)
    v_mfma_f32_16x16x32_bf16 v[64:67], a[248:251], a[84:87], v[64:67]
    s_barrier
    ds_read_b128 a[0:3], v57 offset:3072
    v_mfma_f32_16x16x32_bf16 v[80:83], a[248:251], a[100:103], v[80:83]
    ds_read_b128 a[4:7], v57 offset:1024
    ds_read_b128 a[8:11], v57 offset:2048
    v_mfma_f32_16x16x32_bf16 v[96:99], a[248:251], a[116:119], v[96:99]
    ds_read_b128 a[12:15], v57 offset:0
    ds_read_b128 a[16:19], v56 offset:4096
    v_mfma_f32_16x16x32_bf16 v[64:67], a[252:255], a[92:95], v[64:67]
    ds_read_b128 a[20:23], v57 offset:5120
    ds_read_b128 a[24:27], v58 offset:6144
    v_mfma_f32_16x16x32_bf16 v[80:83], a[252:255], a[108:111], v[80:83]
    s_waitcnt lgkmcnt(6)
    v_mfma_f32_16x16x32_bf16 v[72:75], v[50:53], a[0:3], v[72:75]
    v_mfma_f32_16x16x32_bf16 v[76:79], v[48:51], a[0:3], v[76:79]
    s_waitcnt lgkmcnt(5)
    v_mfma_f32_16x16x32_bf16 v[88:91], v[50:53], a[4:7], v[88:91]
    v_mfma_f32_16x16x32_bf16 v[92:95], v[48:51], a[4:7], v[92:95]
    s_waitcnt lgkmcnt(4)
    v_mfma_f32_16x16x32_bf16 v[64:67], v[50:53], a[8:11], v[64:67]
    v_mfma_f32_16x16x32_bf16 v[68:71], v[48:51], a[8:11], v[68:71]
    s_waitcnt lgkmcnt(3)
    v_cvt_pk_bf16_f32 v72, v72, v73
    v_cvt_pk_bf16_f32 v73, v74, v75
    v_mfma_f32_16x16x32_bf16 v[80:83], v[50:53], a[12:15], v[80:83]
    v_cvt_pk_bf16_f32 v74, v76, v77
    v_cvt_pk_bf16_f32 v75, v78, v79
    v_mfma_f32_16x16x32_bf16 v[84:87], v[48:51], a[12:15], v[84:87]
    s_waitcnt lgkmcnt(2)
    buffer_store_dwordx4 v[72:75], v3, s[40:43], s70 offen sc1
    v_mfma_f32_16x16x32_bf16 v[96:99], v[50:53], a[16:19], v[96:99]
    v_cvt_pk_bf16_f32 v88, v88, v89
    v_cvt_pk_bf16_f32 v89, v90, v91
    v_mfma_f32_16x16x32_bf16 v[100:103], v[48:51], a[16:19], v[100:103]
    s_waitcnt lgkmcnt(1)
    v_cvt_pk_bf16_f32 v90, v92, v93
    v_cvt_pk_bf16_f32 v91, v94, v95
    v_mfma_f32_16x16x32_bf16 v[96:99], v[50:53], a[20:23], v[96:99]
    buffer_store_dwordx4 v[88:91], v3, s[40:43], s72 offen sc1
    v_mfma_f32_16x16x32_bf16 v[100:103], v[48:51], a[20:23], v[100:103]
    s_waitcnt lgkmcnt(0)
    v_cvt_pk_bf16_f32 v64, v64, v65
    v_cvt_pk_bf16_f32 v65, v66, v67
    v_mfma_f32_16x16x32_bf16 v[96:99], v[50:53], a[24:27], v[96:99]
    v_cvt_pk_bf16_f32 v66, v68, v69
    v_cvt_pk_bf16_f32 v67, v70, v71
    v_mfma_f32_16x16x32_bf16 v[100:103], v[48:51], a[24:27], v[100:103]
    buffer_store_dwordx4 v[64:67], v3, s[40:43], s69 offen sc1
    v_cvt_pk_bf16_f32 v80, v80, v81
    v_cvt_pk_bf16_f32 v81, v82, v83
    v_cvt_pk_bf16_f32 v82, v84, v85
    v_cvt_pk_bf16_f32 v83, v86, v87
    buffer_store_dwordx4 v[80:83], v3, s[40:43], s71 offen sc1
    v_cvt_pk_bf16_f32 v96, v96, v97
    v_cvt_pk_bf16_f32 v97, v98, v99
    v_cvt_pk_bf16_f32 v98, v100, v101
    v_cvt_pk_bf16_f32 v99, v102, v103
    buffer_store_dwordx4 v[96:99], v3, s[40:43], s73 offen sc1
    s_mov_b32 s65, 0
    s_waitcnt vmcnt(0)
    s_barrier
    s_cmp_lg_u32 s48, 0
    s_cbranch_scc1 standalone__gqa_block_cached__near_ridge_b_fq
    s_mov_b64 exec, 1
    buffer_store_dword v29, v43, s[40:43], s62 offen sc1
    s_mov_b64 exec, 14
standalone__gqa_block_cached__near_ridge_b_fp:
    buffer_load_dword v208, v43, s[40:43], s62 offen sc1
    s_waitcnt vmcnt(0)
    v_cmp_ne_u32 vcc, 1, v208
    s_add_u32 s65, s65, 1
    s_and_b32 s59, vcc_lo, 14
    s_cbranch_scc0 standalone__gqa_block_cached__near_ridge_b_fq
    s_cmp_lt_u32 s65, 200000
    s_cbranch_scc1 standalone__gqa_block_cached__near_ridge_b_fp
standalone__gqa_block_cached__near_ridge_b_fq:
    s_mov_b64 exec, -1
    s_barrier
    buffer_load_dwordx4 a[0:3], v39, s[40:43], s20 offen sc1
    buffer_load_dwordx4 a[16:19], v39, s[40:43], s21 offen sc1
    buffer_load_dwordx4 a[4:7], v40, s[40:43], s20 offen sc1
    buffer_load_dwordx4 a[20:23], v40, s[40:43], s21 offen sc1
    buffer_load_dwordx4 a[8:11], v41, s[40:43], s20 offen sc1
    buffer_load_dwordx4 a[24:27], v41, s[40:43], s21 offen sc1
    buffer_load_dwordx4 a[12:15], v42, s[40:43], s20 offen sc1
    buffer_load_dwordx4 a[28:31], v42, s[40:43], s21 offen sc1
    s_waitcnt vmcnt(6)
    v_mfma_f32_16x16x32_bf16 v[112:115], v[50:53], a[0:3], 0
    v_mfma_f32_16x16x32_bf16 v[116:119], v[48:51], a[0:3], 0
    v_mfma_f32_16x16x32_bf16 v[120:123], v[50:53], a[16:19], 0
    v_mfma_f32_16x16x32_bf16 v[124:127], v[48:51], a[16:19], 0
    s_waitcnt vmcnt(4)
    v_mfma_f32_16x16x32_bf16 v[112:115], v[50:53], a[4:7], v[112:115]
    v_mfma_f32_16x16x32_bf16 v[116:119], v[48:51], a[4:7], v[116:119]
    v_mfma_f32_16x16x32_bf16 v[120:123], v[50:53], a[20:23], v[120:123]
    v_mfma_f32_16x16x32_bf16 v[124:127], v[48:51], a[20:23], v[124:127]
    s_waitcnt vmcnt(2)
    v_mfma_f32_16x16x32_bf16 v[112:115], v[50:53], a[8:11], v[112:115]
    v_mfma_f32_16x16x32_bf16 v[116:119], v[48:51], a[8:11], v[116:119]
    v_mfma_f32_16x16x32_bf16 v[120:123], v[50:53], a[24:27], v[120:123]
    v_mfma_f32_16x16x32_bf16 v[124:127], v[48:51], a[24:27], v[124:127]
    s_waitcnt vmcnt(0)
    v_mfma_f32_16x16x32_bf16 v[112:115], v[50:53], a[12:15], v[112:115]
    v_mfma_f32_16x16x32_bf16 v[116:119], v[48:51], a[12:15], v[116:119]
    v_mfma_f32_16x16x32_bf16 v[120:123], v[50:53], a[28:31], v[120:123]
    v_mfma_f32_16x16x32_bf16 v[124:127], v[48:51], a[28:31], v[124:127]
    s_nop 4
    v_cvt_pk_bf16_f32 v112, v112, v113
    v_cvt_pk_bf16_f32 v113, v114, v115
    v_cvt_pk_bf16_f32 v114, v116, v117
    v_cvt_pk_bf16_f32 v115, v118, v119
    v_cvt_pk_bf16_f32 v120, v120, v121
    v_cvt_pk_bf16_f32 v121, v122, v123
    v_cvt_pk_bf16_f32 v122, v124, v125
    v_cvt_pk_bf16_f32 v123, v126, v127
    v_permlane16_swap_b32 v112, v114
    v_permlane16_swap_b32 v113, v115
    buffer_store_dwordx4 v[112:115], v59, s[44:47], s22 offen
    v_permlane16_swap_b32 v120, v122
    v_permlane16_swap_b32 v121, v123
    buffer_store_dwordx4 v[120:123], v59, s[44:47], s23 offen
    s_endpgm
standalone__gqa_block_cached__near_ridge_hot:
standalone__gqa_block_cached__near_ridge_safe:
    s_nop 7
    s_mov_b32 s65, 0
    v_lshrrev_b32 v59, 5, v2
    v_bfe_u32 v60, v2, 4, 1
    v_lshl_add_u32 v59, v60, 1, v59
    v_and_b32 v60, 15, v2
    v_xor_b32 v59, v59, v60
    v_lshlrev_b32 v59, 4, v59
    s_lshl_b32 s58, s50, 7
    v_xor_b32 v59, s58, v59
    v_lshl_add_u32 v59, v60, 8, v59
    s_lshl_b32 s58, s50, 13
    s_add_u32 s58, s58, s59
    v_add_u32 v31, s58, v59
    v_xor_b32 v32, 64, v31
    v_xor_b32 v33, 128, v31
    v_xor_b32 v34, 192, v31
    v_xor_b32 v35, 8192, v31
    v_xor_b32 v36, 8256, v31
    v_xor_b32 v37, 8320, v31
    v_xor_b32 v38, 8384, v31
    v_mov_b32 v252, 0x7f800000
    v_mov_b32 v253, 0x7f800000
    v_mov_b32 v254, 0x7f800000
    v_mov_b32 v112, 0
    v_mov_b32 v113, 0
    v_mov_b32 v114, 0
    v_mov_b32 v115, 0
    v_mov_b32 v116, 0
    v_mov_b32 v117, 0
    v_mov_b32 v118, 0
    v_mov_b32 v119, 0
    v_mov_b32 v120, 0
    v_mov_b32 v121, 0
    v_mov_b32 v122, 0
    v_mov_b32 v123, 0
    v_mov_b32 v124, 0
    v_mov_b32 v125, 0
    v_mov_b32 v126, 0
    v_mov_b32 v127, 0
    v_mov_b32 v128, 0
    v_mov_b32 v129, 0
    v_mov_b32 v130, 0
    v_mov_b32 v131, 0
    v_mov_b32 v132, 0
    v_mov_b32 v133, 0
    v_mov_b32 v134, 0
    v_mov_b32 v135, 0
    v_mov_b32 v136, 0
    v_mov_b32 v137, 0
    v_mov_b32 v138, 0
    v_mov_b32 v139, 0
    v_mov_b32 v140, 0
    v_mov_b32 v141, 0
    v_mov_b32 v142, 0
    v_mov_b32 v143, 0
    v_mov_b32 v144, 0
    v_mov_b32 v145, 0
    v_mov_b32 v146, 0
    v_mov_b32 v147, 0
    v_mov_b32 v148, 0
    v_mov_b32 v149, 0
    v_mov_b32 v150, 0
    v_mov_b32 v151, 0
    v_mov_b32 v152, 0
    v_mov_b32 v153, 0
    v_mov_b32 v154, 0
    v_mov_b32 v155, 0
    v_mov_b32 v156, 0
    v_mov_b32 v157, 0
    v_mov_b32 v158, 0
    v_mov_b32 v159, 0
    v_mov_b32 v160, 0
    v_mov_b32 v161, 0
    v_mov_b32 v162, 0
    v_mov_b32 v163, 0
    v_mov_b32 v164, 0
    v_mov_b32 v165, 0
    v_mov_b32 v166, 0
    v_mov_b32 v167, 0
    v_mov_b32 v168, 0
    v_mov_b32 v169, 0
    v_mov_b32 v170, 0
    v_mov_b32 v171, 0
    v_mov_b32 v172, 0
    v_mov_b32 v173, 0
    v_mov_b32 v174, 0
    v_mov_b32 v175, 0
    v_mov_b32 v176, 0
    v_mov_b32 v177, 0
    v_mov_b32 v178, 0
    v_mov_b32 v179, 0
    v_mov_b32 v180, 0
    v_mov_b32 v181, 0
    v_mov_b32 v182, 0
    v_mov_b32 v183, 0
    v_mov_b32 v184, 0
    v_mov_b32 v185, 0
    v_mov_b32 v186, 0
    v_mov_b32 v187, 0
    v_mov_b32 v188, 0
    v_mov_b32 v189, 0
    v_mov_b32 v190, 0
    v_mov_b32 v191, 0
    v_mov_b32 v192, 0
    v_mov_b32 v193, 0
    v_mov_b32 v194, 0
    v_mov_b32 v195, 0
    v_mov_b32 v196, 0
    v_mov_b32 v197, 0
    v_mov_b32 v198, 0
    v_mov_b32 v199, 0
    v_mov_b32 v200, 0
    v_mov_b32 v201, 0
    v_mov_b32 v202, 0
    v_mov_b32 v203, 0
    v_mov_b32 v204, 0
    v_mov_b32 v205, 0
    v_mov_b32 v206, 0
    v_mov_b32 v207, 0
    v_accvgpr_write_b32 a192, 0
    v_accvgpr_write_b32 a193, 0
    v_accvgpr_write_b32 a194, 0
    v_accvgpr_write_b32 a195, 0
    v_accvgpr_write_b32 a196, 0
    v_accvgpr_write_b32 a197, 0
    v_accvgpr_write_b32 a198, 0
    v_accvgpr_write_b32 a199, 0
    v_accvgpr_write_b32 a200, 0
    v_accvgpr_write_b32 a201, 0
    v_accvgpr_write_b32 a202, 0
    v_accvgpr_write_b32 a203, 0
standalone__gqa_block_cached__near_ridge_sl:
    s_barrier
    s_add_u32 m0, s55, s59
    s_add_u32 s58, s55, s65
    buffer_load_dwordx4 v11, s[24:27], s58 offen offset:0 nt lds
    buffer_load_dwordx4 v12, s[24:27], s58 offen offset:1024 nt lds
    buffer_load_dwordx4 v13, s[24:27], s58 offen offset:2048 nt lds
    buffer_load_dwordx4 v14, s[24:27], s58 offen offset:3072 nt lds
    s_add_u32 m0, s55, 65536
    s_add_u32 s58, s55, s65
    buffer_load_dwordx4 v15, s[28:31], s58 offen offset:0 nt lds
    buffer_load_dwordx4 v16, s[28:31], s58 offen offset:1024 nt lds
    buffer_load_dwordx4 v15, s[28:31], s58 offen offset:2048 nt lds
    buffer_load_dwordx4 v16, s[28:31], s58 offen offset:3072 nt lds
    s_waitcnt vmcnt(0)
    s_barrier
    ds_read_b128 a[0:3], v31 offset:0
    ds_read_b128 a[4:7], v32 offset:0
    ds_read_b128 a[8:11], v33 offset:0
    ds_read_b128 a[12:15], v34 offset:0
    ds_read_b128 a[16:19], v31 offset:4096
    ds_read_b128 a[20:23], v32 offset:4096
    ds_read_b128 a[24:27], v33 offset:4096
    ds_read_b128 a[28:31], v34 offset:4096
    ds_read_b128 a[32:35], v35 offset:0
    ds_read_b128 a[36:39], v36 offset:0
    ds_read_b128 a[40:43], v37 offset:0
    ds_read_b128 a[44:47], v38 offset:0
    ds_read_b128 a[48:51], v35 offset:4096
    ds_read_b128 a[52:55], v36 offset:4096
    ds_read_b128 a[56:59], v37 offset:4096
    ds_read_b128 a[60:63], v38 offset:4096
    ds_read_b64_tr_b16 a[128:129], v39 offset:16384
    ds_read_b64_tr_b16 a[130:131], v39 offset:20480
    ds_read_b64_tr_b16 a[132:133], v40 offset:16384
    ds_read_b64_tr_b16 a[134:135], v40 offset:20480
    ds_read_b64_tr_b16 a[136:137], v41 offset:16384
    ds_read_b64_tr_b16 a[138:139], v41 offset:20480
    ds_read_b64_tr_b16 a[140:141], v42 offset:16384
    ds_read_b64_tr_b16 a[142:143], v42 offset:20480
    ds_read_b64_tr_b16 a[144:145], v43 offset:16384
    ds_read_b64_tr_b16 a[146:147], v43 offset:20480
    ds_read_b64_tr_b16 a[148:149], v44 offset:16384
    ds_read_b64_tr_b16 a[150:151], v44 offset:20480
    ds_read_b64_tr_b16 a[152:153], v45 offset:16384
    ds_read_b64_tr_b16 a[154:155], v45 offset:20480
    ds_read_b64_tr_b16 a[156:157], v46 offset:16384
    ds_read_b64_tr_b16 a[158:159], v46 offset:20480
    ds_read_b64_tr_b16 a[160:161], v47 offset:16384
    ds_read_b64_tr_b16 a[162:163], v47 offset:20480
    ds_read_b64_tr_b16 a[164:165], v48 offset:16384
    ds_read_b64_tr_b16 a[166:167], v48 offset:20480
    ds_read_b64_tr_b16 a[168:169], v49 offset:16384
    ds_read_b64_tr_b16 a[170:171], v49 offset:20480
    ds_read_b64_tr_b16 a[172:173], v50 offset:16384
    ds_read_b64_tr_b16 a[174:175], v50 offset:20480
    ds_read_b64_tr_b16 a[176:177], v51 offset:16384
    ds_read_b64_tr_b16 a[178:179], v51 offset:20480
    ds_read_b64_tr_b16 a[180:181], v52 offset:16384
    ds_read_b64_tr_b16 a[182:183], v52 offset:20480
    ds_read_b64_tr_b16 a[184:185], v53 offset:16384
    ds_read_b64_tr_b16 a[186:187], v53 offset:20480
    ds_read_b64_tr_b16 a[188:189], v54 offset:16384
    ds_read_b64_tr_b16 a[190:191], v54 offset:20480
    s_waitcnt lgkmcnt(0)
    v_mfma_f32_16x16x32_bf16 v[208:211], a[0:3], v[64:67], 0
    v_mfma_f32_16x16x32_bf16 v[208:211], a[4:7], v[68:71], v[208:211]
    v_mfma_f32_16x16x32_bf16 v[208:211], a[8:11], v[72:75], v[208:211]
    v_mfma_f32_16x16x32_bf16 v[208:211], a[12:15], v[76:79], v[208:211]
    v_mfma_f32_16x16x32_bf16 v[212:215], a[16:19], v[64:67], 0
    v_mfma_f32_16x16x32_bf16 v[212:215], a[20:23], v[68:71], v[212:215]
    v_mfma_f32_16x16x32_bf16 v[212:215], a[24:27], v[72:75], v[212:215]
    v_mfma_f32_16x16x32_bf16 v[212:215], a[28:31], v[76:79], v[212:215]
    s_nop 7
    v_max3_f32 v59, v208, v209, v210
    v_max3_f32 v59, v59, v211, v212
    v_max3_f32 v59, v59, v213, v214
    v_max_f32 v59, v59, v215
    v_mov_b32 v60, v59
    s_nop 1
    v_permlane32_swap_b32 v59, v60
    s_nop 1
    v_max_f32 v59, v59, v60
    v_mov_b32 v60, v59
    s_nop 1
    v_permlane16_swap_b32 v59, v60
    s_nop 1
    v_min3_f32 v59, -v59, -v60, v252
    v_sub_f32 v60, v59, v252
    v_exp_f32 v60, v60
    v_mov_b32 v252, v59
    v_add_f32 v208, v208, v59
    v_add_f32 v209, v209, v59
    v_add_f32 v210, v210, v59
    v_add_f32 v211, v211, v59
    v_add_f32 v212, v212, v59
    v_add_f32 v213, v213, v59
    v_add_f32 v214, v214, v59
    v_add_f32 v215, v215, v59
    v_exp_f32 v208, v208
    v_exp_f32 v209, v209
    v_exp_f32 v210, v210
    v_exp_f32 v211, v211
    v_exp_f32 v212, v212
    v_exp_f32 v213, v213
    v_exp_f32 v214, v214
    v_exp_f32 v215, v215
    v_mul_f32 v112, v112, v60
    v_mul_f32 v113, v113, v60
    v_mul_f32 v114, v114, v60
    v_mul_f32 v115, v115, v60
    v_mul_f32 v116, v116, v60
    v_mul_f32 v117, v117, v60
    v_mul_f32 v118, v118, v60
    v_mul_f32 v119, v119, v60
    v_mul_f32 v120, v120, v60
    v_mul_f32 v121, v121, v60
    v_mul_f32 v122, v122, v60
    v_mul_f32 v123, v123, v60
    v_mul_f32 v124, v124, v60
    v_mul_f32 v125, v125, v60
    v_mul_f32 v126, v126, v60
    v_mul_f32 v127, v127, v60
    v_mul_f32 v128, v128, v60
    v_mul_f32 v129, v129, v60
    v_mul_f32 v130, v130, v60
    v_mul_f32 v131, v131, v60
    v_mul_f32 v132, v132, v60
    v_mul_f32 v133, v133, v60
    v_mul_f32 v134, v134, v60
    v_mul_f32 v135, v135, v60
    v_mul_f32 v136, v136, v60
    v_mul_f32 v137, v137, v60
    v_mul_f32 v138, v138, v60
    v_mul_f32 v139, v139, v60
    v_mul_f32 v140, v140, v60
    v_mul_f32 v141, v141, v60
    v_mul_f32 v142, v142, v60
    v_mul_f32 v143, v143, v60
    v_accvgpr_read_b32 v59, a192
    v_mul_f32 v59, v59, v60
    v_accvgpr_write_b32 a192, v59
    v_accvgpr_read_b32 v59, a193
    v_mul_f32 v59, v59, v60
    v_accvgpr_write_b32 a193, v59
    v_accvgpr_read_b32 v59, a194
    v_mul_f32 v59, v59, v60
    v_accvgpr_write_b32 a194, v59
    v_accvgpr_read_b32 v59, a195
    v_mul_f32 v59, v59, v60
    v_accvgpr_write_b32 a195, v59
    v_cvt_pk_bf16_f32 v208, v208, v209
    v_cvt_pk_bf16_f32 v209, v210, v211
    v_cvt_pk_bf16_f32 v210, v212, v213
    v_cvt_pk_bf16_f32 v211, v214, v215
    s_nop 1
    v_mfma_f32_16x16x32_bf16 v[112:115], a[128:131], v[208:211], v[112:115]
    v_mfma_f32_16x16x32_bf16 v[116:119], a[132:135], v[208:211], v[116:119]
    v_mfma_f32_16x16x32_bf16 v[120:123], a[136:139], v[208:211], v[120:123]
    v_mfma_f32_16x16x32_bf16 v[124:127], a[140:143], v[208:211], v[124:127]
    v_mfma_f32_16x16x32_bf16 v[128:131], a[144:147], v[208:211], v[128:131]
    v_mfma_f32_16x16x32_bf16 v[132:135], a[148:151], v[208:211], v[132:135]
    v_mfma_f32_16x16x32_bf16 v[136:139], a[152:155], v[208:211], v[136:139]
    v_mfma_f32_16x16x32_bf16 v[140:143], a[156:159], v[208:211], v[140:143]
    v_mfma_f32_16x16x32_bf16 a[192:195], a[204:207], v[208:211], a[192:195]
    v_mfma_f32_16x16x32_bf16 v[216:219], a[0:3], v[80:83], 0
    v_mfma_f32_16x16x32_bf16 v[216:219], a[4:7], v[84:87], v[216:219]
    v_mfma_f32_16x16x32_bf16 v[216:219], a[8:11], v[88:91], v[216:219]
    v_mfma_f32_16x16x32_bf16 v[216:219], a[12:15], v[92:95], v[216:219]
    v_mfma_f32_16x16x32_bf16 v[220:223], a[16:19], v[80:83], 0
    v_mfma_f32_16x16x32_bf16 v[220:223], a[20:23], v[84:87], v[220:223]
    v_mfma_f32_16x16x32_bf16 v[220:223], a[24:27], v[88:91], v[220:223]
    v_mfma_f32_16x16x32_bf16 v[220:223], a[28:31], v[92:95], v[220:223]
    s_nop 7
    v_max3_f32 v59, v216, v217, v218
    v_max3_f32 v59, v59, v219, v220
    v_max3_f32 v59, v59, v221, v222
    v_max_f32 v59, v59, v223
    v_mov_b32 v60, v59
    s_nop 1
    v_permlane32_swap_b32 v59, v60
    s_nop 1
    v_max_f32 v59, v59, v60
    v_mov_b32 v60, v59
    s_nop 1
    v_permlane16_swap_b32 v59, v60
    s_nop 1
    v_min3_f32 v59, -v59, -v60, v253
    v_sub_f32 v60, v59, v253
    v_exp_f32 v60, v60
    v_mov_b32 v253, v59
    v_add_f32 v216, v216, v59
    v_add_f32 v217, v217, v59
    v_add_f32 v218, v218, v59
    v_add_f32 v219, v219, v59
    v_add_f32 v220, v220, v59
    v_add_f32 v221, v221, v59
    v_add_f32 v222, v222, v59
    v_add_f32 v223, v223, v59
    v_exp_f32 v216, v216
    v_exp_f32 v217, v217
    v_exp_f32 v218, v218
    v_exp_f32 v219, v219
    v_exp_f32 v220, v220
    v_exp_f32 v221, v221
    v_exp_f32 v222, v222
    v_exp_f32 v223, v223
    v_mul_f32 v144, v144, v60
    v_mul_f32 v145, v145, v60
    v_mul_f32 v146, v146, v60
    v_mul_f32 v147, v147, v60
    v_mul_f32 v148, v148, v60
    v_mul_f32 v149, v149, v60
    v_mul_f32 v150, v150, v60
    v_mul_f32 v151, v151, v60
    v_mul_f32 v152, v152, v60
    v_mul_f32 v153, v153, v60
    v_mul_f32 v154, v154, v60
    v_mul_f32 v155, v155, v60
    v_mul_f32 v156, v156, v60
    v_mul_f32 v157, v157, v60
    v_mul_f32 v158, v158, v60
    v_mul_f32 v159, v159, v60
    v_mul_f32 v160, v160, v60
    v_mul_f32 v161, v161, v60
    v_mul_f32 v162, v162, v60
    v_mul_f32 v163, v163, v60
    v_mul_f32 v164, v164, v60
    v_mul_f32 v165, v165, v60
    v_mul_f32 v166, v166, v60
    v_mul_f32 v167, v167, v60
    v_mul_f32 v168, v168, v60
    v_mul_f32 v169, v169, v60
    v_mul_f32 v170, v170, v60
    v_mul_f32 v171, v171, v60
    v_mul_f32 v172, v172, v60
    v_mul_f32 v173, v173, v60
    v_mul_f32 v174, v174, v60
    v_mul_f32 v175, v175, v60
    v_accvgpr_read_b32 v59, a196
    v_mul_f32 v59, v59, v60
    v_accvgpr_write_b32 a196, v59
    v_accvgpr_read_b32 v59, a197
    v_mul_f32 v59, v59, v60
    v_accvgpr_write_b32 a197, v59
    v_accvgpr_read_b32 v59, a198
    v_mul_f32 v59, v59, v60
    v_accvgpr_write_b32 a198, v59
    v_accvgpr_read_b32 v59, a199
    v_mul_f32 v59, v59, v60
    v_accvgpr_write_b32 a199, v59
    v_cvt_pk_bf16_f32 v216, v216, v217
    v_cvt_pk_bf16_f32 v217, v218, v219
    v_cvt_pk_bf16_f32 v218, v220, v221
    v_cvt_pk_bf16_f32 v219, v222, v223
    s_nop 1
    v_mfma_f32_16x16x32_bf16 v[144:147], a[128:131], v[216:219], v[144:147]
    v_mfma_f32_16x16x32_bf16 v[148:151], a[132:135], v[216:219], v[148:151]
    v_mfma_f32_16x16x32_bf16 v[152:155], a[136:139], v[216:219], v[152:155]
    v_mfma_f32_16x16x32_bf16 v[156:159], a[140:143], v[216:219], v[156:159]
    v_mfma_f32_16x16x32_bf16 v[160:163], a[144:147], v[216:219], v[160:163]
    v_mfma_f32_16x16x32_bf16 v[164:167], a[148:151], v[216:219], v[164:167]
    v_mfma_f32_16x16x32_bf16 v[168:171], a[152:155], v[216:219], v[168:171]
    v_mfma_f32_16x16x32_bf16 v[172:175], a[156:159], v[216:219], v[172:175]
    v_mfma_f32_16x16x32_bf16 a[196:199], a[204:207], v[216:219], a[196:199]
    v_mfma_f32_16x16x32_bf16 v[224:227], a[0:3], v[96:99], 0
    v_mfma_f32_16x16x32_bf16 v[224:227], a[4:7], v[100:103], v[224:227]
    v_mfma_f32_16x16x32_bf16 v[224:227], a[8:11], v[104:107], v[224:227]
    v_mfma_f32_16x16x32_bf16 v[224:227], a[12:15], v[108:111], v[224:227]
    v_mfma_f32_16x16x32_bf16 v[228:231], a[16:19], v[96:99], 0
    v_mfma_f32_16x16x32_bf16 v[228:231], a[20:23], v[100:103], v[228:231]
    v_mfma_f32_16x16x32_bf16 v[228:231], a[24:27], v[104:107], v[228:231]
    v_mfma_f32_16x16x32_bf16 v[228:231], a[28:31], v[108:111], v[228:231]
    s_nop 7
    v_max3_f32 v59, v224, v225, v226
    v_max3_f32 v59, v59, v227, v228
    v_max3_f32 v59, v59, v229, v230
    v_max_f32 v59, v59, v231
    v_mov_b32 v60, v59
    s_nop 1
    v_permlane32_swap_b32 v59, v60
    s_nop 1
    v_max_f32 v59, v59, v60
    v_mov_b32 v60, v59
    s_nop 1
    v_permlane16_swap_b32 v59, v60
    s_nop 1
    v_min3_f32 v59, -v59, -v60, v254
    v_sub_f32 v60, v59, v254
    v_exp_f32 v60, v60
    v_mov_b32 v254, v59
    v_add_f32 v224, v224, v59
    v_add_f32 v225, v225, v59
    v_add_f32 v226, v226, v59
    v_add_f32 v227, v227, v59
    v_add_f32 v228, v228, v59
    v_add_f32 v229, v229, v59
    v_add_f32 v230, v230, v59
    v_add_f32 v231, v231, v59
    v_exp_f32 v224, v224
    v_exp_f32 v225, v225
    v_exp_f32 v226, v226
    v_exp_f32 v227, v227
    v_exp_f32 v228, v228
    v_exp_f32 v229, v229
    v_exp_f32 v230, v230
    v_exp_f32 v231, v231
    v_mul_f32 v176, v176, v60
    v_mul_f32 v177, v177, v60
    v_mul_f32 v178, v178, v60
    v_mul_f32 v179, v179, v60
    v_mul_f32 v180, v180, v60
    v_mul_f32 v181, v181, v60
    v_mul_f32 v182, v182, v60
    v_mul_f32 v183, v183, v60
    v_mul_f32 v184, v184, v60
    v_mul_f32 v185, v185, v60
    v_mul_f32 v186, v186, v60
    v_mul_f32 v187, v187, v60
    v_mul_f32 v188, v188, v60
    v_mul_f32 v189, v189, v60
    v_mul_f32 v190, v190, v60
    v_mul_f32 v191, v191, v60
    v_mul_f32 v192, v192, v60
    v_mul_f32 v193, v193, v60
    v_mul_f32 v194, v194, v60
    v_mul_f32 v195, v195, v60
    v_mul_f32 v196, v196, v60
    v_mul_f32 v197, v197, v60
    v_mul_f32 v198, v198, v60
    v_mul_f32 v199, v199, v60
    v_mul_f32 v200, v200, v60
    v_mul_f32 v201, v201, v60
    v_mul_f32 v202, v202, v60
    v_mul_f32 v203, v203, v60
    v_mul_f32 v204, v204, v60
    v_mul_f32 v205, v205, v60
    v_mul_f32 v206, v206, v60
    v_mul_f32 v207, v207, v60
    v_accvgpr_read_b32 v59, a200
    v_mul_f32 v59, v59, v60
    v_accvgpr_write_b32 a200, v59
    v_accvgpr_read_b32 v59, a201
    v_mul_f32 v59, v59, v60
    v_accvgpr_write_b32 a201, v59
    v_accvgpr_read_b32 v59, a202
    v_mul_f32 v59, v59, v60
    v_accvgpr_write_b32 a202, v59
    v_accvgpr_read_b32 v59, a203
    v_mul_f32 v59, v59, v60
    v_accvgpr_write_b32 a203, v59
    v_cvt_pk_bf16_f32 v224, v224, v225
    v_cvt_pk_bf16_f32 v225, v226, v227
    v_cvt_pk_bf16_f32 v226, v228, v229
    v_cvt_pk_bf16_f32 v227, v230, v231
    s_nop 1
    v_mfma_f32_16x16x32_bf16 v[176:179], a[128:131], v[224:227], v[176:179]
    v_mfma_f32_16x16x32_bf16 v[180:183], a[132:135], v[224:227], v[180:183]
    v_mfma_f32_16x16x32_bf16 v[184:187], a[136:139], v[224:227], v[184:187]
    v_mfma_f32_16x16x32_bf16 v[188:191], a[140:143], v[224:227], v[188:191]
    v_mfma_f32_16x16x32_bf16 v[192:195], a[144:147], v[224:227], v[192:195]
    v_mfma_f32_16x16x32_bf16 v[196:199], a[148:151], v[224:227], v[196:199]
    v_mfma_f32_16x16x32_bf16 v[200:203], a[152:155], v[224:227], v[200:203]
    v_mfma_f32_16x16x32_bf16 v[204:207], a[156:159], v[224:227], v[204:207]
    v_mfma_f32_16x16x32_bf16 a[200:203], a[204:207], v[224:227], a[200:203]
    v_mfma_f32_16x16x32_bf16 v[232:235], a[32:35], v[64:67], 0
    v_mfma_f32_16x16x32_bf16 v[232:235], a[36:39], v[68:71], v[232:235]
    v_mfma_f32_16x16x32_bf16 v[232:235], a[40:43], v[72:75], v[232:235]
    v_mfma_f32_16x16x32_bf16 v[232:235], a[44:47], v[76:79], v[232:235]
    v_mfma_f32_16x16x32_bf16 v[236:239], a[48:51], v[64:67], 0
    v_mfma_f32_16x16x32_bf16 v[236:239], a[52:55], v[68:71], v[236:239]
    v_mfma_f32_16x16x32_bf16 v[236:239], a[56:59], v[72:75], v[236:239]
    v_mfma_f32_16x16x32_bf16 v[236:239], a[60:63], v[76:79], v[236:239]
    s_nop 7
    v_max3_f32 v59, v232, v233, v234
    v_max3_f32 v59, v59, v235, v236
    v_max3_f32 v59, v59, v237, v238
    v_max_f32 v59, v59, v239
    v_mov_b32 v60, v59
    s_nop 1
    v_permlane32_swap_b32 v59, v60
    s_nop 1
    v_max_f32 v59, v59, v60
    v_mov_b32 v60, v59
    s_nop 1
    v_permlane16_swap_b32 v59, v60
    s_nop 1
    v_min3_f32 v59, -v59, -v60, v252
    v_sub_f32 v60, v59, v252
    v_exp_f32 v60, v60
    v_mov_b32 v252, v59
    v_add_f32 v232, v232, v59
    v_add_f32 v233, v233, v59
    v_add_f32 v234, v234, v59
    v_add_f32 v235, v235, v59
    v_add_f32 v236, v236, v59
    v_add_f32 v237, v237, v59
    v_add_f32 v238, v238, v59
    v_add_f32 v239, v239, v59
    v_exp_f32 v232, v232
    v_exp_f32 v233, v233
    v_exp_f32 v234, v234
    v_exp_f32 v235, v235
    v_exp_f32 v236, v236
    v_exp_f32 v237, v237
    v_exp_f32 v238, v238
    v_exp_f32 v239, v239
    v_mul_f32 v112, v112, v60
    v_mul_f32 v113, v113, v60
    v_mul_f32 v114, v114, v60
    v_mul_f32 v115, v115, v60
    v_mul_f32 v116, v116, v60
    v_mul_f32 v117, v117, v60
    v_mul_f32 v118, v118, v60
    v_mul_f32 v119, v119, v60
    v_mul_f32 v120, v120, v60
    v_mul_f32 v121, v121, v60
    v_mul_f32 v122, v122, v60
    v_mul_f32 v123, v123, v60
    v_mul_f32 v124, v124, v60
    v_mul_f32 v125, v125, v60
    v_mul_f32 v126, v126, v60
    v_mul_f32 v127, v127, v60
    v_mul_f32 v128, v128, v60
    v_mul_f32 v129, v129, v60
    v_mul_f32 v130, v130, v60
    v_mul_f32 v131, v131, v60
    v_mul_f32 v132, v132, v60
    v_mul_f32 v133, v133, v60
    v_mul_f32 v134, v134, v60
    v_mul_f32 v135, v135, v60
    v_mul_f32 v136, v136, v60
    v_mul_f32 v137, v137, v60
    v_mul_f32 v138, v138, v60
    v_mul_f32 v139, v139, v60
    v_mul_f32 v140, v140, v60
    v_mul_f32 v141, v141, v60
    v_mul_f32 v142, v142, v60
    v_mul_f32 v143, v143, v60
    v_accvgpr_read_b32 v59, a192
    v_mul_f32 v59, v59, v60
    v_accvgpr_write_b32 a192, v59
    v_accvgpr_read_b32 v59, a193
    v_mul_f32 v59, v59, v60
    v_accvgpr_write_b32 a193, v59
    v_accvgpr_read_b32 v59, a194
    v_mul_f32 v59, v59, v60
    v_accvgpr_write_b32 a194, v59
    v_accvgpr_read_b32 v59, a195
    v_mul_f32 v59, v59, v60
    v_accvgpr_write_b32 a195, v59
    v_cvt_pk_bf16_f32 v232, v232, v233
    v_cvt_pk_bf16_f32 v233, v234, v235
    v_cvt_pk_bf16_f32 v234, v236, v237
    v_cvt_pk_bf16_f32 v235, v238, v239
    s_nop 1
    v_mfma_f32_16x16x32_bf16 v[112:115], a[160:163], v[232:235], v[112:115]
    v_mfma_f32_16x16x32_bf16 v[116:119], a[164:167], v[232:235], v[116:119]
    v_mfma_f32_16x16x32_bf16 v[120:123], a[168:171], v[232:235], v[120:123]
    v_mfma_f32_16x16x32_bf16 v[124:127], a[172:175], v[232:235], v[124:127]
    v_mfma_f32_16x16x32_bf16 v[128:131], a[176:179], v[232:235], v[128:131]
    v_mfma_f32_16x16x32_bf16 v[132:135], a[180:183], v[232:235], v[132:135]
    v_mfma_f32_16x16x32_bf16 v[136:139], a[184:187], v[232:235], v[136:139]
    v_mfma_f32_16x16x32_bf16 v[140:143], a[188:191], v[232:235], v[140:143]
    v_mfma_f32_16x16x32_bf16 a[192:195], a[204:207], v[232:235], a[192:195]
    v_mfma_f32_16x16x32_bf16 v[240:243], a[32:35], v[80:83], 0
    v_mfma_f32_16x16x32_bf16 v[240:243], a[36:39], v[84:87], v[240:243]
    v_mfma_f32_16x16x32_bf16 v[240:243], a[40:43], v[88:91], v[240:243]
    v_mfma_f32_16x16x32_bf16 v[240:243], a[44:47], v[92:95], v[240:243]
    v_mfma_f32_16x16x32_bf16 v[244:247], a[48:51], v[80:83], 0
    v_mfma_f32_16x16x32_bf16 v[244:247], a[52:55], v[84:87], v[244:247]
    v_mfma_f32_16x16x32_bf16 v[244:247], a[56:59], v[88:91], v[244:247]
    v_mfma_f32_16x16x32_bf16 v[244:247], a[60:63], v[92:95], v[244:247]
    s_nop 7
    v_max3_f32 v59, v240, v241, v242
    v_max3_f32 v59, v59, v243, v244
    v_max3_f32 v59, v59, v245, v246
    v_max_f32 v59, v59, v247
    v_mov_b32 v60, v59
    s_nop 1
    v_permlane32_swap_b32 v59, v60
    s_nop 1
    v_max_f32 v59, v59, v60
    v_mov_b32 v60, v59
    s_nop 1
    v_permlane16_swap_b32 v59, v60
    s_nop 1
    v_min3_f32 v59, -v59, -v60, v253
    v_sub_f32 v60, v59, v253
    v_exp_f32 v60, v60
    v_mov_b32 v253, v59
    v_add_f32 v240, v240, v59
    v_add_f32 v241, v241, v59
    v_add_f32 v242, v242, v59
    v_add_f32 v243, v243, v59
    v_add_f32 v244, v244, v59
    v_add_f32 v245, v245, v59
    v_add_f32 v246, v246, v59
    v_add_f32 v247, v247, v59
    v_exp_f32 v240, v240
    v_exp_f32 v241, v241
    v_exp_f32 v242, v242
    v_exp_f32 v243, v243
    v_exp_f32 v244, v244
    v_exp_f32 v245, v245
    v_exp_f32 v246, v246
    v_exp_f32 v247, v247
    v_mul_f32 v144, v144, v60
    v_mul_f32 v145, v145, v60
    v_mul_f32 v146, v146, v60
    v_mul_f32 v147, v147, v60
    v_mul_f32 v148, v148, v60
    v_mul_f32 v149, v149, v60
    v_mul_f32 v150, v150, v60
    v_mul_f32 v151, v151, v60
    v_mul_f32 v152, v152, v60
    v_mul_f32 v153, v153, v60
    v_mul_f32 v154, v154, v60
    v_mul_f32 v155, v155, v60
    v_mul_f32 v156, v156, v60
    v_mul_f32 v157, v157, v60
    v_mul_f32 v158, v158, v60
    v_mul_f32 v159, v159, v60
    v_mul_f32 v160, v160, v60
    v_mul_f32 v161, v161, v60
    v_mul_f32 v162, v162, v60
    v_mul_f32 v163, v163, v60
    v_mul_f32 v164, v164, v60
    v_mul_f32 v165, v165, v60
    v_mul_f32 v166, v166, v60
    v_mul_f32 v167, v167, v60
    v_mul_f32 v168, v168, v60
    v_mul_f32 v169, v169, v60
    v_mul_f32 v170, v170, v60
    v_mul_f32 v171, v171, v60
    v_mul_f32 v172, v172, v60
    v_mul_f32 v173, v173, v60
    v_mul_f32 v174, v174, v60
    v_mul_f32 v175, v175, v60
    v_accvgpr_read_b32 v59, a196
    v_mul_f32 v59, v59, v60
    v_accvgpr_write_b32 a196, v59
    v_accvgpr_read_b32 v59, a197
    v_mul_f32 v59, v59, v60
    v_accvgpr_write_b32 a197, v59
    v_accvgpr_read_b32 v59, a198
    v_mul_f32 v59, v59, v60
    v_accvgpr_write_b32 a198, v59
    v_accvgpr_read_b32 v59, a199
    v_mul_f32 v59, v59, v60
    v_accvgpr_write_b32 a199, v59
    v_cvt_pk_bf16_f32 v240, v240, v241
    v_cvt_pk_bf16_f32 v241, v242, v243
    v_cvt_pk_bf16_f32 v242, v244, v245
    v_cvt_pk_bf16_f32 v243, v246, v247
    s_nop 1
    v_mfma_f32_16x16x32_bf16 v[144:147], a[160:163], v[240:243], v[144:147]
    v_mfma_f32_16x16x32_bf16 v[148:151], a[164:167], v[240:243], v[148:151]
    v_mfma_f32_16x16x32_bf16 v[152:155], a[168:171], v[240:243], v[152:155]
    v_mfma_f32_16x16x32_bf16 v[156:159], a[172:175], v[240:243], v[156:159]
    v_mfma_f32_16x16x32_bf16 v[160:163], a[176:179], v[240:243], v[160:163]
    v_mfma_f32_16x16x32_bf16 v[164:167], a[180:183], v[240:243], v[164:167]
    v_mfma_f32_16x16x32_bf16 v[168:171], a[184:187], v[240:243], v[168:171]
    v_mfma_f32_16x16x32_bf16 v[172:175], a[188:191], v[240:243], v[172:175]
    v_mfma_f32_16x16x32_bf16 a[196:199], a[204:207], v[240:243], a[196:199]
    s_nop 7
    s_add_u32 s65, s65, 16384
    s_cmp_lt_u32 s65, 131072
    s_cbranch_scc1 standalone__gqa_block_cached__near_ridge_sl
    s_barrier
    v_xor_b32 v31, 8192, v17
    v_xor_b32 v32, 8192, v18
    v_xor_b32 v33, 8192, v19
    v_xor_b32 v34, 8192, v20
    v_xor_b32 v35, 8192, v21
    v_xor_b32 v36, 8192, v22
    v_xor_b32 v37, 8192, v23
    v_xor_b32 v38, 8192, v24
    s_setpc_b64 s[62:63]
standalone__gqa_block_cached__near_ridge_end:
    s_endpgm
.section .rodata,"a"
.p2align 6
.amdhsa_kernel standalone__gqa_block_cached__near_ridge_kernel
  .amdhsa_next_free_vgpr 512
  .amdhsa_next_free_sgpr 102
  .amdhsa_accum_offset 256
  .amdhsa_group_segment_fixed_size 0
  .amdhsa_kernarg_size 64
  .amdhsa_user_sgpr_count 2
  .amdhsa_user_sgpr_kernarg_segment_ptr 1
  .amdhsa_system_sgpr_workgroup_id_x 1
.end_amdhsa_kernel
```
